```python
import torch

def _softmax(x, axis=-1):
    return torch.softmax(x, dim=axis)

def _gelu(x):
    return torch.nn.functional.gelu(x, approximate='tanh')

def _silu(x):
    return torch.nn.functional.silu(x)

def _sigmoid(x):
    return torch.sigmoid(x)

def _layernorm(x, axis=-1, eps=1e-05):
    m = x.mean(dim=axis, keepdim=True)
    v = x.var(dim=axis, keepdim=True, unbiased=False)
    return (x - m) / torch.sqrt(v + eps)

def _scatter_add(tgt, idx, src, axis=0):
    return tgt.clone().index_add_(axis, idx, src)

def _segment_sum(src, seg, n):
    out = torch.zeros((n,) + src.shape[1:], dtype=src.dtype)
    return out.index_add_(0, seg, src)

def _pad(x, pw):
    flat = tuple((v for pair in reversed(pw) for v in pair))
    return torch.nn.functional.pad(x, flat)
kernel_name = 'adaLN_cond__memory_aug_recurrent_mem_tr__mixer_gmlp__prompt'

def setup_inputs():

    _w = lambda a: (lambda t: t.to(torch.bfloat16) if t.is_floating_point() else t)(torch.as_tensor(a))

    def _A_setup():
        B, S, Dm = (1, 2048, 576)
        H, Dh = (32, 128)
        M, seg = (8, 32)
        seg = min(seg, S)
        S = S // seg * seg
        return {'x': _w((lambda *s: torch.randn(*s, dtype=torch.bfloat16) * 0.05)(B, S, Dm)), 'mem0': _w((lambda *s: torch.randn(*s, dtype=torch.bfloat16) * 0.4)(B, M, Dm)), 'Wq': _w((lambda *s: torch.randn(*s, dtype=torch.bfloat16) * 3.2)(Dm, H, Dh) * Dm ** (-0.5)), 'Wk': _w((lambda *s: torch.randn(*s, dtype=torch.bfloat16) * 3.2)(Dm, H, Dh) * Dm ** (-0.5)), 'Wv': _w((lambda *s: torch.randn(*s, dtype=torch.bfloat16) * 0.4)(Dm, H, Dh) * Dm ** (-0.5)), 'Wo': _w((lambda *s: torch.randn(*s, dtype=torch.bfloat16) * 0.4)(H, Dh, Dm) * (H * Dh) ** (-0.5)), 'seg_len': seg}
    _A_in = _A_setup()

    def _B_setup():
        B, S, D, F = (1, 2048, 576, 4608)
        Fh = F // 2
        return {'x': _w((lambda *s: torch.randn(*s, dtype=torch.bfloat16) * 0.05)(B, S, D)), 'w_in': _w((lambda *s: torch.randn(*s, dtype=torch.bfloat16) * 0.8)(D, 2 * Fh)), 'w_sp': _w(0.01 * (lambda *s: torch.randn(*s, dtype=torch.bfloat16) * 0.8)(S, S)), 'b_sp': _w(1.0 + 0.01 * (lambda *s: torch.randn(*s, dtype=torch.bfloat16) * 0.05)(S)), 'w_out': _w((lambda *s: torch.randn(*s, dtype=torch.bfloat16) * 0.05)(Fh, D))}
    _B_in = _B_setup()
    return {'A_x': _A_in['x'], 'A_mem0': _A_in['mem0'], 'A_Wq': _A_in['Wq'], 'A_Wk': _A_in['Wk'], 'A_Wv': _A_in['Wv'], 'A_Wo': _A_in['Wo'], 'A_seg_len': _A_in['seg_len'], 'B_x': _B_in['x'], 'B_w_in': _B_in['w_in'], 'B_w_sp': _B_in['w_sp'], 'B_b_sp': _B_in['b_sp'], 'B_w_out': _B_in['w_out'], 'c': _w((lambda *s: torch.randn(*s, dtype=torch.bfloat16) * 0.1)(1, 576) * 8.0), 'w_mod': _w((lambda *s: torch.randn(*s, dtype=torch.bfloat16) * 0.1)(576, 6 * 576) * 576 ** (-0.5) * 8.0)}

def reference(A_x, A_mem0, A_Wq, A_Wk, A_Wv, A_Wo, A_seg_len, B_x, B_w_in, B_w_sp, B_b_sp, B_w_out, c, w_mod):

    def _A_ref(x, mem0, Wq, Wk, Wv, Wo, seg_len):
        B, S, Dm = x.shape
        H, Dh = (Wq.shape[1], Wq.shape[2])
        M = mem0.shape[1]
        scale = Dh ** (-0.5)
        n_seg = S // seg_len
        L = M + seg_len
        idx = torch.arange(L)
        mask = (idx[:, None] < M) | (idx[:, None] >= idx[None, :])
        mem = mem0
        outs = []
        for s in range(n_seg):
            xs = x[:, s * seg_len:(s + 1) * seg_len, :].clone()
            h = torch.concatenate([mem, xs], axis=1)
            q = torch.einsum('btd,dhe->bhte', h, Wq)
            k = torch.einsum('btd,dhe->bhte', h, Wk)
            v = torch.einsum('btd,dhe->bhte', h, Wv)
            scores = torch.einsum('bhqe,bhke->bhqk', q, k) * scale
            scores = torch.where(mask[None, None], scores, -1000000000.0)
            p = _softmax(scores, axis=-1)
            o = torch.einsum('bhqk,bhke->bhqe', p, v)
            o = torch.einsum('bhte,hed->btd', o, Wo)
            mem = o[:, :M, :].clone()
            outs.append(o[:, M:, :])
        return torch.concatenate(outs, axis=1)

    def _B_ref(x, w_in, w_sp, b_sp, w_out):
        B, S, D = x.shape
        F = w_in.shape[-1]
        Fh = F // 2
        z = _gelu(torch.einsum('bsd,df->bsf', x, w_in))
        z1 = z[..., :Fh].clone()
        z2 = _layernorm(z[..., Fh:], axis=-1)
        g = torch.einsum('ts,bsf->btf', w_sp, z2) + b_sp[None, :, None]
        return torch.einsum('bsf,fd->bsd', z1 * g, w_out)
    x = A_x
    mod = (_silu(c) @ w_mod).reshape(c.shape[0], 6, 1, -1)
    sa, ca, ga, sb, cb, gb = (mod[:, 0].clone(), mod[:, 1].clone(), mod[:, 2].clone(), mod[:, 3].clone(), mod[:, 4].clone(), mod[:, 5].clone())
    h = _layernorm(x, axis=-1) * (1 + ca) + sa
    x = x + ga * _A_ref(h, A_mem0, A_Wq, A_Wk, A_Wv, A_Wo, A_seg_len)
    h = _layernorm(x, axis=-1) * (1 + cb) + sb
    x = x + gb * _B_ref(h, B_w_in, B_w_sp, B_b_sp, B_w_out)
    return x
```

```asm
; @launch kernel=mega_kernel grid=(256,1,1) block=(256,1,1) lds=163840
.amdgcn_target "amdgcn-amd-amdhsa--gfx950"
.text
.globl mega_kernel
.p2align 8
.type mega_kernel,@function
mega_kernel:
  s_cmp_ge_u32 s2, 256
  s_cbranch_scc1 Lmg_done_1
  v_lshrrev_b32 v1, 6, v0
  s_nop 0
  v_readfirstlane_b32 s3, v1
  s_nop 3
  s_cmp_eq_u32 s3, 0
  s_cbranch_scc1 Lmg_pf_4
  s_lshr_b32 s63, s2, 3
  s_sub_u32 s63, s63, 16
  s_cmp_ge_u32 s63, 6
  s_cbranch_scc1 Lmg_pf_4
  s_mul_i32 s63, s63, 3
  s_add_u32 s63, s63, s3
  s_sub_u32 s63, s63, 1
  s_getpc_b64 s[60:61]
Lpc_5:
  s_sub_u32 s60, s60, Lpc_5-mega_kernel
  s_subb_u32 s61, s61, 0
  v_mbcnt_lo_u32_b32 v254, -1, 0
  v_mbcnt_hi_u32_b32 v254, -1, v254
  v_lshlrev_b32 v254, 7, v254
  s_lshl_b32 s62, s63, 13
  v_add_u32 v254, s62, v254
  v_min_u32 v254, Lmg_done_1-mega_kernel-4, v254
  global_load_dword v255, v254, s[60:61]
Lmg_pf_4:
  s_load_dwordx2 s[98:99], s[0:1], 128
  s_load_dwordx2 s[96:97], s[0:1], 120
  s_waitcnt lgkmcnt(0)
  s_mov_b32 s88, s98
  s_mov_b32 s89, s99
  s_mov_b32 s90, 0x10000
  s_mov_b32 s91, 0x20000
  s_mov_b32 s84, s96
  s_mov_b32 s85, s97
  s_mov_b32 s86, 0x100
  s_mov_b32 s87, 0x20000
  s_cmp_ge_u32 s2, 16
  s_cbranch_scc1 Lmg_nz_6
  v_mov_b64 v[4:5], 0
  v_mov_b64 v[6:7], 0
  v_lshlrev_b32 v2, 4, v0
  s_lshl_b32 s24, s2, 12
  buffer_store_dwordx4 v[4:7], v2, s[88:91], s24 offen sc1
  s_waitcnt vmcnt(0)
  s_barrier
  s_cmp_lg_u32 s3, 0
  s_cbranch_scc1 Lmg_zs_7
  v_mov_b32 v2, 1
  s_mov_b64 exec, 1
  buffer_atomic_add v2, off, s[84:87], 0
  s_mov_b64 exec, -1
Lmg_zs_7:
Lmg_nz_6:
  s_cmp_ge_u32 s2, 108
  s_cbranch_scc1 Lmg_nm_8
  s_load_dwordx2 s[4:5], s[0:1], 96
  s_load_dwordx2 s[6:7], s[0:1], 104
  s_load_dwordx2 s[8:9], s[0:1], 128
  s_waitcnt lgkmcnt(0)
  s_mov_b32 s12, s4
  s_mov_b32 s13, s5
  s_mov_b32 s14, 0x480
  s_mov_b32 s15, 0x20000
  s_mov_b32 s16, s6
  s_mov_b32 s17, s7
  s_mov_b32 s18, 0x3cc000
  s_mov_b32 s19, 0x20000
  s_add_u32 s20, s8, 0x10000
  s_addc_u32 s21, s9, 0
  s_mov_b32 s22, 0x1b00
  s_mov_b32 s23, 0x20000
  v_and_b32 v1, 3, v0
  v_lshrrev_b32 v2, 2, v0
  v_mul_u32_u24 v3, 18, v2
  s_mov_b32 s24, 62208
  v_mul_lo_u32 v4, v2, s24
  s_lshl_b32 s25, s2, 6
  v_lshlrev_b32 v5, 4, v1
  v_add3_u32 v4, v4, v5, s25
  buffer_load_ushort v10, v3, s[12:15], 0 offen offset:0
  buffer_load_ushort v11, v3, s[12:15], 0 offen offset:2
  buffer_load_ushort v12, v3, s[12:15], 0 offen offset:4
  buffer_load_ushort v13, v3, s[12:15], 0 offen offset:6
  buffer_load_ushort v14, v3, s[12:15], 0 offen offset:8
  buffer_load_ushort v15, v3, s[12:15], 0 offen offset:10
  buffer_load_ushort v16, v3, s[12:15], 0 offen offset:12
  buffer_load_ushort v17, v3, s[12:15], 0 offen offset:14
  buffer_load_ushort v18, v3, s[12:15], 0 offen offset:16
  s_mov_b32 s26, 0
  buffer_load_dwordx4 v[20:23], v4, s[16:19], s26 offen
  s_mov_b32 s26, 6912
  buffer_load_dwordx4 v[24:27], v4, s[16:19], s26 offen
  s_mov_b32 s26, 13824
  buffer_load_dwordx4 v[28:31], v4, s[16:19], s26 offen
  s_mov_b32 s26, 20736
  buffer_load_dwordx4 v[32:35], v4, s[16:19], s26 offen
  s_mov_b32 s26, 27648
  buffer_load_dwordx4 v[36:39], v4, s[16:19], s26 offen
  s_mov_b32 s26, 34560
  buffer_load_dwordx4 v[40:43], v4, s[16:19], s26 offen
  s_mov_b32 s26, 41472
  buffer_load_dwordx4 v[44:47], v4, s[16:19], s26 offen
  s_mov_b32 s26, 48384
  buffer_load_dwordx4 v[48:51], v4, s[16:19], s26 offen
  s_mov_b32 s26, 55296
  buffer_load_dwordx4 v[52:55], v4, s[16:19], s26 offen
  v_mov_b32 v60, 0
  v_mov_b32 v61, 0
  v_mov_b32 v62, 0
  v_mov_b32 v63, 0
  v_mov_b32 v64, 0
  v_mov_b32 v65, 0
  v_mov_b32 v66, 0
  v_mov_b32 v67, 0
  s_mov_b32 s27, 0xbfb8aa3b
  s_waitcnt vmcnt(9)
  v_lshlrev_b32 v10, 16, v10
  v_mul_f32 v8, s27, v10
  v_exp_f32 v8, v8
  s_nop 0
  v_add_f32 v8, 1.0, v8
  v_rcp_f32 v8, v8
  s_nop 0
  v_mul_f32 v10, v10, v8
  v_cvt_pk_bf16_f32 v8, v10, v10
  v_lshlrev_b32 v10, 16, v8
  v_lshlrev_b32 v11, 16, v11
  v_mul_f32 v8, s27, v11
  v_exp_f32 v8, v8
  s_nop 0
  v_add_f32 v8, 1.0, v8
  v_rcp_f32 v8, v8
  s_nop 0
  v_mul_f32 v11, v11, v8
  v_cvt_pk_bf16_f32 v8, v11, v11
  v_lshlrev_b32 v11, 16, v8
  v_lshlrev_b32 v12, 16, v12
  v_mul_f32 v8, s27, v12
  v_exp_f32 v8, v8
  s_nop 0
  v_add_f32 v8, 1.0, v8
  v_rcp_f32 v8, v8
  s_nop 0
  v_mul_f32 v12, v12, v8
  v_cvt_pk_bf16_f32 v8, v12, v12
  v_lshlrev_b32 v12, 16, v8
  v_lshlrev_b32 v13, 16, v13
  v_mul_f32 v8, s27, v13
  v_exp_f32 v8, v8
  s_nop 0
  v_add_f32 v8, 1.0, v8
  v_rcp_f32 v8, v8
  s_nop 0
  v_mul_f32 v13, v13, v8
  v_cvt_pk_bf16_f32 v8, v13, v13
  v_lshlrev_b32 v13, 16, v8
  v_lshlrev_b32 v14, 16, v14
  v_mul_f32 v8, s27, v14
  v_exp_f32 v8, v8
  s_nop 0
  v_add_f32 v8, 1.0, v8
  v_rcp_f32 v8, v8
  s_nop 0
  v_mul_f32 v14, v14, v8
  v_cvt_pk_bf16_f32 v8, v14, v14
  v_lshlrev_b32 v14, 16, v8
  v_lshlrev_b32 v15, 16, v15
  v_mul_f32 v8, s27, v15
  v_exp_f32 v8, v8
  s_nop 0
  v_add_f32 v8, 1.0, v8
  v_rcp_f32 v8, v8
  s_nop 0
  v_mul_f32 v15, v15, v8
  v_cvt_pk_bf16_f32 v8, v15, v15
  v_lshlrev_b32 v15, 16, v8
  v_lshlrev_b32 v16, 16, v16
  v_mul_f32 v8, s27, v16
  v_exp_f32 v8, v8
  s_nop 0
  v_add_f32 v8, 1.0, v8
  v_rcp_f32 v8, v8
  s_nop 0
  v_mul_f32 v16, v16, v8
  v_cvt_pk_bf16_f32 v8, v16, v16
  v_lshlrev_b32 v16, 16, v8
  v_lshlrev_b32 v17, 16, v17
  v_mul_f32 v8, s27, v17
  v_exp_f32 v8, v8
  s_nop 0
  v_add_f32 v8, 1.0, v8
  v_rcp_f32 v8, v8
  s_nop 0
  v_mul_f32 v17, v17, v8
  v_cvt_pk_bf16_f32 v8, v17, v17
  v_lshlrev_b32 v17, 16, v8
  v_lshlrev_b32 v18, 16, v18
  v_mul_f32 v8, s27, v18
  v_exp_f32 v8, v8
  s_nop 0
  v_add_f32 v8, 1.0, v8
  v_rcp_f32 v8, v8
  s_nop 0
  v_mul_f32 v18, v18, v8
  v_cvt_pk_bf16_f32 v8, v18, v18
  v_lshlrev_b32 v18, 16, v8
  s_waitcnt vmcnt(8)
  v_lshlrev_b32 v8, 16, v20
  v_and_b32 v9, 0xffff0000, v20
  v_fmac_f32 v60, v10, v8
  v_fmac_f32 v61, v10, v9
  v_lshlrev_b32 v8, 16, v21
  v_and_b32 v9, 0xffff0000, v21
  v_fmac_f32 v62, v10, v8
  v_fmac_f32 v63, v10, v9
  v_lshlrev_b32 v8, 16, v22
  v_and_b32 v9, 0xffff0000, v22
  v_fmac_f32 v64, v10, v8
  v_fmac_f32 v65, v10, v9
  v_lshlrev_b32 v8, 16, v23
  v_and_b32 v9, 0xffff0000, v23
  v_fmac_f32 v66, v10, v8
  v_fmac_f32 v67, v10, v9
  s_waitcnt vmcnt(7)
  v_lshlrev_b32 v8, 16, v24
  v_and_b32 v9, 0xffff0000, v24
  v_fmac_f32 v60, v11, v8
  v_fmac_f32 v61, v11, v9
  v_lshlrev_b32 v8, 16, v25
  v_and_b32 v9, 0xffff0000, v25
  v_fmac_f32 v62, v11, v8
  v_fmac_f32 v63, v11, v9
  v_lshlrev_b32 v8, 16, v26
  v_and_b32 v9, 0xffff0000, v26
  v_fmac_f32 v64, v11, v8
  v_fmac_f32 v65, v11, v9
  v_lshlrev_b32 v8, 16, v27
  v_and_b32 v9, 0xffff0000, v27
  v_fmac_f32 v66, v11, v8
  v_fmac_f32 v67, v11, v9
  s_waitcnt vmcnt(6)
  v_lshlrev_b32 v8, 16, v28
  v_and_b32 v9, 0xffff0000, v28
  v_fmac_f32 v60, v12, v8
  v_fmac_f32 v61, v12, v9
  v_lshlrev_b32 v8, 16, v29
  v_and_b32 v9, 0xffff0000, v29
  v_fmac_f32 v62, v12, v8
  v_fmac_f32 v63, v12, v9
  v_lshlrev_b32 v8, 16, v30
  v_and_b32 v9, 0xffff0000, v30
  v_fmac_f32 v64, v12, v8
  v_fmac_f32 v65, v12, v9
  v_lshlrev_b32 v8, 16, v31
  v_and_b32 v9, 0xffff0000, v31
  v_fmac_f32 v66, v12, v8
  v_fmac_f32 v67, v12, v9
  s_waitcnt vmcnt(5)
  v_lshlrev_b32 v8, 16, v32
  v_and_b32 v9, 0xffff0000, v32
  v_fmac_f32 v60, v13, v8
  v_fmac_f32 v61, v13, v9
  v_lshlrev_b32 v8, 16, v33
  v_and_b32 v9, 0xffff0000, v33
  v_fmac_f32 v62, v13, v8
  v_fmac_f32 v63, v13, v9
  v_lshlrev_b32 v8, 16, v34
  v_and_b32 v9, 0xffff0000, v34
  v_fmac_f32 v64, v13, v8
  v_fmac_f32 v65, v13, v9
  v_lshlrev_b32 v8, 16, v35
  v_and_b32 v9, 0xffff0000, v35
  v_fmac_f32 v66, v13, v8
  v_fmac_f32 v67, v13, v9
  s_waitcnt vmcnt(4)
  v_lshlrev_b32 v8, 16, v36
  v_and_b32 v9, 0xffff0000, v36
  v_fmac_f32 v60, v14, v8
  v_fmac_f32 v61, v14, v9
  v_lshlrev_b32 v8, 16, v37
  v_and_b32 v9, 0xffff0000, v37
  v_fmac_f32 v62, v14, v8
  v_fmac_f32 v63, v14, v9
  v_lshlrev_b32 v8, 16, v38
  v_and_b32 v9, 0xffff0000, v38
  v_fmac_f32 v64, v14, v8
  v_fmac_f32 v65, v14, v9
  v_lshlrev_b32 v8, 16, v39
  v_and_b32 v9, 0xffff0000, v39
  v_fmac_f32 v66, v14, v8
  v_fmac_f32 v67, v14, v9
  s_waitcnt vmcnt(3)
  v_lshlrev_b32 v8, 16, v40
  v_and_b32 v9, 0xffff0000, v40
  v_fmac_f32 v60, v15, v8
  v_fmac_f32 v61, v15, v9
  v_lshlrev_b32 v8, 16, v41
  v_and_b32 v9, 0xffff0000, v41
  v_fmac_f32 v62, v15, v8
  v_fmac_f32 v63, v15, v9
  v_lshlrev_b32 v8, 16, v42
  v_and_b32 v9, 0xffff0000, v42
  v_fmac_f32 v64, v15, v8
  v_fmac_f32 v65, v15, v9
  v_lshlrev_b32 v8, 16, v43
  v_and_b32 v9, 0xffff0000, v43
  v_fmac_f32 v66, v15, v8
  v_fmac_f32 v67, v15, v9
  s_waitcnt vmcnt(2)
  v_lshlrev_b32 v8, 16, v44
  v_and_b32 v9, 0xffff0000, v44
  v_fmac_f32 v60, v16, v8
  v_fmac_f32 v61, v16, v9
  v_lshlrev_b32 v8, 16, v45
  v_and_b32 v9, 0xffff0000, v45
  v_fmac_f32 v62, v16, v8
  v_fmac_f32 v63, v16, v9
  v_lshlrev_b32 v8, 16, v46
  v_and_b32 v9, 0xffff0000, v46
  v_fmac_f32 v64, v16, v8
  v_fmac_f32 v65, v16, v9
  v_lshlrev_b32 v8, 16, v47
  v_and_b32 v9, 0xffff0000, v47
  v_fmac_f32 v66, v16, v8
  v_fmac_f32 v67, v16, v9
  s_waitcnt vmcnt(1)
  v_lshlrev_b32 v8, 16, v48
  v_and_b32 v9, 0xffff0000, v48
  v_fmac_f32 v60, v17, v8
  v_fmac_f32 v61, v17, v9
  v_lshlrev_b32 v8, 16, v49
  v_and_b32 v9, 0xffff0000, v49
  v_fmac_f32 v62, v17, v8
  v_fmac_f32 v63, v17, v9
  v_lshlrev_b32 v8, 16, v50
  v_and_b32 v9, 0xffff0000, v50
  v_fmac_f32 v64, v17, v8
  v_fmac_f32 v65, v17, v9
  v_lshlrev_b32 v8, 16, v51
  v_and_b32 v9, 0xffff0000, v51
  v_fmac_f32 v66, v17, v8
  v_fmac_f32 v67, v17, v9
  s_waitcnt vmcnt(0)
  v_lshlrev_b32 v8, 16, v52
  v_and_b32 v9, 0xffff0000, v52
  v_fmac_f32 v60, v18, v8
  v_fmac_f32 v61, v18, v9
  v_lshlrev_b32 v8, 16, v53
  v_and_b32 v9, 0xffff0000, v53
  v_fmac_f32 v62, v18, v8
  v_fmac_f32 v63, v18, v9
  v_lshlrev_b32 v8, 16, v54
  v_and_b32 v9, 0xffff0000, v54
  v_fmac_f32 v64, v18, v8
  v_fmac_f32 v65, v18, v9
  v_lshlrev_b32 v8, 16, v55
  v_and_b32 v9, 0xffff0000, v55
  v_fmac_f32 v66, v18, v8
  v_fmac_f32 v67, v18, v9
  s_nop 1
  v_add_f32_dpp v60, v60, v60 row_ror:4 row_mask:0xf bank_mask:0xf
  v_add_f32_dpp v61, v61, v61 row_ror:4 row_mask:0xf bank_mask:0xf
  v_add_f32_dpp v62, v62, v62 row_ror:4 row_mask:0xf bank_mask:0xf
  v_add_f32_dpp v63, v63, v63 row_ror:4 row_mask:0xf bank_mask:0xf
  v_add_f32_dpp v64, v64, v64 row_ror:4 row_mask:0xf bank_mask:0xf
  v_add_f32_dpp v65, v65, v65 row_ror:4 row_mask:0xf bank_mask:0xf
  v_add_f32_dpp v66, v66, v66 row_ror:4 row_mask:0xf bank_mask:0xf
  v_add_f32_dpp v67, v67, v67 row_ror:4 row_mask:0xf bank_mask:0xf
  s_nop 1
  v_add_f32_dpp v60, v60, v60 row_ror:8 row_mask:0xf bank_mask:0xf
  v_add_f32_dpp v61, v61, v61 row_ror:8 row_mask:0xf bank_mask:0xf
  v_add_f32_dpp v62, v62, v62 row_ror:8 row_mask:0xf bank_mask:0xf
  v_add_f32_dpp v63, v63, v63 row_ror:8 row_mask:0xf bank_mask:0xf
  v_add_f32_dpp v64, v64, v64 row_ror:8 row_mask:0xf bank_mask:0xf
  v_add_f32_dpp v65, v65, v65 row_ror:8 row_mask:0xf bank_mask:0xf
  v_add_f32_dpp v66, v66, v66 row_ror:8 row_mask:0xf bank_mask:0xf
  v_add_f32_dpp v67, v67, v67 row_ror:8 row_mask:0xf bank_mask:0xf
  v_lshrrev_b32 v6, 4, v0
  v_lshlrev_b32 v6, 7, v6
  v_lshl_add_u32 v6, v1, 5, v6
  v_and_b32 v7, 12, v0
  v_cmp_eq_u32 vcc, 0, v7
  s_and_saveexec_b64 s[28:29], vcc
  ds_write_b128 v6, v[60:63]
  ds_write_b128 v6, v[64:67] offset:16
  s_mov_b64 exec, s[28:29]
  s_waitcnt lgkmcnt(0)
  s_barrier
  v_cmp_gt_u32 vcc, 32, v0
  s_and_saveexec_b64 s[28:29], vcc
  s_cbranch_execz Lmod_dn2_9
  v_lshlrev_b32 v6, 2, v0
  ds_read_b32 v20, v6 offset:0
  ds_read_b32 v21, v6 offset:128
  ds_read_b32 v22, v6 offset:256
  ds_read_b32 v23, v6 offset:384
  ds_read_b32 v24, v6 offset:512
  ds_read_b32 v25, v6 offset:640
  ds_read_b32 v26, v6 offset:768
  ds_read_b32 v27, v6 offset:896
  ds_read_b32 v28, v6 offset:1024
  ds_read_b32 v29, v6 offset:1152
  ds_read_b32 v30, v6 offset:1280
  ds_read_b32 v31, v6 offset:1408
  ds_read_b32 v32, v6 offset:1536
  ds_read_b32 v33, v6 offset:1664
  ds_read_b32 v34, v6 offset:1792
  ds_read_b32 v35, v6 offset:1920
  s_waitcnt lgkmcnt(0)
  v_add_f32 v20, v20, v21
  v_add_f32 v20, v20, v22
  v_add_f32 v20, v20, v23
  v_add_f32 v20, v20, v24
  v_add_f32 v20, v20, v25
  v_add_f32 v20, v20, v26
  v_add_f32 v20, v20, v27
  v_add_f32 v20, v20, v28
  v_add_f32 v20, v20, v29
  v_add_f32 v20, v20, v30
  v_add_f32 v20, v20, v31
  v_add_f32 v20, v20, v32
  v_add_f32 v20, v20, v33
  v_add_f32 v20, v20, v34
  v_add_f32 v20, v20, v35
  v_cvt_pk_bf16_f32 v8, v20, v20
  v_lshlrev_b32 v20, 16, v8
  s_cmp_ge_u32 s2, 90
  s_cbranch_scc1 Lmod_skip_10
  s_cmp_ge_u32 s2, 72
  s_cbranch_scc1 Lmod_one_11
  s_cmp_ge_u32 s2, 36
  s_cbranch_scc1 Lmod_skip_10
  s_cmp_lt_u32 s2, 18
  s_cbranch_scc1 Lmod_skip_10
Lmod_one_11:
  v_add_f32 v20, 1.0, v20
Lmod_skip_10:
  v_cvt_pk_bf16_f32 v20, v20, v20
  v_lshlrev_b32 v6, 1, v0
  v_add_u32 v6, s25, v6
  buffer_store_short v20, v6, s[20:23], 0 offen sc1
Lmod_dn2_9:
  s_mov_b64 exec, s[28:29]
Lmg_nm_8:
  s_cmp_lg_u32 s3, 0
  s_cbranch_scc1 Lmg_zw_12
  s_mov_b32 s52, 0
Lmg_zl_13:
  buffer_load_dword v2, off, s[84:87], 0 sc1
  s_waitcnt vmcnt(0)
  v_readfirstlane_b32 s51, v2
  s_add_u32 s52, s52, 1
  s_cmp_gt_u32 s52, 2000000
  s_cbranch_scc1 Lmg_zw_12
  s_cmp_lt_u32 s51, 16
  s_cbranch_scc1 Lmg_zl_13
Lmg_zw_12:
  s_barrier
  s_cmp_ge_u32 s2, 108
  s_cbranch_scc1 Lmg_nm2_14
  s_mov_b32 s30, 0
  s_waitcnt vmcnt(0)
  s_barrier
  s_cmp_lg_u32 s3, 0
  s_cbranch_scc1 Ls_skip_15
  s_lshl_b32 s50, s30, 7
  s_add_u32 s50, s50, 36352
  v_mov_b32 v2, 1
  s_mov_b64 exec, 1
  buffer_atomic_add v2, off, s[88:91], s50
  s_mov_b64 exec, -1
Ls_skip_15:
Lmg_nm2_14:
  s_load_dwordx2 s[12:13], s[0:1], 16
  s_load_dwordx2 s[14:15], s[0:1], 24
  s_load_dwordx2 s[16:17], s[0:1], 32
  s_load_dwordx2 s[18:19], s[0:1], 40
  s_load_dwordx2 s[76:77], s[0:1], 8
  s_load_dwordx2 s[78:79], s[0:1], 128
  s_waitcnt lgkmcnt(0)
  s_mov_b32 s52, s78
  s_mov_b32 s53, s79
  s_mov_b32 s54, 0x10000
  s_mov_b32 s55, 0x20000
  s_cmp_lg_u32 s3, 0
  s_cbranch_scc1 Lch_16_seld
  s_getreg_b32 s20, hwreg(HW_REG_XCC_ID)
  s_and_b32 s20, s20, 7
  s_mov_b64 s[86:87], exec
  s_mov_b64 exec, 1
  s_lshl_b32 s21, s20, 8
  v_mov_b32 v16, s21
  v_mov_b32 v17, 1
  buffer_atomic_add v17, v16, s[52:55], 0 offen sc0
  s_waitcnt vmcnt(0)
  v_readfirstlane_b32 s21, v17
  s_add_u32 s23, s20, 1
  s_mov_b32 s22, -1
  s_cmp_ge_u32 s21, 32
  s_cbranch_scc1 Lch_16_pub
  v_mov_b32 v16, 2048
  s_cmp_lg_u32 s21, 31
  s_cbranch_scc1 Lch_16_spin0
  v_mov_b32 v18, s23
  v_mov_b32 v19, 0
  buffer_atomic_cmpswap v[18:19], v16, s[52:55], 0 offen
Lch_16_spin0:
  s_mov_b32 s85, 0
Lch_16_spin:
  buffer_load_dword v18, v16, s[52:55], 0 offen sc1
  s_waitcnt vmcnt(0)
  v_readfirstlane_b32 s84, v18
  s_add_u32 s85, s85, 1
  s_cmp_lg_u32 s84, 0
  s_cbranch_scc1 Lch_16_got
  s_cmp_lt_u32 s85, 2000
  s_cbranch_scc1 Lch_16_spin
  v_mov_b32 v18, 255
  v_mov_b32 v19, 0
  buffer_atomic_cmpswap v[18:19], v16, s[52:55], 0 offen
  s_waitcnt vmcnt(0)
  s_branch Lch_16_spin0
Lch_16_got:
  s_cmp_eq_u32 s84, 255
  s_cbranch_scc1 Lch_16_gen
  s_cmp_eq_u32 s84, s23
  s_cbranch_scc0 Lch_16_pub
  s_or_b32 s22, s21, 0x100
  s_branch Lch_16_pub
Lch_16_gen:
  v_mov_b32 v16, 2304
  v_mov_b32 v17, 1
  buffer_atomic_add v17, v16, s[52:55], 0 offen sc0
  s_waitcnt vmcnt(0)
  v_readfirstlane_b32 s22, v17
  s_cmp_lt_u32 s22, 32
  s_cselect_b32 s22, s22, -1
Lch_16_pub:
  v_mov_b32 v16, 147456
  v_mov_b32 v17, s22
  ds_write_b32 v16, v17
  s_waitcnt lgkmcnt(0)
  s_mov_b64 exec, s[86:87]
Lch_16_seld:
  s_barrier
  v_mov_b32 v16, 147456
  ds_read_b32 v17, v16
  s_waitcnt lgkmcnt(0)
  v_readfirstlane_b32 s22, v17
  s_barrier
  s_cmp_eq_u32 s22, -1
  s_cbranch_scc1 Lmg_worker_2
  s_lshr_b32 s84, s22, 8
  s_and_b32 s4, s22, 31
  s_mov_b32 s24, s12
  s_mov_b32 s25, s13
  s_mov_b32 s26, 0x480000
  s_mov_b32 s27, 0x20000
  s_mov_b32 s28, s14
  s_mov_b32 s29, s15
  s_mov_b32 s30, 0x480000
  s_mov_b32 s31, 0x20000
  s_mov_b32 s32, s16
  s_mov_b32 s33, s17
  s_mov_b32 s34, 0x480000
  s_mov_b32 s35, 0x20000
  s_mov_b32 s36, s18
  s_mov_b32 s37, s19
  s_mov_b32 s38, 0x480000
  s_mov_b32 s39, 0x20000
  s_mov_b32 s40, s76
  s_mov_b32 s41, s77
  s_mov_b32 s42, 0x2400
  s_mov_b32 s43, 0x20000
  s_add_u32 s44, s78, 0x8dd2000
  s_addc_u32 s45, s79, 0
  s_mov_b32 s46, 0x120000
  s_mov_b32 s47, 0x20000
  s_add_u32 s48, s78, 0x8ef2000
  s_addc_u32 s49, s79, 0
  s_mov_b32 s50, 0x9000
  s_mov_b32 s51, 0x20000
  s_add_u32 s56, s78, 0x1252000
  s_addc_u32 s57, s79, 0
  s_mov_b32 s58, 0x1000000
  s_mov_b32 s59, 0x20000
  s_add_u32 s60, s78, 0x2252000
  s_addc_u32 s61, s79, 0
  s_mov_b32 s62, 0x1000000
  s_mov_b32 s63, 0x20000
  s_add_u32 s64, s78, 0x3252000
  s_addc_u32 s65, s79, 0
  s_mov_b32 s66, 0x400000
  s_mov_b32 s67, 0x20000
  s_add_u32 s68, s78, 0x3652000
  s_addc_u32 s69, s79, 0
  s_mov_b32 s70, 0x400000
  s_mov_b32 s71, 0x20000
  s_add_u32 s72, s78, 0x8efb000
  s_addc_u32 s73, s79, 0
  s_mov_b32 s74, 0x92400
  s_mov_b32 s75, 0x20000
  s_add_u32 s88, s78, 0x8f8e000
  s_addc_u32 s89, s79, 0
  s_mov_b32 s90, 0x100000
  s_mov_b32 s91, 0x20000
  v_and_b32 v76, 63, v0
  v_lshrrev_b32 v77, 4, v76
  v_and_b32 v78, 15, v76
  v_bfe_u32 v16, v76, 2, 2
  v_and_b32 v17, 3, v76
  v_and_b32 v18, 7, v76
  v_lshrrev_b32 v19, 2, v18
  v_lshlrev_b32 v19, 1, v19
  v_xor_b32 v19, v19, v77
  v_lshlrev_b32 v18, 6, v18
  v_lshl_add_u32 v18, v19, 4, v18
  v_add_u32 v1, 147456, v18
  v_lshl_add_u32 v18, v77, 3, v16
  v_lshlrev_b32 v18, 4, v18
  v_and_b32 v19, 1, v17
  v_lshl_add_u32 v18, v19, 3, v18
  v_add_u32 v2, 156672, v18
  v_lshrrev_b32 v18, 1, v77
  v_lshl_add_u32 v18, v18, 4, v78
  s_lshl_b32 s20, s3, 5
  v_add_u32 v18, s20, v18
  v_and_b32 v19, 1, v77
  v_lshlrev_b32 v3, 4, v18
  v_lshl_add_u32 v3, v19, 3, v3
  v_add_u32 v3, 156672, v3
  v_and_b32 v18, 8, v76
  v_cmp_eq_u32 vcc, 0, v18
  v_mov_b32 v18, 0xeeeeeeee
  v_mov_b32 v4, 0x44444444
  v_cndmask_b32 v4, v18, v4, vcc
  v_cmp_gt_u32 vcc, 2, v77
  v_mov_b32 v18, 0
  v_mov_b32 v19, -1
  v_cndmask_b32 v15, v18, v19, vcc
  s_mul_i32 s21, s3, 5
  s_cmp_eq_u32 s3, 3
  s_cselect_b32 s21, 14, s21
  s_lshl_b32 s20, s21, 11
  v_lshlrev_b32 v18, 4, v76
  v_add_u32 v5, s20, v18
  s_lshl_b32 s20, s21, 9
  s_mul_i32 s22, s4, 9216
  s_add_u32 s85, s20, s22
  v_lshlrev_b32 v9, 3, v76
  v_and_b32 v18, 1, v76
  v_lshlrev_b32 v18, 4, v18
  v_mov_b32 v19, 0x3f80
  v_lshlrev_b32 v19, v18, v19
  v_and_b32 v18, 2, v76
  v_cmp_eq_u32 vcc, 0, v18
  v_mov_b32 v20, 0
  s_nop 0
  v_cndmask_b32 v22, v20, v19, vcc
  v_cndmask_b32 v23, v19, v20, vcc
  v_add_u32 v24, 162432, v9
  ds_write_b64 v24, v[22:23]
  s_and_b32 s20, s3, 1
  s_lshl_b32 s20, s20, 12
  v_lshlrev_b32 v19, 4, v76
  v_add_u32 v19, s20, v19
  v_and_b32 v18, 7, v76
  v_lshlrev_b32 v18, 4, v18
  v_lshl_add_u32 v18, v77, 7, v18
  s_cmp_eq_u32 s3, 3
  s_cselect_b64 vcc, -1, 0
  v_cndmask_b32 v6, v19, v18, vcc
  s_lshl_b32 s20, s3, 11
  v_lshlrev_b32 v18, 4, v76
  v_add_u32 v7, s20, v18
  s_lshl_b32 s20, s3, 9
  v_lshlrev_b32 v18, 2, v76
  v_add_u32 v8, s20, v18
  s_lshl_b32 s20, s3, 5
  s_add_u32 s5, s20, s4
  s_cmp_lt_u32 s5, 72
  s_cselect_b32 s6, 1, 0
  s_min_u32 s5, s5, 71
  s_mov_b32 s20, 9216
  v_mul_lo_u32 v18, v77, s20
  v_lshl_add_u32 v18, v78, 3, v18
  s_lshl_b32 s20, s5, 7
  v_add_u32 v10, s20, v18
  s_and_b32 s20, s5, 1
  s_lshl_b32 s21, s20, 2
  v_and_b32 v18, 3, v76
  v_add_u32 v18, s21, v18
  v_lshlrev_b32 v18, 6, v18
  s_and_b32 s21, s5, 2
  s_lshl_b32 s20, s20, 1
  s_xor_b32 s21, s21, s20
  v_lshrrev_b32 v19, 1, v77
  v_or_b32 v19, s21, v19
  v_lshl_add_u32 v18, v19, 4, v18
  v_and_b32 v19, 1, v77
  v_lshl_add_u32 v18, v19, 3, v18
  s_lshr_b32 s20, s5, 2
  s_lshl_b32 s20, s20, 9
  v_add_u32 v12, s20, v18
  v_lshlrev_b32 v11, 4, v0
  v_and_b32 v18, 7, v76
  v_mul_u32_u24 v18, 48, v18
  v_add_u32 v18, 160768, v18
  s_and_b32 s20, s3, 1
  s_mul_i32 s20, s20, 800
  v_lshrrev_b32 v19, 1, v77
  v_mul_u32_u24 v19, 400, v19
  v_add_u32 v19, v19, v18
  v_and_b32 v20, 1, v77
  v_lshl_add_u32 v19, v20, 4, v19
  v_add_u32 v19, s20, v19
  v_mul_u32_u24 v20, 800, v20
  v_add3_u32 v20, v20, v18, 32
  s_cmp_eq_u32 s3, 2
  s_cselect_b64 vcc, -1, 0
  v_cndmask_b32 v13, v19, v20, vcc
  v_mul_u32_u24 v19, 400, v77
  v_add_u32 v14, v19, v18
  s_cmp_eq_u32 s84, 0
  s_cbranch_scc1 Lch_16_geninit
  s_cmp_lg_u32 s4, 0
  s_cbranch_scc1 Lch_16fi_m0skip
  v_add_u32 v16, 0, v0
  v_bfe_u32 v17, v16, 2, 3
  v_lshrrev_b32 v18, 2, v17
  v_lshlrev_b32 v18, 1, v18
  v_xor_b32 v18, v18, v16
  v_and_b32 v18, 3, v18
  v_lshrrev_b32 v19, 5, v16
  v_lshlrev_b32 v19, 6, v19
  v_lshl_add_u32 v19, v18, 4, v19
  v_mul_u32_u24 v17, 1152, v17
  v_add_u32 v19, v19, v17
  buffer_load_dwordx4 v[20:23], v19, s[40:43], 0 offen
  s_waitcnt vmcnt(0)
  v_lshlrev_b32 v17, 4, v16
  buffer_store_dwordx4 v[20:23], v17, s[48:51], 0 offen
  v_add_u32 v16, 256, v0
  v_bfe_u32 v17, v16, 2, 3
  v_lshrrev_b32 v18, 2, v17
  v_lshlrev_b32 v18, 1, v18
  v_xor_b32 v18, v18, v16
  v_and_b32 v18, 3, v18
  v_lshrrev_b32 v19, 5, v16
  v_lshlrev_b32 v19, 6, v19
  v_lshl_add_u32 v19, v18, 4, v19
  v_mul_u32_u24 v17, 1152, v17
  v_add_u32 v19, v19, v17
  buffer_load_dwordx4 v[20:23], v19, s[40:43], 0 offen
  s_waitcnt vmcnt(0)
  v_lshlrev_b32 v17, 4, v16
  buffer_store_dwordx4 v[20:23], v17, s[48:51], 0 offen
  v_cmp_gt_u32 vcc, 64, v0
  s_and_saveexec_b64 s[20:21], vcc
  s_cbranch_execz Lch_16fi_m0skip_x
  v_add_u32 v16, 512, v0
  v_bfe_u32 v17, v16, 2, 3
  v_lshrrev_b32 v18, 2, v17
  v_lshlrev_b32 v18, 1, v18
  v_xor_b32 v18, v18, v16
  v_and_b32 v18, 3, v18
  v_lshrrev_b32 v19, 5, v16
  v_lshlrev_b32 v19, 6, v19
  v_lshl_add_u32 v19, v18, 4, v19
  v_mul_u32_u24 v17, 1152, v17
  v_add_u32 v19, v19, v17
  buffer_load_dwordx4 v[20:23], v19, s[40:43], 0 offen
  s_waitcnt vmcnt(0)
  v_lshlrev_b32 v17, 4, v16
  buffer_store_dwordx4 v[20:23], v17, s[48:51], 0 offen
Lch_16fi_m0skip_x:
  s_mov_b64 exec, s[20:21]
Lch_16fi_m0skip:
  v_mov_b64 v[20:21], 0
  v_mov_b64 v[24:25], -1
  s_cmp_eq_u32 s6, 0
  s_cbranch_scc1 Lch_16fi_initskip
  s_mov_b32 s22, 0
  buffer_store_dwordx2 v[20:21], v10, s[44:47], s22 offen
  s_add_u32 s22, s22, 36864
  buffer_store_dwordx2 v[20:21], v10, s[44:47], s22 offen
  s_add_u32 s22, s22, 36864
  buffer_store_dwordx2 v[20:21], v10, s[44:47], s22 offen
  s_add_u32 s22, s22, 36864
  buffer_store_dwordx2 v[20:21], v10, s[44:47], s22 offen
  s_add_u32 s22, s22, 36864
  buffer_store_dwordx2 v[20:21], v10, s[44:47], s22 offen
  s_add_u32 s22, s22, 36864
  buffer_store_dwordx2 v[20:21], v10, s[44:47], s22 offen
  s_add_u32 s22, s22, 36864
  buffer_store_dwordx2 v[20:21], v10, s[44:47], s22 offen
  s_add_u32 s22, s22, 36864
  buffer_store_dwordx2 v[20:21], v10, s[44:47], s22 offen
  s_add_u32 s22, s22, 36864
  s_mov_b32 s22, 9216
  buffer_store_dwordx2 v[24:25], v12, s[48:51], s22 offen
  s_mov_b32 s22, 18432
  buffer_store_dwordx2 v[24:25], v12, s[48:51], s22 offen
  s_mov_b32 s22, 27648
  buffer_store_dwordx2 v[24:25], v12, s[48:51], s22 offen
Lch_16fi_initskip:
  s_waitcnt vmcnt(0) lgkmcnt(0)
  s_barrier
  s_branch Lch_16_initdone
Lch_16_geninit:
  s_cmp_lg_u32 s4, 0
  s_cbranch_scc1 Lch_16gi_m0skip
  v_add_u32 v16, 0, v0
  v_bfe_u32 v17, v16, 2, 3
  v_lshrrev_b32 v18, 2, v17
  v_lshlrev_b32 v18, 1, v18
  v_xor_b32 v18, v18, v16
  v_and_b32 v18, 3, v18
  v_lshrrev_b32 v19, 5, v16
  v_lshlrev_b32 v19, 6, v19
  v_lshl_add_u32 v19, v18, 4, v19
  v_mul_u32_u24 v17, 1152, v17
  v_add_u32 v19, v19, v17
  buffer_load_dwordx4 v[20:23], v19, s[40:43], 0 offen
  s_waitcnt vmcnt(0)
  v_lshlrev_b32 v17, 4, v16
  buffer_store_dwordx4 v[20:23], v17, s[48:51], 0 offen sc1
  v_add_u32 v16, 256, v0
  v_bfe_u32 v17, v16, 2, 3
  v_lshrrev_b32 v18, 2, v17
  v_lshlrev_b32 v18, 1, v18
  v_xor_b32 v18, v18, v16
  v_and_b32 v18, 3, v18
  v_lshrrev_b32 v19, 5, v16
  v_lshlrev_b32 v19, 6, v19
  v_lshl_add_u32 v19, v18, 4, v19
  v_mul_u32_u24 v17, 1152, v17
  v_add_u32 v19, v19, v17
  buffer_load_dwordx4 v[20:23], v19, s[40:43], 0 offen
  s_waitcnt vmcnt(0)
  v_lshlrev_b32 v17, 4, v16
  buffer_store_dwordx4 v[20:23], v17, s[48:51], 0 offen sc1
  v_cmp_gt_u32 vcc, 64, v0
  s_and_saveexec_b64 s[20:21], vcc
  s_cbranch_execz Lch_16gi_m0skip_x
  v_add_u32 v16, 512, v0
  v_bfe_u32 v17, v16, 2, 3
  v_lshrrev_b32 v18, 2, v17
  v_lshlrev_b32 v18, 1, v18
  v_xor_b32 v18, v18, v16
  v_and_b32 v18, 3, v18
  v_lshrrev_b32 v19, 5, v16
  v_lshlrev_b32 v19, 6, v19
  v_lshl_add_u32 v19, v18, 4, v19
  v_mul_u32_u24 v17, 1152, v17
  v_add_u32 v19, v19, v17
  buffer_load_dwordx4 v[20:23], v19, s[40:43], 0 offen
  s_waitcnt vmcnt(0)
  v_lshlrev_b32 v17, 4, v16
  buffer_store_dwordx4 v[20:23], v17, s[48:51], 0 offen sc1
Lch_16gi_m0skip_x:
  s_mov_b64 exec, s[20:21]
Lch_16gi_m0skip:
  v_mov_b64 v[20:21], 0
  v_mov_b64 v[24:25], -1
  s_cmp_eq_u32 s6, 0
  s_cbranch_scc1 Lch_16gi_initskip
  s_mov_b32 s22, 0
  buffer_store_dwordx2 v[20:21], v10, s[44:47], s22 offen sc1
  s_add_u32 s22, s22, 36864
  buffer_store_dwordx2 v[20:21], v10, s[44:47], s22 offen sc1
  s_add_u32 s22, s22, 36864
  buffer_store_dwordx2 v[20:21], v10, s[44:47], s22 offen sc1
  s_add_u32 s22, s22, 36864
  buffer_store_dwordx2 v[20:21], v10, s[44:47], s22 offen sc1
  s_add_u32 s22, s22, 36864
  buffer_store_dwordx2 v[20:21], v10, s[44:47], s22 offen sc1
  s_add_u32 s22, s22, 36864
  buffer_store_dwordx2 v[20:21], v10, s[44:47], s22 offen sc1
  s_add_u32 s22, s22, 36864
  buffer_store_dwordx2 v[20:21], v10, s[44:47], s22 offen sc1
  s_add_u32 s22, s22, 36864
  buffer_store_dwordx2 v[20:21], v10, s[44:47], s22 offen sc1
  s_add_u32 s22, s22, 36864
  s_mov_b32 s22, 9216
  buffer_store_dwordx2 v[24:25], v12, s[48:51], s22 offen sc1
  s_mov_b32 s22, 18432
  buffer_store_dwordx2 v[24:25], v12, s[48:51], s22 offen sc1
  s_mov_b32 s22, 27648
  buffer_store_dwordx2 v[24:25], v12, s[48:51], s22 offen sc1
Lch_16gi_initskip:
  s_waitcnt vmcnt(0) lgkmcnt(0)
  s_barrier
Lch_16_initdone:
  s_cmp_lg_u32 s3, 0
  s_cbranch_scc1 Lch_16_tad
  v_mov_b32 v17, 1
  s_mov_b32 s22, 2560
  s_mov_b64 exec, 1
  buffer_atomic_add v17, off, s[52:55], s22
  s_mov_b64 exec, -1
Lch_16_tad:
  v_and_b32 v76, 63, v0
  v_lshrrev_b32 v16, 4, v76
  v_bfe_u32 v17, v76, 1, 3
  v_and_b32 v19, 1, v76
  v_lshlrev_b32 v19, 4, v19
  v_lshlrev_b32 v20, 13, v16
  v_add_u32 v20, v20, v19
  v_bfe_u32 v23, v76, 2, 2
  v_and_b32 v24, 1, v23
  v_lshl_add_u32 v24, v16, 2, v24
  v_lshlrev_b32 v24, 8, v24
  v_and_b32 v25, 3, v76
  v_lshl_add_u32 v24, v25, 3, v24
  v_lshrrev_b32 v25, 1, v23
  s_lshl_b32 s20, s3, 1
  v_add_u32 v25, s20, v25
  v_xor_b32 v26, v25, v16
  v_xor_b32 v27, 4, v26
  v_lshl_add_u32 v26, v26, 5, v24
  v_lshl_add_u32 v27, v27, 5, v24
  v_add_u32 v27, 4096, v27
  s_mul_i32 s20, s3, 36
  s_lshl_b32 s21, s20, 10
  s_lshl_b32 s22, s20, 15
  s_lshl_b32 s23, s4, 8
  s_add_u32 s22, s22, s23
  s_lshl_b32 s23, s3, 2
  s_add_u32 s23, s23, 0
  s_and_b32 s23, s23, 7
  v_xor_b32 v21, s23, v17
  v_lshl_add_u32 v21, v21, 5, v20
  s_mov_b32 m0, s21
  s_add_u32 s21, s21, 1024
  buffer_load_dwordx4 v21, s[24:27], s22 offen lds
  s_add_u32 s22, s22, 0x8000
  s_lshl_b32 s23, s3, 2
  s_add_u32 s23, s23, 1
  s_and_b32 s23, s23, 7
  v_xor_b32 v21, s23, v17
  v_lshl_add_u32 v21, v21, 5, v20
  s_mov_b32 m0, s21
  s_add_u32 s21, s21, 1024
  buffer_load_dwordx4 v21, s[24:27], s22 offen lds
  s_add_u32 s22, s22, 0x8000
  s_lshl_b32 s23, s3, 2
  s_add_u32 s23, s23, 2
  s_and_b32 s23, s23, 7
  v_xor_b32 v21, s23, v17
  v_lshl_add_u32 v21, v21, 5, v20
  s_mov_b32 m0, s21
  s_add_u32 s21, s21, 1024
  buffer_load_dwordx4 v21, s[24:27], s22 offen lds
  s_add_u32 s22, s22, 0x8000
  s_lshl_b32 s23, s3, 2
  s_add_u32 s23, s23, 3
  s_and_b32 s23, s23, 7
  v_xor_b32 v21, s23, v17
  v_lshl_add_u32 v21, v21, 5, v20
  s_mov_b32 m0, s21
  s_add_u32 s21, s21, 1024
  buffer_load_dwordx4 v21, s[24:27], s22 offen lds
  s_add_u32 s22, s22, 0x8000
  s_lshl_b32 s23, s3, 2
  s_add_u32 s23, s23, 4
  s_and_b32 s23, s23, 7
  v_xor_b32 v21, s23, v17
  v_lshl_add_u32 v21, v21, 5, v20
  s_mov_b32 m0, s21
  s_add_u32 s21, s21, 1024
  buffer_load_dwordx4 v21, s[24:27], s22 offen lds
  s_add_u32 s22, s22, 0x8000
  s_lshl_b32 s23, s3, 2
  s_add_u32 s23, s23, 5
  s_and_b32 s23, s23, 7
  v_xor_b32 v21, s23, v17
  v_lshl_add_u32 v21, v21, 5, v20
  s_mov_b32 m0, s21
  s_add_u32 s21, s21, 1024
  buffer_load_dwordx4 v21, s[24:27], s22 offen lds
  s_add_u32 s22, s22, 0x8000
  s_lshl_b32 s23, s3, 2
  s_add_u32 s23, s23, 6
  s_and_b32 s23, s23, 7
  v_xor_b32 v21, s23, v17
  v_lshl_add_u32 v21, v21, 5, v20
  s_mov_b32 m0, s21
  s_add_u32 s21, s21, 1024
  buffer_load_dwordx4 v21, s[24:27], s22 offen lds
  s_add_u32 s22, s22, 0x8000
  s_lshl_b32 s23, s3, 2
  s_add_u32 s23, s23, 7
  s_and_b32 s23, s23, 7
  v_xor_b32 v21, s23, v17
  v_lshl_add_u32 v21, v21, 5, v20
  s_mov_b32 m0, s21
  s_add_u32 s21, s21, 1024
  buffer_load_dwordx4 v21, s[24:27], s22 offen lds
  s_add_u32 s22, s22, 0x8000
  s_lshl_b32 s23, s3, 2
  s_add_u32 s23, s23, 8
  s_and_b32 s23, s23, 7
  v_xor_b32 v21, s23, v17
  v_lshl_add_u32 v21, v21, 5, v20
  s_mov_b32 m0, s21
  s_add_u32 s21, s21, 1024
  buffer_load_dwordx4 v21, s[24:27], s22 offen lds
  s_add_u32 s22, s22, 0x8000
  s_lshl_b32 s23, s3, 2
  s_add_u32 s23, s23, 9
  s_and_b32 s23, s23, 7
  v_xor_b32 v21, s23, v17
  v_lshl_add_u32 v21, v21, 5, v20
  s_mov_b32 m0, s21
  s_add_u32 s21, s21, 1024
  buffer_load_dwordx4 v21, s[24:27], s22 offen lds
  s_add_u32 s22, s22, 0x8000
  s_lshl_b32 s23, s3, 2
  s_add_u32 s23, s23, 10
  s_and_b32 s23, s23, 7
  v_xor_b32 v21, s23, v17
  v_lshl_add_u32 v21, v21, 5, v20
  s_mov_b32 m0, s21
  s_add_u32 s21, s21, 1024
  buffer_load_dwordx4 v21, s[24:27], s22 offen lds
  s_add_u32 s22, s22, 0x8000
  s_lshl_b32 s23, s3, 2
  s_add_u32 s23, s23, 11
  s_and_b32 s23, s23, 7
  v_xor_b32 v21, s23, v17
  v_lshl_add_u32 v21, v21, 5, v20
  s_mov_b32 m0, s21
  s_add_u32 s21, s21, 1024
  buffer_load_dwordx4 v21, s[24:27], s22 offen lds
  s_add_u32 s22, s22, 0x8000
  s_lshl_b32 s23, s3, 2
  s_add_u32 s23, s23, 12
  s_and_b32 s23, s23, 7
  v_xor_b32 v21, s23, v17
  v_lshl_add_u32 v21, v21, 5, v20
  s_mov_b32 m0, s21
  s_add_u32 s21, s21, 1024
  buffer_load_dwordx4 v21, s[24:27], s22 offen lds
  s_add_u32 s22, s22, 0x8000
  s_lshl_b32 s23, s3, 2
  s_add_u32 s23, s23, 13
  s_and_b32 s23, s23, 7
  v_xor_b32 v21, s23, v17
  v_lshl_add_u32 v21, v21, 5, v20
  s_mov_b32 m0, s21
  s_add_u32 s21, s21, 1024
  buffer_load_dwordx4 v21, s[24:27], s22 offen lds
  s_add_u32 s22, s22, 0x8000
  s_lshl_b32 s23, s3, 2
  s_add_u32 s23, s23, 14
  s_and_b32 s23, s23, 7
  v_xor_b32 v21, s23, v17
  v_lshl_add_u32 v21, v21, 5, v20
  s_mov_b32 m0, s21
  s_add_u32 s21, s21, 1024
  buffer_load_dwordx4 v21, s[24:27], s22 offen lds
  s_add_u32 s22, s22, 0x8000
  s_lshl_b32 s23, s3, 2
  s_add_u32 s23, s23, 15
  s_and_b32 s23, s23, 7
  v_xor_b32 v21, s23, v17
  v_lshl_add_u32 v21, v21, 5, v20
  s_mov_b32 m0, s21
  s_add_u32 s21, s21, 1024
  buffer_load_dwordx4 v21, s[24:27], s22 offen lds
  s_add_u32 s22, s22, 0x8000
  s_lshl_b32 s23, s3, 2
  s_add_u32 s23, s23, 16
  s_and_b32 s23, s23, 7
  v_xor_b32 v21, s23, v17
  v_lshl_add_u32 v21, v21, 5, v20
  s_mov_b32 m0, s21
  s_add_u32 s21, s21, 1024
  buffer_load_dwordx4 v21, s[24:27], s22 offen lds
  s_add_u32 s22, s22, 0x8000
  s_lshl_b32 s23, s3, 2
  s_add_u32 s23, s23, 17
  s_and_b32 s23, s23, 7
  v_xor_b32 v21, s23, v17
  v_lshl_add_u32 v21, v21, 5, v20
  s_mov_b32 m0, s21
  s_add_u32 s21, s21, 1024
  buffer_load_dwordx4 v21, s[24:27], s22 offen lds
  s_add_u32 s22, s22, 0x8000
  s_lshl_b32 s23, s3, 2
  s_add_u32 s23, s23, 18
  s_and_b32 s23, s23, 7
  v_xor_b32 v21, s23, v17
  v_lshl_add_u32 v21, v21, 5, v20
  s_mov_b32 m0, s21
  s_add_u32 s21, s21, 1024
  buffer_load_dwordx4 v21, s[24:27], s22 offen lds
  s_add_u32 s22, s22, 0x8000
  s_lshl_b32 s23, s3, 2
  s_add_u32 s23, s23, 19
  s_and_b32 s23, s23, 7
  v_xor_b32 v21, s23, v17
  v_lshl_add_u32 v21, v21, 5, v20
  s_mov_b32 m0, s21
  s_add_u32 s21, s21, 1024
  buffer_load_dwordx4 v21, s[24:27], s22 offen lds
  s_add_u32 s22, s22, 0x8000
  s_lshl_b32 s23, s3, 2
  s_add_u32 s23, s23, 20
  s_and_b32 s23, s23, 7
  v_xor_b32 v21, s23, v17
  v_lshl_add_u32 v21, v21, 5, v20
  s_mov_b32 m0, s21
  s_add_u32 s21, s21, 1024
  buffer_load_dwordx4 v21, s[24:27], s22 offen lds
  s_add_u32 s22, s22, 0x8000
  s_lshl_b32 s23, s3, 2
  s_add_u32 s23, s23, 21
  s_and_b32 s23, s23, 7
  v_xor_b32 v21, s23, v17
  v_lshl_add_u32 v21, v21, 5, v20
  s_mov_b32 m0, s21
  s_add_u32 s21, s21, 1024
  buffer_load_dwordx4 v21, s[24:27], s22 offen lds
  s_add_u32 s22, s22, 0x8000
  s_lshl_b32 s23, s3, 2
  s_add_u32 s23, s23, 22
  s_and_b32 s23, s23, 7
  v_xor_b32 v21, s23, v17
  v_lshl_add_u32 v21, v21, 5, v20
  s_mov_b32 m0, s21
  s_add_u32 s21, s21, 1024
  buffer_load_dwordx4 v21, s[24:27], s22 offen lds
  s_add_u32 s22, s22, 0x8000
  s_lshl_b32 s23, s3, 2
  s_add_u32 s23, s23, 23
  s_and_b32 s23, s23, 7
  v_xor_b32 v21, s23, v17
  v_lshl_add_u32 v21, v21, 5, v20
  s_mov_b32 m0, s21
  s_add_u32 s21, s21, 1024
  buffer_load_dwordx4 v21, s[24:27], s22 offen lds
  s_add_u32 s22, s22, 0x8000
  s_lshl_b32 s23, s3, 2
  s_add_u32 s23, s23, 24
  s_and_b32 s23, s23, 7
  v_xor_b32 v21, s23, v17
  v_lshl_add_u32 v21, v21, 5, v20
  s_mov_b32 m0, s21
  s_add_u32 s21, s21, 1024
  buffer_load_dwordx4 v21, s[24:27], s22 offen lds
  s_add_u32 s22, s22, 0x8000
  s_lshl_b32 s23, s3, 2
  s_add_u32 s23, s23, 25
  s_and_b32 s23, s23, 7
  v_xor_b32 v21, s23, v17
  v_lshl_add_u32 v21, v21, 5, v20
  s_mov_b32 m0, s21
  s_add_u32 s21, s21, 1024
  buffer_load_dwordx4 v21, s[24:27], s22 offen lds
  s_add_u32 s22, s22, 0x8000
  s_lshl_b32 s23, s3, 2
  s_add_u32 s23, s23, 26
  s_and_b32 s23, s23, 7
  v_xor_b32 v21, s23, v17
  v_lshl_add_u32 v21, v21, 5, v20
  s_mov_b32 m0, s21
  s_add_u32 s21, s21, 1024
  buffer_load_dwordx4 v21, s[24:27], s22 offen lds
  s_add_u32 s22, s22, 0x8000
  s_lshl_b32 s23, s3, 2
  s_add_u32 s23, s23, 27
  s_and_b32 s23, s23, 7
  v_xor_b32 v21, s23, v17
  v_lshl_add_u32 v21, v21, 5, v20
  s_mov_b32 m0, s21
  s_add_u32 s21, s21, 1024
  buffer_load_dwordx4 v21, s[24:27], s22 offen lds
  s_add_u32 s22, s22, 0x8000
  s_lshl_b32 s23, s3, 2
  s_add_u32 s23, s23, 28
  s_and_b32 s23, s23, 7
  v_xor_b32 v21, s23, v17
  v_lshl_add_u32 v21, v21, 5, v20
  s_mov_b32 m0, s21
  s_add_u32 s21, s21, 1024
  buffer_load_dwordx4 v21, s[24:27], s22 offen lds
  s_add_u32 s22, s22, 0x8000
  s_lshl_b32 s23, s3, 2
  s_add_u32 s23, s23, 29
  s_and_b32 s23, s23, 7
  v_xor_b32 v21, s23, v17
  v_lshl_add_u32 v21, v21, 5, v20
  s_mov_b32 m0, s21
  s_add_u32 s21, s21, 1024
  buffer_load_dwordx4 v21, s[24:27], s22 offen lds
  s_add_u32 s22, s22, 0x8000
  s_lshl_b32 s23, s3, 2
  s_add_u32 s23, s23, 30
  s_and_b32 s23, s23, 7
  v_xor_b32 v21, s23, v17
  v_lshl_add_u32 v21, v21, 5, v20
  s_mov_b32 m0, s21
  s_add_u32 s21, s21, 1024
  buffer_load_dwordx4 v21, s[24:27], s22 offen lds
  s_add_u32 s22, s22, 0x8000
  s_lshl_b32 s23, s3, 2
  s_add_u32 s23, s23, 31
  s_and_b32 s23, s23, 7
  v_xor_b32 v21, s23, v17
  v_lshl_add_u32 v21, v21, 5, v20
  s_mov_b32 m0, s21
  s_add_u32 s21, s21, 1024
  buffer_load_dwordx4 v21, s[24:27], s22 offen lds
  s_add_u32 s22, s22, 0x8000
  s_lshl_b32 s23, s3, 2
  s_add_u32 s23, s23, 32
  s_and_b32 s23, s23, 7
  v_xor_b32 v21, s23, v17
  v_lshl_add_u32 v21, v21, 5, v20
  s_mov_b32 m0, s21
  s_add_u32 s21, s21, 1024
  buffer_load_dwordx4 v21, s[24:27], s22 offen lds
  s_add_u32 s22, s22, 0x8000
  s_lshl_b32 s23, s3, 2
  s_add_u32 s23, s23, 33
  s_and_b32 s23, s23, 7
  v_xor_b32 v21, s23, v17
  v_lshl_add_u32 v21, v21, 5, v20
  s_mov_b32 m0, s21
  s_add_u32 s21, s21, 1024
  buffer_load_dwordx4 v21, s[24:27], s22 offen lds
  s_add_u32 s22, s22, 0x8000
  s_lshl_b32 s23, s3, 2
  s_add_u32 s23, s23, 34
  s_and_b32 s23, s23, 7
  v_xor_b32 v21, s23, v17
  v_lshl_add_u32 v21, v21, 5, v20
  s_mov_b32 m0, s21
  s_add_u32 s21, s21, 1024
  buffer_load_dwordx4 v21, s[24:27], s22 offen lds
  s_add_u32 s22, s22, 0x8000
  s_lshl_b32 s23, s3, 2
  s_add_u32 s23, s23, 35
  s_and_b32 s23, s23, 7
  v_xor_b32 v21, s23, v17
  v_lshl_add_u32 v21, v21, 5, v20
  s_mov_b32 m0, s21
  s_add_u32 s21, s21, 1024
  buffer_load_dwordx4 v21, s[24:27], s22 offen lds
  s_add_u32 s22, s22, 0x8000
  s_waitcnt vmcnt(0)
  s_barrier
  v_mov_b32 v28, v26
  v_mov_b32 v29, v27
  ds_read_b64_tr_b16 a[0:1], v28 offset:0
  ds_read_b64_tr_b16 a[2:3], v28 offset:512
  ds_read_b64_tr_b16 a[4:5], v29 offset:0
  ds_read_b64_tr_b16 a[6:7], v29 offset:512
  v_add_u32 v28, 8192, v28
  v_add_u32 v29, 8192, v29
  ds_read_b64_tr_b16 a[8:9], v28 offset:0
  ds_read_b64_tr_b16 a[10:11], v28 offset:512
  ds_read_b64_tr_b16 a[12:13], v29 offset:0
  ds_read_b64_tr_b16 a[14:15], v29 offset:512
  v_add_u32 v28, 8192, v28
  v_add_u32 v29, 8192, v29
  ds_read_b64_tr_b16 a[16:17], v28 offset:0
  ds_read_b64_tr_b16 a[18:19], v28 offset:512
  ds_read_b64_tr_b16 a[20:21], v29 offset:0
  ds_read_b64_tr_b16 a[22:23], v29 offset:512
  v_add_u32 v28, 8192, v28
  v_add_u32 v29, 8192, v29
  s_waitcnt lgkmcnt(0)
  ds_read_b64_tr_b16 a[24:25], v28 offset:0
  ds_read_b64_tr_b16 a[26:27], v28 offset:512
  ds_read_b64_tr_b16 a[28:29], v29 offset:0
  ds_read_b64_tr_b16 a[30:31], v29 offset:512
  v_add_u32 v28, 8192, v28
  v_add_u32 v29, 8192, v29
  ds_read_b64_tr_b16 a[32:33], v28 offset:0
  ds_read_b64_tr_b16 a[34:35], v28 offset:512
  ds_read_b64_tr_b16 a[36:37], v29 offset:0
  ds_read_b64_tr_b16 a[38:39], v29 offset:512
  v_add_u32 v28, 8192, v28
  v_add_u32 v29, 8192, v29
  ds_read_b64_tr_b16 a[40:41], v28 offset:0
  ds_read_b64_tr_b16 a[42:43], v28 offset:512
  ds_read_b64_tr_b16 a[44:45], v29 offset:0
  ds_read_b64_tr_b16 a[46:47], v29 offset:512
  v_add_u32 v28, 8192, v28
  v_add_u32 v29, 8192, v29
  s_waitcnt lgkmcnt(0)
  ds_read_b64_tr_b16 a[48:49], v28 offset:0
  ds_read_b64_tr_b16 a[50:51], v28 offset:512
  ds_read_b64_tr_b16 a[52:53], v29 offset:0
  ds_read_b64_tr_b16 a[54:55], v29 offset:512
  v_add_u32 v28, 8192, v28
  v_add_u32 v29, 8192, v29
  ds_read_b64_tr_b16 a[56:57], v28 offset:0
  ds_read_b64_tr_b16 a[58:59], v28 offset:512
  ds_read_b64_tr_b16 a[60:61], v29 offset:0
  ds_read_b64_tr_b16 a[62:63], v29 offset:512
  v_add_u32 v28, 8192, v28
  v_add_u32 v29, 8192, v29
  ds_read_b64_tr_b16 a[64:65], v28 offset:0
  ds_read_b64_tr_b16 a[66:67], v28 offset:512
  ds_read_b64_tr_b16 a[68:69], v29 offset:0
  ds_read_b64_tr_b16 a[70:71], v29 offset:512
  v_add_u32 v28, 8192, v28
  v_add_u32 v29, 8192, v29
  s_waitcnt lgkmcnt(0)
  ds_read_b64_tr_b16 a[72:73], v28 offset:0
  ds_read_b64_tr_b16 a[74:75], v28 offset:512
  ds_read_b64_tr_b16 a[76:77], v29 offset:0
  ds_read_b64_tr_b16 a[78:79], v29 offset:512
  v_add_u32 v28, 8192, v28
  v_add_u32 v29, 8192, v29
  ds_read_b64_tr_b16 a[80:81], v28 offset:0
  ds_read_b64_tr_b16 a[82:83], v28 offset:512
  ds_read_b64_tr_b16 a[84:85], v29 offset:0
  ds_read_b64_tr_b16 a[86:87], v29 offset:512
  v_add_u32 v28, 8192, v28
  v_add_u32 v29, 8192, v29
  ds_read_b64_tr_b16 a[88:89], v28 offset:0
  ds_read_b64_tr_b16 a[90:91], v28 offset:512
  ds_read_b64_tr_b16 a[92:93], v29 offset:0
  ds_read_b64_tr_b16 a[94:95], v29 offset:512
  v_add_u32 v28, 8192, v28
  v_add_u32 v29, 8192, v29
  s_waitcnt lgkmcnt(0)
  ds_read_b64_tr_b16 a[96:97], v28 offset:0
  ds_read_b64_tr_b16 a[98:99], v28 offset:512
  ds_read_b64_tr_b16 a[100:101], v29 offset:0
  ds_read_b64_tr_b16 a[102:103], v29 offset:512
  v_add_u32 v28, 8192, v28
  v_add_u32 v29, 8192, v29
  ds_read_b64_tr_b16 a[104:105], v28 offset:0
  ds_read_b64_tr_b16 a[106:107], v28 offset:512
  ds_read_b64_tr_b16 a[108:109], v29 offset:0
  ds_read_b64_tr_b16 a[110:111], v29 offset:512
  v_add_u32 v28, 8192, v28
  v_add_u32 v29, 8192, v29
  ds_read_b64_tr_b16 a[112:113], v28 offset:0
  ds_read_b64_tr_b16 a[114:115], v28 offset:512
  ds_read_b64_tr_b16 a[116:117], v29 offset:0
  ds_read_b64_tr_b16 a[118:119], v29 offset:512
  v_add_u32 v28, 8192, v28
  v_add_u32 v29, 8192, v29
  s_waitcnt lgkmcnt(0)
  ds_read_b64_tr_b16 a[120:121], v28 offset:0
  ds_read_b64_tr_b16 a[122:123], v28 offset:512
  ds_read_b64_tr_b16 a[124:125], v29 offset:0
  ds_read_b64_tr_b16 a[126:127], v29 offset:512
  v_add_u32 v28, 8192, v28
  v_add_u32 v29, 8192, v29
  ds_read_b64_tr_b16 a[128:129], v28 offset:0
  ds_read_b64_tr_b16 a[130:131], v28 offset:512
  ds_read_b64_tr_b16 a[132:133], v29 offset:0
  ds_read_b64_tr_b16 a[134:135], v29 offset:512
  v_add_u32 v28, 8192, v28
  v_add_u32 v29, 8192, v29
  ds_read_b64_tr_b16 a[136:137], v28 offset:0
  ds_read_b64_tr_b16 a[138:139], v28 offset:512
  ds_read_b64_tr_b16 a[140:141], v29 offset:0
  ds_read_b64_tr_b16 a[142:143], v29 offset:512
  v_add_u32 v28, 8192, v28
  v_add_u32 v29, 8192, v29
  s_waitcnt lgkmcnt(0)
  s_barrier
  s_mul_i32 s20, s3, 36
  s_lshl_b32 s21, s20, 10
  s_lshl_b32 s22, s20, 15
  s_lshl_b32 s23, s4, 8
  s_add_u32 s22, s22, s23
  s_lshl_b32 s23, s3, 2
  s_add_u32 s23, s23, 0
  s_and_b32 s23, s23, 7
  v_xor_b32 v21, s23, v17
  v_lshl_add_u32 v21, v21, 5, v20
  s_mov_b32 m0, s21
  s_add_u32 s21, s21, 1024
  buffer_load_dwordx4 v21, s[28:31], s22 offen lds
  s_add_u32 s22, s22, 0x8000
  s_lshl_b32 s23, s3, 2
  s_add_u32 s23, s23, 1
  s_and_b32 s23, s23, 7
  v_xor_b32 v21, s23, v17
  v_lshl_add_u32 v21, v21, 5, v20
  s_mov_b32 m0, s21
  s_add_u32 s21, s21, 1024
  buffer_load_dwordx4 v21, s[28:31], s22 offen lds
  s_add_u32 s22, s22, 0x8000
  s_lshl_b32 s23, s3, 2
  s_add_u32 s23, s23, 2
  s_and_b32 s23, s23, 7
  v_xor_b32 v21, s23, v17
  v_lshl_add_u32 v21, v21, 5, v20
  s_mov_b32 m0, s21
  s_add_u32 s21, s21, 1024
  buffer_load_dwordx4 v21, s[28:31], s22 offen lds
  s_add_u32 s22, s22, 0x8000
  s_lshl_b32 s23, s3, 2
  s_add_u32 s23, s23, 3
  s_and_b32 s23, s23, 7
  v_xor_b32 v21, s23, v17
  v_lshl_add_u32 v21, v21, 5, v20
  s_mov_b32 m0, s21
  s_add_u32 s21, s21, 1024
  buffer_load_dwordx4 v21, s[28:31], s22 offen lds
  s_add_u32 s22, s22, 0x8000
  s_lshl_b32 s23, s3, 2
  s_add_u32 s23, s23, 4
  s_and_b32 s23, s23, 7
  v_xor_b32 v21, s23, v17
  v_lshl_add_u32 v21, v21, 5, v20
  s_mov_b32 m0, s21
  s_add_u32 s21, s21, 1024
  buffer_load_dwordx4 v21, s[28:31], s22 offen lds
  s_add_u32 s22, s22, 0x8000
  s_lshl_b32 s23, s3, 2
  s_add_u32 s23, s23, 5
  s_and_b32 s23, s23, 7
  v_xor_b32 v21, s23, v17
  v_lshl_add_u32 v21, v21, 5, v20
  s_mov_b32 m0, s21
  s_add_u32 s21, s21, 1024
  buffer_load_dwordx4 v21, s[28:31], s22 offen lds
  s_add_u32 s22, s22, 0x8000
  s_lshl_b32 s23, s3, 2
  s_add_u32 s23, s23, 6
  s_and_b32 s23, s23, 7
  v_xor_b32 v21, s23, v17
  v_lshl_add_u32 v21, v21, 5, v20
  s_mov_b32 m0, s21
  s_add_u32 s21, s21, 1024
  buffer_load_dwordx4 v21, s[28:31], s22 offen lds
  s_add_u32 s22, s22, 0x8000
  s_lshl_b32 s23, s3, 2
  s_add_u32 s23, s23, 7
  s_and_b32 s23, s23, 7
  v_xor_b32 v21, s23, v17
  v_lshl_add_u32 v21, v21, 5, v20
  s_mov_b32 m0, s21
  s_add_u32 s21, s21, 1024
  buffer_load_dwordx4 v21, s[28:31], s22 offen lds
  s_add_u32 s22, s22, 0x8000
  s_lshl_b32 s23, s3, 2
  s_add_u32 s23, s23, 8
  s_and_b32 s23, s23, 7
  v_xor_b32 v21, s23, v17
  v_lshl_add_u32 v21, v21, 5, v20
  s_mov_b32 m0, s21
  s_add_u32 s21, s21, 1024
  buffer_load_dwordx4 v21, s[28:31], s22 offen lds
  s_add_u32 s22, s22, 0x8000
  s_lshl_b32 s23, s3, 2
  s_add_u32 s23, s23, 9
  s_and_b32 s23, s23, 7
  v_xor_b32 v21, s23, v17
  v_lshl_add_u32 v21, v21, 5, v20
  s_mov_b32 m0, s21
  s_add_u32 s21, s21, 1024
  buffer_load_dwordx4 v21, s[28:31], s22 offen lds
  s_add_u32 s22, s22, 0x8000
  s_lshl_b32 s23, s3, 2
  s_add_u32 s23, s23, 10
  s_and_b32 s23, s23, 7
  v_xor_b32 v21, s23, v17
  v_lshl_add_u32 v21, v21, 5, v20
  s_mov_b32 m0, s21
  s_add_u32 s21, s21, 1024
  buffer_load_dwordx4 v21, s[28:31], s22 offen lds
  s_add_u32 s22, s22, 0x8000
  s_lshl_b32 s23, s3, 2
  s_add_u32 s23, s23, 11
  s_and_b32 s23, s23, 7
  v_xor_b32 v21, s23, v17
  v_lshl_add_u32 v21, v21, 5, v20
  s_mov_b32 m0, s21
  s_add_u32 s21, s21, 1024
  buffer_load_dwordx4 v21, s[28:31], s22 offen lds
  s_add_u32 s22, s22, 0x8000
  s_lshl_b32 s23, s3, 2
  s_add_u32 s23, s23, 12
  s_and_b32 s23, s23, 7
  v_xor_b32 v21, s23, v17
  v_lshl_add_u32 v21, v21, 5, v20
  s_mov_b32 m0, s21
  s_add_u32 s21, s21, 1024
  buffer_load_dwordx4 v21, s[28:31], s22 offen lds
  s_add_u32 s22, s22, 0x8000
  s_lshl_b32 s23, s3, 2
  s_add_u32 s23, s23, 13
  s_and_b32 s23, s23, 7
  v_xor_b32 v21, s23, v17
  v_lshl_add_u32 v21, v21, 5, v20
  s_mov_b32 m0, s21
  s_add_u32 s21, s21, 1024
  buffer_load_dwordx4 v21, s[28:31], s22 offen lds
  s_add_u32 s22, s22, 0x8000
  s_lshl_b32 s23, s3, 2
  s_add_u32 s23, s23, 14
  s_and_b32 s23, s23, 7
  v_xor_b32 v21, s23, v17
  v_lshl_add_u32 v21, v21, 5, v20
  s_mov_b32 m0, s21
  s_add_u32 s21, s21, 1024
  buffer_load_dwordx4 v21, s[28:31], s22 offen lds
  s_add_u32 s22, s22, 0x8000
  s_lshl_b32 s23, s3, 2
  s_add_u32 s23, s23, 15
  s_and_b32 s23, s23, 7
  v_xor_b32 v21, s23, v17
  v_lshl_add_u32 v21, v21, 5, v20
  s_mov_b32 m0, s21
  s_add_u32 s21, s21, 1024
  buffer_load_dwordx4 v21, s[28:31], s22 offen lds
  s_add_u32 s22, s22, 0x8000
  s_lshl_b32 s23, s3, 2
  s_add_u32 s23, s23, 16
  s_and_b32 s23, s23, 7
  v_xor_b32 v21, s23, v17
  v_lshl_add_u32 v21, v21, 5, v20
  s_mov_b32 m0, s21
  s_add_u32 s21, s21, 1024
  buffer_load_dwordx4 v21, s[28:31], s22 offen lds
  s_add_u32 s22, s22, 0x8000
  s_lshl_b32 s23, s3, 2
  s_add_u32 s23, s23, 17
  s_and_b32 s23, s23, 7
  v_xor_b32 v21, s23, v17
  v_lshl_add_u32 v21, v21, 5, v20
  s_mov_b32 m0, s21
  s_add_u32 s21, s21, 1024
  buffer_load_dwordx4 v21, s[28:31], s22 offen lds
  s_add_u32 s22, s22, 0x8000
  s_lshl_b32 s23, s3, 2
  s_add_u32 s23, s23, 18
  s_and_b32 s23, s23, 7
  v_xor_b32 v21, s23, v17
  v_lshl_add_u32 v21, v21, 5, v20
  s_mov_b32 m0, s21
  s_add_u32 s21, s21, 1024
  buffer_load_dwordx4 v21, s[28:31], s22 offen lds
  s_add_u32 s22, s22, 0x8000
  s_lshl_b32 s23, s3, 2
  s_add_u32 s23, s23, 19
  s_and_b32 s23, s23, 7
  v_xor_b32 v21, s23, v17
  v_lshl_add_u32 v21, v21, 5, v20
  s_mov_b32 m0, s21
  s_add_u32 s21, s21, 1024
  buffer_load_dwordx4 v21, s[28:31], s22 offen lds
  s_add_u32 s22, s22, 0x8000
  s_lshl_b32 s23, s3, 2
  s_add_u32 s23, s23, 20
  s_and_b32 s23, s23, 7
  v_xor_b32 v21, s23, v17
  v_lshl_add_u32 v21, v21, 5, v20
  s_mov_b32 m0, s21
  s_add_u32 s21, s21, 1024
  buffer_load_dwordx4 v21, s[28:31], s22 offen lds
  s_add_u32 s22, s22, 0x8000
  s_lshl_b32 s23, s3, 2
  s_add_u32 s23, s23, 21
  s_and_b32 s23, s23, 7
  v_xor_b32 v21, s23, v17
  v_lshl_add_u32 v21, v21, 5, v20
  s_mov_b32 m0, s21
  s_add_u32 s21, s21, 1024
  buffer_load_dwordx4 v21, s[28:31], s22 offen lds
  s_add_u32 s22, s22, 0x8000
  s_lshl_b32 s23, s3, 2
  s_add_u32 s23, s23, 22
  s_and_b32 s23, s23, 7
  v_xor_b32 v21, s23, v17
  v_lshl_add_u32 v21, v21, 5, v20
  s_mov_b32 m0, s21
  s_add_u32 s21, s21, 1024
  buffer_load_dwordx4 v21, s[28:31], s22 offen lds
  s_add_u32 s22, s22, 0x8000
  s_lshl_b32 s23, s3, 2
  s_add_u32 s23, s23, 23
  s_and_b32 s23, s23, 7
  v_xor_b32 v21, s23, v17
  v_lshl_add_u32 v21, v21, 5, v20
  s_mov_b32 m0, s21
  s_add_u32 s21, s21, 1024
  buffer_load_dwordx4 v21, s[28:31], s22 offen lds
  s_add_u32 s22, s22, 0x8000
  s_lshl_b32 s23, s3, 2
  s_add_u32 s23, s23, 24
  s_and_b32 s23, s23, 7
  v_xor_b32 v21, s23, v17
  v_lshl_add_u32 v21, v21, 5, v20
  s_mov_b32 m0, s21
  s_add_u32 s21, s21, 1024
  buffer_load_dwordx4 v21, s[28:31], s22 offen lds
  s_add_u32 s22, s22, 0x8000
  s_lshl_b32 s23, s3, 2
  s_add_u32 s23, s23, 25
  s_and_b32 s23, s23, 7
  v_xor_b32 v21, s23, v17
  v_lshl_add_u32 v21, v21, 5, v20
  s_mov_b32 m0, s21
  s_add_u32 s21, s21, 1024
  buffer_load_dwordx4 v21, s[28:31], s22 offen lds
  s_add_u32 s22, s22, 0x8000
  s_lshl_b32 s23, s3, 2
  s_add_u32 s23, s23, 26
  s_and_b32 s23, s23, 7
  v_xor_b32 v21, s23, v17
  v_lshl_add_u32 v21, v21, 5, v20
  s_mov_b32 m0, s21
  s_add_u32 s21, s21, 1024
  buffer_load_dwordx4 v21, s[28:31], s22 offen lds
  s_add_u32 s22, s22, 0x8000
  s_lshl_b32 s23, s3, 2
  s_add_u32 s23, s23, 27
  s_and_b32 s23, s23, 7
  v_xor_b32 v21, s23, v17
  v_lshl_add_u32 v21, v21, 5, v20
  s_mov_b32 m0, s21
  s_add_u32 s21, s21, 1024
  buffer_load_dwordx4 v21, s[28:31], s22 offen lds
  s_add_u32 s22, s22, 0x8000
  s_lshl_b32 s23, s3, 2
  s_add_u32 s23, s23, 28
  s_and_b32 s23, s23, 7
  v_xor_b32 v21, s23, v17
  v_lshl_add_u32 v21, v21, 5, v20
  s_mov_b32 m0, s21
  s_add_u32 s21, s21, 1024
  buffer_load_dwordx4 v21, s[28:31], s22 offen lds
  s_add_u32 s22, s22, 0x8000
  s_lshl_b32 s23, s3, 2
  s_add_u32 s23, s23, 29
  s_and_b32 s23, s23, 7
  v_xor_b32 v21, s23, v17
  v_lshl_add_u32 v21, v21, 5, v20
  s_mov_b32 m0, s21
  s_add_u32 s21, s21, 1024
  buffer_load_dwordx4 v21, s[28:31], s22 offen lds
  s_add_u32 s22, s22, 0x8000
  s_lshl_b32 s23, s3, 2
  s_add_u32 s23, s23, 30
  s_and_b32 s23, s23, 7
  v_xor_b32 v21, s23, v17
  v_lshl_add_u32 v21, v21, 5, v20
  s_mov_b32 m0, s21
  s_add_u32 s21, s21, 1024
  buffer_load_dwordx4 v21, s[28:31], s22 offen lds
  s_add_u32 s22, s22, 0x8000
  s_lshl_b32 s23, s3, 2
  s_add_u32 s23, s23, 31
  s_and_b32 s23, s23, 7
  v_xor_b32 v21, s23, v17
  v_lshl_add_u32 v21, v21, 5, v20
  s_mov_b32 m0, s21
  s_add_u32 s21, s21, 1024
  buffer_load_dwordx4 v21, s[28:31], s22 offen lds
  s_add_u32 s22, s22, 0x8000
  s_lshl_b32 s23, s3, 2
  s_add_u32 s23, s23, 32
  s_and_b32 s23, s23, 7
  v_xor_b32 v21, s23, v17
  v_lshl_add_u32 v21, v21, 5, v20
  s_mov_b32 m0, s21
  s_add_u32 s21, s21, 1024
  buffer_load_dwordx4 v21, s[28:31], s22 offen lds
  s_add_u32 s22, s22, 0x8000
  s_lshl_b32 s23, s3, 2
  s_add_u32 s23, s23, 33
  s_and_b32 s23, s23, 7
  v_xor_b32 v21, s23, v17
  v_lshl_add_u32 v21, v21, 5, v20
  s_mov_b32 m0, s21
  s_add_u32 s21, s21, 1024
  buffer_load_dwordx4 v21, s[28:31], s22 offen lds
  s_add_u32 s22, s22, 0x8000
  s_lshl_b32 s23, s3, 2
  s_add_u32 s23, s23, 34
  s_and_b32 s23, s23, 7
  v_xor_b32 v21, s23, v17
  v_lshl_add_u32 v21, v21, 5, v20
  s_mov_b32 m0, s21
  s_add_u32 s21, s21, 1024
  buffer_load_dwordx4 v21, s[28:31], s22 offen lds
  s_add_u32 s22, s22, 0x8000
  s_lshl_b32 s23, s3, 2
  s_add_u32 s23, s23, 35
  s_and_b32 s23, s23, 7
  v_xor_b32 v21, s23, v17
  v_lshl_add_u32 v21, v21, 5, v20
  s_mov_b32 m0, s21
  s_add_u32 s21, s21, 1024
  buffer_load_dwordx4 v21, s[28:31], s22 offen lds
  s_add_u32 s22, s22, 0x8000
  s_waitcnt vmcnt(0)
  s_barrier
  v_mov_b32 v28, v26
  v_mov_b32 v29, v27
  ds_read_b64_tr_b16 a[144:145], v28 offset:0
  ds_read_b64_tr_b16 a[146:147], v28 offset:512
  ds_read_b64_tr_b16 a[148:149], v29 offset:0
  ds_read_b64_tr_b16 a[150:151], v29 offset:512
  v_add_u32 v28, 8192, v28
  v_add_u32 v29, 8192, v29
  ds_read_b64_tr_b16 a[152:153], v28 offset:0
  ds_read_b64_tr_b16 a[154:155], v28 offset:512
  ds_read_b64_tr_b16 a[156:157], v29 offset:0
  ds_read_b64_tr_b16 a[158:159], v29 offset:512
  v_add_u32 v28, 8192, v28
  v_add_u32 v29, 8192, v29
  ds_read_b64_tr_b16 a[160:161], v28 offset:0
  ds_read_b64_tr_b16 a[162:163], v28 offset:512
  ds_read_b64_tr_b16 a[164:165], v29 offset:0
  ds_read_b64_tr_b16 a[166:167], v29 offset:512
  v_add_u32 v28, 8192, v28
  v_add_u32 v29, 8192, v29
  s_waitcnt lgkmcnt(0)
  ds_read_b64_tr_b16 a[168:169], v28 offset:0
  ds_read_b64_tr_b16 a[170:171], v28 offset:512
  ds_read_b64_tr_b16 a[172:173], v29 offset:0
  ds_read_b64_tr_b16 a[174:175], v29 offset:512
  v_add_u32 v28, 8192, v28
  v_add_u32 v29, 8192, v29
  ds_read_b64_tr_b16 a[176:177], v28 offset:0
  ds_read_b64_tr_b16 a[178:179], v28 offset:512
  ds_read_b64_tr_b16 a[180:181], v29 offset:0
  ds_read_b64_tr_b16 a[182:183], v29 offset:512
  v_add_u32 v28, 8192, v28
  v_add_u32 v29, 8192, v29
  ds_read_b64_tr_b16 a[184:185], v28 offset:0
  ds_read_b64_tr_b16 a[186:187], v28 offset:512
  ds_read_b64_tr_b16 a[188:189], v29 offset:0
  ds_read_b64_tr_b16 a[190:191], v29 offset:512
  v_add_u32 v28, 8192, v28
  v_add_u32 v29, 8192, v29
  s_waitcnt lgkmcnt(0)
  ds_read_b64_tr_b16 a[192:193], v28 offset:0
  ds_read_b64_tr_b16 a[194:195], v28 offset:512
  ds_read_b64_tr_b16 a[196:197], v29 offset:0
  ds_read_b64_tr_b16 a[198:199], v29 offset:512
  v_add_u32 v28, 8192, v28
  v_add_u32 v29, 8192, v29
  ds_read_b64_tr_b16 a[200:201], v28 offset:0
  ds_read_b64_tr_b16 a[202:203], v28 offset:512
  ds_read_b64_tr_b16 a[204:205], v29 offset:0
  ds_read_b64_tr_b16 a[206:207], v29 offset:512
  v_add_u32 v28, 8192, v28
  v_add_u32 v29, 8192, v29
  ds_read_b64_tr_b16 a[208:209], v28 offset:0
  ds_read_b64_tr_b16 a[210:211], v28 offset:512
  ds_read_b64_tr_b16 a[212:213], v29 offset:0
  ds_read_b64_tr_b16 a[214:215], v29 offset:512
  v_add_u32 v28, 8192, v28
  v_add_u32 v29, 8192, v29
  s_waitcnt lgkmcnt(0)
  ds_read_b64_tr_b16 a[216:217], v28 offset:0
  ds_read_b64_tr_b16 a[218:219], v28 offset:512
  ds_read_b64_tr_b16 a[220:221], v29 offset:0
  ds_read_b64_tr_b16 a[222:223], v29 offset:512
  v_add_u32 v28, 8192, v28
  v_add_u32 v29, 8192, v29
  ds_read_b64_tr_b16 a[224:225], v28 offset:0
  ds_read_b64_tr_b16 a[226:227], v28 offset:512
  ds_read_b64_tr_b16 a[228:229], v29 offset:0
  ds_read_b64_tr_b16 a[230:231], v29 offset:512
  v_add_u32 v28, 8192, v28
  v_add_u32 v29, 8192, v29
  ds_read_b64_tr_b16 a[232:233], v28 offset:0
  ds_read_b64_tr_b16 a[234:235], v28 offset:512
  ds_read_b64_tr_b16 a[236:237], v29 offset:0
  ds_read_b64_tr_b16 a[238:239], v29 offset:512
  v_add_u32 v28, 8192, v28
  v_add_u32 v29, 8192, v29
  s_waitcnt lgkmcnt(0)
  ds_read_b64_tr_b16 a[240:241], v28 offset:0
  ds_read_b64_tr_b16 a[242:243], v28 offset:512
  ds_read_b64_tr_b16 a[244:245], v29 offset:0
  ds_read_b64_tr_b16 a[246:247], v29 offset:512
  v_add_u32 v28, 8192, v28
  v_add_u32 v29, 8192, v29
  ds_read_b64_tr_b16 a[248:249], v28 offset:0
  ds_read_b64_tr_b16 a[250:251], v28 offset:512
  ds_read_b64_tr_b16 a[252:253], v29 offset:0
  ds_read_b64_tr_b16 a[254:255], v29 offset:512
  v_add_u32 v28, 8192, v28
  v_add_u32 v29, 8192, v29
  ds_read_b64_tr_b16 v[80:81], v28 offset:0
  ds_read_b64_tr_b16 v[82:83], v28 offset:512
  ds_read_b64_tr_b16 v[84:85], v29 offset:0
  ds_read_b64_tr_b16 v[86:87], v29 offset:512
  v_add_u32 v28, 8192, v28
  v_add_u32 v29, 8192, v29
  s_waitcnt lgkmcnt(0)
  ds_read_b64_tr_b16 v[88:89], v28 offset:0
  ds_read_b64_tr_b16 v[90:91], v28 offset:512
  ds_read_b64_tr_b16 v[92:93], v29 offset:0
  ds_read_b64_tr_b16 v[94:95], v29 offset:512
  v_add_u32 v28, 8192, v28
  v_add_u32 v29, 8192, v29
  ds_read_b64_tr_b16 v[96:97], v28 offset:0
  ds_read_b64_tr_b16 v[98:99], v28 offset:512
  ds_read_b64_tr_b16 v[100:101], v29 offset:0
  ds_read_b64_tr_b16 v[102:103], v29 offset:512
  v_add_u32 v28, 8192, v28
  v_add_u32 v29, 8192, v29
  ds_read_b64_tr_b16 v[104:105], v28 offset:0
  ds_read_b64_tr_b16 v[106:107], v28 offset:512
  ds_read_b64_tr_b16 v[108:109], v29 offset:0
  ds_read_b64_tr_b16 v[110:111], v29 offset:512
  v_add_u32 v28, 8192, v28
  v_add_u32 v29, 8192, v29
  s_waitcnt lgkmcnt(0)
  s_barrier
  s_mul_i32 s20, s3, 36
  s_lshl_b32 s21, s20, 10
  s_lshl_b32 s22, s20, 15
  s_lshl_b32 s23, s4, 8
  s_add_u32 s22, s22, s23
  s_lshl_b32 s23, s3, 2
  s_add_u32 s23, s23, 0
  s_and_b32 s23, s23, 7
  v_xor_b32 v21, s23, v17
  v_lshl_add_u32 v21, v21, 5, v20
  s_mov_b32 m0, s21
  s_add_u32 s21, s21, 1024
  buffer_load_dwordx4 v21, s[32:35], s22 offen lds
  s_add_u32 s22, s22, 0x8000
  s_lshl_b32 s23, s3, 2
  s_add_u32 s23, s23, 1
  s_and_b32 s23, s23, 7
  v_xor_b32 v21, s23, v17
  v_lshl_add_u32 v21, v21, 5, v20
  s_mov_b32 m0, s21
  s_add_u32 s21, s21, 1024
  buffer_load_dwordx4 v21, s[32:35], s22 offen lds
  s_add_u32 s22, s22, 0x8000
  s_lshl_b32 s23, s3, 2
  s_add_u32 s23, s23, 2
  s_and_b32 s23, s23, 7
  v_xor_b32 v21, s23, v17
  v_lshl_add_u32 v21, v21, 5, v20
  s_mov_b32 m0, s21
  s_add_u32 s21, s21, 1024
  buffer_load_dwordx4 v21, s[32:35], s22 offen lds
  s_add_u32 s22, s22, 0x8000
  s_lshl_b32 s23, s3, 2
  s_add_u32 s23, s23, 3
  s_and_b32 s23, s23, 7
  v_xor_b32 v21, s23, v17
  v_lshl_add_u32 v21, v21, 5, v20
  s_mov_b32 m0, s21
  s_add_u32 s21, s21, 1024
  buffer_load_dwordx4 v21, s[32:35], s22 offen lds
  s_add_u32 s22, s22, 0x8000
  s_lshl_b32 s23, s3, 2
  s_add_u32 s23, s23, 4
  s_and_b32 s23, s23, 7
  v_xor_b32 v21, s23, v17
  v_lshl_add_u32 v21, v21, 5, v20
  s_mov_b32 m0, s21
  s_add_u32 s21, s21, 1024
  buffer_load_dwordx4 v21, s[32:35], s22 offen lds
  s_add_u32 s22, s22, 0x8000
  s_lshl_b32 s23, s3, 2
  s_add_u32 s23, s23, 5
  s_and_b32 s23, s23, 7
  v_xor_b32 v21, s23, v17
  v_lshl_add_u32 v21, v21, 5, v20
  s_mov_b32 m0, s21
  s_add_u32 s21, s21, 1024
  buffer_load_dwordx4 v21, s[32:35], s22 offen lds
  s_add_u32 s22, s22, 0x8000
  s_lshl_b32 s23, s3, 2
  s_add_u32 s23, s23, 6
  s_and_b32 s23, s23, 7
  v_xor_b32 v21, s23, v17
  v_lshl_add_u32 v21, v21, 5, v20
  s_mov_b32 m0, s21
  s_add_u32 s21, s21, 1024
  buffer_load_dwordx4 v21, s[32:35], s22 offen lds
  s_add_u32 s22, s22, 0x8000
  s_lshl_b32 s23, s3, 2
  s_add_u32 s23, s23, 7
  s_and_b32 s23, s23, 7
  v_xor_b32 v21, s23, v17
  v_lshl_add_u32 v21, v21, 5, v20
  s_mov_b32 m0, s21
  s_add_u32 s21, s21, 1024
  buffer_load_dwordx4 v21, s[32:35], s22 offen lds
  s_add_u32 s22, s22, 0x8000
  s_lshl_b32 s23, s3, 2
  s_add_u32 s23, s23, 8
  s_and_b32 s23, s23, 7
  v_xor_b32 v21, s23, v17
  v_lshl_add_u32 v21, v21, 5, v20
  s_mov_b32 m0, s21
  s_add_u32 s21, s21, 1024
  buffer_load_dwordx4 v21, s[32:35], s22 offen lds
  s_add_u32 s22, s22, 0x8000
  s_lshl_b32 s23, s3, 2
  s_add_u32 s23, s23, 9
  s_and_b32 s23, s23, 7
  v_xor_b32 v21, s23, v17
  v_lshl_add_u32 v21, v21, 5, v20
  s_mov_b32 m0, s21
  s_add_u32 s21, s21, 1024
  buffer_load_dwordx4 v21, s[32:35], s22 offen lds
  s_add_u32 s22, s22, 0x8000
  s_lshl_b32 s23, s3, 2
  s_add_u32 s23, s23, 10
  s_and_b32 s23, s23, 7
  v_xor_b32 v21, s23, v17
  v_lshl_add_u32 v21, v21, 5, v20
  s_mov_b32 m0, s21
  s_add_u32 s21, s21, 1024
  buffer_load_dwordx4 v21, s[32:35], s22 offen lds
  s_add_u32 s22, s22, 0x8000
  s_lshl_b32 s23, s3, 2
  s_add_u32 s23, s23, 11
  s_and_b32 s23, s23, 7
  v_xor_b32 v21, s23, v17
  v_lshl_add_u32 v21, v21, 5, v20
  s_mov_b32 m0, s21
  s_add_u32 s21, s21, 1024
  buffer_load_dwordx4 v21, s[32:35], s22 offen lds
  s_add_u32 s22, s22, 0x8000
  s_lshl_b32 s23, s3, 2
  s_add_u32 s23, s23, 12
  s_and_b32 s23, s23, 7
  v_xor_b32 v21, s23, v17
  v_lshl_add_u32 v21, v21, 5, v20
  s_mov_b32 m0, s21
  s_add_u32 s21, s21, 1024
  buffer_load_dwordx4 v21, s[32:35], s22 offen lds
  s_add_u32 s22, s22, 0x8000
  s_lshl_b32 s23, s3, 2
  s_add_u32 s23, s23, 13
  s_and_b32 s23, s23, 7
  v_xor_b32 v21, s23, v17
  v_lshl_add_u32 v21, v21, 5, v20
  s_mov_b32 m0, s21
  s_add_u32 s21, s21, 1024
  buffer_load_dwordx4 v21, s[32:35], s22 offen lds
  s_add_u32 s22, s22, 0x8000
  s_lshl_b32 s23, s3, 2
  s_add_u32 s23, s23, 14
  s_and_b32 s23, s23, 7
  v_xor_b32 v21, s23, v17
  v_lshl_add_u32 v21, v21, 5, v20
  s_mov_b32 m0, s21
  s_add_u32 s21, s21, 1024
  buffer_load_dwordx4 v21, s[32:35], s22 offen lds
  s_add_u32 s22, s22, 0x8000
  s_lshl_b32 s23, s3, 2
  s_add_u32 s23, s23, 15
  s_and_b32 s23, s23, 7
  v_xor_b32 v21, s23, v17
  v_lshl_add_u32 v21, v21, 5, v20
  s_mov_b32 m0, s21
  s_add_u32 s21, s21, 1024
  buffer_load_dwordx4 v21, s[32:35], s22 offen lds
  s_add_u32 s22, s22, 0x8000
  s_lshl_b32 s23, s3, 2
  s_add_u32 s23, s23, 16
  s_and_b32 s23, s23, 7
  v_xor_b32 v21, s23, v17
  v_lshl_add_u32 v21, v21, 5, v20
  s_mov_b32 m0, s21
  s_add_u32 s21, s21, 1024
  buffer_load_dwordx4 v21, s[32:35], s22 offen lds
  s_add_u32 s22, s22, 0x8000
  s_lshl_b32 s23, s3, 2
  s_add_u32 s23, s23, 17
  s_and_b32 s23, s23, 7
  v_xor_b32 v21, s23, v17
  v_lshl_add_u32 v21, v21, 5, v20
  s_mov_b32 m0, s21
  s_add_u32 s21, s21, 1024
  buffer_load_dwordx4 v21, s[32:35], s22 offen lds
  s_add_u32 s22, s22, 0x8000
  s_lshl_b32 s23, s3, 2
  s_add_u32 s23, s23, 18
  s_and_b32 s23, s23, 7
  v_xor_b32 v21, s23, v17
  v_lshl_add_u32 v21, v21, 5, v20
  s_mov_b32 m0, s21
  s_add_u32 s21, s21, 1024
  buffer_load_dwordx4 v21, s[32:35], s22 offen lds
  s_add_u32 s22, s22, 0x8000
  s_lshl_b32 s23, s3, 2
  s_add_u32 s23, s23, 19
  s_and_b32 s23, s23, 7
  v_xor_b32 v21, s23, v17
  v_lshl_add_u32 v21, v21, 5, v20
  s_mov_b32 m0, s21
  s_add_u32 s21, s21, 1024
  buffer_load_dwordx4 v21, s[32:35], s22 offen lds
  s_add_u32 s22, s22, 0x8000
  s_lshl_b32 s23, s3, 2
  s_add_u32 s23, s23, 20
  s_and_b32 s23, s23, 7
  v_xor_b32 v21, s23, v17
  v_lshl_add_u32 v21, v21, 5, v20
  s_mov_b32 m0, s21
  s_add_u32 s21, s21, 1024
  buffer_load_dwordx4 v21, s[32:35], s22 offen lds
  s_add_u32 s22, s22, 0x8000
  s_lshl_b32 s23, s3, 2
  s_add_u32 s23, s23, 21
  s_and_b32 s23, s23, 7
  v_xor_b32 v21, s23, v17
  v_lshl_add_u32 v21, v21, 5, v20
  s_mov_b32 m0, s21
  s_add_u32 s21, s21, 1024
  buffer_load_dwordx4 v21, s[32:35], s22 offen lds
  s_add_u32 s22, s22, 0x8000
  s_lshl_b32 s23, s3, 2
  s_add_u32 s23, s23, 22
  s_and_b32 s23, s23, 7
  v_xor_b32 v21, s23, v17
  v_lshl_add_u32 v21, v21, 5, v20
  s_mov_b32 m0, s21
  s_add_u32 s21, s21, 1024
  buffer_load_dwordx4 v21, s[32:35], s22 offen lds
  s_add_u32 s22, s22, 0x8000
  s_lshl_b32 s23, s3, 2
  s_add_u32 s23, s23, 23
  s_and_b32 s23, s23, 7
  v_xor_b32 v21, s23, v17
  v_lshl_add_u32 v21, v21, 5, v20
  s_mov_b32 m0, s21
  s_add_u32 s21, s21, 1024
  buffer_load_dwordx4 v21, s[32:35], s22 offen lds
  s_add_u32 s22, s22, 0x8000
  s_lshl_b32 s23, s3, 2
  s_add_u32 s23, s23, 24
  s_and_b32 s23, s23, 7
  v_xor_b32 v21, s23, v17
  v_lshl_add_u32 v21, v21, 5, v20
  s_mov_b32 m0, s21
  s_add_u32 s21, s21, 1024
  buffer_load_dwordx4 v21, s[32:35], s22 offen lds
  s_add_u32 s22, s22, 0x8000
  s_lshl_b32 s23, s3, 2
  s_add_u32 s23, s23, 25
  s_and_b32 s23, s23, 7
  v_xor_b32 v21, s23, v17
  v_lshl_add_u32 v21, v21, 5, v20
  s_mov_b32 m0, s21
  s_add_u32 s21, s21, 1024
  buffer_load_dwordx4 v21, s[32:35], s22 offen lds
  s_add_u32 s22, s22, 0x8000
  s_lshl_b32 s23, s3, 2
  s_add_u32 s23, s23, 26
  s_and_b32 s23, s23, 7
  v_xor_b32 v21, s23, v17
  v_lshl_add_u32 v21, v21, 5, v20
  s_mov_b32 m0, s21
  s_add_u32 s21, s21, 1024
  buffer_load_dwordx4 v21, s[32:35], s22 offen lds
  s_add_u32 s22, s22, 0x8000
  s_lshl_b32 s23, s3, 2
  s_add_u32 s23, s23, 27
  s_and_b32 s23, s23, 7
  v_xor_b32 v21, s23, v17
  v_lshl_add_u32 v21, v21, 5, v20
  s_mov_b32 m0, s21
  s_add_u32 s21, s21, 1024
  buffer_load_dwordx4 v21, s[32:35], s22 offen lds
  s_add_u32 s22, s22, 0x8000
  s_lshl_b32 s23, s3, 2
  s_add_u32 s23, s23, 28
  s_and_b32 s23, s23, 7
  v_xor_b32 v21, s23, v17
  v_lshl_add_u32 v21, v21, 5, v20
  s_mov_b32 m0, s21
  s_add_u32 s21, s21, 1024
  buffer_load_dwordx4 v21, s[32:35], s22 offen lds
  s_add_u32 s22, s22, 0x8000
  s_lshl_b32 s23, s3, 2
  s_add_u32 s23, s23, 29
  s_and_b32 s23, s23, 7
  v_xor_b32 v21, s23, v17
  v_lshl_add_u32 v21, v21, 5, v20
  s_mov_b32 m0, s21
  s_add_u32 s21, s21, 1024
  buffer_load_dwordx4 v21, s[32:35], s22 offen lds
  s_add_u32 s22, s22, 0x8000
  s_lshl_b32 s23, s3, 2
  s_add_u32 s23, s23, 30
  s_and_b32 s23, s23, 7
  v_xor_b32 v21, s23, v17
  v_lshl_add_u32 v21, v21, 5, v20
  s_mov_b32 m0, s21
  s_add_u32 s21, s21, 1024
  buffer_load_dwordx4 v21, s[32:35], s22 offen lds
  s_add_u32 s22, s22, 0x8000
  s_lshl_b32 s23, s3, 2
  s_add_u32 s23, s23, 31
  s_and_b32 s23, s23, 7
  v_xor_b32 v21, s23, v17
  v_lshl_add_u32 v21, v21, 5, v20
  s_mov_b32 m0, s21
  s_add_u32 s21, s21, 1024
  buffer_load_dwordx4 v21, s[32:35], s22 offen lds
  s_add_u32 s22, s22, 0x8000
  s_lshl_b32 s23, s3, 2
  s_add_u32 s23, s23, 32
  s_and_b32 s23, s23, 7
  v_xor_b32 v21, s23, v17
  v_lshl_add_u32 v21, v21, 5, v20
  s_mov_b32 m0, s21
  s_add_u32 s21, s21, 1024
  buffer_load_dwordx4 v21, s[32:35], s22 offen lds
  s_add_u32 s22, s22, 0x8000
  s_lshl_b32 s23, s3, 2
  s_add_u32 s23, s23, 33
  s_and_b32 s23, s23, 7
  v_xor_b32 v21, s23, v17
  v_lshl_add_u32 v21, v21, 5, v20
  s_mov_b32 m0, s21
  s_add_u32 s21, s21, 1024
  buffer_load_dwordx4 v21, s[32:35], s22 offen lds
  s_add_u32 s22, s22, 0x8000
  s_lshl_b32 s23, s3, 2
  s_add_u32 s23, s23, 34
  s_and_b32 s23, s23, 7
  v_xor_b32 v21, s23, v17
  v_lshl_add_u32 v21, v21, 5, v20
  s_mov_b32 m0, s21
  s_add_u32 s21, s21, 1024
  buffer_load_dwordx4 v21, s[32:35], s22 offen lds
  s_add_u32 s22, s22, 0x8000
  s_lshl_b32 s23, s3, 2
  s_add_u32 s23, s23, 35
  s_and_b32 s23, s23, 7
  v_xor_b32 v21, s23, v17
  v_lshl_add_u32 v21, v21, 5, v20
  s_mov_b32 m0, s21
  s_add_u32 s21, s21, 1024
  buffer_load_dwordx4 v21, s[32:35], s22 offen lds
  s_add_u32 s22, s22, 0x8000
  s_waitcnt vmcnt(0)
  s_barrier
  v_mov_b32 v28, v26
  v_mov_b32 v29, v27
  ds_read_b64_tr_b16 v[112:113], v28 offset:0
  ds_read_b64_tr_b16 v[114:115], v28 offset:512
  ds_read_b64_tr_b16 v[116:117], v29 offset:0
  ds_read_b64_tr_b16 v[118:119], v29 offset:512
  v_add_u32 v28, 8192, v28
  v_add_u32 v29, 8192, v29
  ds_read_b64_tr_b16 v[120:121], v28 offset:0
  ds_read_b64_tr_b16 v[122:123], v28 offset:512
  ds_read_b64_tr_b16 v[124:125], v29 offset:0
  ds_read_b64_tr_b16 v[126:127], v29 offset:512
  v_add_u32 v28, 8192, v28
  v_add_u32 v29, 8192, v29
  ds_read_b64_tr_b16 v[128:129], v28 offset:0
  ds_read_b64_tr_b16 v[130:131], v28 offset:512
  ds_read_b64_tr_b16 v[132:133], v29 offset:0
  ds_read_b64_tr_b16 v[134:135], v29 offset:512
  v_add_u32 v28, 8192, v28
  v_add_u32 v29, 8192, v29
  s_waitcnt lgkmcnt(0)
  ds_read_b64_tr_b16 v[136:137], v28 offset:0
  ds_read_b64_tr_b16 v[138:139], v28 offset:512
  ds_read_b64_tr_b16 v[140:141], v29 offset:0
  ds_read_b64_tr_b16 v[142:143], v29 offset:512
  v_add_u32 v28, 8192, v28
  v_add_u32 v29, 8192, v29
  ds_read_b64_tr_b16 v[144:145], v28 offset:0
  ds_read_b64_tr_b16 v[146:147], v28 offset:512
  ds_read_b64_tr_b16 v[148:149], v29 offset:0
  ds_read_b64_tr_b16 v[150:151], v29 offset:512
  v_add_u32 v28, 8192, v28
  v_add_u32 v29, 8192, v29
  ds_read_b64_tr_b16 v[152:153], v28 offset:0
  ds_read_b64_tr_b16 v[154:155], v28 offset:512
  ds_read_b64_tr_b16 v[156:157], v29 offset:0
  ds_read_b64_tr_b16 v[158:159], v29 offset:512
  v_add_u32 v28, 8192, v28
  v_add_u32 v29, 8192, v29
  s_waitcnt lgkmcnt(0)
  ds_read_b64_tr_b16 v[160:161], v28 offset:0
  ds_read_b64_tr_b16 v[162:163], v28 offset:512
  ds_read_b64_tr_b16 v[164:165], v29 offset:0
  ds_read_b64_tr_b16 v[166:167], v29 offset:512
  v_add_u32 v28, 8192, v28
  v_add_u32 v29, 8192, v29
  ds_read_b64_tr_b16 v[168:169], v28 offset:0
  ds_read_b64_tr_b16 v[170:171], v28 offset:512
  ds_read_b64_tr_b16 v[172:173], v29 offset:0
  ds_read_b64_tr_b16 v[174:175], v29 offset:512
  v_add_u32 v28, 8192, v28
  v_add_u32 v29, 8192, v29
  ds_read_b64_tr_b16 v[176:177], v28 offset:0
  ds_read_b64_tr_b16 v[178:179], v28 offset:512
  ds_read_b64_tr_b16 v[180:181], v29 offset:0
  ds_read_b64_tr_b16 v[182:183], v29 offset:512
  v_add_u32 v28, 8192, v28
  v_add_u32 v29, 8192, v29
  s_waitcnt lgkmcnt(0)
  ds_read_b64_tr_b16 v[184:185], v28 offset:0
  ds_read_b64_tr_b16 v[186:187], v28 offset:512
  ds_read_b64_tr_b16 v[188:189], v29 offset:0
  ds_read_b64_tr_b16 v[190:191], v29 offset:512
  v_add_u32 v28, 8192, v28
  v_add_u32 v29, 8192, v29
  ds_read_b64_tr_b16 v[192:193], v28 offset:0
  ds_read_b64_tr_b16 v[194:195], v28 offset:512
  ds_read_b64_tr_b16 v[196:197], v29 offset:0
  ds_read_b64_tr_b16 v[198:199], v29 offset:512
  v_add_u32 v28, 8192, v28
  v_add_u32 v29, 8192, v29
  ds_read_b64_tr_b16 v[200:201], v28 offset:0
  ds_read_b64_tr_b16 v[202:203], v28 offset:512
  ds_read_b64_tr_b16 v[204:205], v29 offset:0
  ds_read_b64_tr_b16 v[206:207], v29 offset:512
  v_add_u32 v28, 8192, v28
  v_add_u32 v29, 8192, v29
  s_waitcnt lgkmcnt(0)
  ds_read_b64_tr_b16 v[208:209], v28 offset:0
  ds_read_b64_tr_b16 v[210:211], v28 offset:512
  ds_read_b64_tr_b16 v[212:213], v29 offset:0
  ds_read_b64_tr_b16 v[214:215], v29 offset:512
  v_add_u32 v28, 8192, v28
  v_add_u32 v29, 8192, v29
  ds_read_b64_tr_b16 v[216:217], v28 offset:0
  ds_read_b64_tr_b16 v[218:219], v28 offset:512
  ds_read_b64_tr_b16 v[220:221], v29 offset:0
  ds_read_b64_tr_b16 v[222:223], v29 offset:512
  v_add_u32 v28, 8192, v28
  v_add_u32 v29, 8192, v29
  ds_read_b64_tr_b16 v[224:225], v28 offset:0
  ds_read_b64_tr_b16 v[226:227], v28 offset:512
  ds_read_b64_tr_b16 v[228:229], v29 offset:0
  ds_read_b64_tr_b16 v[230:231], v29 offset:512
  v_add_u32 v28, 8192, v28
  v_add_u32 v29, 8192, v29
  s_waitcnt lgkmcnt(0)
  ds_read_b64_tr_b16 v[232:233], v28 offset:0
  ds_read_b64_tr_b16 v[234:235], v28 offset:512
  ds_read_b64_tr_b16 v[236:237], v29 offset:0
  ds_read_b64_tr_b16 v[238:239], v29 offset:512
  v_add_u32 v28, 8192, v28
  v_add_u32 v29, 8192, v29
  ds_read_b64_tr_b16 v[240:241], v28 offset:0
  ds_read_b64_tr_b16 v[242:243], v28 offset:512
  ds_read_b64_tr_b16 v[244:245], v29 offset:0
  ds_read_b64_tr_b16 v[246:247], v29 offset:512
  v_add_u32 v28, 8192, v28
  v_add_u32 v29, 8192, v29
  ds_read_b64_tr_b16 v[248:249], v28 offset:0
  ds_read_b64_tr_b16 v[250:251], v28 offset:512
  ds_read_b64_tr_b16 v[252:253], v29 offset:0
  ds_read_b64_tr_b16 v[254:255], v29 offset:512
  v_add_u32 v28, 8192, v28
  v_add_u32 v29, 8192, v29
  s_waitcnt lgkmcnt(0)
  s_barrier
  v_lshlrev_b32 v21, 4, v76
  s_mul_i32 s20, s3, 36
  s_lshl_b32 s21, s20, 10
  s_mul_i32 s22, s4, 147456
  s_add_u32 s22, s22, s21
  s_mov_b32 m0, s21
  s_add_u32 s21, s21, 1024
  buffer_load_dwordx4 v21, s[36:39], s22 offen lds
  s_add_u32 s22, s22, 1024
  s_mov_b32 m0, s21
  s_add_u32 s21, s21, 1024
  buffer_load_dwordx4 v21, s[36:39], s22 offen lds
  s_add_u32 s22, s22, 1024
  s_mov_b32 m0, s21
  s_add_u32 s21, s21, 1024
  buffer_load_dwordx4 v21, s[36:39], s22 offen lds
  s_add_u32 s22, s22, 1024
  s_mov_b32 m0, s21
  s_add_u32 s21, s21, 1024
  buffer_load_dwordx4 v21, s[36:39], s22 offen lds
  s_add_u32 s22, s22, 1024
  s_mov_b32 m0, s21
  s_add_u32 s21, s21, 1024
  buffer_load_dwordx4 v21, s[36:39], s22 offen lds
  s_add_u32 s22, s22, 1024
  s_mov_b32 m0, s21
  s_add_u32 s21, s21, 1024
  buffer_load_dwordx4 v21, s[36:39], s22 offen lds
  s_add_u32 s22, s22, 1024
  s_mov_b32 m0, s21
  s_add_u32 s21, s21, 1024
  buffer_load_dwordx4 v21, s[36:39], s22 offen lds
  s_add_u32 s22, s22, 1024
  s_mov_b32 m0, s21
  s_add_u32 s21, s21, 1024
  buffer_load_dwordx4 v21, s[36:39], s22 offen lds
  s_add_u32 s22, s22, 1024
  s_mov_b32 m0, s21
  s_add_u32 s21, s21, 1024
  buffer_load_dwordx4 v21, s[36:39], s22 offen lds
  s_add_u32 s22, s22, 1024
  s_mov_b32 m0, s21
  s_add_u32 s21, s21, 1024
  buffer_load_dwordx4 v21, s[36:39], s22 offen lds
  s_add_u32 s22, s22, 1024
  s_mov_b32 m0, s21
  s_add_u32 s21, s21, 1024
  buffer_load_dwordx4 v21, s[36:39], s22 offen lds
  s_add_u32 s22, s22, 1024
  s_mov_b32 m0, s21
  s_add_u32 s21, s21, 1024
  buffer_load_dwordx4 v21, s[36:39], s22 offen lds
  s_add_u32 s22, s22, 1024
  s_mov_b32 m0, s21
  s_add_u32 s21, s21, 1024
  buffer_load_dwordx4 v21, s[36:39], s22 offen lds
  s_add_u32 s22, s22, 1024
  s_mov_b32 m0, s21
  s_add_u32 s21, s21, 1024
  buffer_load_dwordx4 v21, s[36:39], s22 offen lds
  s_add_u32 s22, s22, 1024
  s_mov_b32 m0, s21
  s_add_u32 s21, s21, 1024
  buffer_load_dwordx4 v21, s[36:39], s22 offen lds
  s_add_u32 s22, s22, 1024
  s_mov_b32 m0, s21
  s_add_u32 s21, s21, 1024
  buffer_load_dwordx4 v21, s[36:39], s22 offen lds
  s_add_u32 s22, s22, 1024
  s_mov_b32 m0, s21
  s_add_u32 s21, s21, 1024
  buffer_load_dwordx4 v21, s[36:39], s22 offen lds
  s_add_u32 s22, s22, 1024
  s_mov_b32 m0, s21
  s_add_u32 s21, s21, 1024
  buffer_load_dwordx4 v21, s[36:39], s22 offen lds
  s_add_u32 s22, s22, 1024
  s_mov_b32 m0, s21
  s_add_u32 s21, s21, 1024
  buffer_load_dwordx4 v21, s[36:39], s22 offen lds
  s_add_u32 s22, s22, 1024
  s_mov_b32 m0, s21
  s_add_u32 s21, s21, 1024
  buffer_load_dwordx4 v21, s[36:39], s22 offen lds
  s_add_u32 s22, s22, 1024
  s_mov_b32 m0, s21
  s_add_u32 s21, s21, 1024
  buffer_load_dwordx4 v21, s[36:39], s22 offen lds
  s_add_u32 s22, s22, 1024
  s_mov_b32 m0, s21
  s_add_u32 s21, s21, 1024
  buffer_load_dwordx4 v21, s[36:39], s22 offen lds
  s_add_u32 s22, s22, 1024
  s_mov_b32 m0, s21
  s_add_u32 s21, s21, 1024
  buffer_load_dwordx4 v21, s[36:39], s22 offen lds
  s_add_u32 s22, s22, 1024
  s_mov_b32 m0, s21
  s_add_u32 s21, s21, 1024
  buffer_load_dwordx4 v21, s[36:39], s22 offen lds
  s_add_u32 s22, s22, 1024
  s_mov_b32 m0, s21
  s_add_u32 s21, s21, 1024
  buffer_load_dwordx4 v21, s[36:39], s22 offen lds
  s_add_u32 s22, s22, 1024
  s_mov_b32 m0, s21
  s_add_u32 s21, s21, 1024
  buffer_load_dwordx4 v21, s[36:39], s22 offen lds
  s_add_u32 s22, s22, 1024
  s_mov_b32 m0, s21
  s_add_u32 s21, s21, 1024
  buffer_load_dwordx4 v21, s[36:39], s22 offen lds
  s_add_u32 s22, s22, 1024
  s_mov_b32 m0, s21
  s_add_u32 s21, s21, 1024
  buffer_load_dwordx4 v21, s[36:39], s22 offen lds
  s_add_u32 s22, s22, 1024
  s_mov_b32 m0, s21
  s_add_u32 s21, s21, 1024
  buffer_load_dwordx4 v21, s[36:39], s22 offen lds
  s_add_u32 s22, s22, 1024
  s_mov_b32 m0, s21
  s_add_u32 s21, s21, 1024
  buffer_load_dwordx4 v21, s[36:39], s22 offen lds
  s_add_u32 s22, s22, 1024
  s_mov_b32 m0, s21
  s_add_u32 s21, s21, 1024
  buffer_load_dwordx4 v21, s[36:39], s22 offen lds
  s_add_u32 s22, s22, 1024
  s_mov_b32 m0, s21
  s_add_u32 s21, s21, 1024
  buffer_load_dwordx4 v21, s[36:39], s22 offen lds
  s_add_u32 s22, s22, 1024
  s_mov_b32 m0, s21
  s_add_u32 s21, s21, 1024
  buffer_load_dwordx4 v21, s[36:39], s22 offen lds
  s_add_u32 s22, s22, 1024
  s_mov_b32 m0, s21
  s_add_u32 s21, s21, 1024
  buffer_load_dwordx4 v21, s[36:39], s22 offen lds
  s_add_u32 s22, s22, 1024
  s_mov_b32 m0, s21
  s_add_u32 s21, s21, 1024
  buffer_load_dwordx4 v21, s[36:39], s22 offen lds
  s_add_u32 s22, s22, 1024
  s_mov_b32 m0, s21
  s_add_u32 s21, s21, 1024
  buffer_load_dwordx4 v21, s[36:39], s22 offen lds
  s_add_u32 s22, s22, 1024
  s_waitcnt vmcnt(0)
  s_barrier
  v_and_b32 v24, 1, v23
  v_lshl_add_u32 v24, v16, 2, v24
  v_mul_u32_u24 v24, 1152, v24
  v_and_b32 v25, 3, v76
  v_lshl_add_u32 v24, v25, 3, v24
  v_lshrrev_b32 v25, 1, v23
  v_lshl_add_u32 v24, v25, 5, v24
  s_mul_i32 s21, s3, 5
  s_cmp_eq_u32 s3, 3
  s_cselect_b32 s21, 13, s21
  s_lshl_b32 s20, s21, 6
  v_add_u32 v24, s20, v24
  s_lshl_b32 s20, s21, 11
  v_lshlrev_b32 v26, 4, v76
  v_add_u32 v26, s20, v26
  ds_read_b64_tr_b16 v[32:33], v24 offset:0
  ds_read_b64_tr_b16 v[34:35], v24 offset:2304
  ds_read_b64_tr_b16 v[36:37], v24 offset:18432
  ds_read_b64_tr_b16 v[38:39], v24 offset:20736
  ds_read_b64_tr_b16 v[40:41], v24 offset:64
  ds_read_b64_tr_b16 v[42:43], v24 offset:2368
  ds_read_b64_tr_b16 v[44:45], v24 offset:18496
  ds_read_b64_tr_b16 v[46:47], v24 offset:20800
  s_waitcnt lgkmcnt(0)
  ds_read_b64_tr_b16 v[48:49], v24 offset:128
  ds_read_b64_tr_b16 v[50:51], v24 offset:2432
  ds_read_b64_tr_b16 v[52:53], v24 offset:18560
  ds_read_b64_tr_b16 v[54:55], v24 offset:20864
  ds_read_b64_tr_b16 v[56:57], v24 offset:192
  ds_read_b64_tr_b16 v[58:59], v24 offset:2496
  ds_read_b64_tr_b16 v[60:61], v24 offset:18624
  ds_read_b64_tr_b16 v[62:63], v24 offset:20928
  s_waitcnt lgkmcnt(0)
  ds_read_b64_tr_b16 v[64:65], v24 offset:256
  ds_read_b64_tr_b16 v[66:67], v24 offset:2560
  ds_read_b64_tr_b16 v[68:69], v24 offset:18688
  ds_read_b64_tr_b16 v[70:71], v24 offset:20992
  s_waitcnt lgkmcnt(0)
  s_barrier
  ds_write_b128 v26, v[32:35] offset:0
  ds_write_b128 v26, v[36:39] offset:1024
  ds_write_b128 v26, v[40:43] offset:2048
  ds_write_b128 v26, v[44:47] offset:3072
  ds_write_b128 v26, v[48:51] offset:4096
  ds_write_b128 v26, v[52:55] offset:5120
  ds_write_b128 v26, v[56:59] offset:6144
  ds_write_b128 v26, v[60:63] offset:7168
  ds_write_b128 v26, v[64:67] offset:8192
  ds_write_b128 v26, v[68:71] offset:9216
  v_add_u32 v24, 36864, v24
  v_add_u32 v26, 36864, v26
  s_waitcnt lgkmcnt(0)
  ds_read_b64_tr_b16 v[32:33], v24 offset:0
  ds_read_b64_tr_b16 v[34:35], v24 offset:2304
  ds_read_b64_tr_b16 v[36:37], v24 offset:18432
  ds_read_b64_tr_b16 v[38:39], v24 offset:20736
  ds_read_b64_tr_b16 v[40:41], v24 offset:64
  ds_read_b64_tr_b16 v[42:43], v24 offset:2368
  ds_read_b64_tr_b16 v[44:45], v24 offset:18496
  ds_read_b64_tr_b16 v[46:47], v24 offset:20800
  s_waitcnt lgkmcnt(0)
  ds_read_b64_tr_b16 v[48:49], v24 offset:128
  ds_read_b64_tr_b16 v[50:51], v24 offset:2432
  ds_read_b64_tr_b16 v[52:53], v24 offset:18560
  ds_read_b64_tr_b16 v[54:55], v24 offset:20864
  ds_read_b64_tr_b16 v[56:57], v24 offset:192
  ds_read_b64_tr_b16 v[58:59], v24 offset:2496
  ds_read_b64_tr_b16 v[60:61], v24 offset:18624
  ds_read_b64_tr_b16 v[62:63], v24 offset:20928
  s_waitcnt lgkmcnt(0)
  ds_read_b64_tr_b16 v[64:65], v24 offset:256
  ds_read_b64_tr_b16 v[66:67], v24 offset:2560
  ds_read_b64_tr_b16 v[68:69], v24 offset:18688
  ds_read_b64_tr_b16 v[70:71], v24 offset:20992
  s_waitcnt lgkmcnt(0)
  s_barrier
  ds_write_b128 v26, v[32:35] offset:0
  ds_write_b128 v26, v[36:39] offset:1024
  ds_write_b128 v26, v[40:43] offset:2048
  ds_write_b128 v26, v[44:47] offset:3072
  ds_write_b128 v26, v[48:51] offset:4096
  ds_write_b128 v26, v[52:55] offset:5120
  ds_write_b128 v26, v[56:59] offset:6144
  ds_write_b128 v26, v[60:63] offset:7168
  ds_write_b128 v26, v[64:67] offset:8192
  ds_write_b128 v26, v[68:71] offset:9216
  v_add_u32 v24, 36864, v24
  v_add_u32 v26, 36864, v26
  s_waitcnt lgkmcnt(0)
  ds_read_b64_tr_b16 v[32:33], v24 offset:0
  ds_read_b64_tr_b16 v[34:35], v24 offset:2304
  ds_read_b64_tr_b16 v[36:37], v24 offset:18432
  ds_read_b64_tr_b16 v[38:39], v24 offset:20736
  ds_read_b64_tr_b16 v[40:41], v24 offset:64
  ds_read_b64_tr_b16 v[42:43], v24 offset:2368
  ds_read_b64_tr_b16 v[44:45], v24 offset:18496
  ds_read_b64_tr_b16 v[46:47], v24 offset:20800
  s_waitcnt lgkmcnt(0)
  ds_read_b64_tr_b16 v[48:49], v24 offset:128
  ds_read_b64_tr_b16 v[50:51], v24 offset:2432
  ds_read_b64_tr_b16 v[52:53], v24 offset:18560
  ds_read_b64_tr_b16 v[54:55], v24 offset:20864
  ds_read_b64_tr_b16 v[56:57], v24 offset:192
  ds_read_b64_tr_b16 v[58:59], v24 offset:2496
  ds_read_b64_tr_b16 v[60:61], v24 offset:18624
  ds_read_b64_tr_b16 v[62:63], v24 offset:20928
  s_waitcnt lgkmcnt(0)
  ds_read_b64_tr_b16 v[64:65], v24 offset:256
  ds_read_b64_tr_b16 v[66:67], v24 offset:2560
  ds_read_b64_tr_b16 v[68:69], v24 offset:18688
  ds_read_b64_tr_b16 v[70:71], v24 offset:20992
  s_waitcnt lgkmcnt(0)
  s_barrier
  ds_write_b128 v26, v[32:35] offset:0
  ds_write_b128 v26, v[36:39] offset:1024
  ds_write_b128 v26, v[40:43] offset:2048
  ds_write_b128 v26, v[44:47] offset:3072
  ds_write_b128 v26, v[48:51] offset:4096
  ds_write_b128 v26, v[52:55] offset:5120
  ds_write_b128 v26, v[56:59] offset:6144
  ds_write_b128 v26, v[60:63] offset:7168
  ds_write_b128 v26, v[64:67] offset:8192
  ds_write_b128 v26, v[68:71] offset:9216
  v_add_u32 v24, 36864, v24
  v_add_u32 v26, 36864, v26
  s_waitcnt lgkmcnt(0)
  ds_read_b64_tr_b16 v[32:33], v24 offset:0
  ds_read_b64_tr_b16 v[34:35], v24 offset:2304
  ds_read_b64_tr_b16 v[36:37], v24 offset:18432
  ds_read_b64_tr_b16 v[38:39], v24 offset:20736
  ds_read_b64_tr_b16 v[40:41], v24 offset:64
  ds_read_b64_tr_b16 v[42:43], v24 offset:2368
  ds_read_b64_tr_b16 v[44:45], v24 offset:18496
  ds_read_b64_tr_b16 v[46:47], v24 offset:20800
  s_waitcnt lgkmcnt(0)
  ds_read_b64_tr_b16 v[48:49], v24 offset:128
  ds_read_b64_tr_b16 v[50:51], v24 offset:2432
  ds_read_b64_tr_b16 v[52:53], v24 offset:18560
  ds_read_b64_tr_b16 v[54:55], v24 offset:20864
  ds_read_b64_tr_b16 v[56:57], v24 offset:192
  ds_read_b64_tr_b16 v[58:59], v24 offset:2496
  ds_read_b64_tr_b16 v[60:61], v24 offset:18624
  ds_read_b64_tr_b16 v[62:63], v24 offset:20928
  s_waitcnt lgkmcnt(0)
  ds_read_b64_tr_b16 v[64:65], v24 offset:256
  ds_read_b64_tr_b16 v[66:67], v24 offset:2560
  ds_read_b64_tr_b16 v[68:69], v24 offset:18688
  ds_read_b64_tr_b16 v[70:71], v24 offset:20992
  s_waitcnt lgkmcnt(0)
  s_barrier
  ds_write_b128 v26, v[32:35] offset:0
  ds_write_b128 v26, v[36:39] offset:1024
  ds_write_b128 v26, v[40:43] offset:2048
  ds_write_b128 v26, v[44:47] offset:3072
  ds_write_b128 v26, v[48:51] offset:4096
  ds_write_b128 v26, v[52:55] offset:5120
  ds_write_b128 v26, v[56:59] offset:6144
  ds_write_b128 v26, v[60:63] offset:7168
  ds_write_b128 v26, v[64:67] offset:8192
  ds_write_b128 v26, v[68:71] offset:9216
  v_add_u32 v24, 36864, v24
  v_add_u32 v26, 36864, v26
  s_waitcnt lgkmcnt(0)
  s_barrier
  s_cmp_lg_u32 s3, 0
  s_cbranch_scc1 Lch_16_tbd
  s_mov_b32 s20, 2560
  s_mov_b32 s22, 0
Lch_16_tbw:
  buffer_load_dword v18, off, s[52:55], s20 sc1
  s_waitcnt vmcnt(0)
  v_readfirstlane_b32 s23, v18
  s_add_u32 s22, s22, 1
  s_cmp_gt_u32 s22, 200000
  s_cbranch_scc1 Lch_16_tbw_x
  s_cmp_lt_u32 s23, 32
  s_cbranch_scc1 Lch_16_tbw
Lch_16_tbw_x:
Lch_16_tbd:
  s_barrier
  s_cmp_eq_u32 s84, 0
  s_cbranch_scc1 Lch_16_generic
  s_mov_b32 s7, 0
  s_lshl_b32 s8, s4, 13
  s_lshl_b32 s9, s4, 13
  s_lshl_b32 s10, s4, 11
  s_mov_b32 s11, 1
  s_mov_b32 s86, 0xfffffffe
  s_mov_b32 s80, 0x3e0293ee
  s_mov_b32 s81, 0x3e0293ee
  s_mov_b32 s18, 0
  s_mov_b32 s24, 0
  s_mov_b32 s25, 36864
  s_mov_b32 s26, 73728
  s_mov_b32 s27, 110592
  s_mov_b32 s28, 147456
  s_mov_b32 s29, 184320
  s_mov_b32 s30, 221184
  s_mov_b32 s31, 258048
  v_mov_b64 v[16:17], 0
  v_mov_b64 v[18:19], 0
  v_mov_b64 v[20:21], 0
  v_mov_b64 v[22:23], 0
  v_mov_b64 v[24:25], 0
  v_mov_b64 v[26:27], 0
  s_mov_b32 s20, 9216
  s_mov_b32 s22, 0
Lch_16f_kv0:
  buffer_load_dword v79, off, s[52:55], s20 sc1
  s_waitcnt vmcnt(0)
  v_readfirstlane_b32 s23, v79
  s_add_u32 s22, s22, 1
  s_cmp_gt_u32 s22, 1000000
  s_cbranch_scc1 Lch_16f_kv0_x
  s_cmp_ge_u32 s23, 32
  s_cbranch_scc1 Lch_16f_kv0_x
  s_sleep 2
  s_branch Lch_16f_kv0
Lch_16f_kv0_x:
  v_mov_b32 v0, 32
  s_barrier
  s_mov_b32 s23, 4096
  s_mov_b32 s19, 5120
  v_mov_b64 v[36:37], 0
  v_mov_b64 v[38:39], 0
Lch_16f_step:
  s_mov_b32 s22, 0
Lch_16f_ml:
  buffer_load_dwordx4 v[28:31], v11, s[48:51], s18 offen sc1
  buffer_load_dwordx4 v[32:35], v11, s[48:51], s23 offen sc1
  s_cmp_lg_u32 s3, 3
  s_cbranch_scc1 Lch_16f_m2
  buffer_load_dwordx4 v[36:39], v11, s[48:51], s19 offen sc1
Lch_16f_m2:
  s_add_u32 s22, s22, 1
  v_add_u32 v71, 147456, v11
  s_waitcnt vmcnt(0)
  v_max3_u32 v69, v28, v30, v32
  v_max3_u32 v70, v34, v36, v38
  v_max_u32 v69, v69, v70
  v_cmp_eq_u32 vcc, -1, v69
  s_cmp_gt_u32 s22, 40000
  s_cbranch_scc1 Lch_16f_mok
  s_cbranch_vccnz Lch_16f_ml
Lch_16f_mok:
  ds_write_b128 v71, v[28:31]
  ds_write_b128 v71, v[32:35] offset:4096
  s_cmp_lg_u32 s3, 3
  s_cbranch_scc1 Lch_16f_m3
  ds_write_b128 v71, v[36:39] offset:5120
Lch_16f_m3:
  s_waitcnt lgkmcnt(0)
  s_barrier
  ds_read_b128 v[28:31], v1 offset:0
  ds_read_b128 v[32:35], v1 offset:512
  ds_read_b128 v[36:39], v1 offset:1024
  ds_read_b128 v[40:43], v1 offset:1536
  s_waitcnt lgkmcnt(3)
  v_smfmac_f32_16x16x64_bf16 v[16:19], v[28:31], a[0:7], v4
  buffer_load_dwordx4 v[44:47], v6, s[56:59], s8 offen offset:0
  v_smfmac_f32_16x16x64_bf16 v[20:23], v[28:31], a[144:151], v4
  v_smfmac_f32_16x16x64_bf16 v[24:27], v[28:31], v[112:119], v4
  ds_read_b128 v[28:31], v1 offset:2048
  s_waitcnt lgkmcnt(3)
  v_smfmac_f32_16x16x64_bf16 v[16:19], v[32:35], a[8:15], v4
  buffer_load_dwordx4 v[48:51], v6, s[56:59], s8 offen offset:1024
  v_smfmac_f32_16x16x64_bf16 v[20:23], v[32:35], a[152:159], v4
  v_smfmac_f32_16x16x64_bf16 v[24:27], v[32:35], v[120:127], v4
  ds_read_b128 v[32:35], v1 offset:2560
  s_waitcnt lgkmcnt(3)
  v_smfmac_f32_16x16x64_bf16 v[16:19], v[36:39], a[16:23], v4
  buffer_load_dwordx4 v[52:55], v6, s[56:59], s8 offen offset:2048
  v_smfmac_f32_16x16x64_bf16 v[20:23], v[36:39], a[160:167], v4
  v_smfmac_f32_16x16x64_bf16 v[24:27], v[36:39], v[128:135], v4
  ds_read_b128 v[36:39], v1 offset:3072
  s_waitcnt lgkmcnt(3)
  v_smfmac_f32_16x16x64_bf16 v[16:19], v[40:43], a[24:31], v4
  buffer_load_dwordx4 v[56:59], v6, s[56:59], s8 offen offset:3072
  v_smfmac_f32_16x16x64_bf16 v[20:23], v[40:43], a[168:175], v4
  v_smfmac_f32_16x16x64_bf16 v[24:27], v[40:43], v[136:143], v4
  ds_read_b128 v[40:43], v1 offset:3584
  s_waitcnt lgkmcnt(3)
  v_smfmac_f32_16x16x64_bf16 v[16:19], v[28:31], a[32:39], v4
  buffer_load_dwordx4 v[60:63], v7, s[60:63], s9 offen
  v_smfmac_f32_16x16x64_bf16 v[20:23], v[28:31], a[176:183], v4
  v_smfmac_f32_16x16x64_bf16 v[24:27], v[28:31], v[144:151], v4
  ds_read_b128 v[28:31], v1 offset:4096
  s_waitcnt lgkmcnt(3)
  v_smfmac_f32_16x16x64_bf16 v[16:19], v[32:35], a[40:47], v4
  buffer_load_dwordx4 v[64:67], v7, s[60:63], s9 offen offset:1024
  v_smfmac_f32_16x16x64_bf16 v[20:23], v[32:35], a[184:191], v4
  v_smfmac_f32_16x16x64_bf16 v[24:27], v[32:35], v[152:159], v4
  ds_read_b128 v[32:35], v1 offset:4608
  s_waitcnt lgkmcnt(3)
  v_smfmac_f32_16x16x64_bf16 v[16:19], v[36:39], a[48:55], v4
  v_smfmac_f32_16x16x64_bf16 v[20:23], v[36:39], a[192:199], v4
  v_smfmac_f32_16x16x64_bf16 v[24:27], v[36:39], v[160:167], v4
  ds_read_b128 v[36:39], v1 offset:5120
  s_waitcnt lgkmcnt(3)
  v_smfmac_f32_16x16x64_bf16 v[16:19], v[40:43], a[56:63], v4
  v_smfmac_f32_16x16x64_bf16 v[20:23], v[40:43], a[200:207], v4
  v_smfmac_f32_16x16x64_bf16 v[24:27], v[40:43], v[168:175], v4
  ds_read_b128 v[40:43], v1 offset:5632
  s_waitcnt lgkmcnt(3)
  v_smfmac_f32_16x16x64_bf16 v[16:19], v[28:31], a[64:71], v4
  v_smfmac_f32_16x16x64_bf16 v[20:23], v[28:31], a[208:215], v4
  v_smfmac_f32_16x16x64_bf16 v[24:27], v[28:31], v[176:183], v4
  ds_read_b128 v[28:31], v1 offset:6144
  s_waitcnt lgkmcnt(3)
  v_smfmac_f32_16x16x64_bf16 v[16:19], v[32:35], a[72:79], v4
  v_smfmac_f32_16x16x64_bf16 v[20:23], v[32:35], a[216:223], v4
  v_smfmac_f32_16x16x64_bf16 v[24:27], v[32:35], v[184:191], v4
  ds_read_b128 v[32:35], v1 offset:6656
  s_waitcnt lgkmcnt(3)
  v_smfmac_f32_16x16x64_bf16 v[16:19], v[36:39], a[80:87], v4
  v_smfmac_f32_16x16x64_bf16 v[20:23], v[36:39], a[224:231], v4
  v_smfmac_f32_16x16x64_bf16 v[24:27], v[36:39], v[192:199], v4
  ds_read_b128 v[36:39], v1 offset:7168
  s_waitcnt lgkmcnt(3)
  v_smfmac_f32_16x16x64_bf16 v[16:19], v[40:43], a[88:95], v4
  v_smfmac_f32_16x16x64_bf16 v[20:23], v[40:43], a[232:239], v4
  v_smfmac_f32_16x16x64_bf16 v[24:27], v[40:43], v[200:207], v4
  ds_read_b128 v[40:43], v1 offset:7680
  s_waitcnt lgkmcnt(3)
  v_smfmac_f32_16x16x64_bf16 v[16:19], v[28:31], a[96:103], v4
  v_smfmac_f32_16x16x64_bf16 v[20:23], v[28:31], a[240:247], v4
  v_smfmac_f32_16x16x64_bf16 v[24:27], v[28:31], v[208:215], v4
  ds_read_b128 v[28:31], v1 offset:8192
  s_waitcnt lgkmcnt(3)
  v_smfmac_f32_16x16x64_bf16 v[16:19], v[32:35], a[104:111], v4
  v_smfmac_f32_16x16x64_bf16 v[20:23], v[32:35], a[248:255], v4
  v_smfmac_f32_16x16x64_bf16 v[24:27], v[32:35], v[216:223], v4
  ds_read_b128 v[32:35], v1 offset:8704
  s_waitcnt lgkmcnt(3)
  v_smfmac_f32_16x16x64_bf16 v[16:19], v[36:39], a[112:119], v4
  v_smfmac_f32_16x16x64_bf16 v[20:23], v[36:39], v[80:87], v4
  v_smfmac_f32_16x16x64_bf16 v[24:27], v[36:39], v[224:231], v4
  s_waitcnt lgkmcnt(2)
  v_smfmac_f32_16x16x64_bf16 v[16:19], v[40:43], a[120:127], v4
  v_smfmac_f32_16x16x64_bf16 v[20:23], v[40:43], v[88:95], v4
  v_smfmac_f32_16x16x64_bf16 v[24:27], v[40:43], v[232:239], v4
  s_waitcnt lgkmcnt(1)
  v_smfmac_f32_16x16x64_bf16 v[16:19], v[28:31], a[128:135], v4
  v_smfmac_f32_16x16x64_bf16 v[20:23], v[28:31], v[96:103], v4
  v_smfmac_f32_16x16x64_bf16 v[24:27], v[28:31], v[240:247], v4
  s_waitcnt lgkmcnt(0)
  v_smfmac_f32_16x16x64_bf16 v[16:19], v[32:35], a[136:143], v4
  v_smfmac_f32_16x16x64_bf16 v[20:23], v[32:35], v[104:111], v4
  v_smfmac_f32_16x16x64_bf16 v[24:27], v[32:35], v[248:255], v4
  s_waitcnt vmcnt(0)
  v_swap_b32 v61, v64
  v_swap_b32 v62, v64
  v_swap_b32 v63, v65
  v_swap_b32 v65, v66
  v_cvt_pk_bf16_f32 v76, v16, v17
  v_cvt_pk_bf16_f32 v77, v18, v19
  ds_write_b64 v3, v[76:77]
  v_cvt_pk_bf16_f32 v78, v20, v21
  v_cvt_pk_bf16_f32 v79, v22, v23
  ds_write_b64 v3, v[78:79] offset:2048
  v_cvt_pk_bf16_f32 v68, v24, v25
  v_cvt_pk_bf16_f32 v69, v26, v27
  v_mov_b64 v[70:71], 0
  v_mov_b64 v[74:75], 0
  v_permlane32_swap_b32 v68, v69
  s_waitcnt lgkmcnt(0)
  s_barrier
  s_cmp_eq_u32 s3, 2
  s_cbranch_scc1 Lch_16f_rm
  s_cmp_eq_u32 s3, 3
  s_cbranch_scc1 Lch_16f_ra
  ds_read_b64_tr_b16 v[28:29], v2 offset:0
  ds_read_b64_tr_b16 v[30:31], v2 offset:64
  ds_read_b64_tr_b16 v[32:33], v2 offset:512
  ds_read_b64_tr_b16 v[34:35], v2 offset:576
  ds_read_b64_tr_b16 v[36:37], v2 offset:1024
  ds_read_b64_tr_b16 v[38:39], v2 offset:1088
  ds_read_b64_tr_b16 v[40:41], v2 offset:1536
  ds_read_b64_tr_b16 v[42:43], v2 offset:1600
  buffer_store_dword v68, v8, s[68:71], s10 offen sc1
  buffer_store_dword v69, v8, s[68:71], s10 offen offset:256 sc1
  v_mov_b64 v[72:73], v[68:69]
  v_mov_b64 v[16:17], 0
  v_mov_b64 v[18:19], 0
  v_mov_b64 v[20:21], 0
  v_mov_b64 v[22:23], 0
  v_mov_b64 v[24:25], 0
  v_mov_b64 v[26:27], 0
  s_waitcnt lgkmcnt(0)
  v_mfma_f32_16x16x32_bf16 v[76:79], v[44:47], v[28:31], 0
  v_mfma_f32_16x16x32_bf16 v[76:79], v[48:51], v[32:35], v[76:79]
  v_mfma_f32_16x16x32_bf16 v[76:79], v[52:55], v[36:39], v[76:79]
  v_mfma_f32_16x16x32_bf16 v[76:79], v[56:59], v[40:43], v[76:79]
  s_nop 6
  s_nop 0
  v_pk_mul_f32 v[76:77], v[76:77], s[80:81]
  v_pk_mul_f32 v[78:79], v[78:79], s[80:81]
  ds_write_b128 v13, v[76:79]
  v_mov_b64 v[36:37], 0
  v_mov_b64 v[38:39], 0
  s_waitcnt lgkmcnt(0)
  s_branch Lch_16f_p3j
Lch_16f_rm:
  ds_read_b64_tr_b16 v[28:29], v2 offset:0
  ds_read_b64_tr_b16 v[30:31], v2 offset:64
  ds_read_b64_tr_b16 v[32:33], v2 offset:512
  ds_read_b64_tr_b16 v[34:35], v2 offset:576
  ds_read_b64_tr_b16 v[36:37], v2 offset:1024
  ds_read_b64_tr_b16 v[38:39], v2 offset:1088
  ds_read_b64_tr_b16 v[40:41], v2 offset:1536
  ds_read_b64_tr_b16 v[42:43], v2 offset:1600
  ds_read_b64_tr_b16 v[44:45], v2 offset:2048
  ds_read_b64_tr_b16 v[46:47], v2 offset:2112
  ds_read_b64_tr_b16 v[48:49], v2 offset:2560
  ds_read_b64_tr_b16 v[50:51], v2 offset:2624
  ds_read_b64_tr_b16 v[52:53], v2 offset:3072
  ds_read_b64_tr_b16 v[54:55], v2 offset:3136
  ds_read_b64_tr_b16 v[56:57], v2 offset:3584
  ds_read_b64_tr_b16 v[58:59], v2 offset:3648
  buffer_store_dword v68, v8, s[68:71], s10 offen sc1
  buffer_store_dword v69, v8, s[68:71], s10 offen offset:256 sc1
  v_mov_b64 v[72:73], v[68:69]
  v_mov_b64 v[16:17], 0
  v_mov_b64 v[18:19], 0
  v_mov_b64 v[20:21], 0
  v_mov_b64 v[22:23], 0
  v_mov_b64 v[24:25], 0
  v_mov_b64 v[26:27], 0
  s_waitcnt lgkmcnt(0)
  v_mfma_f32_16x16x32_bf16 v[76:79], v[44:47], v[28:31], 0
  v_mfma_f32_16x16x32_bf16 v[76:79], v[48:51], v[32:35], v[76:79]
  v_mfma_f32_16x16x32_bf16 v[76:79], v[52:55], v[36:39], v[76:79]
  v_mfma_f32_16x16x32_bf16 v[76:79], v[56:59], v[40:43], v[76:79]
  s_nop 6
  s_nop 0
  v_pk_mul_f32 v[76:77], v[76:77], s[80:81]
  v_pk_mul_f32 v[78:79], v[78:79], s[80:81]
  ds_write2_b64 v13, v[76:77], v[78:79] offset0:0 offset1:50
  v_mov_b64 v[36:37], 0
  v_mov_b64 v[38:39], 0
  s_waitcnt lgkmcnt(0)
  s_branch Lch_16f_p3j
Lch_16f_ra:
  ds_read_b64_tr_b16 v[44:45], v2 offset:2048
  ds_read_b64_tr_b16 v[46:47], v2 offset:2112
  ds_read_b64_tr_b16 v[48:49], v2 offset:2560
  ds_read_b64_tr_b16 v[50:51], v2 offset:2624
  ds_read_b64_tr_b16 v[52:53], v2 offset:3072
  ds_read_b64_tr_b16 v[54:55], v2 offset:3136
  ds_read_b64_tr_b16 v[56:57], v2 offset:3584
  ds_read_b64_tr_b16 v[58:59], v2 offset:3648
  buffer_store_dword v68, v8, s[68:71], s10 offen sc1
  buffer_store_dword v69, v8, s[68:71], s10 offen offset:256 sc1
  v_mov_b64 v[72:73], v[68:69]
  v_mov_b64 v[16:17], 0
  v_mov_b64 v[18:19], 0
  v_mov_b64 v[20:21], 0
  v_mov_b64 v[22:23], 0
  v_mov_b64 v[24:25], 0
  v_mov_b64 v[26:27], 0
  s_and_b32 s20, s7, 3
  s_cmp_lg_u32 s20, 0
  s_cbranch_scc1 Lch_16f_nopub_17
  s_cmp_lg_u32 s3, 3
  s_cbranch_scc1 Lch_16f_nopub_17
  s_cmp_eq_u32 s7, 0
  s_cbranch_scc1 Lch_16f_nopub_17
  s_lshl_b32 s20, s7, 5
  s_add_u32 s20, s20, 11136
  v_mov_b32 v79, 1
  s_mov_b64 exec, 1
  buffer_atomic_add v79, off, s[52:55], s20
  s_mov_b64 exec, -1
Lch_16f_nopub_17:
  v_lshlrev_b32 v76, 4, v9
  v_mov_b32 v77, v76
  v_readfirstlane_b32 s20, v0
  s_cmp_ge_u32 s20, 32
  s_cbranch_scc1 Lch_16f_kvok_18
  s_add_u32 s21, s7, 2
  s_lshr_b32 s20, s21, 3
  s_min_u32 s20, s20, 7
  s_lshl_b32 s20, s20, 7
  s_add_u32 s20, s20, 9216
  s_mov_b32 s22, 0
Lch_16f_kvw_19:
  buffer_load_dword v79, off, s[52:55], s20 sc1
  s_waitcnt vmcnt(0)
  v_readfirstlane_b32 s23, v79
  s_add_u32 s22, s22, 1
  s_cmp_gt_u32 s22, 1000000
  s_cbranch_scc1 Lch_16f_kvw_19_x
  s_cmp_ge_u32 s23, 32
  s_cbranch_scc1 Lch_16f_kvw_19_x
  s_sleep 2
  s_branch Lch_16f_kvw_19
Lch_16f_kvw_19_x:
Lch_16f_kvok_18:
  s_add_u32 s20, s8, 524288
  s_add_u32 s21, s9, 524288
  buffer_load_dword v0, v77, s[56:59], s20 offen
  buffer_load_dword v0, v76, s[60:63], s21 offen
  s_add_u32 s20, s7, 3
  s_lshr_b32 s20, s20, 3
  s_min_u32 s20, s20, 7
  s_lshl_b32 s20, s20, 7
  s_add_u32 s20, s20, 9216
  buffer_load_dword v0, off, s[52:55], s20 sc1
  s_waitcnt lgkmcnt(0)
  buffer_store_dwordx4 v[44:47], v6, s[64:67], s10 offen offset:0 sc1
  buffer_store_dwordx4 v[48:51], v6, s[64:67], s10 offen offset:512 sc1
  buffer_store_dwordx4 v[52:55], v6, s[64:67], s10 offen offset:1024 sc1
  buffer_store_dwordx4 v[56:59], v6, s[64:67], s10 offen offset:1536 sc1
  v_mov_b64 v[36:37], 0
  v_mov_b64 v[38:39], 0
  s_waitcnt lgkmcnt(0)
Lch_16f_p3j:
  s_barrier
  s_cmp_eq_u32 s7, 63
  s_cbranch_scc1 Lch_16f_end
  ds_read_b128 v[48:51], v14
  ds_read_b128 v[52:55], v14 offset:16
  ds_read_b64 v[56:57], v14 offset:32
  v_add_u32 v44, 73728, v5
  v_mov_b32 v45, s11
  s_add_u32 s8, s8, 262144
  s_add_u32 s9, s9, 262144
  s_waitcnt lgkmcnt(0)
  v_max3_f32 v76, v48, v49, v50
  v_max3_f32 v77, v51, v52, v53
  v_max3_f32 v76, v76, v54, v55
  v_max3_f32 v77, v77, v56, v57
  v_max_f32 v76, v76, v77
  v_mov_b32 v77, v76
  s_add_u32 s10, s10, 65536
  v_mov_b64 v[28:29], 0
  v_permlane16_swap_b32 v76, v77
  v_mov_b64 v[30:31], 0
  v_max_f32 v76, v76, v77
  v_mov_b32 v77, v76
  v_mov_b64 v[32:33], 0
  v_mov_b64 v[34:35], 0
  v_permlane32_swap_b32 v76, v77
  s_nop 0
  v_max_f32 v76, v76, v77
  v_mov_b32 v77, v76
  v_pk_add_f32 v[48:49], v[48:49], v[76:77] neg_lo:[0,1] neg_hi:[0,1]
  v_pk_add_f32 v[50:51], v[50:51], v[76:77] neg_lo:[0,1] neg_hi:[0,1]
  v_pk_add_f32 v[52:53], v[52:53], v[76:77] neg_lo:[0,1] neg_hi:[0,1]
  v_pk_add_f32 v[54:55], v[54:55], v[76:77] neg_lo:[0,1] neg_hi:[0,1]
  v_pk_add_f32 v[56:57], v[56:57], v[76:77] neg_lo:[0,1] neg_hi:[0,1]
  v_exp_f32 v48, v48
  v_exp_f32 v49, v49
  v_exp_f32 v50, v50
  v_exp_f32 v51, v51
  v_exp_f32 v52, v52
  v_exp_f32 v53, v53
  v_exp_f32 v54, v54
  v_exp_f32 v55, v55
  v_exp_f32 v56, v56
  v_exp_f32 v57, v57
  s_nop 0
  v_pk_add_f32 v[76:77], v[48:49], v[50:51]
  v_pk_add_f32 v[78:79], v[52:53], v[54:55]
  v_pk_add_f32 v[76:77], v[76:77], v[56:57]
  v_pk_add_f32 v[76:77], v[76:77], v[78:79]
  v_add_f32 v76, v76, v77
  v_mov_b32 v77, v76
  s_nop 1
  v_permlane16_swap_b32 v76, v77
  s_nop 0
  v_add_f32 v76, v76, v77
  v_mov_b32 v77, v76
  s_nop 1
  v_permlane32_swap_b32 v76, v77
  s_nop 0
  v_add_f32 v76, v76, v77
  v_rcp_f32 v76, v76
  s_nop 0
  v_mov_b32 v77, v76
  v_pk_mul_f32 v[48:49], v[48:49], v[76:77]
  v_pk_mul_f32 v[50:51], v[50:51], v[76:77]
  v_pk_mul_f32 v[52:53], v[52:53], v[76:77]
  v_pk_mul_f32 v[54:55], v[54:55], v[76:77]
  v_pk_mul_f32 v[56:57], v[56:57], v[76:77]
  v_cvt_pk_bf16_f32 v78, v56, v57
  v_cvt_pk_bf16_f32 v40, v48, v49
  v_cvt_pk_bf16_f32 v41, v50, v51
  v_cvt_pk_bf16_f32 v42, v52, v53
  v_cvt_pk_bf16_f32 v43, v54, v55
  v_and_b32 v76, v15, v78
  v_mov_b32 v77, 0
  v_xor_b32 v78, v76, v78
  v_mov_b32 v79, 0
  s_nop 0
  v_smfmac_f32_16x16x64_bf16 v[36:39], v[40:43], v[60:67], v4
  v_smfmac_f32_16x16x64_bf16 v[36:39], v[76:79], v[68:75], v4
  ds_read_b128 v[48:51], v5 offset:0
  ds_read_b128 v[52:55], v5 offset:1024
  s_nop 5
  v_cvt_pk_bf16_f32 v58, v36, v37
  v_cvt_pk_bf16_f32 v59, v38, v39
  ds_write_b64 v3, v[58:59] offset:0
  ds_read_b128 v[64:67], v44 offset:0
  ds_read_b128 v[68:71], v44 offset:1024
  s_waitcnt lgkmcnt(2)
  s_barrier
  ds_read_b64_tr_b16 v[36:37], v2 offset:0
  ds_read_b64_tr_b16 v[38:39], v2 offset:64
  ds_read_b128 v[56:59], v5 offset:36864
  ds_read_b128 v[60:63], v5 offset:37888
  ds_read_b64_tr_b16 v[40:41], v2 offset:512
  ds_read_b64_tr_b16 v[42:43], v2 offset:576
  ds_read_b64_tr_b16 v[72:73], v2 offset:1024
  ds_read_b64_tr_b16 v[74:75], v2 offset:1088
  ds_read_b64_tr_b16 v[76:77], v2 offset:1536
  ds_read_b64_tr_b16 v[78:79], v2 offset:1600
  s_waitcnt lgkmcnt(8)
  v_smfmac_f32_16x16x64_bf16 v[16:19], v[36:39], v[48:55], v4
  ds_read_b128 v[48:51], v44 offset:36864
  ds_read_b128 v[52:55], v44 offset:37888
  s_waitcnt lgkmcnt(6)
  v_smfmac_f32_16x16x64_bf16 v[16:19], v[40:43], v[56:63], v4
  ds_read_b128 v[56:59], v5 offset:2048
  ds_read_b128 v[60:63], v5 offset:3072
  s_waitcnt lgkmcnt(6)
  v_smfmac_f32_16x16x64_bf16 v[16:19], v[72:75], v[64:71], v4
  ds_read_b128 v[64:67], v5 offset:38912
  ds_read_b128 v[68:71], v5 offset:39936
  s_waitcnt lgkmcnt(6)
  s_waitcnt lgkmcnt(4)
  v_smfmac_f32_16x16x64_bf16 v[16:19], v[76:79], v[48:55], v4
  ds_read_b128 v[48:51], v44 offset:2048
  ds_read_b128 v[52:55], v44 offset:3072
  s_waitcnt lgkmcnt(4)
  v_smfmac_f32_16x16x64_bf16 v[20:23], v[36:39], v[56:63], v4
  ds_read_b128 v[56:59], v44 offset:38912
  ds_read_b128 v[60:63], v44 offset:39936
  s_waitcnt lgkmcnt(4)
  v_smfmac_f32_16x16x64_bf16 v[20:23], v[40:43], v[64:71], v4
  ds_read_b128 v[64:67], v5 offset:4096
  ds_read_b128 v[68:71], v5 offset:5120
  v_cvt_pk_bf16_f32 v16, v16, v17
  v_cvt_pk_bf16_f32 v17, v18, v19
  v_and_or_b32 v16, v16, s86, v45
  buffer_store_dwordx2 v[16:17], v9, s[44:47], s85 offen offset:0
  s_waitcnt lgkmcnt(4)
  v_smfmac_f32_16x16x64_bf16 v[20:23], v[72:75], v[48:55], v4
  ds_read_b128 v[48:51], v5 offset:40960
  ds_read_b128 v[52:55], v5 offset:41984
  s_waitcnt lgkmcnt(4)
  v_smfmac_f32_16x16x64_bf16 v[20:23], v[76:79], v[56:63], v4
  ds_read_b128 v[56:59], v44 offset:4096
  ds_read_b128 v[60:63], v44 offset:5120
  s_waitcnt lgkmcnt(4)
  v_smfmac_f32_16x16x64_bf16 v[24:27], v[36:39], v[64:71], v4
  ds_read_b128 v[64:67], v44 offset:40960
  ds_read_b128 v[68:71], v44 offset:41984
  s_waitcnt lgkmcnt(4)
  v_smfmac_f32_16x16x64_bf16 v[24:27], v[40:43], v[48:55], v4
  ds_read_b128 v[48:51], v5 offset:6144
  ds_read_b128 v[52:55], v5 offset:7168
  v_cvt_pk_bf16_f32 v20, v20, v21
  v_cvt_pk_bf16_f32 v21, v22, v23
  v_and_or_b32 v20, v20, s86, v45
  buffer_store_dwordx2 v[20:21], v9, s[44:47], s85 offen offset:512
  s_waitcnt lgkmcnt(4)
  v_smfmac_f32_16x16x64_bf16 v[24:27], v[72:75], v[56:63], v4
  ds_read_b128 v[56:59], v5 offset:43008
  ds_read_b128 v[60:63], v5 offset:44032
  s_waitcnt lgkmcnt(4)
  v_smfmac_f32_16x16x64_bf16 v[24:27], v[76:79], v[64:71], v4
  ds_read_b128 v[64:67], v44 offset:6144
  ds_read_b128 v[68:71], v44 offset:7168
  s_waitcnt lgkmcnt(4)
  v_smfmac_f32_16x16x64_bf16 v[28:31], v[36:39], v[48:55], v4
  ds_read_b128 v[48:51], v44 offset:43008
  ds_read_b128 v[52:55], v44 offset:44032
  s_waitcnt lgkmcnt(4)
  v_smfmac_f32_16x16x64_bf16 v[28:31], v[40:43], v[56:63], v4
  ds_read_b128 v[56:59], v5 offset:8192
  ds_read_b128 v[60:63], v5 offset:9216
  v_cvt_pk_bf16_f32 v24, v24, v25
  v_cvt_pk_bf16_f32 v25, v26, v27
  v_and_or_b32 v24, v24, s86, v45
  buffer_store_dwordx2 v[24:25], v9, s[44:47], s85 offen offset:1024
  s_waitcnt lgkmcnt(4)
  v_smfmac_f32_16x16x64_bf16 v[28:31], v[72:75], v[64:71], v4
  ds_read_b128 v[64:67], v5 offset:45056
  ds_read_b128 v[68:71], v5 offset:46080
  s_waitcnt lgkmcnt(4)
  v_smfmac_f32_16x16x64_bf16 v[28:31], v[76:79], v[48:55], v4
  ds_read_b128 v[48:51], v44 offset:8192
  ds_read_b128 v[52:55], v44 offset:9216
  s_cmp_ge_u32 s3, 2
  s_cbranch_scc1 Lch_16f_p5e
  s_waitcnt lgkmcnt(4)
  v_smfmac_f32_16x16x64_bf16 v[32:35], v[36:39], v[56:63], v4
  ds_read_b128 v[56:59], v44 offset:45056
  ds_read_b128 v[60:63], v44 offset:46080
  s_waitcnt lgkmcnt(4)
  v_smfmac_f32_16x16x64_bf16 v[32:35], v[40:43], v[64:71], v4
  v_cvt_pk_bf16_f32 v28, v28, v29
  v_cvt_pk_bf16_f32 v29, v30, v31
  v_and_or_b32 v28, v28, s86, v45
  buffer_store_dwordx2 v[28:29], v9, s[44:47], s85 offen offset:1536
  s_waitcnt lgkmcnt(2)
  v_smfmac_f32_16x16x64_bf16 v[32:35], v[72:75], v[48:55], v4
  s_waitcnt lgkmcnt(0)
  v_smfmac_f32_16x16x64_bf16 v[32:35], v[76:79], v[56:63], v4
  s_nop 6
  v_cvt_pk_bf16_f32 v32, v32, v33
  v_cvt_pk_bf16_f32 v33, v34, v35
  v_and_or_b32 v32, v32, s86, v45
  buffer_store_dwordx2 v[32:33], v9, s[44:47], s85 offen offset:2048
  s_branch Lch_16f_p5e_j
Lch_16f_p5e:
  s_waitcnt lgkmcnt(0)
  s_nop 5
  v_cvt_pk_bf16_f32 v28, v28, v29
  v_cvt_pk_bf16_f32 v29, v30, v31
  v_and_or_b32 v28, v28, s86, v45
  buffer_store_dwordx2 v[28:29], v9, s[44:47], s85 offen offset:1536
Lch_16f_p5e_j:
  s_cmp_eq_u32 s6, 0
  s_cbranch_scc1 Lch_16f_nr2
  buffer_load_dwordx2 v[28:29], v10, s[44:47], s24 offen sc1
  buffer_load_dwordx2 v[30:31], v10, s[44:47], s25 offen sc1
  buffer_load_dwordx2 v[32:33], v10, s[44:47], s26 offen sc1
  buffer_load_dwordx2 v[34:35], v10, s[44:47], s27 offen sc1
  buffer_load_dwordx2 v[36:37], v10, s[44:47], s28 offen sc1
  buffer_load_dwordx2 v[38:39], v10, s[44:47], s29 offen sc1
  buffer_load_dwordx2 v[40:41], v10, s[44:47], s30 offen sc1
  buffer_load_dwordx2 v[42:43], v10, s[44:47], s31 offen sc1
  v_add_u32 v56, 162432, v9
  ds_read_b64 v[48:49], v56
  ds_read_b64 v[50:51], v56
  v_mov_b64 v[16:17], 0
  v_mov_b64 v[18:19], 0
  v_mov_b64 v[20:21], 0
  v_mov_b64 v[22:23], 0
  v_mov_b64 v[24:25], 0
  v_mov_b64 v[26:27], 0
  s_add_u32 s20, s7, 1
  s_and_b32 s21, s20, 3
  s_mul_i32 s21, s21, 9216
  s_mul_i32 s23, s20, 9216
  v_mov_b64 v[58:59], -1
  s_mov_b32 s22, 0
  s_branch Lch_16f_rl_c
Lch_16f_rl:
  buffer_load_dwordx2 v[28:29], v10, s[44:47], s24 offen sc1
  buffer_load_dwordx2 v[30:31], v10, s[44:47], s25 offen sc1
  buffer_load_dwordx2 v[32:33], v10, s[44:47], s26 offen sc1
  buffer_load_dwordx2 v[34:35], v10, s[44:47], s27 offen sc1
  buffer_load_dwordx2 v[36:37], v10, s[44:47], s28 offen sc1
  buffer_load_dwordx2 v[38:39], v10, s[44:47], s29 offen sc1
  buffer_load_dwordx2 v[40:41], v10, s[44:47], s30 offen sc1
  buffer_load_dwordx2 v[42:43], v10, s[44:47], s31 offen sc1
Lch_16f_rl_c:
  s_add_u32 s22, s22, 1
  s_waitcnt vmcnt(0) lgkmcnt(0)
  v_mfma_f32_16x16x32_bf16 v[52:55], v[28:31], v[48:51], 0
  v_mfma_f32_16x16x32_bf16 v[52:55], v[32:35], v[48:51], v[52:55]
  v_mfma_f32_16x16x32_bf16 v[52:55], v[36:39], v[48:51], v[52:55]
  v_mfma_f32_16x16x32_bf16 v[52:55], v[40:43], v[48:51], v[52:55]
  v_xor_b32 v56, v28, v45
  v_bitop3_b32 v56, v56, v30, v45 bitop3:0xf6
  v_bitop3_b32 v56, v56, v32, v45 bitop3:0xf6
  v_bitop3_b32 v56, v56, v34, v45 bitop3:0xf6
  v_bitop3_b32 v56, v56, v36, v45 bitop3:0xf6
  v_bitop3_b32 v56, v56, v38, v45 bitop3:0xf6
  v_bitop3_b32 v56, v56, v40, v45 bitop3:0xf6
  v_bitop3_b32 v56, v56, v42, v45 bitop3:0xf6
  v_and_b32 v56, 1, v56
  v_cmp_ne_u32 vcc, 0, v56
  s_cmp_gt_u32 s22, 20000
  s_cbranch_scc1 Lch_16f_rok
  s_cbranch_vccnz Lch_16f_rl
Lch_16f_rok:
  v_cvt_pk_bf16_f32 v52, v52, v53
  v_cvt_pk_bf16_f32 v53, v54, v55
  buffer_store_dwordx2 v[52:53], v12, s[48:51], s21 offen
  buffer_store_dwordx2 v[58:59], v12, s[48:51], s18 offen
  s_branch Lch_16f_nored
Lch_16f_nr2:
  v_mov_b64 v[16:17], 0
  v_mov_b64 v[18:19], 0
  v_mov_b64 v[20:21], 0
  v_mov_b64 v[22:23], 0
  v_mov_b64 v[24:25], 0
  v_mov_b64 v[26:27], 0
Lch_16f_nored:
  s_add_u32 s7, s7, 1
  s_xor_b32 s11, s11, 1
  s_and_b32 s18, s7, 3
  s_mul_i32 s18, s18, 9216
  s_add_u32 s23, s18, 4096
  s_add_u32 s19, s18, 5120
  v_mov_b64 v[36:37], 0
  v_mov_b64 v[38:39], 0
  s_barrier
  s_branch Lch_16f_step
Lch_16f_end:
  s_waitcnt vmcnt(0)
  s_barrier
  s_cmp_lg_u32 s3, 3
  s_cbranch_scc1 Lch_16f_pubend
  s_mov_b32 s20, 13184
  v_mov_b32 v76, 1
  s_mov_b64 exec, 1
  buffer_atomic_add v76, off, s[52:55], s20
  s_mov_b64 exec, -1
Lch_16f_pubend:
  s_branch Lmg_worker_2
Lch_16_generic:
  s_mov_b32 s7, 0
  s_lshl_b32 s8, s4, 13
  s_lshl_b32 s9, s4, 13
  s_lshl_b32 s10, s4, 11
  s_mov_b32 s11, 1
  s_mov_b32 s86, 0xfffffffe
  s_mov_b32 s80, 0x3e0293ee
  s_mov_b32 s81, 0x3e0293ee
  s_mov_b32 s18, 0
  s_mov_b32 s24, 0
  s_mov_b32 s25, 36864
  s_mov_b32 s26, 73728
  s_mov_b32 s27, 110592
  s_mov_b32 s28, 147456
  s_mov_b32 s29, 184320
  s_mov_b32 s30, 221184
  s_mov_b32 s31, 258048
  v_mov_b64 v[16:17], 0
  v_mov_b64 v[18:19], 0
  v_mov_b64 v[20:21], 0
  v_mov_b64 v[22:23], 0
  v_mov_b64 v[24:25], 0
  v_mov_b64 v[26:27], 0
  s_mov_b32 s20, 9216
  s_mov_b32 s22, 0
Lch_16g_kv0:
  buffer_load_dword v79, off, s[52:55], s20 sc1
  s_waitcnt vmcnt(0)
  v_readfirstlane_b32 s23, v79
  s_add_u32 s22, s22, 1
  s_cmp_gt_u32 s22, 1000000
  s_cbranch_scc1 Lch_16g_kv0_x
  s_cmp_ge_u32 s23, 32
  s_cbranch_scc1 Lch_16g_kv0_x
  s_sleep 2
  s_branch Lch_16g_kv0
Lch_16g_kv0_x:
  v_mov_b32 v0, 32
  s_barrier
  s_mov_b32 s23, 4096
  s_mov_b32 s19, 5120
  v_mov_b64 v[36:37], 0
  v_mov_b64 v[38:39], 0
Lch_16g_step:
  s_mov_b32 s22, 0
Lch_16g_ml:
  buffer_load_dwordx4 v[28:31], v11, s[48:51], s18 offen sc1
  buffer_load_dwordx4 v[32:35], v11, s[48:51], s23 offen sc1
  s_cmp_lg_u32 s3, 3
  s_cbranch_scc1 Lch_16g_m2
  buffer_load_dwordx4 v[36:39], v11, s[48:51], s19 offen sc1
Lch_16g_m2:
  s_add_u32 s22, s22, 1
  v_add_u32 v71, 147456, v11
  s_waitcnt vmcnt(0)
  v_max3_u32 v69, v28, v30, v32
  v_max3_u32 v70, v34, v36, v38
  v_max_u32 v69, v69, v70
  v_cmp_eq_u32 vcc, -1, v69
  s_cmp_gt_u32 s22, 40000
  s_cbranch_scc1 Lch_16g_mok
  s_cbranch_vccnz Lch_16g_ml
Lch_16g_mok:
  ds_write_b128 v71, v[28:31]
  ds_write_b128 v71, v[32:35] offset:4096
  s_cmp_lg_u32 s3, 3
  s_cbranch_scc1 Lch_16g_m3
  ds_write_b128 v71, v[36:39] offset:5120
Lch_16g_m3:
  s_waitcnt lgkmcnt(0)
  s_barrier
  ds_read_b128 v[28:31], v1 offset:0
  ds_read_b128 v[32:35], v1 offset:512
  ds_read_b128 v[36:39], v1 offset:1024
  ds_read_b128 v[40:43], v1 offset:1536
  s_waitcnt lgkmcnt(3)
  v_smfmac_f32_16x16x64_bf16 v[16:19], v[28:31], a[0:7], v4
  buffer_load_dwordx4 v[44:47], v6, s[56:59], s8 offen offset:0
  v_smfmac_f32_16x16x64_bf16 v[20:23], v[28:31], a[144:151], v4
  v_smfmac_f32_16x16x64_bf16 v[24:27], v[28:31], v[112:119], v4
  ds_read_b128 v[28:31], v1 offset:2048
  s_waitcnt lgkmcnt(3)
  v_smfmac_f32_16x16x64_bf16 v[16:19], v[32:35], a[8:15], v4
  buffer_load_dwordx4 v[48:51], v6, s[56:59], s8 offen offset:1024
  v_smfmac_f32_16x16x64_bf16 v[20:23], v[32:35], a[152:159], v4
  v_smfmac_f32_16x16x64_bf16 v[24:27], v[32:35], v[120:127], v4
  ds_read_b128 v[32:35], v1 offset:2560
  s_waitcnt lgkmcnt(3)
  v_smfmac_f32_16x16x64_bf16 v[16:19], v[36:39], a[16:23], v4
  buffer_load_dwordx4 v[52:55], v6, s[56:59], s8 offen offset:2048
  v_smfmac_f32_16x16x64_bf16 v[20:23], v[36:39], a[160:167], v4
  v_smfmac_f32_16x16x64_bf16 v[24:27], v[36:39], v[128:135], v4
  ds_read_b128 v[36:39], v1 offset:3072
  s_waitcnt lgkmcnt(3)
  v_smfmac_f32_16x16x64_bf16 v[16:19], v[40:43], a[24:31], v4
  buffer_load_dwordx4 v[56:59], v6, s[56:59], s8 offen offset:3072
  v_smfmac_f32_16x16x64_bf16 v[20:23], v[40:43], a[168:175], v4
  v_smfmac_f32_16x16x64_bf16 v[24:27], v[40:43], v[136:143], v4
  ds_read_b128 v[40:43], v1 offset:3584
  s_waitcnt lgkmcnt(3)
  v_smfmac_f32_16x16x64_bf16 v[16:19], v[28:31], a[32:39], v4
  buffer_load_dwordx4 v[60:63], v7, s[60:63], s9 offen
  v_smfmac_f32_16x16x64_bf16 v[20:23], v[28:31], a[176:183], v4
  v_smfmac_f32_16x16x64_bf16 v[24:27], v[28:31], v[144:151], v4
  ds_read_b128 v[28:31], v1 offset:4096
  s_waitcnt lgkmcnt(3)
  v_smfmac_f32_16x16x64_bf16 v[16:19], v[32:35], a[40:47], v4
  buffer_load_dwordx4 v[64:67], v7, s[60:63], s9 offen offset:1024
  v_smfmac_f32_16x16x64_bf16 v[20:23], v[32:35], a[184:191], v4
  v_smfmac_f32_16x16x64_bf16 v[24:27], v[32:35], v[152:159], v4
  ds_read_b128 v[32:35], v1 offset:4608
  s_waitcnt lgkmcnt(3)
  v_smfmac_f32_16x16x64_bf16 v[16:19], v[36:39], a[48:55], v4
  v_smfmac_f32_16x16x64_bf16 v[20:23], v[36:39], a[192:199], v4
  v_smfmac_f32_16x16x64_bf16 v[24:27], v[36:39], v[160:167], v4
  ds_read_b128 v[36:39], v1 offset:5120
  s_waitcnt lgkmcnt(3)
  v_smfmac_f32_16x16x64_bf16 v[16:19], v[40:43], a[56:63], v4
  v_smfmac_f32_16x16x64_bf16 v[20:23], v[40:43], a[200:207], v4
  v_smfmac_f32_16x16x64_bf16 v[24:27], v[40:43], v[168:175], v4
  ds_read_b128 v[40:43], v1 offset:5632
  s_waitcnt lgkmcnt(3)
  v_smfmac_f32_16x16x64_bf16 v[16:19], v[28:31], a[64:71], v4
  v_smfmac_f32_16x16x64_bf16 v[20:23], v[28:31], a[208:215], v4
  v_smfmac_f32_16x16x64_bf16 v[24:27], v[28:31], v[176:183], v4
  ds_read_b128 v[28:31], v1 offset:6144
  s_waitcnt lgkmcnt(3)
  v_smfmac_f32_16x16x64_bf16 v[16:19], v[32:35], a[72:79], v4
  v_smfmac_f32_16x16x64_bf16 v[20:23], v[32:35], a[216:223], v4
  v_smfmac_f32_16x16x64_bf16 v[24:27], v[32:35], v[184:191], v4
  ds_read_b128 v[32:35], v1 offset:6656
  s_waitcnt lgkmcnt(3)
  v_smfmac_f32_16x16x64_bf16 v[16:19], v[36:39], a[80:87], v4
  v_smfmac_f32_16x16x64_bf16 v[20:23], v[36:39], a[224:231], v4
  v_smfmac_f32_16x16x64_bf16 v[24:27], v[36:39], v[192:199], v4
  ds_read_b128 v[36:39], v1 offset:7168
  s_waitcnt lgkmcnt(3)
  v_smfmac_f32_16x16x64_bf16 v[16:19], v[40:43], a[88:95], v4
  v_smfmac_f32_16x16x64_bf16 v[20:23], v[40:43], a[232:239], v4
  v_smfmac_f32_16x16x64_bf16 v[24:27], v[40:43], v[200:207], v4
  ds_read_b128 v[40:43], v1 offset:7680
  s_waitcnt lgkmcnt(3)
  v_smfmac_f32_16x16x64_bf16 v[16:19], v[28:31], a[96:103], v4
  v_smfmac_f32_16x16x64_bf16 v[20:23], v[28:31], a[240:247], v4
  v_smfmac_f32_16x16x64_bf16 v[24:27], v[28:31], v[208:215], v4
  ds_read_b128 v[28:31], v1 offset:8192
  s_waitcnt lgkmcnt(3)
  v_smfmac_f32_16x16x64_bf16 v[16:19], v[32:35], a[104:111], v4
  v_smfmac_f32_16x16x64_bf16 v[20:23], v[32:35], a[248:255], v4
  v_smfmac_f32_16x16x64_bf16 v[24:27], v[32:35], v[216:223], v4
  ds_read_b128 v[32:35], v1 offset:8704
  s_waitcnt lgkmcnt(3)
  v_smfmac_f32_16x16x64_bf16 v[16:19], v[36:39], a[112:119], v4
  v_smfmac_f32_16x16x64_bf16 v[20:23], v[36:39], v[80:87], v4
  v_smfmac_f32_16x16x64_bf16 v[24:27], v[36:39], v[224:231], v4
  s_waitcnt lgkmcnt(2)
  v_smfmac_f32_16x16x64_bf16 v[16:19], v[40:43], a[120:127], v4
  v_smfmac_f32_16x16x64_bf16 v[20:23], v[40:43], v[88:95], v4
  v_smfmac_f32_16x16x64_bf16 v[24:27], v[40:43], v[232:239], v4
  s_waitcnt lgkmcnt(1)
  v_smfmac_f32_16x16x64_bf16 v[16:19], v[28:31], a[128:135], v4
  v_smfmac_f32_16x16x64_bf16 v[20:23], v[28:31], v[96:103], v4
  v_smfmac_f32_16x16x64_bf16 v[24:27], v[28:31], v[240:247], v4
  s_waitcnt lgkmcnt(0)
  v_smfmac_f32_16x16x64_bf16 v[16:19], v[32:35], a[136:143], v4
  v_smfmac_f32_16x16x64_bf16 v[20:23], v[32:35], v[104:111], v4
  v_smfmac_f32_16x16x64_bf16 v[24:27], v[32:35], v[248:255], v4
  s_waitcnt vmcnt(0)
  v_swap_b32 v61, v64
  v_swap_b32 v62, v64
  v_swap_b32 v63, v65
  v_swap_b32 v65, v66
  v_cvt_pk_bf16_f32 v76, v16, v17
  v_cvt_pk_bf16_f32 v77, v18, v19
  ds_write_b64 v3, v[76:77]
  v_cvt_pk_bf16_f32 v78, v20, v21
  v_cvt_pk_bf16_f32 v79, v22, v23
  ds_write_b64 v3, v[78:79] offset:2048
  v_cvt_pk_bf16_f32 v68, v24, v25
  v_cvt_pk_bf16_f32 v69, v26, v27
  v_mov_b64 v[70:71], 0
  v_mov_b64 v[74:75], 0
  v_permlane32_swap_b32 v68, v69
  s_waitcnt lgkmcnt(0)
  s_barrier
  s_cmp_eq_u32 s3, 2
  s_cbranch_scc1 Lch_16g_rm
  s_cmp_eq_u32 s3, 3
  s_cbranch_scc1 Lch_16g_ra
  ds_read_b64_tr_b16 v[28:29], v2 offset:0
  ds_read_b64_tr_b16 v[30:31], v2 offset:64
  ds_read_b64_tr_b16 v[32:33], v2 offset:512
  ds_read_b64_tr_b16 v[34:35], v2 offset:576
  ds_read_b64_tr_b16 v[36:37], v2 offset:1024
  ds_read_b64_tr_b16 v[38:39], v2 offset:1088
  ds_read_b64_tr_b16 v[40:41], v2 offset:1536
  ds_read_b64_tr_b16 v[42:43], v2 offset:1600
  buffer_store_dword v68, v8, s[68:71], s10 offen sc1
  buffer_store_dword v69, v8, s[68:71], s10 offen offset:256 sc1
  v_mov_b64 v[72:73], v[68:69]
  v_mov_b64 v[16:17], 0
  v_mov_b64 v[18:19], 0
  v_mov_b64 v[20:21], 0
  v_mov_b64 v[22:23], 0
  v_mov_b64 v[24:25], 0
  v_mov_b64 v[26:27], 0
  s_waitcnt lgkmcnt(0)
  v_mfma_f32_16x16x32_bf16 v[76:79], v[44:47], v[28:31], 0
  v_mfma_f32_16x16x32_bf16 v[76:79], v[48:51], v[32:35], v[76:79]
  v_mfma_f32_16x16x32_bf16 v[76:79], v[52:55], v[36:39], v[76:79]
  v_mfma_f32_16x16x32_bf16 v[76:79], v[56:59], v[40:43], v[76:79]
  s_nop 6
  s_nop 0
  v_pk_mul_f32 v[76:77], v[76:77], s[80:81]
  v_pk_mul_f32 v[78:79], v[78:79], s[80:81]
  ds_write_b128 v13, v[76:79]
  v_mov_b64 v[36:37], 0
  v_mov_b64 v[38:39], 0
  s_waitcnt lgkmcnt(0)
  s_branch Lch_16g_p3j
Lch_16g_rm:
  ds_read_b64_tr_b16 v[28:29], v2 offset:0
  ds_read_b64_tr_b16 v[30:31], v2 offset:64
  ds_read_b64_tr_b16 v[32:33], v2 offset:512
  ds_read_b64_tr_b16 v[34:35], v2 offset:576
  ds_read_b64_tr_b16 v[36:37], v2 offset:1024
  ds_read_b64_tr_b16 v[38:39], v2 offset:1088
  ds_read_b64_tr_b16 v[40:41], v2 offset:1536
  ds_read_b64_tr_b16 v[42:43], v2 offset:1600
  ds_read_b64_tr_b16 v[44:45], v2 offset:2048
  ds_read_b64_tr_b16 v[46:47], v2 offset:2112
  ds_read_b64_tr_b16 v[48:49], v2 offset:2560
  ds_read_b64_tr_b16 v[50:51], v2 offset:2624
  ds_read_b64_tr_b16 v[52:53], v2 offset:3072
  ds_read_b64_tr_b16 v[54:55], v2 offset:3136
  ds_read_b64_tr_b16 v[56:57], v2 offset:3584
  ds_read_b64_tr_b16 v[58:59], v2 offset:3648
  buffer_store_dword v68, v8, s[68:71], s10 offen sc1
  buffer_store_dword v69, v8, s[68:71], s10 offen offset:256 sc1
  v_mov_b64 v[72:73], v[68:69]
  v_mov_b64 v[16:17], 0
  v_mov_b64 v[18:19], 0
  v_mov_b64 v[20:21], 0
  v_mov_b64 v[22:23], 0
  v_mov_b64 v[24:25], 0
  v_mov_b64 v[26:27], 0
  s_waitcnt lgkmcnt(0)
  v_mfma_f32_16x16x32_bf16 v[76:79], v[44:47], v[28:31], 0
  v_mfma_f32_16x16x32_bf16 v[76:79], v[48:51], v[32:35], v[76:79]
  v_mfma_f32_16x16x32_bf16 v[76:79], v[52:55], v[36:39], v[76:79]
  v_mfma_f32_16x16x32_bf16 v[76:79], v[56:59], v[40:43], v[76:79]
  s_nop 6
  s_nop 0
  v_pk_mul_f32 v[76:77], v[76:77], s[80:81]
  v_pk_mul_f32 v[78:79], v[78:79], s[80:81]
  ds_write2_b64 v13, v[76:77], v[78:79] offset0:0 offset1:50
  v_mov_b64 v[36:37], 0
  v_mov_b64 v[38:39], 0
  s_waitcnt lgkmcnt(0)
  s_branch Lch_16g_p3j
Lch_16g_ra:
  ds_read_b64_tr_b16 v[44:45], v2 offset:2048
  ds_read_b64_tr_b16 v[46:47], v2 offset:2112
  ds_read_b64_tr_b16 v[48:49], v2 offset:2560
  ds_read_b64_tr_b16 v[50:51], v2 offset:2624
  ds_read_b64_tr_b16 v[52:53], v2 offset:3072
  ds_read_b64_tr_b16 v[54:55], v2 offset:3136
  ds_read_b64_tr_b16 v[56:57], v2 offset:3584
  ds_read_b64_tr_b16 v[58:59], v2 offset:3648
  buffer_store_dword v68, v8, s[68:71], s10 offen sc1
  buffer_store_dword v69, v8, s[68:71], s10 offen offset:256 sc1
  v_mov_b64 v[72:73], v[68:69]
  v_mov_b64 v[16:17], 0
  v_mov_b64 v[18:19], 0
  v_mov_b64 v[20:21], 0
  v_mov_b64 v[22:23], 0
  v_mov_b64 v[24:25], 0
  v_mov_b64 v[26:27], 0
  s_and_b32 s20, s7, 3
  s_cmp_lg_u32 s20, 0
  s_cbranch_scc1 Lch_16g_nopub_20
  s_cmp_lg_u32 s3, 3
  s_cbranch_scc1 Lch_16g_nopub_20
  s_cmp_eq_u32 s7, 0
  s_cbranch_scc1 Lch_16g_nopub_20
  s_lshl_b32 s20, s7, 5
  s_add_u32 s20, s20, 11136
  v_mov_b32 v79, 1
  s_mov_b64 exec, 1
  buffer_atomic_add v79, off, s[52:55], s20
  s_mov_b64 exec, -1
Lch_16g_nopub_20:
  v_lshlrev_b32 v76, 4, v9
  v_mov_b32 v77, v76
  v_readfirstlane_b32 s20, v0
  s_cmp_ge_u32 s20, 32
  s_cbranch_scc1 Lch_16g_kvok_21
  s_add_u32 s21, s7, 2
  s_lshr_b32 s20, s21, 3
  s_min_u32 s20, s20, 7
  s_lshl_b32 s20, s20, 7
  s_add_u32 s20, s20, 9216
  s_mov_b32 s22, 0
Lch_16g_kvw_22:
  buffer_load_dword v79, off, s[52:55], s20 sc1
  s_waitcnt vmcnt(0)
  v_readfirstlane_b32 s23, v79
  s_add_u32 s22, s22, 1
  s_cmp_gt_u32 s22, 1000000
  s_cbranch_scc1 Lch_16g_kvw_22_x
  s_cmp_ge_u32 s23, 32
  s_cbranch_scc1 Lch_16g_kvw_22_x
  s_sleep 2
  s_branch Lch_16g_kvw_22
Lch_16g_kvw_22_x:
Lch_16g_kvok_21:
  s_add_u32 s20, s8, 524288
  s_add_u32 s21, s9, 524288
  buffer_load_dword v0, v77, s[56:59], s20 offen
  buffer_load_dword v0, v76, s[60:63], s21 offen
  s_add_u32 s20, s7, 3
  s_lshr_b32 s20, s20, 3
  s_min_u32 s20, s20, 7
  s_lshl_b32 s20, s20, 7
  s_add_u32 s20, s20, 9216
  buffer_load_dword v0, off, s[52:55], s20 sc1
  s_waitcnt lgkmcnt(0)
  buffer_store_dwordx4 v[44:47], v6, s[64:67], s10 offen offset:0 sc1
  buffer_store_dwordx4 v[48:51], v6, s[64:67], s10 offen offset:512 sc1
  buffer_store_dwordx4 v[52:55], v6, s[64:67], s10 offen offset:1024 sc1
  buffer_store_dwordx4 v[56:59], v6, s[64:67], s10 offen offset:1536 sc1
  v_mov_b64 v[36:37], 0
  v_mov_b64 v[38:39], 0
  s_waitcnt lgkmcnt(0)
Lch_16g_p3j:
  s_barrier
  s_cmp_eq_u32 s7, 63
  s_cbranch_scc1 Lch_16g_end
  ds_read_b128 v[48:51], v14
  ds_read_b128 v[52:55], v14 offset:16
  ds_read_b64 v[56:57], v14 offset:32
  v_add_u32 v44, 73728, v5
  v_mov_b32 v45, s11
  s_add_u32 s8, s8, 262144
  s_add_u32 s9, s9, 262144
  s_waitcnt lgkmcnt(0)
  v_max3_f32 v76, v48, v49, v50
  v_max3_f32 v77, v51, v52, v53
  v_max3_f32 v76, v76, v54, v55
  v_max3_f32 v77, v77, v56, v57
  v_max_f32 v76, v76, v77
  v_mov_b32 v77, v76
  s_add_u32 s10, s10, 65536
  v_mov_b64 v[28:29], 0
  v_permlane16_swap_b32 v76, v77
  v_mov_b64 v[30:31], 0
  v_max_f32 v76, v76, v77
  v_mov_b32 v77, v76
  v_mov_b64 v[32:33], 0
  v_mov_b64 v[34:35], 0
  v_permlane32_swap_b32 v76, v77
  s_nop 0
  v_max_f32 v76, v76, v77
  v_mov_b32 v77, v76
  v_pk_add_f32 v[48:49], v[48:49], v[76:77] neg_lo:[0,1] neg_hi:[0,1]
  v_pk_add_f32 v[50:51], v[50:51], v[76:77] neg_lo:[0,1] neg_hi:[0,1]
  v_pk_add_f32 v[52:53], v[52:53], v[76:77] neg_lo:[0,1] neg_hi:[0,1]
  v_pk_add_f32 v[54:55], v[54:55], v[76:77] neg_lo:[0,1] neg_hi:[0,1]
  v_pk_add_f32 v[56:57], v[56:57], v[76:77] neg_lo:[0,1] neg_hi:[0,1]
  v_exp_f32 v48, v48
  v_exp_f32 v49, v49
  v_exp_f32 v50, v50
  v_exp_f32 v51, v51
  v_exp_f32 v52, v52
  v_exp_f32 v53, v53
  v_exp_f32 v54, v54
  v_exp_f32 v55, v55
  v_exp_f32 v56, v56
  v_exp_f32 v57, v57
  s_nop 0
  v_pk_add_f32 v[76:77], v[48:49], v[50:51]
  v_pk_add_f32 v[78:79], v[52:53], v[54:55]
  v_pk_add_f32 v[76:77], v[76:77], v[56:57]
  v_pk_add_f32 v[76:77], v[76:77], v[78:79]
  v_add_f32 v76, v76, v77
  v_mov_b32 v77, v76
  s_nop 1
  v_permlane16_swap_b32 v76, v77
  s_nop 0
  v_add_f32 v76, v76, v77
  v_mov_b32 v77, v76
  s_nop 1
  v_permlane32_swap_b32 v76, v77
  s_nop 0
  v_add_f32 v76, v76, v77
  v_rcp_f32 v76, v76
  s_nop 0
  v_mov_b32 v77, v76
  v_pk_mul_f32 v[48:49], v[48:49], v[76:77]
  v_pk_mul_f32 v[50:51], v[50:51], v[76:77]
  v_pk_mul_f32 v[52:53], v[52:53], v[76:77]
  v_pk_mul_f32 v[54:55], v[54:55], v[76:77]
  v_pk_mul_f32 v[56:57], v[56:57], v[76:77]
  v_cvt_pk_bf16_f32 v78, v56, v57
  v_cvt_pk_bf16_f32 v40, v48, v49
  v_cvt_pk_bf16_f32 v41, v50, v51
  v_cvt_pk_bf16_f32 v42, v52, v53
  v_cvt_pk_bf16_f32 v43, v54, v55
  v_and_b32 v76, v15, v78
  v_mov_b32 v77, 0
  v_xor_b32 v78, v76, v78
  v_mov_b32 v79, 0
  s_nop 0
  v_smfmac_f32_16x16x64_bf16 v[36:39], v[40:43], v[60:67], v4
  v_smfmac_f32_16x16x64_bf16 v[36:39], v[76:79], v[68:75], v4
  ds_read_b128 v[48:51], v5 offset:0
  ds_read_b128 v[52:55], v5 offset:1024
  s_nop 5
  v_cvt_pk_bf16_f32 v58, v36, v37
  v_cvt_pk_bf16_f32 v59, v38, v39
  ds_write_b64 v3, v[58:59] offset:0
  ds_read_b128 v[64:67], v44 offset:0
  ds_read_b128 v[68:71], v44 offset:1024
  s_waitcnt lgkmcnt(2)
  s_barrier
  ds_read_b64_tr_b16 v[36:37], v2 offset:0
  ds_read_b64_tr_b16 v[38:39], v2 offset:64
  ds_read_b128 v[56:59], v5 offset:36864
  ds_read_b128 v[60:63], v5 offset:37888
  ds_read_b64_tr_b16 v[40:41], v2 offset:512
  ds_read_b64_tr_b16 v[42:43], v2 offset:576
  ds_read_b64_tr_b16 v[72:73], v2 offset:1024
  ds_read_b64_tr_b16 v[74:75], v2 offset:1088
  ds_read_b64_tr_b16 v[76:77], v2 offset:1536
  ds_read_b64_tr_b16 v[78:79], v2 offset:1600
  s_waitcnt lgkmcnt(8)
  v_smfmac_f32_16x16x64_bf16 v[16:19], v[36:39], v[48:55], v4
  ds_read_b128 v[48:51], v44 offset:36864
  ds_read_b128 v[52:55], v44 offset:37888
  s_waitcnt lgkmcnt(6)
  v_smfmac_f32_16x16x64_bf16 v[16:19], v[40:43], v[56:63], v4
  ds_read_b128 v[56:59], v5 offset:2048
  ds_read_b128 v[60:63], v5 offset:3072
  s_waitcnt lgkmcnt(6)
  v_smfmac_f32_16x16x64_bf16 v[16:19], v[72:75], v[64:71], v4
  ds_read_b128 v[64:67], v5 offset:38912
  ds_read_b128 v[68:71], v5 offset:39936
  s_waitcnt lgkmcnt(6)
  s_waitcnt lgkmcnt(4)
  v_smfmac_f32_16x16x64_bf16 v[16:19], v[76:79], v[48:55], v4
  ds_read_b128 v[48:51], v44 offset:2048
  ds_read_b128 v[52:55], v44 offset:3072
  s_waitcnt lgkmcnt(4)
  v_smfmac_f32_16x16x64_bf16 v[20:23], v[36:39], v[56:63], v4
  ds_read_b128 v[56:59], v44 offset:38912
  ds_read_b128 v[60:63], v44 offset:39936
  s_waitcnt lgkmcnt(4)
  v_smfmac_f32_16x16x64_bf16 v[20:23], v[40:43], v[64:71], v4
  ds_read_b128 v[64:67], v5 offset:4096
  ds_read_b128 v[68:71], v5 offset:5120
  v_cvt_pk_bf16_f32 v16, v16, v17
  v_cvt_pk_bf16_f32 v17, v18, v19
  v_and_or_b32 v16, v16, s86, v45
  buffer_store_dwordx2 v[16:17], v9, s[44:47], s85 offen offset:0 sc1
  s_waitcnt lgkmcnt(4)
  v_smfmac_f32_16x16x64_bf16 v[20:23], v[72:75], v[48:55], v4
  ds_read_b128 v[48:51], v5 offset:40960
  ds_read_b128 v[52:55], v5 offset:41984
  s_waitcnt lgkmcnt(4)
  v_smfmac_f32_16x16x64_bf16 v[20:23], v[76:79], v[56:63], v4
  ds_read_b128 v[56:59], v44 offset:4096
  ds_read_b128 v[60:63], v44 offset:5120
  s_waitcnt lgkmcnt(4)
  v_smfmac_f32_16x16x64_bf16 v[24:27], v[36:39], v[64:71], v4
  ds_read_b128 v[64:67], v44 offset:40960
  ds_read_b128 v[68:71], v44 offset:41984
  s_waitcnt lgkmcnt(4)
  v_smfmac_f32_16x16x64_bf16 v[24:27], v[40:43], v[48:55], v4
  ds_read_b128 v[48:51], v5 offset:6144
  ds_read_b128 v[52:55], v5 offset:7168
  v_cvt_pk_bf16_f32 v20, v20, v21
  v_cvt_pk_bf16_f32 v21, v22, v23
  v_and_or_b32 v20, v20, s86, v45
  buffer_store_dwordx2 v[20:21], v9, s[44:47], s85 offen offset:512 sc1
  s_waitcnt lgkmcnt(4)
  v_smfmac_f32_16x16x64_bf16 v[24:27], v[72:75], v[56:63], v4
  ds_read_b128 v[56:59], v5 offset:43008
  ds_read_b128 v[60:63], v5 offset:44032
  s_waitcnt lgkmcnt(4)
  v_smfmac_f32_16x16x64_bf16 v[24:27], v[76:79], v[64:71], v4
  ds_read_b128 v[64:67], v44 offset:6144
  ds_read_b128 v[68:71], v44 offset:7168
  s_waitcnt lgkmcnt(4)
  v_smfmac_f32_16x16x64_bf16 v[28:31], v[36:39], v[48:55], v4
  ds_read_b128 v[48:51], v44 offset:43008
  ds_read_b128 v[52:55], v44 offset:44032
  s_waitcnt lgkmcnt(4)
  v_smfmac_f32_16x16x64_bf16 v[28:31], v[40:43], v[56:63], v4
  ds_read_b128 v[56:59], v5 offset:8192
  ds_read_b128 v[60:63], v5 offset:9216
  v_cvt_pk_bf16_f32 v24, v24, v25
  v_cvt_pk_bf16_f32 v25, v26, v27
  v_and_or_b32 v24, v24, s86, v45
  buffer_store_dwordx2 v[24:25], v9, s[44:47], s85 offen offset:1024 sc1
  s_waitcnt lgkmcnt(4)
  v_smfmac_f32_16x16x64_bf16 v[28:31], v[72:75], v[64:71], v4
  ds_read_b128 v[64:67], v5 offset:45056
  ds_read_b128 v[68:71], v5 offset:46080
  s_waitcnt lgkmcnt(4)
  v_smfmac_f32_16x16x64_bf16 v[28:31], v[76:79], v[48:55], v4
  ds_read_b128 v[48:51], v44 offset:8192
  ds_read_b128 v[52:55], v44 offset:9216
  s_cmp_ge_u32 s3, 2
  s_cbranch_scc1 Lch_16g_p5e
  s_waitcnt lgkmcnt(4)
  v_smfmac_f32_16x16x64_bf16 v[32:35], v[36:39], v[56:63], v4
  ds_read_b128 v[56:59], v44 offset:45056
  ds_read_b128 v[60:63], v44 offset:46080
  s_waitcnt lgkmcnt(4)
  v_smfmac_f32_16x16x64_bf16 v[32:35], v[40:43], v[64:71], v4
  v_cvt_pk_bf16_f32 v28, v28, v29
  v_cvt_pk_bf16_f32 v29, v30, v31
  v_and_or_b32 v28, v28, s86, v45
  buffer_store_dwordx2 v[28:29], v9, s[44:47], s85 offen offset:1536 sc1
  s_waitcnt lgkmcnt(2)
  v_smfmac_f32_16x16x64_bf16 v[32:35], v[72:75], v[48:55], v4
  s_waitcnt lgkmcnt(0)
  v_smfmac_f32_16x16x64_bf16 v[32:35], v[76:79], v[56:63], v4
  s_nop 6
  v_cvt_pk_bf16_f32 v32, v32, v33
  v_cvt_pk_bf16_f32 v33, v34, v35
  v_and_or_b32 v32, v32, s86, v45
  buffer_store_dwordx2 v[32:33], v9, s[44:47], s85 offen offset:2048 sc1
  s_branch Lch_16g_p5e_j
Lch_16g_p5e:
  s_waitcnt lgkmcnt(0)
  s_nop 5
  v_cvt_pk_bf16_f32 v28, v28, v29
  v_cvt_pk_bf16_f32 v29, v30, v31
  v_and_or_b32 v28, v28, s86, v45
  buffer_store_dwordx2 v[28:29], v9, s[44:47], s85 offen offset:1536 sc1
Lch_16g_p5e_j:
  s_cmp_eq_u32 s6, 0
  s_cbranch_scc1 Lch_16g_nr2
  buffer_load_dwordx2 v[28:29], v10, s[44:47], s24 offen sc1
  buffer_load_dwordx2 v[30:31], v10, s[44:47], s25 offen sc1
  buffer_load_dwordx2 v[32:33], v10, s[44:47], s26 offen sc1
  buffer_load_dwordx2 v[34:35], v10, s[44:47], s27 offen sc1
  buffer_load_dwordx2 v[36:37], v10, s[44:47], s28 offen sc1
  buffer_load_dwordx2 v[38:39], v10, s[44:47], s29 offen sc1
  buffer_load_dwordx2 v[40:41], v10, s[44:47], s30 offen sc1
  buffer_load_dwordx2 v[42:43], v10, s[44:47], s31 offen sc1
  v_add_u32 v56, 162432, v9
  ds_read_b64 v[48:49], v56
  ds_read_b64 v[50:51], v56
  v_mov_b64 v[16:17], 0
  v_mov_b64 v[18:19], 0
  v_mov_b64 v[20:21], 0
  v_mov_b64 v[22:23], 0
  v_mov_b64 v[24:25], 0
  v_mov_b64 v[26:27], 0
  s_add_u32 s20, s7, 1
  s_and_b32 s21, s20, 3
  s_mul_i32 s21, s21, 9216
  s_mul_i32 s23, s20, 9216
  v_mov_b64 v[58:59], -1
  s_mov_b32 s22, 0
  s_branch Lch_16g_rl_c
Lch_16g_rl:
  buffer_load_dwordx2 v[28:29], v10, s[44:47], s24 offen sc1
  buffer_load_dwordx2 v[30:31], v10, s[44:47], s25 offen sc1
  buffer_load_dwordx2 v[32:33], v10, s[44:47], s26 offen sc1
  buffer_load_dwordx2 v[34:35], v10, s[44:47], s27 offen sc1
  buffer_load_dwordx2 v[36:37], v10, s[44:47], s28 offen sc1
  buffer_load_dwordx2 v[38:39], v10, s[44:47], s29 offen sc1
  buffer_load_dwordx2 v[40:41], v10, s[44:47], s30 offen sc1
  buffer_load_dwordx2 v[42:43], v10, s[44:47], s31 offen sc1
Lch_16g_rl_c:
  s_add_u32 s22, s22, 1
  s_waitcnt vmcnt(0) lgkmcnt(0)
  v_mfma_f32_16x16x32_bf16 v[52:55], v[28:31], v[48:51], 0
  v_mfma_f32_16x16x32_bf16 v[52:55], v[32:35], v[48:51], v[52:55]
  v_mfma_f32_16x16x32_bf16 v[52:55], v[36:39], v[48:51], v[52:55]
  v_mfma_f32_16x16x32_bf16 v[52:55], v[40:43], v[48:51], v[52:55]
  v_xor_b32 v56, v28, v45
  v_bitop3_b32 v56, v56, v30, v45 bitop3:0xf6
  v_bitop3_b32 v56, v56, v32, v45 bitop3:0xf6
  v_bitop3_b32 v56, v56, v34, v45 bitop3:0xf6
  v_bitop3_b32 v56, v56, v36, v45 bitop3:0xf6
  v_bitop3_b32 v56, v56, v38, v45 bitop3:0xf6
  v_bitop3_b32 v56, v56, v40, v45 bitop3:0xf6
  v_bitop3_b32 v56, v56, v42, v45 bitop3:0xf6
  v_and_b32 v56, 1, v56
  v_cmp_ne_u32 vcc, 0, v56
  s_cmp_gt_u32 s22, 20000
  s_cbranch_scc1 Lch_16g_rok
  s_cbranch_vccnz Lch_16g_rl
Lch_16g_rok:
  v_cvt_pk_bf16_f32 v52, v52, v53
  v_cvt_pk_bf16_f32 v53, v54, v55
  buffer_store_dwordx2 v[52:53], v12, s[48:51], s21 offen sc1
  buffer_store_dwordx2 v[58:59], v12, s[48:51], s18 offen sc1
  s_branch Lch_16g_nored
Lch_16g_nr2:
  v_mov_b64 v[16:17], 0
  v_mov_b64 v[18:19], 0
  v_mov_b64 v[20:21], 0
  v_mov_b64 v[22:23], 0
  v_mov_b64 v[24:25], 0
  v_mov_b64 v[26:27], 0
Lch_16g_nored:
  s_add_u32 s7, s7, 1
  s_xor_b32 s11, s11, 1
  s_and_b32 s18, s7, 3
  s_mul_i32 s18, s18, 9216
  s_add_u32 s23, s18, 4096
  s_add_u32 s19, s18, 5120
  v_mov_b64 v[36:37], 0
  v_mov_b64 v[38:39], 0
  s_barrier
  s_branch Lch_16g_step
Lch_16g_end:
  s_waitcnt vmcnt(0)
  s_barrier
  s_cmp_lg_u32 s3, 3
  s_cbranch_scc1 Lch_16g_pubend
  s_mov_b32 s20, 13184
  v_mov_b32 v76, 1
  s_mov_b64 exec, 1
  buffer_atomic_add v76, off, s[52:55], s20
  s_mov_b64 exec, -1
Lch_16g_pubend:
  s_branch Lmg_worker_2
Lmg_worker_2:
  v_mbcnt_lo_u32_b32 v0, -1, 0
  v_mbcnt_hi_u32_b32 v0, -1, v0
  s_lshl_b32 s4, s3, 6
  v_add_u32 v0, s4, v0
  s_load_dwordx2 s[98:99], s[0:1], 128
  s_waitcnt lgkmcnt(0)
  s_mov_b32 s88, s98
  s_mov_b32 s89, s99
  s_mov_b32 s90, 0x10000
  s_mov_b32 s91, 0x20000
Lmg_next_3:
  s_mov_b32 s50, 33792
  s_barrier
  s_cmp_lg_u32 s3, 0
  s_cbranch_scc1 Lmg_tk_23
  v_mov_b32 v2, 1
  s_mov_b64 exec, 1
  buffer_atomic_add v2, off, s[88:91], s50 sc0
  s_waitcnt vmcnt(0)
  v_mov_b32 v3, 163824
  ds_write_b32 v3, v2
  s_waitcnt lgkmcnt(0)
  s_mov_b64 exec, -1
Lmg_tk_23:
  s_barrier
  v_mov_b32 v3, 163824
  ds_read_b32 v2, v3
  s_waitcnt lgkmcnt(0)
  v_readfirstlane_b32 s96, v2
  s_nop 3
  s_cmp_ge_u32 s96, 724
  s_cbranch_scc1 Lmg_wout_24
  s_getpc_b64 s[94:95]
Lmg_pc_25:
  s_add_u32 s94, s94, mega_kernel_tab-Lmg_pc_25
  s_addc_u32 s95, s95, 0
  s_lshl_b32 s86, s96, 4
  s_lshl_b32 s96, s96, 2
  s_load_dword s97, s[94:95], s96
  s_waitcnt lgkmcnt(0)
  s_and_b32 s96, s97, 15
  s_bfe_u32 s92, s97, 0x80004
  s_bfe_u32 s93, s97, 0x8000c
  s_bfe_u32 s87, s97, 0x80014
  s_cmp_eq_u32 s96, 0
  s_cbranch_scc1 Lmg_t0_26
  s_cmp_eq_u32 s96, 1
  s_cbranch_scc1 Lmg_t1_27
  s_cmp_eq_u32 s96, 2
  s_cbranch_scc1 Lmg_t2_28
  s_cmp_eq_u32 s96, 3
  s_cbranch_scc1 Lmg_t3_29
  s_cmp_eq_u32 s96, 4
  s_cbranch_scc1 Lmg_t4_30
  s_cmp_eq_u32 s96, 5
  s_cbranch_scc1 Lmg_t5_31
  s_cmp_eq_u32 s96, 6
  s_cbranch_scc1 Lmg_t6_32
  s_cmp_eq_u32 s96, 7
  s_cbranch_scc1 Lmg_t7_33
  s_branch Lmg_done_1
Lmg_t0_26:
  s_cmp_lg_u32 s3, 0
  s_cbranch_scc1 Lw_skip_34
  s_mov_b64 exec, 1
  s_mov_b32 s50, 36352
  s_mov_b32 s52, 0
Lw_lp_35:
  buffer_load_dword v2, off, s[88:91], s50 sc1
  s_waitcnt vmcnt(0)
  v_readfirstlane_b32 s51, v2
  s_add_u32 s52, s52, 1
  s_cmp_gt_u32 s52, 2000000
  s_cbranch_scc1 Lw_lp_35_x
  s_cmp_ge_u32 s51, 108
  s_cbranch_scc1 Lw_lp_35_x
  s_sleep 4
  s_branch Lw_lp_35
Lw_lp_35_x:
  s_mov_b64 exec, -1
Lw_skip_34:
  s_barrier
  s_load_dwordx2 s[4:5], s[0:1], 0
  s_waitcnt lgkmcnt(0)
  s_mov_b32 s12, s4
  s_mov_b32 s13, s5
  s_mov_b32 s14, 0x240000
  s_mov_b32 s15, 0x20000
  s_add_u32 s16, s98, 0x12000
  s_addc_u32 s17, s99, 0
  s_mov_b32 s18, 0x240000
  s_mov_b32 s19, 0x20000
  s_add_u32 s20, s98, 0x10000
  s_addc_u32 s21, s99, 0
  s_mov_b32 s22, 0x1b00
  s_mov_b32 s23, 0x20000
  v_and_b32 v1, 15, v0
  v_lshrrev_b32 v2, 4, v0
  s_lshl_b32 s28, s92, 4
  v_add_u32 v2, s28, v2
  s_movk_i32 s29, 1152
  v_mul_lo_u32 v2, v2, s29
  v_lshl_add_u32 v3, v1, 4, v2
  v_lshlrev_b32 v4, 4, v1
  v_cmp_gt_u32 vcc, 8, v1
  v_mov_b32 v5, 0x7ffffff0
  s_nop 0
  v_cndmask_b32 v6, v5, v3, vcc
  v_cndmask_b32 v7, v5, v4, vcc
  v_cndmask_b32 v9, 0, 1.0, vcc
  buffer_load_dwordx4 v[12:15], v3, s[12:15], 0 offen offset:0
  buffer_load_dwordx4 v[16:19], v3, s[12:15], 0 offen offset:256
  buffer_load_dwordx4 v[20:23], v3, s[12:15], 0 offen offset:512
  buffer_load_dwordx4 v[24:27], v3, s[12:15], 0 offen offset:768
  buffer_load_dwordx4 v[28:31], v6, s[12:15], 0 offen offset:1024
  s_mov_b32 s29, 1152
  buffer_load_dwordx4 v[32:35], v4, s[20:23], s29 offen offset:0
  buffer_load_dwordx4 v[36:39], v4, s[20:23], s29 offen offset:256
  buffer_load_dwordx4 v[40:43], v4, s[20:23], s29 offen offset:512
  buffer_load_dwordx4 v[44:47], v4, s[20:23], s29 offen offset:768
  buffer_load_dwordx4 v[48:51], v7, s[20:23], s29 offen offset:1024
  s_mov_b32 s29, 0
  buffer_load_dwordx4 v[52:55], v4, s[20:23], s29 offen offset:0
  buffer_load_dwordx4 v[56:59], v4, s[20:23], s29 offen offset:256
  buffer_load_dwordx4 v[60:63], v4, s[20:23], s29 offen offset:512
  buffer_load_dwordx4 v[64:67], v4, s[20:23], s29 offen offset:768
  buffer_load_dwordx4 v[68:71], v7, s[20:23], s29 offen offset:1024
  s_waitcnt vmcnt(10)
  v_lshlrev_b32 v72, 16, v12
  v_and_b32 v73, 0xffff0000, v12
  v_lshlrev_b32 v74, 16, v13
  v_and_b32 v75, 0xffff0000, v13
  v_lshlrev_b32 v76, 16, v14
  v_and_b32 v77, 0xffff0000, v14
  v_lshlrev_b32 v78, 16, v15
  v_and_b32 v79, 0xffff0000, v15
  v_lshlrev_b32 v80, 16, v16
  v_and_b32 v81, 0xffff0000, v16
  v_lshlrev_b32 v82, 16, v17
  v_and_b32 v83, 0xffff0000, v17
  v_lshlrev_b32 v84, 16, v18
  v_and_b32 v85, 0xffff0000, v18
  v_lshlrev_b32 v86, 16, v19
  v_and_b32 v87, 0xffff0000, v19
  v_lshlrev_b32 v88, 16, v20
  v_and_b32 v89, 0xffff0000, v20
  v_lshlrev_b32 v90, 16, v21
  v_and_b32 v91, 0xffff0000, v21
  v_lshlrev_b32 v92, 16, v22
  v_and_b32 v93, 0xffff0000, v22
  v_lshlrev_b32 v94, 16, v23
  v_and_b32 v95, 0xffff0000, v23
  v_lshlrev_b32 v96, 16, v24
  v_and_b32 v97, 0xffff0000, v24
  v_lshlrev_b32 v98, 16, v25
  v_and_b32 v99, 0xffff0000, v25
  v_lshlrev_b32 v100, 16, v26
  v_and_b32 v101, 0xffff0000, v26
  v_lshlrev_b32 v102, 16, v27
  v_and_b32 v103, 0xffff0000, v27
  v_lshlrev_b32 v104, 16, v28
  v_and_b32 v105, 0xffff0000, v28
  v_lshlrev_b32 v106, 16, v29
  v_and_b32 v107, 0xffff0000, v29
  v_lshlrev_b32 v108, 16, v30
  v_and_b32 v109, 0xffff0000, v30
  v_lshlrev_b32 v110, 16, v31
  v_and_b32 v111, 0xffff0000, v31
  v_add_f32 v8, v72, v73
  v_add_f32 v8, v8, v74
  v_add_f32 v8, v8, v75
  v_add_f32 v8, v8, v76
  v_add_f32 v8, v8, v77
  v_add_f32 v8, v8, v78
  v_add_f32 v8, v8, v79
  v_add_f32 v8, v8, v80
  v_add_f32 v8, v8, v81
  v_add_f32 v8, v8, v82
  v_add_f32 v8, v8, v83
  v_add_f32 v8, v8, v84
  v_add_f32 v8, v8, v85
  v_add_f32 v8, v8, v86
  v_add_f32 v8, v8, v87
  v_add_f32 v8, v8, v88
  v_add_f32 v8, v8, v89
  v_add_f32 v8, v8, v90
  v_add_f32 v8, v8, v91
  v_add_f32 v8, v8, v92
  v_add_f32 v8, v8, v93
  v_add_f32 v8, v8, v94
  v_add_f32 v8, v8, v95
  v_add_f32 v8, v8, v96
  v_add_f32 v8, v8, v97
  v_add_f32 v8, v8, v98
  v_add_f32 v8, v8, v99
  v_add_f32 v8, v8, v100
  v_add_f32 v8, v8, v101
  v_add_f32 v8, v8, v102
  v_add_f32 v8, v8, v103
  v_add_f32 v8, v8, v104
  v_add_f32 v8, v8, v105
  v_add_f32 v8, v8, v106
  v_add_f32 v8, v8, v107
  v_add_f32 v8, v8, v108
  v_add_f32 v8, v8, v109
  v_add_f32 v8, v8, v110
  v_add_f32 v8, v8, v111
  s_nop 1
  v_add_f32_dpp v8, v8, v8 row_ror:8 row_mask:0xf bank_mask:0xf
  s_nop 1
  v_add_f32_dpp v8, v8, v8 row_ror:4 row_mask:0xf bank_mask:0xf
  s_nop 1
  v_add_f32_dpp v8, v8, v8 row_ror:2 row_mask:0xf bank_mask:0xf
  s_nop 1
  v_add_f32_dpp v8, v8, v8 row_ror:1 row_mask:0xf bank_mask:0xf
  s_mov_b32 s31, 0x3ae38e39
  v_mul_f32 v8, s31, v8
  v_mov_b32 v10, 0
  v_mov_b32 v112, 0
  v_sub_f32 v11, v72, v8
  v_fmac_f32 v10, v11, v11
  v_sub_f32 v11, v73, v8
  v_fmac_f32 v10, v11, v11
  v_sub_f32 v11, v74, v8
  v_fmac_f32 v10, v11, v11
  v_sub_f32 v11, v75, v8
  v_fmac_f32 v10, v11, v11
  v_sub_f32 v11, v76, v8
  v_fmac_f32 v10, v11, v11
  v_sub_f32 v11, v77, v8
  v_fmac_f32 v10, v11, v11
  v_sub_f32 v11, v78, v8
  v_fmac_f32 v10, v11, v11
  v_sub_f32 v11, v79, v8
  v_fmac_f32 v10, v11, v11
  v_sub_f32 v11, v80, v8
  v_fmac_f32 v10, v11, v11
  v_sub_f32 v11, v81, v8
  v_fmac_f32 v10, v11, v11
  v_sub_f32 v11, v82, v8
  v_fmac_f32 v10, v11, v11
  v_sub_f32 v11, v83, v8
  v_fmac_f32 v10, v11, v11
  v_sub_f32 v11, v84, v8
  v_fmac_f32 v10, v11, v11
  v_sub_f32 v11, v85, v8
  v_fmac_f32 v10, v11, v11
  v_sub_f32 v11, v86, v8
  v_fmac_f32 v10, v11, v11
  v_sub_f32 v11, v87, v8
  v_fmac_f32 v10, v11, v11
  v_sub_f32 v11, v88, v8
  v_fmac_f32 v10, v11, v11
  v_sub_f32 v11, v89, v8
  v_fmac_f32 v10, v11, v11
  v_sub_f32 v11, v90, v8
  v_fmac_f32 v10, v11, v11
  v_sub_f32 v11, v91, v8
  v_fmac_f32 v10, v11, v11
  v_sub_f32 v11, v92, v8
  v_fmac_f32 v10, v11, v11
  v_sub_f32 v11, v93, v8
  v_fmac_f32 v10, v11, v11
  v_sub_f32 v11, v94, v8
  v_fmac_f32 v10, v11, v11
  v_sub_f32 v11, v95, v8
  v_fmac_f32 v10, v11, v11
  v_sub_f32 v11, v96, v8
  v_fmac_f32 v10, v11, v11
  v_sub_f32 v11, v97, v8
  v_fmac_f32 v10, v11, v11
  v_sub_f32 v11, v98, v8
  v_fmac_f32 v10, v11, v11
  v_sub_f32 v11, v99, v8
  v_fmac_f32 v10, v11, v11
  v_sub_f32 v11, v100, v8
  v_fmac_f32 v10, v11, v11
  v_sub_f32 v11, v101, v8
  v_fmac_f32 v10, v11, v11
  v_sub_f32 v11, v102, v8
  v_fmac_f32 v10, v11, v11
  v_sub_f32 v11, v103, v8
  v_fmac_f32 v10, v11, v11
  v_sub_f32 v11, v104, v8
  v_fmac_f32 v112, v11, v11
  v_sub_f32 v11, v105, v8
  v_fmac_f32 v112, v11, v11
  v_sub_f32 v11, v106, v8
  v_fmac_f32 v112, v11, v11
  v_sub_f32 v11, v107, v8
  v_fmac_f32 v112, v11, v11
  v_sub_f32 v11, v108, v8
  v_fmac_f32 v112, v11, v11
  v_sub_f32 v11, v109, v8
  v_fmac_f32 v112, v11, v11
  v_sub_f32 v11, v110, v8
  v_fmac_f32 v112, v11, v11
  v_sub_f32 v11, v111, v8
  v_fmac_f32 v112, v11, v11
  v_fmac_f32 v10, v112, v9
  s_nop 1
  v_add_f32_dpp v10, v10, v10 row_ror:8 row_mask:0xf bank_mask:0xf
  s_nop 1
  v_add_f32_dpp v10, v10, v10 row_ror:4 row_mask:0xf bank_mask:0xf
  s_nop 1
  v_add_f32_dpp v10, v10, v10 row_ror:2 row_mask:0xf bank_mask:0xf
  s_nop 1
  v_add_f32_dpp v10, v10, v10 row_ror:1 row_mask:0xf bank_mask:0xf
  v_mul_f32 v10, s31, v10
  v_cvt_pk_bf16_f32 v11, v10, v10
  v_lshlrev_b32 v10, 16, v11
  v_cvt_pk_bf16_f32 v11, v8, v8
  v_lshlrev_b32 v8, 16, v11
  v_add_f32 v10, 0x3727c5ac, v10
  v_cvt_pk_bf16_f32 v11, v10, v10
  v_lshlrev_b32 v10, 16, v11
  v_sqrt_f32 v10, v10
  s_nop 0
  v_cvt_pk_bf16_f32 v11, v10, v10
  v_lshlrev_b32 v10, 16, v11
  v_rcp_f32 v10, v10
  s_waitcnt vmcnt(0)
  v_sub_f32 v72, v72, v8
  v_sub_f32 v73, v73, v8
  v_cvt_pk_bf16_f32 v11, v72, v73
  v_lshlrev_b32 v72, 16, v11
  v_and_b32 v73, 0xffff0000, v11
  v_mul_f32 v72, v72, v10
  v_mul_f32 v73, v73, v10
  v_cvt_pk_bf16_f32 v11, v72, v73
  v_lshlrev_b32 v72, 16, v11
  v_and_b32 v73, 0xffff0000, v11
  v_lshlrev_b32 v113, 16, v32
  v_and_b32 v114, 0xffff0000, v32
  v_mul_f32 v72, v72, v113
  v_mul_f32 v73, v73, v114
  v_cvt_pk_bf16_f32 v11, v72, v73
  v_lshlrev_b32 v72, 16, v11
  v_and_b32 v73, 0xffff0000, v11
  v_lshlrev_b32 v113, 16, v52
  v_and_b32 v114, 0xffff0000, v52
  v_add_f32 v72, v72, v113
  v_add_f32 v73, v73, v114
  v_cvt_pk_bf16_f32 v12, v72, v73
  v_sub_f32 v74, v74, v8
  v_sub_f32 v75, v75, v8
  v_cvt_pk_bf16_f32 v11, v74, v75
  v_lshlrev_b32 v74, 16, v11
  v_and_b32 v75, 0xffff0000, v11
  v_mul_f32 v74, v74, v10
  v_mul_f32 v75, v75, v10
  v_cvt_pk_bf16_f32 v11, v74, v75
  v_lshlrev_b32 v74, 16, v11
  v_and_b32 v75, 0xffff0000, v11
  v_lshlrev_b32 v113, 16, v33
  v_and_b32 v114, 0xffff0000, v33
  v_mul_f32 v74, v74, v113
  v_mul_f32 v75, v75, v114
  v_cvt_pk_bf16_f32 v11, v74, v75
  v_lshlrev_b32 v74, 16, v11
  v_and_b32 v75, 0xffff0000, v11
  v_lshlrev_b32 v113, 16, v53
  v_and_b32 v114, 0xffff0000, v53
  v_add_f32 v74, v74, v113
  v_add_f32 v75, v75, v114
  v_cvt_pk_bf16_f32 v13, v74, v75
  v_sub_f32 v76, v76, v8
  v_sub_f32 v77, v77, v8
  v_cvt_pk_bf16_f32 v11, v76, v77
  v_lshlrev_b32 v76, 16, v11
  v_and_b32 v77, 0xffff0000, v11
  v_mul_f32 v76, v76, v10
  v_mul_f32 v77, v77, v10
  v_cvt_pk_bf16_f32 v11, v76, v77
  v_lshlrev_b32 v76, 16, v11
  v_and_b32 v77, 0xffff0000, v11
  v_lshlrev_b32 v113, 16, v34
  v_and_b32 v114, 0xffff0000, v34
  v_mul_f32 v76, v76, v113
  v_mul_f32 v77, v77, v114
  v_cvt_pk_bf16_f32 v11, v76, v77
  v_lshlrev_b32 v76, 16, v11
  v_and_b32 v77, 0xffff0000, v11
  v_lshlrev_b32 v113, 16, v54
  v_and_b32 v114, 0xffff0000, v54
  v_add_f32 v76, v76, v113
  v_add_f32 v77, v77, v114
  v_cvt_pk_bf16_f32 v14, v76, v77
  v_sub_f32 v78, v78, v8
  v_sub_f32 v79, v79, v8
  v_cvt_pk_bf16_f32 v11, v78, v79
  v_lshlrev_b32 v78, 16, v11
  v_and_b32 v79, 0xffff0000, v11
  v_mul_f32 v78, v78, v10
  v_mul_f32 v79, v79, v10
  v_cvt_pk_bf16_f32 v11, v78, v79
  v_lshlrev_b32 v78, 16, v11
  v_and_b32 v79, 0xffff0000, v11
  v_lshlrev_b32 v113, 16, v35
  v_and_b32 v114, 0xffff0000, v35
  v_mul_f32 v78, v78, v113
  v_mul_f32 v79, v79, v114
  v_cvt_pk_bf16_f32 v11, v78, v79
  v_lshlrev_b32 v78, 16, v11
  v_and_b32 v79, 0xffff0000, v11
  v_lshlrev_b32 v113, 16, v55
  v_and_b32 v114, 0xffff0000, v55
  v_add_f32 v78, v78, v113
  v_add_f32 v79, v79, v114
  v_cvt_pk_bf16_f32 v15, v78, v79
  v_sub_f32 v80, v80, v8
  v_sub_f32 v81, v81, v8
  v_cvt_pk_bf16_f32 v11, v80, v81
  v_lshlrev_b32 v80, 16, v11
  v_and_b32 v81, 0xffff0000, v11
  v_mul_f32 v80, v80, v10
  v_mul_f32 v81, v81, v10
  v_cvt_pk_bf16_f32 v11, v80, v81
  v_lshlrev_b32 v80, 16, v11
  v_and_b32 v81, 0xffff0000, v11
  v_lshlrev_b32 v113, 16, v36
  v_and_b32 v114, 0xffff0000, v36
  v_mul_f32 v80, v80, v113
  v_mul_f32 v81, v81, v114
  v_cvt_pk_bf16_f32 v11, v80, v81
  v_lshlrev_b32 v80, 16, v11
  v_and_b32 v81, 0xffff0000, v11
  v_lshlrev_b32 v113, 16, v56
  v_and_b32 v114, 0xffff0000, v56
  v_add_f32 v80, v80, v113
  v_add_f32 v81, v81, v114
  v_cvt_pk_bf16_f32 v16, v80, v81
  v_sub_f32 v82, v82, v8
  v_sub_f32 v83, v83, v8
  v_cvt_pk_bf16_f32 v11, v82, v83
  v_lshlrev_b32 v82, 16, v11
  v_and_b32 v83, 0xffff0000, v11
  v_mul_f32 v82, v82, v10
  v_mul_f32 v83, v83, v10
  v_cvt_pk_bf16_f32 v11, v82, v83
  v_lshlrev_b32 v82, 16, v11
  v_and_b32 v83, 0xffff0000, v11
  v_lshlrev_b32 v113, 16, v37
  v_and_b32 v114, 0xffff0000, v37
  v_mul_f32 v82, v82, v113
  v_mul_f32 v83, v83, v114
  v_cvt_pk_bf16_f32 v11, v82, v83
  v_lshlrev_b32 v82, 16, v11
  v_and_b32 v83, 0xffff0000, v11
  v_lshlrev_b32 v113, 16, v57
  v_and_b32 v114, 0xffff0000, v57
  v_add_f32 v82, v82, v113
  v_add_f32 v83, v83, v114
  v_cvt_pk_bf16_f32 v17, v82, v83
  v_sub_f32 v84, v84, v8
  v_sub_f32 v85, v85, v8
  v_cvt_pk_bf16_f32 v11, v84, v85
  v_lshlrev_b32 v84, 16, v11
  v_and_b32 v85, 0xffff0000, v11
  v_mul_f32 v84, v84, v10
  v_mul_f32 v85, v85, v10
  v_cvt_pk_bf16_f32 v11, v84, v85
  v_lshlrev_b32 v84, 16, v11
  v_and_b32 v85, 0xffff0000, v11
  v_lshlrev_b32 v113, 16, v38
  v_and_b32 v114, 0xffff0000, v38
  v_mul_f32 v84, v84, v113
  v_mul_f32 v85, v85, v114
  v_cvt_pk_bf16_f32 v11, v84, v85
  v_lshlrev_b32 v84, 16, v11
  v_and_b32 v85, 0xffff0000, v11
  v_lshlrev_b32 v113, 16, v58
  v_and_b32 v114, 0xffff0000, v58
  v_add_f32 v84, v84, v113
  v_add_f32 v85, v85, v114
  v_cvt_pk_bf16_f32 v18, v84, v85
  v_sub_f32 v86, v86, v8
  v_sub_f32 v87, v87, v8
  v_cvt_pk_bf16_f32 v11, v86, v87
  v_lshlrev_b32 v86, 16, v11
  v_and_b32 v87, 0xffff0000, v11
  v_mul_f32 v86, v86, v10
  v_mul_f32 v87, v87, v10
  v_cvt_pk_bf16_f32 v11, v86, v87
  v_lshlrev_b32 v86, 16, v11
  v_and_b32 v87, 0xffff0000, v11
  v_lshlrev_b32 v113, 16, v39
  v_and_b32 v114, 0xffff0000, v39
  v_mul_f32 v86, v86, v113
  v_mul_f32 v87, v87, v114
  v_cvt_pk_bf16_f32 v11, v86, v87
  v_lshlrev_b32 v86, 16, v11
  v_and_b32 v87, 0xffff0000, v11
  v_lshlrev_b32 v113, 16, v59
  v_and_b32 v114, 0xffff0000, v59
  v_add_f32 v86, v86, v113
  v_add_f32 v87, v87, v114
  v_cvt_pk_bf16_f32 v19, v86, v87
  v_sub_f32 v88, v88, v8
  v_sub_f32 v89, v89, v8
  v_cvt_pk_bf16_f32 v11, v88, v89
  v_lshlrev_b32 v88, 16, v11
  v_and_b32 v89, 0xffff0000, v11
  v_mul_f32 v88, v88, v10
  v_mul_f32 v89, v89, v10
  v_cvt_pk_bf16_f32 v11, v88, v89
  v_lshlrev_b32 v88, 16, v11
  v_and_b32 v89, 0xffff0000, v11
  v_lshlrev_b32 v113, 16, v40
  v_and_b32 v114, 0xffff0000, v40
  v_mul_f32 v88, v88, v113
  v_mul_f32 v89, v89, v114
  v_cvt_pk_bf16_f32 v11, v88, v89
  v_lshlrev_b32 v88, 16, v11
  v_and_b32 v89, 0xffff0000, v11
  v_lshlrev_b32 v113, 16, v60
  v_and_b32 v114, 0xffff0000, v60
  v_add_f32 v88, v88, v113
  v_add_f32 v89, v89, v114
  v_cvt_pk_bf16_f32 v20, v88, v89
  v_sub_f32 v90, v90, v8
  v_sub_f32 v91, v91, v8
  v_cvt_pk_bf16_f32 v11, v90, v91
  v_lshlrev_b32 v90, 16, v11
  v_and_b32 v91, 0xffff0000, v11
  v_mul_f32 v90, v90, v10
  v_mul_f32 v91, v91, v10
  v_cvt_pk_bf16_f32 v11, v90, v91
  v_lshlrev_b32 v90, 16, v11
  v_and_b32 v91, 0xffff0000, v11
  v_lshlrev_b32 v113, 16, v41
  v_and_b32 v114, 0xffff0000, v41
  v_mul_f32 v90, v90, v113
  v_mul_f32 v91, v91, v114
  v_cvt_pk_bf16_f32 v11, v90, v91
  v_lshlrev_b32 v90, 16, v11
  v_and_b32 v91, 0xffff0000, v11
  v_lshlrev_b32 v113, 16, v61
  v_and_b32 v114, 0xffff0000, v61
  v_add_f32 v90, v90, v113
  v_add_f32 v91, v91, v114
  v_cvt_pk_bf16_f32 v21, v90, v91
  v_sub_f32 v92, v92, v8
  v_sub_f32 v93, v93, v8
  v_cvt_pk_bf16_f32 v11, v92, v93
  v_lshlrev_b32 v92, 16, v11
  v_and_b32 v93, 0xffff0000, v11
  v_mul_f32 v92, v92, v10
  v_mul_f32 v93, v93, v10
  v_cvt_pk_bf16_f32 v11, v92, v93
  v_lshlrev_b32 v92, 16, v11
  v_and_b32 v93, 0xffff0000, v11
  v_lshlrev_b32 v113, 16, v42
  v_and_b32 v114, 0xffff0000, v42
  v_mul_f32 v92, v92, v113
  v_mul_f32 v93, v93, v114
  v_cvt_pk_bf16_f32 v11, v92, v93
  v_lshlrev_b32 v92, 16, v11
  v_and_b32 v93, 0xffff0000, v11
  v_lshlrev_b32 v113, 16, v62
  v_and_b32 v114, 0xffff0000, v62
  v_add_f32 v92, v92, v113
  v_add_f32 v93, v93, v114
  v_cvt_pk_bf16_f32 v22, v92, v93
  v_sub_f32 v94, v94, v8
  v_sub_f32 v95, v95, v8
  v_cvt_pk_bf16_f32 v11, v94, v95
  v_lshlrev_b32 v94, 16, v11
  v_and_b32 v95, 0xffff0000, v11
  v_mul_f32 v94, v94, v10
  v_mul_f32 v95, v95, v10
  v_cvt_pk_bf16_f32 v11, v94, v95
  v_lshlrev_b32 v94, 16, v11
  v_and_b32 v95, 0xffff0000, v11
  v_lshlrev_b32 v113, 16, v43
  v_and_b32 v114, 0xffff0000, v43
  v_mul_f32 v94, v94, v113
  v_mul_f32 v95, v95, v114
  v_cvt_pk_bf16_f32 v11, v94, v95
  v_lshlrev_b32 v94, 16, v11
  v_and_b32 v95, 0xffff0000, v11
  v_lshlrev_b32 v113, 16, v63
  v_and_b32 v114, 0xffff0000, v63
  v_add_f32 v94, v94, v113
  v_add_f32 v95, v95, v114
  v_cvt_pk_bf16_f32 v23, v94, v95
  v_sub_f32 v96, v96, v8
  v_sub_f32 v97, v97, v8
  v_cvt_pk_bf16_f32 v11, v96, v97
  v_lshlrev_b32 v96, 16, v11
  v_and_b32 v97, 0xffff0000, v11
  v_mul_f32 v96, v96, v10
  v_mul_f32 v97, v97, v10
  v_cvt_pk_bf16_f32 v11, v96, v97
  v_lshlrev_b32 v96, 16, v11
  v_and_b32 v97, 0xffff0000, v11
  v_lshlrev_b32 v113, 16, v44
  v_and_b32 v114, 0xffff0000, v44
  v_mul_f32 v96, v96, v113
  v_mul_f32 v97, v97, v114
  v_cvt_pk_bf16_f32 v11, v96, v97
  v_lshlrev_b32 v96, 16, v11
  v_and_b32 v97, 0xffff0000, v11
  v_lshlrev_b32 v113, 16, v64
  v_and_b32 v114, 0xffff0000, v64
  v_add_f32 v96, v96, v113
  v_add_f32 v97, v97, v114
  v_cvt_pk_bf16_f32 v24, v96, v97
  v_sub_f32 v98, v98, v8
  v_sub_f32 v99, v99, v8
  v_cvt_pk_bf16_f32 v11, v98, v99
  v_lshlrev_b32 v98, 16, v11
  v_and_b32 v99, 0xffff0000, v11
  v_mul_f32 v98, v98, v10
  v_mul_f32 v99, v99, v10
  v_cvt_pk_bf16_f32 v11, v98, v99
  v_lshlrev_b32 v98, 16, v11
  v_and_b32 v99, 0xffff0000, v11
  v_lshlrev_b32 v113, 16, v45
  v_and_b32 v114, 0xffff0000, v45
  v_mul_f32 v98, v98, v113
  v_mul_f32 v99, v99, v114
  v_cvt_pk_bf16_f32 v11, v98, v99
  v_lshlrev_b32 v98, 16, v11
  v_and_b32 v99, 0xffff0000, v11
  v_lshlrev_b32 v113, 16, v65
  v_and_b32 v114, 0xffff0000, v65
  v_add_f32 v98, v98, v113
  v_add_f32 v99, v99, v114
  v_cvt_pk_bf16_f32 v25, v98, v99
  v_sub_f32 v100, v100, v8
  v_sub_f32 v101, v101, v8
  v_cvt_pk_bf16_f32 v11, v100, v101
  v_lshlrev_b32 v100, 16, v11
  v_and_b32 v101, 0xffff0000, v11
  v_mul_f32 v100, v100, v10
  v_mul_f32 v101, v101, v10
  v_cvt_pk_bf16_f32 v11, v100, v101
  v_lshlrev_b32 v100, 16, v11
  v_and_b32 v101, 0xffff0000, v11
  v_lshlrev_b32 v113, 16, v46
  v_and_b32 v114, 0xffff0000, v46
  v_mul_f32 v100, v100, v113
  v_mul_f32 v101, v101, v114
  v_cvt_pk_bf16_f32 v11, v100, v101
  v_lshlrev_b32 v100, 16, v11
  v_and_b32 v101, 0xffff0000, v11
  v_lshlrev_b32 v113, 16, v66
  v_and_b32 v114, 0xffff0000, v66
  v_add_f32 v100, v100, v113
  v_add_f32 v101, v101, v114
  v_cvt_pk_bf16_f32 v26, v100, v101
  v_sub_f32 v102, v102, v8
  v_sub_f32 v103, v103, v8
  v_cvt_pk_bf16_f32 v11, v102, v103
  v_lshlrev_b32 v102, 16, v11
  v_and_b32 v103, 0xffff0000, v11
  v_mul_f32 v102, v102, v10
  v_mul_f32 v103, v103, v10
  v_cvt_pk_bf16_f32 v11, v102, v103
  v_lshlrev_b32 v102, 16, v11
  v_and_b32 v103, 0xffff0000, v11
  v_lshlrev_b32 v113, 16, v47
  v_and_b32 v114, 0xffff0000, v47
  v_mul_f32 v102, v102, v113
  v_mul_f32 v103, v103, v114
  v_cvt_pk_bf16_f32 v11, v102, v103
  v_lshlrev_b32 v102, 16, v11
  v_and_b32 v103, 0xffff0000, v11
  v_lshlrev_b32 v113, 16, v67
  v_and_b32 v114, 0xffff0000, v67
  v_add_f32 v102, v102, v113
  v_add_f32 v103, v103, v114
  v_cvt_pk_bf16_f32 v27, v102, v103
  v_sub_f32 v104, v104, v8
  v_sub_f32 v105, v105, v8
  v_cvt_pk_bf16_f32 v11, v104, v105
  v_lshlrev_b32 v104, 16, v11
  v_and_b32 v105, 0xffff0000, v11
  v_mul_f32 v104, v104, v10
  v_mul_f32 v105, v105, v10
  v_cvt_pk_bf16_f32 v11, v104, v105
  v_lshlrev_b32 v104, 16, v11
  v_and_b32 v105, 0xffff0000, v11
  v_lshlrev_b32 v113, 16, v48
  v_and_b32 v114, 0xffff0000, v48
  v_mul_f32 v104, v104, v113
  v_mul_f32 v105, v105, v114
  v_cvt_pk_bf16_f32 v11, v104, v105
  v_lshlrev_b32 v104, 16, v11
  v_and_b32 v105, 0xffff0000, v11
  v_lshlrev_b32 v113, 16, v68
  v_and_b32 v114, 0xffff0000, v68
  v_add_f32 v104, v104, v113
  v_add_f32 v105, v105, v114
  v_cvt_pk_bf16_f32 v28, v104, v105
  v_sub_f32 v106, v106, v8
  v_sub_f32 v107, v107, v8
  v_cvt_pk_bf16_f32 v11, v106, v107
  v_lshlrev_b32 v106, 16, v11
  v_and_b32 v107, 0xffff0000, v11
  v_mul_f32 v106, v106, v10
  v_mul_f32 v107, v107, v10
  v_cvt_pk_bf16_f32 v11, v106, v107
  v_lshlrev_b32 v106, 16, v11
  v_and_b32 v107, 0xffff0000, v11
  v_lshlrev_b32 v113, 16, v49
  v_and_b32 v114, 0xffff0000, v49
  v_mul_f32 v106, v106, v113
  v_mul_f32 v107, v107, v114
  v_cvt_pk_bf16_f32 v11, v106, v107
  v_lshlrev_b32 v106, 16, v11
  v_and_b32 v107, 0xffff0000, v11
  v_lshlrev_b32 v113, 16, v69
  v_and_b32 v114, 0xffff0000, v69
  v_add_f32 v106, v106, v113
  v_add_f32 v107, v107, v114
  v_cvt_pk_bf16_f32 v29, v106, v107
  v_sub_f32 v108, v108, v8
  v_sub_f32 v109, v109, v8
  v_cvt_pk_bf16_f32 v11, v108, v109
  v_lshlrev_b32 v108, 16, v11
  v_and_b32 v109, 0xffff0000, v11
  v_mul_f32 v108, v108, v10
  v_mul_f32 v109, v109, v10
  v_cvt_pk_bf16_f32 v11, v108, v109
  v_lshlrev_b32 v108, 16, v11
  v_and_b32 v109, 0xffff0000, v11
  v_lshlrev_b32 v113, 16, v50
  v_and_b32 v114, 0xffff0000, v50
  v_mul_f32 v108, v108, v113
  v_mul_f32 v109, v109, v114
  v_cvt_pk_bf16_f32 v11, v108, v109
  v_lshlrev_b32 v108, 16, v11
  v_and_b32 v109, 0xffff0000, v11
  v_lshlrev_b32 v113, 16, v70
  v_and_b32 v114, 0xffff0000, v70
  v_add_f32 v108, v108, v113
  v_add_f32 v109, v109, v114
  v_cvt_pk_bf16_f32 v30, v108, v109
  v_sub_f32 v110, v110, v8
  v_sub_f32 v111, v111, v8
  v_cvt_pk_bf16_f32 v11, v110, v111
  v_lshlrev_b32 v110, 16, v11
  v_and_b32 v111, 0xffff0000, v11
  v_mul_f32 v110, v110, v10
  v_mul_f32 v111, v111, v10
  v_cvt_pk_bf16_f32 v11, v110, v111
  v_lshlrev_b32 v110, 16, v11
  v_and_b32 v111, 0xffff0000, v11
  v_lshlrev_b32 v113, 16, v51
  v_and_b32 v114, 0xffff0000, v51
  v_mul_f32 v110, v110, v113
  v_mul_f32 v111, v111, v114
  v_cvt_pk_bf16_f32 v11, v110, v111
  v_lshlrev_b32 v110, 16, v11
  v_and_b32 v111, 0xffff0000, v11
  v_lshlrev_b32 v113, 16, v71
  v_and_b32 v114, 0xffff0000, v71
  v_add_f32 v110, v110, v113
  v_add_f32 v111, v111, v114
  v_cvt_pk_bf16_f32 v31, v110, v111
  buffer_store_dwordx4 v[12:15], v3, s[16:19], 0 offen offset:0 sc1
  buffer_store_dwordx4 v[16:19], v3, s[16:19], 0 offen offset:256 sc1
  buffer_store_dwordx4 v[20:23], v3, s[16:19], 0 offen offset:512 sc1
  buffer_store_dwordx4 v[24:27], v3, s[16:19], 0 offen offset:768 sc1
  buffer_store_dwordx4 v[28:31], v6, s[16:19], 0 offen offset:1024 sc1
  s_lshr_b32 s30, s92, 4
  s_waitcnt vmcnt(0)
  s_barrier
  s_cmp_lg_u32 s3, 0
  s_cbranch_scc1 Ls_skip_36
  s_lshl_b32 s50, s30, 7
  s_add_u32 s50, s50, 8192
  v_mov_b32 v2, 1
  s_mov_b64 exec, 1
  buffer_atomic_add v2, off, s[88:91], s50
  s_mov_b64 exec, -1
Ls_skip_36:
  s_branch Lmg_next_3
Lmg_t1_27:
  s_cmp_lt_u32 s92, 2
  s_cbranch_scc1 Lmg_qa_37
  s_cmp_lg_u32 s3, 0
  s_cbranch_scc1 Lw_skip_38
  s_mov_b64 exec, 1
  s_mov_b32 s50, 9216
  s_mov_b32 s52, 0
Lw_lp_39:
  buffer_load_dword v2, off, s[88:91], s50 sc1
  s_waitcnt vmcnt(0)
  v_readfirstlane_b32 s51, v2
  s_add_u32 s52, s52, 1
  s_cmp_gt_u32 s52, 2000000
  s_cbranch_scc1 Lw_lp_39_x
  s_cmp_ge_u32 s51, 32
  s_cbranch_scc1 Lw_lp_39_x
  s_sleep 4
  s_branch Lw_lp_39
Lw_lp_39_x:
  s_mov_b64 exec, -1
Lw_skip_38:
  s_barrier
Lmg_qa_37:
  s_cmp_lg_u32 s3, 0
  s_cbranch_scc1 Lw_skip_40
  s_mov_b64 exec, 1
  s_lshl_b32 s50, s92, 7
  s_add_u32 s50, s50, 8192
  s_mov_b32 s52, 0
Lw_lp_41:
  buffer_load_dword v2, off, s[88:91], s50 sc1
  s_waitcnt vmcnt(0)
  v_readfirstlane_b32 s51, v2
  s_add_u32 s52, s52, 1
  s_cmp_gt_u32 s52, 2000000
  s_cbranch_scc1 Lw_lp_41_x
  s_cmp_ge_u32 s51, 16
  s_cbranch_scc1 Lw_lp_41_x
  s_sleep 4
  s_branch Lw_lp_41
Lw_lp_41_x:
  s_mov_b64 exec, -1
Lw_skip_40:
  s_barrier
  s_mov_b32 s32, s92
  s_mov_b32 s30, s93
  s_load_dwordx2 s[4:5], s[0:1], 16
  s_load_dwordx2 s[6:7], s[0:1], 24
  s_load_dwordx2 s[8:9], s[0:1], 32
  s_load_dwordx2 s[10:11], s[0:1], 128
  s_lshr_b32 s35, s30, 4
  s_and_b32 s36, s30, 15
  s_waitcnt lgkmcnt(0)
  s_add_u32 s12, s10, 0x12000
  s_addc_u32 s13, s11, 0
  s_mov_b32 s14, 0x240000
  s_mov_b32 s15, 0x20000
  s_cmp_eq_u32 s35, 1
  s_cselect_b32 s16, s6, s4
  s_cselect_b32 s17, s7, s5
  s_cmp_eq_u32 s35, 2
  s_cselect_b32 s16, s8, s16
  s_cselect_b32 s17, s9, s17
  s_mov_b32 s18, 4718592
  s_mov_b32 s19, 0x20000
  s_mul_i32 s46, s32, 294912
  s_lshl_b32 s47, s36, 9
  v_and_b32 v1, 63, v0
  v_lshrrev_b32 v2, 3, v1
  v_xor_b32 v3, v2, v1
  v_and_b32 v3, 7, v3
  s_mov_b32 s40, 1152
  v_mul_lo_u32 v2, v2, s40
  v_lshl_add_u32 v2, v3, 4, v2
  s_add_u32 s41, s3, 0
  s_mul_i32 s41, s41, 9216
  v_add_u32 v4, s41, v2
  s_add_u32 s41, s3, 4
  s_mul_i32 s41, s41, 9216
  v_add_u32 v5, s41, v2
  s_add_u32 s41, s3, 8
  s_mul_i32 s41, s41, 9216
  v_add_u32 v6, s41, v2
  s_add_u32 s41, s3, 12
  s_mul_i32 s41, s41, 9216
  v_add_u32 v7, s41, v2
  s_add_u32 s41, s3, 16
  s_mul_i32 s41, s41, 9216
  v_add_u32 v8, s41, v2
  s_add_u32 s41, s3, 20
  s_mul_i32 s41, s41, 9216
  v_add_u32 v9, s41, v2
  s_add_u32 s41, s3, 24
  s_mul_i32 s41, s41, 9216
  v_add_u32 v10, s41, v2
  s_add_u32 s41, s3, 28
  s_mul_i32 s41, s41, 9216
  v_add_u32 v11, s41, v2
  s_add_u32 s41, s3, 0
  s_min_u32 s41, s41, 15
  s_lshl_b32 s41, s41, 6
  v_add_u32 v28, s41, v1
  s_mov_b32 s42, 0x8000000
  v_mul_hi_u32 v29, v28, s42
  v_mul_u32_u24 v30, 32, v29
  v_sub_u32 v30, v28, v30
  v_and_b32 v31, 3, v29
  v_bfe_u32 v32, v29, 3, 1
  v_lshl_add_u32 v31, v32, 2, v31
  v_lshrrev_b32 v32, 1, v30
  v_sub_u32 v32, v32, v31
  v_add_u32 v31, 16, v32
  v_cmp_gt_i32 vcc, 0, v32
  s_nop 1
  v_cndmask_b32 v32, v32, v31, vcc
  v_and_b32 v30, 1, v30
  v_lshlrev_b32 v30, 4, v30
  v_lshl_add_u32 v30, v32, 5, v30
  s_mov_b32 s42, 8192
  v_mul_lo_u32 v29, v29, s42
  v_add_u32 v12, v29, v30
  s_add_u32 s41, s3, 4
  s_min_u32 s41, s41, 15
  s_lshl_b32 s41, s41, 6
  v_add_u32 v28, s41, v1
  s_mov_b32 s42, 0x8000000
  v_mul_hi_u32 v29, v28, s42
  v_mul_u32_u24 v30, 32, v29
  v_sub_u32 v30, v28, v30
  v_and_b32 v31, 3, v29
  v_bfe_u32 v32, v29, 3, 1
  v_lshl_add_u32 v31, v32, 2, v31
  v_lshrrev_b32 v32, 1, v30
  v_sub_u32 v32, v32, v31
  v_add_u32 v31, 16, v32
  v_cmp_gt_i32 vcc, 0, v32
  s_nop 1
  v_cndmask_b32 v32, v32, v31, vcc
  v_and_b32 v30, 1, v30
  v_lshlrev_b32 v30, 4, v30
  v_lshl_add_u32 v30, v32, 5, v30
  s_mov_b32 s42, 8192
  v_mul_lo_u32 v29, v29, s42
  v_add_u32 v13, v29, v30
  s_add_u32 s41, s3, 8
  s_min_u32 s41, s41, 15
  s_lshl_b32 s41, s41, 6
  v_add_u32 v28, s41, v1
  s_mov_b32 s42, 0x8000000
  v_mul_hi_u32 v29, v28, s42
  v_mul_u32_u24 v30, 32, v29
  v_sub_u32 v30, v28, v30
  v_and_b32 v31, 3, v29
  v_bfe_u32 v32, v29, 3, 1
  v_lshl_add_u32 v31, v32, 2, v31
  v_lshrrev_b32 v32, 1, v30
  v_sub_u32 v32, v32, v31
  v_add_u32 v31, 16, v32
  v_cmp_gt_i32 vcc, 0, v32
  s_nop 1
  v_cndmask_b32 v32, v32, v31, vcc
  v_and_b32 v30, 1, v30
  v_lshlrev_b32 v30, 4, v30
  v_lshl_add_u32 v30, v32, 5, v30
  s_mov_b32 s42, 8192
  v_mul_lo_u32 v29, v29, s42
  v_add_u32 v14, v29, v30
  s_add_u32 s41, s3, 12
  s_min_u32 s41, s41, 15
  s_lshl_b32 s41, s41, 6
  v_add_u32 v28, s41, v1
  s_mov_b32 s42, 0x8000000
  v_mul_hi_u32 v29, v28, s42
  v_mul_u32_u24 v30, 32, v29
  v_sub_u32 v30, v28, v30
  v_and_b32 v31, 3, v29
  v_bfe_u32 v32, v29, 3, 1
  v_lshl_add_u32 v31, v32, 2, v31
  v_lshrrev_b32 v32, 1, v30
  v_sub_u32 v32, v32, v31
  v_add_u32 v31, 16, v32
  v_cmp_gt_i32 vcc, 0, v32
  s_nop 1
  v_cndmask_b32 v32, v32, v31, vcc
  v_and_b32 v30, 1, v30
  v_lshlrev_b32 v30, 4, v30
  v_lshl_add_u32 v30, v32, 5, v30
  s_mov_b32 s42, 8192
  v_mul_lo_u32 v29, v29, s42
  v_add_u32 v15, v29, v30
  v_and_b32 v2, 15, v1
  v_lshrrev_b32 v28, 4, v1
  v_and_b32 v3, 7, v2
  v_xor_b32 v3, v3, v28
  v_lshlrev_b32 v3, 4, v3
  v_lshl_add_u32 v3, v2, 7, v3
  s_lshr_b32 s41, s3, 1
  s_mul_i32 s41, s41, 16384
  s_add_u32 s41, s41, 65536
  v_add_u32 v16, s41, v3
  v_xor_b32 v17, 64, v16
  v_bfe_u32 v2, v1, 2, 2
  v_lshl_add_u32 v2, v28, 3, v2
  v_and_b32 v31, 3, v2
  v_bfe_u32 v32, v2, 3, 1
  v_lshl_add_u32 v31, v32, 2, v31
  v_mul_u32_u24 v2, 512, v2
  v_and_b32 v3, 3, v1
  v_lshl_add_u32 v2, v3, 3, v2
  s_and_b32 s41, s3, 1
  s_mul_i32 s41, s41, 8
  s_add_u32 s42, s41, 0
  v_add_u32 v29, s42, v31
  v_subrev_u32 v30, 16, v29
  v_cmp_le_u32 vcc, 16, v29
  s_nop 1
  v_cndmask_b32 v29, v29, v30, vcc
  v_lshl_add_u32 v18, v29, 5, v2
  s_add_u32 s42, s41, 1
  v_add_u32 v29, s42, v31
  v_subrev_u32 v30, 16, v29
  v_cmp_le_u32 vcc, 16, v29
  s_nop 1
  v_cndmask_b32 v29, v29, v30, vcc
  v_lshl_add_u32 v19, v29, 5, v2
  s_add_u32 s42, s41, 2
  v_add_u32 v29, s42, v31
  v_subrev_u32 v30, 16, v29
  v_cmp_le_u32 vcc, 16, v29
  s_nop 1
  v_cndmask_b32 v29, v29, v30, vcc
  v_lshl_add_u32 v20, v29, 5, v2
  s_add_u32 s42, s41, 3
  v_add_u32 v29, s42, v31
  v_subrev_u32 v30, 16, v29
  v_cmp_le_u32 vcc, 16, v29
  s_nop 1
  v_cndmask_b32 v29, v29, v30, vcc
  v_lshl_add_u32 v21, v29, 5, v2
  s_add_u32 s42, s41, 4
  v_add_u32 v29, s42, v31
  v_subrev_u32 v30, 16, v29
  v_cmp_le_u32 vcc, 16, v29
  s_nop 1
  v_cndmask_b32 v29, v29, v30, vcc
  v_lshl_add_u32 v22, v29, 5, v2
  s_add_u32 s42, s41, 5
  v_add_u32 v29, s42, v31
  v_subrev_u32 v30, 16, v29
  v_cmp_le_u32 vcc, 16, v29
  s_nop 1
  v_cndmask_b32 v29, v29, v30, vcc
  v_lshl_add_u32 v23, v29, 5, v2
  s_add_u32 s42, s41, 6
  v_add_u32 v29, s42, v31
  v_subrev_u32 v30, 16, v29
  v_cmp_le_u32 vcc, 16, v29
  s_nop 1
  v_cndmask_b32 v29, v29, v30, vcc
  v_lshl_add_u32 v24, v29, 5, v2
  s_add_u32 s42, s41, 7
  v_add_u32 v29, s42, v31
  v_subrev_u32 v30, 16, v29
  v_cmp_le_u32 vcc, 16, v29
  s_nop 1
  v_cndmask_b32 v29, v29, v30, vcc
  v_lshl_add_u32 v25, v29, 5, v2
  s_lshl_b32 s44, s3, 10
  s_add_u32 s45, s44, 65536
  s_cmp_eq_u32 s35, 2
  s_cbranch_scc1 Lqkv_v_43
  s_add_u32 m0, s45, 0
  s_nop 0
  buffer_load_dwordx4 v4, s[12:15], s46 offen lds
  s_add_u32 m0, s45, 4096
  s_nop 0
  buffer_load_dwordx4 v5, s[12:15], s46 offen lds
  s_add_u32 m0, s45, 8192
  s_nop 0
  buffer_load_dwordx4 v6, s[12:15], s46 offen lds
  s_add_u32 m0, s45, 12288
  s_nop 0
  buffer_load_dwordx4 v7, s[12:15], s46 offen lds
  s_add_u32 m0, s44, 0
  s_nop 0
  buffer_load_dwordx4 v12, s[16:19], s47 offen lds
  s_add_u32 m0, s44, 4096
  s_nop 0
  buffer_load_dwordx4 v13, s[16:19], s47 offen lds
  s_add_u32 m0, s44, 8192
  s_nop 0
  buffer_load_dwordx4 v14, s[16:19], s47 offen lds
  s_add_u32 m0, s44, 12288
  s_nop 0
  buffer_load_dwordx4 v15, s[16:19], s47 offen lds
  s_add_u32 s47, s47, 262144
  s_add_u32 m0, s45, 16384
  s_nop 0
  buffer_load_dwordx4 v8, s[12:15], s46 offen lds
  s_add_u32 m0, s45, 20480
  s_nop 0
  buffer_load_dwordx4 v9, s[12:15], s46 offen lds
  s_add_u32 m0, s45, 24576
  s_nop 0
  buffer_load_dwordx4 v10, s[12:15], s46 offen lds
  s_add_u32 m0, s45, 28672
  s_nop 0
  buffer_load_dwordx4 v11, s[12:15], s46 offen lds
  s_add_u32 m0, s44, 16384
  s_nop 0
  buffer_load_dwordx4 v12, s[16:19], s47 offen lds
  s_add_u32 m0, s44, 20480
  s_nop 0
  buffer_load_dwordx4 v13, s[16:19], s47 offen lds
  s_add_u32 m0, s44, 24576
  s_nop 0
  buffer_load_dwordx4 v14, s[16:19], s47 offen lds
  s_add_u32 m0, s44, 28672
  s_nop 0
  buffer_load_dwordx4 v15, s[16:19], s47 offen lds
  s_add_u32 s46, s46, 128
  s_add_u32 s47, s47, 262144
  s_add_u32 m0, s45, 32768
  s_nop 0
  buffer_load_dwordx4 v4, s[12:15], s46 offen lds
  s_add_u32 m0, s45, 36864
  s_nop 0
  buffer_load_dwordx4 v5, s[12:15], s46 offen lds
  s_add_u32 m0, s45, 40960
  s_nop 0
  buffer_load_dwordx4 v6, s[12:15], s46 offen lds
  s_add_u32 m0, s45, 45056
  s_nop 0
  buffer_load_dwordx4 v7, s[12:15], s46 offen lds
  s_add_u32 m0, s44, 32768
  s_nop 0
  buffer_load_dwordx4 v12, s[16:19], s47 offen lds
  s_add_u32 m0, s44, 36864
  s_nop 0
  buffer_load_dwordx4 v13, s[16:19], s47 offen lds
  s_add_u32 m0, s44, 40960
  s_nop 0
  buffer_load_dwordx4 v14, s[16:19], s47 offen lds
  s_add_u32 m0, s44, 45056
  s_nop 0
  buffer_load_dwordx4 v15, s[16:19], s47 offen lds
  s_add_u32 s47, s47, 262144
  s_add_u32 m0, s45, 49152
  s_nop 0
  buffer_load_dwordx4 v8, s[12:15], s46 offen lds
  s_add_u32 m0, s45, 53248
  s_nop 0
  buffer_load_dwordx4 v9, s[12:15], s46 offen lds
  s_add_u32 m0, s45, 57344
  s_nop 0
  buffer_load_dwordx4 v10, s[12:15], s46 offen lds
  s_add_u32 m0, s45, 61440
  s_nop 0
  buffer_load_dwordx4 v11, s[12:15], s46 offen lds
  s_add_u32 m0, s44, 49152
  s_nop 0
  buffer_load_dwordx4 v12, s[16:19], s47 offen lds
  s_add_u32 m0, s44, 53248
  s_nop 0
  buffer_load_dwordx4 v13, s[16:19], s47 offen lds
  s_add_u32 m0, s44, 57344
  s_nop 0
  buffer_load_dwordx4 v14, s[16:19], s47 offen lds
  s_add_u32 m0, s44, 61440
  s_nop 0
  buffer_load_dwordx4 v15, s[16:19], s47 offen lds
  s_add_u32 s46, s46, 128
  s_add_u32 s47, s47, 262144
  v_accvgpr_write_b32 a0, 0
  v_accvgpr_write_b32 a1, 0
  v_accvgpr_write_b32 a2, 0
  v_accvgpr_write_b32 a3, 0
  v_accvgpr_write_b32 a4, 0
  v_accvgpr_write_b32 a5, 0
  v_accvgpr_write_b32 a6, 0
  v_accvgpr_write_b32 a7, 0
  v_accvgpr_write_b32 a8, 0
  v_accvgpr_write_b32 a9, 0
  v_accvgpr_write_b32 a10, 0
  v_accvgpr_write_b32 a11, 0
  v_accvgpr_write_b32 a12, 0
  v_accvgpr_write_b32 a13, 0
  v_accvgpr_write_b32 a14, 0
  v_accvgpr_write_b32 a15, 0
  v_accvgpr_write_b32 a16, 0
  v_accvgpr_write_b32 a17, 0
  v_accvgpr_write_b32 a18, 0
  v_accvgpr_write_b32 a19, 0
  v_accvgpr_write_b32 a20, 0
  v_accvgpr_write_b32 a21, 0
  v_accvgpr_write_b32 a22, 0
  v_accvgpr_write_b32 a23, 0
  v_accvgpr_write_b32 a24, 0
  v_accvgpr_write_b32 a25, 0
  v_accvgpr_write_b32 a26, 0
  v_accvgpr_write_b32 a27, 0
  v_accvgpr_write_b32 a28, 0
  v_accvgpr_write_b32 a29, 0
  v_accvgpr_write_b32 a30, 0
  v_accvgpr_write_b32 a31, 0
  v_accvgpr_write_b32 a32, 0
  v_accvgpr_write_b32 a33, 0
  v_accvgpr_write_b32 a34, 0
  v_accvgpr_write_b32 a35, 0
  v_accvgpr_write_b32 a36, 0
  v_accvgpr_write_b32 a37, 0
  v_accvgpr_write_b32 a38, 0
  v_accvgpr_write_b32 a39, 0
  v_accvgpr_write_b32 a40, 0
  v_accvgpr_write_b32 a41, 0
  v_accvgpr_write_b32 a42, 0
  v_accvgpr_write_b32 a43, 0
  v_accvgpr_write_b32 a44, 0
  v_accvgpr_write_b32 a45, 0
  v_accvgpr_write_b32 a46, 0
  v_accvgpr_write_b32 a47, 0
  v_accvgpr_write_b32 a48, 0
  v_accvgpr_write_b32 a49, 0
  v_accvgpr_write_b32 a50, 0
  v_accvgpr_write_b32 a51, 0
  v_accvgpr_write_b32 a52, 0
  v_accvgpr_write_b32 a53, 0
  v_accvgpr_write_b32 a54, 0
  v_accvgpr_write_b32 a55, 0
  v_accvgpr_write_b32 a56, 0
  v_accvgpr_write_b32 a57, 0
  v_accvgpr_write_b32 a58, 0
  v_accvgpr_write_b32 a59, 0
  v_accvgpr_write_b32 a60, 0
  v_accvgpr_write_b32 a61, 0
  v_accvgpr_write_b32 a62, 0
  v_accvgpr_write_b32 a63, 0
  v_accvgpr_write_b32 a64, 0
  v_accvgpr_write_b32 a65, 0
  v_accvgpr_write_b32 a66, 0
  v_accvgpr_write_b32 a67, 0
  v_accvgpr_write_b32 a68, 0
  v_accvgpr_write_b32 a69, 0
  v_accvgpr_write_b32 a70, 0
  v_accvgpr_write_b32 a71, 0
  v_accvgpr_write_b32 a72, 0
  v_accvgpr_write_b32 a73, 0
  v_accvgpr_write_b32 a74, 0
  v_accvgpr_write_b32 a75, 0
  v_accvgpr_write_b32 a76, 0
  v_accvgpr_write_b32 a77, 0
  v_accvgpr_write_b32 a78, 0
  v_accvgpr_write_b32 a79, 0
  v_accvgpr_write_b32 a80, 0
  v_accvgpr_write_b32 a81, 0
  v_accvgpr_write_b32 a82, 0
  v_accvgpr_write_b32 a83, 0
  v_accvgpr_write_b32 a84, 0
  v_accvgpr_write_b32 a85, 0
  v_accvgpr_write_b32 a86, 0
  v_accvgpr_write_b32 a87, 0
  v_accvgpr_write_b32 a88, 0
  v_accvgpr_write_b32 a89, 0
  v_accvgpr_write_b32 a90, 0
  v_accvgpr_write_b32 a91, 0
  v_accvgpr_write_b32 a92, 0
  v_accvgpr_write_b32 a93, 0
  v_accvgpr_write_b32 a94, 0
  v_accvgpr_write_b32 a95, 0
  v_accvgpr_write_b32 a96, 0
  v_accvgpr_write_b32 a97, 0
  v_accvgpr_write_b32 a98, 0
  v_accvgpr_write_b32 a99, 0
  v_accvgpr_write_b32 a100, 0
  v_accvgpr_write_b32 a101, 0
  v_accvgpr_write_b32 a102, 0
  v_accvgpr_write_b32 a103, 0
  v_accvgpr_write_b32 a104, 0
  v_accvgpr_write_b32 a105, 0
  v_accvgpr_write_b32 a106, 0
  v_accvgpr_write_b32 a107, 0
  v_accvgpr_write_b32 a108, 0
  v_accvgpr_write_b32 a109, 0
  v_accvgpr_write_b32 a110, 0
  v_accvgpr_write_b32 a111, 0
  v_accvgpr_write_b32 a112, 0
  v_accvgpr_write_b32 a113, 0
  v_accvgpr_write_b32 a114, 0
  v_accvgpr_write_b32 a115, 0
  v_accvgpr_write_b32 a116, 0
  v_accvgpr_write_b32 a117, 0
  v_accvgpr_write_b32 a118, 0
  v_accvgpr_write_b32 a119, 0
  v_accvgpr_write_b32 a120, 0
  v_accvgpr_write_b32 a121, 0
  v_accvgpr_write_b32 a122, 0
  v_accvgpr_write_b32 a123, 0
  v_accvgpr_write_b32 a124, 0
  v_accvgpr_write_b32 a125, 0
  v_accvgpr_write_b32 a126, 0
  v_accvgpr_write_b32 a127, 0
  v_accvgpr_write_b32 a128, 0
  v_accvgpr_write_b32 a129, 0
  v_accvgpr_write_b32 a130, 0
  v_accvgpr_write_b32 a131, 0
  v_accvgpr_write_b32 a132, 0
  v_accvgpr_write_b32 a133, 0
  v_accvgpr_write_b32 a134, 0
  v_accvgpr_write_b32 a135, 0
  v_accvgpr_write_b32 a136, 0
  v_accvgpr_write_b32 a137, 0
  v_accvgpr_write_b32 a138, 0
  v_accvgpr_write_b32 a139, 0
  v_accvgpr_write_b32 a140, 0
  v_accvgpr_write_b32 a141, 0
  v_accvgpr_write_b32 a142, 0
  v_accvgpr_write_b32 a143, 0
  v_accvgpr_write_b32 a144, 0
  v_accvgpr_write_b32 a145, 0
  v_accvgpr_write_b32 a146, 0
  v_accvgpr_write_b32 a147, 0
  v_accvgpr_write_b32 a148, 0
  v_accvgpr_write_b32 a149, 0
  v_accvgpr_write_b32 a150, 0
  v_accvgpr_write_b32 a151, 0
  v_accvgpr_write_b32 a152, 0
  v_accvgpr_write_b32 a153, 0
  v_accvgpr_write_b32 a154, 0
  v_accvgpr_write_b32 a155, 0
  v_accvgpr_write_b32 a156, 0
  v_accvgpr_write_b32 a157, 0
  v_accvgpr_write_b32 a158, 0
  v_accvgpr_write_b32 a159, 0
  v_accvgpr_write_b32 a160, 0
  v_accvgpr_write_b32 a161, 0
  v_accvgpr_write_b32 a162, 0
  v_accvgpr_write_b32 a163, 0
  v_accvgpr_write_b32 a164, 0
  v_accvgpr_write_b32 a165, 0
  v_accvgpr_write_b32 a166, 0
  v_accvgpr_write_b32 a167, 0
  v_accvgpr_write_b32 a168, 0
  v_accvgpr_write_b32 a169, 0
  v_accvgpr_write_b32 a170, 0
  v_accvgpr_write_b32 a171, 0
  v_accvgpr_write_b32 a172, 0
  v_accvgpr_write_b32 a173, 0
  v_accvgpr_write_b32 a174, 0
  v_accvgpr_write_b32 a175, 0
  v_accvgpr_write_b32 a176, 0
  v_accvgpr_write_b32 a177, 0
  v_accvgpr_write_b32 a178, 0
  v_accvgpr_write_b32 a179, 0
  v_accvgpr_write_b32 a180, 0
  v_accvgpr_write_b32 a181, 0
  v_accvgpr_write_b32 a182, 0
  v_accvgpr_write_b32 a183, 0
  v_accvgpr_write_b32 a184, 0
  v_accvgpr_write_b32 a185, 0
  v_accvgpr_write_b32 a186, 0
  v_accvgpr_write_b32 a187, 0
  v_accvgpr_write_b32 a188, 0
  v_accvgpr_write_b32 a189, 0
  v_accvgpr_write_b32 a190, 0
  v_accvgpr_write_b32 a191, 0
  v_accvgpr_write_b32 a192, 0
  v_accvgpr_write_b32 a193, 0
  v_accvgpr_write_b32 a194, 0
  v_accvgpr_write_b32 a195, 0
  v_accvgpr_write_b32 a196, 0
  v_accvgpr_write_b32 a197, 0
  v_accvgpr_write_b32 a198, 0
  v_accvgpr_write_b32 a199, 0
  v_accvgpr_write_b32 a200, 0
  v_accvgpr_write_b32 a201, 0
  v_accvgpr_write_b32 a202, 0
  v_accvgpr_write_b32 a203, 0
  v_accvgpr_write_b32 a204, 0
  v_accvgpr_write_b32 a205, 0
  v_accvgpr_write_b32 a206, 0
  v_accvgpr_write_b32 a207, 0
  v_accvgpr_write_b32 a208, 0
  v_accvgpr_write_b32 a209, 0
  v_accvgpr_write_b32 a210, 0
  v_accvgpr_write_b32 a211, 0
  v_accvgpr_write_b32 a212, 0
  v_accvgpr_write_b32 a213, 0
  v_accvgpr_write_b32 a214, 0
  v_accvgpr_write_b32 a215, 0
  v_accvgpr_write_b32 a216, 0
  v_accvgpr_write_b32 a217, 0
  v_accvgpr_write_b32 a218, 0
  v_accvgpr_write_b32 a219, 0
  v_accvgpr_write_b32 a220, 0
  v_accvgpr_write_b32 a221, 0
  v_accvgpr_write_b32 a222, 0
  v_accvgpr_write_b32 a223, 0
  v_accvgpr_write_b32 a224, 0
  v_accvgpr_write_b32 a225, 0
  v_accvgpr_write_b32 a226, 0
  v_accvgpr_write_b32 a227, 0
  v_accvgpr_write_b32 a228, 0
  v_accvgpr_write_b32 a229, 0
  v_accvgpr_write_b32 a230, 0
  v_accvgpr_write_b32 a231, 0
  v_accvgpr_write_b32 a232, 0
  v_accvgpr_write_b32 a233, 0
  v_accvgpr_write_b32 a234, 0
  v_accvgpr_write_b32 a235, 0
  v_accvgpr_write_b32 a236, 0
  v_accvgpr_write_b32 a237, 0
  v_accvgpr_write_b32 a238, 0
  v_accvgpr_write_b32 a239, 0
  v_accvgpr_write_b32 a240, 0
  v_accvgpr_write_b32 a241, 0
  v_accvgpr_write_b32 a242, 0
  v_accvgpr_write_b32 a243, 0
  v_accvgpr_write_b32 a244, 0
  v_accvgpr_write_b32 a245, 0
  v_accvgpr_write_b32 a246, 0
  v_accvgpr_write_b32 a247, 0
  v_accvgpr_write_b32 a248, 0
  v_accvgpr_write_b32 a249, 0
  v_accvgpr_write_b32 a250, 0
  v_accvgpr_write_b32 a251, 0
  v_accvgpr_write_b32 a252, 0
  v_accvgpr_write_b32 a253, 0
  v_accvgpr_write_b32 a254, 0
  v_accvgpr_write_b32 a255, 0
  s_waitcnt vmcnt(16)
  s_barrier
  ds_read_b128 v[28:31], v16 offset:0
  ds_read_b128 v[32:35], v16 offset:2048
  ds_read_b128 v[36:39], v16 offset:4096
  ds_read_b128 v[40:43], v16 offset:6144
  ds_read_b128 v[44:47], v16 offset:8192
  ds_read_b128 v[48:51], v16 offset:10240
  ds_read_b128 v[52:55], v16 offset:12288
  ds_read_b128 v[56:59], v16 offset:14336
  ds_read_b64_tr_b16 v[60:61], v18 offset:0
  ds_read_b64_tr_b16 v[62:63], v18 offset:2048
  ds_read_b64_tr_b16 v[64:65], v19 offset:0
  ds_read_b64_tr_b16 v[66:67], v19 offset:2048
  ds_read_b64_tr_b16 v[68:69], v20 offset:0
  ds_read_b64_tr_b16 v[70:71], v20 offset:2048
  ds_read_b64_tr_b16 v[72:73], v21 offset:0
  ds_read_b64_tr_b16 v[74:75], v21 offset:2048
  ds_read_b64_tr_b16 v[76:77], v22 offset:0
  ds_read_b64_tr_b16 v[78:79], v22 offset:2048
  ds_read_b64_tr_b16 v[80:81], v23 offset:0
  ds_read_b64_tr_b16 v[82:83], v23 offset:2048
  ds_read_b64_tr_b16 v[84:85], v24 offset:0
  ds_read_b64_tr_b16 v[86:87], v24 offset:2048
  ds_read_b64_tr_b16 v[88:89], v25 offset:0
  ds_read_b64_tr_b16 v[90:91], v25 offset:2048
  s_waitcnt lgkmcnt(0)
  v_mfma_f32_16x16x32_bf16 a[0:3], v[60:63], v[28:31], a[0:3]
  ds_read_b128 v[92:95], v17 offset:0
  v_mfma_f32_16x16x32_bf16 a[4:7], v[64:67], v[28:31], a[4:7]
  ds_read_b128 v[96:99], v17 offset:2048
  v_mfma_f32_16x16x32_bf16 a[8:11], v[68:71], v[28:31], a[8:11]
  ds_read_b128 v[100:103], v17 offset:4096
  v_mfma_f32_16x16x32_bf16 a[12:15], v[72:75], v[28:31], a[12:15]
  v_mfma_f32_16x16x32_bf16 a[16:19], v[76:79], v[28:31], a[16:19]
  ds_read_b128 v[104:107], v17 offset:6144
  v_mfma_f32_16x16x32_bf16 a[20:23], v[80:83], v[28:31], a[20:23]
  ds_read_b128 v[108:111], v17 offset:8192
  v_mfma_f32_16x16x32_bf16 a[24:27], v[84:87], v[28:31], a[24:27]
  v_mfma_f32_16x16x32_bf16 a[28:31], v[88:91], v[28:31], a[28:31]
  ds_read_b128 v[112:115], v17 offset:10240
  v_mfma_f32_16x16x32_bf16 a[32:35], v[60:63], v[32:35], a[32:35]
  ds_read_b128 v[116:119], v17 offset:12288
  v_mfma_f32_16x16x32_bf16 a[36:39], v[64:67], v[32:35], a[36:39]
  v_mfma_f32_16x16x32_bf16 a[40:43], v[68:71], v[32:35], a[40:43]
  ds_read_b128 v[120:123], v17 offset:14336
  v_mfma_f32_16x16x32_bf16 a[44:47], v[72:75], v[32:35], a[44:47]
  ds_read_b64_tr_b16 v[124:125], v18 offset:16384
  v_mfma_f32_16x16x32_bf16 a[48:51], v[76:79], v[32:35], a[48:51]
  v_mfma_f32_16x16x32_bf16 a[52:55], v[80:83], v[32:35], a[52:55]
  ds_read_b64_tr_b16 v[126:127], v18 offset:18432
  v_mfma_f32_16x16x32_bf16 a[56:59], v[84:87], v[32:35], a[56:59]
  ds_read_b64_tr_b16 v[128:129], v19 offset:16384
  v_mfma_f32_16x16x32_bf16 a[60:63], v[88:91], v[32:35], a[60:63]
  v_mfma_f32_16x16x32_bf16 a[64:67], v[60:63], v[36:39], a[64:67]
  ds_read_b64_tr_b16 v[130:131], v19 offset:18432
  v_mfma_f32_16x16x32_bf16 a[68:71], v[64:67], v[36:39], a[68:71]
  ds_read_b64_tr_b16 v[132:133], v20 offset:16384
  v_mfma_f32_16x16x32_bf16 a[72:75], v[68:71], v[36:39], a[72:75]
  ds_read_b64_tr_b16 v[134:135], v20 offset:18432
  v_mfma_f32_16x16x32_bf16 a[76:79], v[72:75], v[36:39], a[76:79]
  v_mfma_f32_16x16x32_bf16 a[80:83], v[76:79], v[36:39], a[80:83]
  ds_read_b64_tr_b16 v[136:137], v21 offset:16384
  v_mfma_f32_16x16x32_bf16 a[84:87], v[80:83], v[36:39], a[84:87]
  ds_read_b64_tr_b16 v[138:139], v21 offset:18432
  v_mfma_f32_16x16x32_bf16 a[88:91], v[84:87], v[36:39], a[88:91]
  v_mfma_f32_16x16x32_bf16 a[92:95], v[88:91], v[36:39], a[92:95]
  ds_read_b64_tr_b16 v[140:141], v22 offset:16384
  v_mfma_f32_16x16x32_bf16 a[96:99], v[60:63], v[40:43], a[96:99]
  ds_read_b64_tr_b16 v[142:143], v22 offset:18432
  v_mfma_f32_16x16x32_bf16 a[100:103], v[64:67], v[40:43], a[100:103]
  v_mfma_f32_16x16x32_bf16 a[104:107], v[68:71], v[40:43], a[104:107]
  ds_read_b64_tr_b16 v[144:145], v23 offset:16384
  v_mfma_f32_16x16x32_bf16 a[108:111], v[72:75], v[40:43], a[108:111]
  ds_read_b64_tr_b16 v[146:147], v23 offset:18432
  v_mfma_f32_16x16x32_bf16 a[112:115], v[76:79], v[40:43], a[112:115]
  v_mfma_f32_16x16x32_bf16 a[116:119], v[80:83], v[40:43], a[116:119]
  ds_read_b64_tr_b16 v[148:149], v24 offset:16384
  v_mfma_f32_16x16x32_bf16 a[120:123], v[84:87], v[40:43], a[120:123]
  ds_read_b64_tr_b16 v[150:151], v24 offset:18432
  v_mfma_f32_16x16x32_bf16 a[124:127], v[88:91], v[40:43], a[124:127]
  v_mfma_f32_16x16x32_bf16 a[128:131], v[60:63], v[44:47], a[128:131]
  ds_read_b64_tr_b16 v[152:153], v25 offset:16384
  v_mfma_f32_16x16x32_bf16 a[132:135], v[64:67], v[44:47], a[132:135]
  ds_read_b64_tr_b16 v[154:155], v25 offset:18432
  v_mfma_f32_16x16x32_bf16 a[136:139], v[68:71], v[44:47], a[136:139]
  v_mfma_f32_16x16x32_bf16 a[140:143], v[72:75], v[44:47], a[140:143]
  v_mfma_f32_16x16x32_bf16 a[144:147], v[76:79], v[44:47], a[144:147]
  v_mfma_f32_16x16x32_bf16 a[148:151], v[80:83], v[44:47], a[148:151]
  v_mfma_f32_16x16x32_bf16 a[152:155], v[84:87], v[44:47], a[152:155]
  v_mfma_f32_16x16x32_bf16 a[156:159], v[88:91], v[44:47], a[156:159]
  v_mfma_f32_16x16x32_bf16 a[160:163], v[60:63], v[48:51], a[160:163]
  v_mfma_f32_16x16x32_bf16 a[164:167], v[64:67], v[48:51], a[164:167]
  v_mfma_f32_16x16x32_bf16 a[168:171], v[68:71], v[48:51], a[168:171]
  v_mfma_f32_16x16x32_bf16 a[172:175], v[72:75], v[48:51], a[172:175]
  v_mfma_f32_16x16x32_bf16 a[176:179], v[76:79], v[48:51], a[176:179]
  v_mfma_f32_16x16x32_bf16 a[180:183], v[80:83], v[48:51], a[180:183]
  v_mfma_f32_16x16x32_bf16 a[184:187], v[84:87], v[48:51], a[184:187]
  v_mfma_f32_16x16x32_bf16 a[188:191], v[88:91], v[48:51], a[188:191]
  v_mfma_f32_16x16x32_bf16 a[192:195], v[60:63], v[52:55], a[192:195]
  v_mfma_f32_16x16x32_bf16 a[196:199], v[64:67], v[52:55], a[196:199]
  v_mfma_f32_16x16x32_bf16 a[200:203], v[68:71], v[52:55], a[200:203]
  v_mfma_f32_16x16x32_bf16 a[204:207], v[72:75], v[52:55], a[204:207]
  v_mfma_f32_16x16x32_bf16 a[208:211], v[76:79], v[52:55], a[208:211]
  v_mfma_f32_16x16x32_bf16 a[212:215], v[80:83], v[52:55], a[212:215]
  v_mfma_f32_16x16x32_bf16 a[216:219], v[84:87], v[52:55], a[216:219]
  v_mfma_f32_16x16x32_bf16 a[220:223], v[88:91], v[52:55], a[220:223]
  v_mfma_f32_16x16x32_bf16 a[224:227], v[60:63], v[56:59], a[224:227]
  v_mfma_f32_16x16x32_bf16 a[228:231], v[64:67], v[56:59], a[228:231]
  v_mfma_f32_16x16x32_bf16 a[232:235], v[68:71], v[56:59], a[232:235]
  v_mfma_f32_16x16x32_bf16 a[236:239], v[72:75], v[56:59], a[236:239]
  v_mfma_f32_16x16x32_bf16 a[240:243], v[76:79], v[56:59], a[240:243]
  v_mfma_f32_16x16x32_bf16 a[244:247], v[80:83], v[56:59], a[244:247]
  v_mfma_f32_16x16x32_bf16 a[248:251], v[84:87], v[56:59], a[248:251]
  v_mfma_f32_16x16x32_bf16 a[252:255], v[88:91], v[56:59], a[252:255]
  s_waitcnt vmcnt(0) lgkmcnt(0)
  s_barrier
  v_mfma_f32_16x16x32_bf16 a[0:3], v[124:127], v[92:95], a[0:3]
  ds_read_b128 v[28:31], v16 offset:32768
  s_add_u32 m0, s45, 0
  v_mfma_f32_16x16x32_bf16 a[4:7], v[128:131], v[92:95], a[4:7]
  ds_read_b128 v[32:35], v16 offset:34816
  buffer_load_dwordx4 v4, s[12:15], s46 offen lds
  v_mfma_f32_16x16x32_bf16 a[8:11], v[132:135], v[92:95], a[8:11]
  ds_read_b128 v[36:39], v16 offset:36864
  v_mfma_f32_16x16x32_bf16 a[12:15], v[136:139], v[92:95], a[12:15]
  s_add_u32 m0, s45, 4096
  v_mfma_f32_16x16x32_bf16 a[16:19], v[140:143], v[92:95], a[16:19]
  ds_read_b128 v[40:43], v16 offset:38912
  v_mfma_f32_16x16x32_bf16 a[20:23], v[144:147], v[92:95], a[20:23]
  ds_read_b128 v[44:47], v16 offset:40960
  buffer_load_dwordx4 v5, s[12:15], s46 offen lds
  v_mfma_f32_16x16x32_bf16 a[24:27], v[148:151], v[92:95], a[24:27]
  v_mfma_f32_16x16x32_bf16 a[28:31], v[152:155], v[92:95], a[28:31]
  ds_read_b128 v[48:51], v16 offset:43008
  s_add_u32 m0, s45, 8192
  v_mfma_f32_16x16x32_bf16 a[32:35], v[124:127], v[96:99], a[32:35]
  ds_read_b128 v[52:55], v16 offset:45056
  v_mfma_f32_16x16x32_bf16 a[36:39], v[128:131], v[96:99], a[36:39]
  buffer_load_dwordx4 v6, s[12:15], s46 offen lds
  v_mfma_f32_16x16x32_bf16 a[40:43], v[132:135], v[96:99], a[40:43]
  ds_read_b128 v[56:59], v16 offset:47104
  v_mfma_f32_16x16x32_bf16 a[44:47], v[136:139], v[96:99], a[44:47]
  ds_read_b64_tr_b16 v[60:61], v18 offset:32768
  s_add_u32 m0, s45, 12288
  v_mfma_f32_16x16x32_bf16 a[48:51], v[140:143], v[96:99], a[48:51]
  v_mfma_f32_16x16x32_bf16 a[52:55], v[144:147], v[96:99], a[52:55]
  ds_read_b64_tr_b16 v[62:63], v18 offset:34816
  buffer_load_dwordx4 v7, s[12:15], s46 offen lds
  v_mfma_f32_16x16x32_bf16 a[56:59], v[148:151], v[96:99], a[56:59]
  ds_read_b64_tr_b16 v[64:65], v19 offset:32768
  v_mfma_f32_16x16x32_bf16 a[60:63], v[152:155], v[96:99], a[60:63]
  s_add_u32 m0, s44, 0
  v_mfma_f32_16x16x32_bf16 a[64:67], v[124:127], v[100:103], a[64:67]
  ds_read_b64_tr_b16 v[66:67], v19 offset:34816
  buffer_load_dwordx4 v12, s[16:19], s47 offen lds
  v_mfma_f32_16x16x32_bf16 a[68:71], v[128:131], v[100:103], a[68:71]
  ds_read_b64_tr_b16 v[68:69], v20 offset:32768
  v_mfma_f32_16x16x32_bf16 a[72:75], v[132:135], v[100:103], a[72:75]
  ds_read_b64_tr_b16 v[70:71], v20 offset:34816
  s_add_u32 m0, s44, 4096
  v_mfma_f32_16x16x32_bf16 a[76:79], v[136:139], v[100:103], a[76:79]
  v_mfma_f32_16x16x32_bf16 a[80:83], v[140:143], v[100:103], a[80:83]
  ds_read_b64_tr_b16 v[72:73], v21 offset:32768
  buffer_load_dwordx4 v13, s[16:19], s47 offen lds
  v_mfma_f32_16x16x32_bf16 a[84:87], v[144:147], v[100:103], a[84:87]
  ds_read_b64_tr_b16 v[74:75], v21 offset:34816
  v_mfma_f32_16x16x32_bf16 a[88:91], v[148:151], v[100:103], a[88:91]
  s_add_u32 m0, s44, 8192
  v_mfma_f32_16x16x32_bf16 a[92:95], v[152:155], v[100:103], a[92:95]
  ds_read_b64_tr_b16 v[76:77], v22 offset:32768
  v_mfma_f32_16x16x32_bf16 a[96:99], v[124:127], v[104:107], a[96:99]
  ds_read_b64_tr_b16 v[78:79], v22 offset:34816
  buffer_load_dwordx4 v14, s[16:19], s47 offen lds
  v_mfma_f32_16x16x32_bf16 a[100:103], v[128:131], v[104:107], a[100:103]
  v_mfma_f32_16x16x32_bf16 a[104:107], v[132:135], v[104:107], a[104:107]
  ds_read_b64_tr_b16 v[80:81], v23 offset:32768
  s_add_u32 m0, s44, 12288
  v_mfma_f32_16x16x32_bf16 a[108:111], v[136:139], v[104:107], a[108:111]
  ds_read_b64_tr_b16 v[82:83], v23 offset:34816
  v_mfma_f32_16x16x32_bf16 a[112:115], v[140:143], v[104:107], a[112:115]
  buffer_load_dwordx4 v15, s[16:19], s47 offen lds
  v_mfma_f32_16x16x32_bf16 a[116:119], v[144:147], v[104:107], a[116:119]
  ds_read_b64_tr_b16 v[84:85], v24 offset:32768
  v_mfma_f32_16x16x32_bf16 a[120:123], v[148:151], v[104:107], a[120:123]
  ds_read_b64_tr_b16 v[86:87], v24 offset:34816
  s_add_u32 s47, s47, 262144
  v_mfma_f32_16x16x32_bf16 a[124:127], v[152:155], v[104:107], a[124:127]
  v_mfma_f32_16x16x32_bf16 a[128:131], v[124:127], v[108:111], a[128:131]
  ds_read_b64_tr_b16 v[88:89], v25 offset:32768
  s_add_u32 m0, s45, 16384
  v_mfma_f32_16x16x32_bf16 a[132:135], v[128:131], v[108:111], a[132:135]
  ds_read_b64_tr_b16 v[90:91], v25 offset:34816
  buffer_load_dwordx4 v8, s[12:15], s46 offen lds
  v_mfma_f32_16x16x32_bf16 a[136:139], v[132:135], v[108:111], a[136:139]
  v_mfma_f32_16x16x32_bf16 a[140:143], v[136:139], v[108:111], a[140:143]
  s_add_u32 m0, s45, 20480
  v_mfma_f32_16x16x32_bf16 a[144:147], v[140:143], v[108:111], a[144:147]
  v_mfma_f32_16x16x32_bf16 a[148:151], v[144:147], v[108:111], a[148:151]
  buffer_load_dwordx4 v9, s[12:15], s46 offen lds
  v_mfma_f32_16x16x32_bf16 a[152:155], v[148:151], v[108:111], a[152:155]
  v_mfma_f32_16x16x32_bf16 a[156:159], v[152:155], v[108:111], a[156:159]
  s_add_u32 m0, s45, 24576
  v_mfma_f32_16x16x32_bf16 a[160:163], v[124:127], v[112:115], a[160:163]
  v_mfma_f32_16x16x32_bf16 a[164:167], v[128:131], v[112:115], a[164:167]
  buffer_load_dwordx4 v10, s[12:15], s46 offen lds
  v_mfma_f32_16x16x32_bf16 a[168:171], v[132:135], v[112:115], a[168:171]
  v_mfma_f32_16x16x32_bf16 a[172:175], v[136:139], v[112:115], a[172:175]
  s_add_u32 m0, s45, 28672
  v_mfma_f32_16x16x32_bf16 a[176:179], v[140:143], v[112:115], a[176:179]
  v_mfma_f32_16x16x32_bf16 a[180:183], v[144:147], v[112:115], a[180:183]
  buffer_load_dwordx4 v11, s[12:15], s46 offen lds
  v_mfma_f32_16x16x32_bf16 a[184:187], v[148:151], v[112:115], a[184:187]
  v_mfma_f32_16x16x32_bf16 a[188:191], v[152:155], v[112:115], a[188:191]
  s_add_u32 m0, s44, 16384
  v_mfma_f32_16x16x32_bf16 a[192:195], v[124:127], v[116:119], a[192:195]
  buffer_load_dwordx4 v12, s[16:19], s47 offen lds
  v_mfma_f32_16x16x32_bf16 a[196:199], v[128:131], v[116:119], a[196:199]
  v_mfma_f32_16x16x32_bf16 a[200:203], v[132:135], v[116:119], a[200:203]
  s_add_u32 m0, s44, 20480
  v_mfma_f32_16x16x32_bf16 a[204:207], v[136:139], v[116:119], a[204:207]
  v_mfma_f32_16x16x32_bf16 a[208:211], v[140:143], v[116:119], a[208:211]
  buffer_load_dwordx4 v13, s[16:19], s47 offen lds
  v_mfma_f32_16x16x32_bf16 a[212:215], v[144:147], v[116:119], a[212:215]
  v_mfma_f32_16x16x32_bf16 a[216:219], v[148:151], v[116:119], a[216:219]
  s_add_u32 m0, s44, 24576
  v_mfma_f32_16x16x32_bf16 a[220:223], v[152:155], v[116:119], a[220:223]
  v_mfma_f32_16x16x32_bf16 a[224:227], v[124:127], v[120:123], a[224:227]
  buffer_load_dwordx4 v14, s[16:19], s47 offen lds
  v_mfma_f32_16x16x32_bf16 a[228:231], v[128:131], v[120:123], a[228:231]
  v_mfma_f32_16x16x32_bf16 a[232:235], v[132:135], v[120:123], a[232:235]
  s_add_u32 m0, s44, 28672
  v_mfma_f32_16x16x32_bf16 a[236:239], v[136:139], v[120:123], a[236:239]
  v_mfma_f32_16x16x32_bf16 a[240:243], v[140:143], v[120:123], a[240:243]
  buffer_load_dwordx4 v15, s[16:19], s47 offen lds
  v_mfma_f32_16x16x32_bf16 a[244:247], v[144:147], v[120:123], a[244:247]
  v_mfma_f32_16x16x32_bf16 a[248:251], v[148:151], v[120:123], a[248:251]
  s_add_u32 s46, s46, 128
  s_add_u32 s47, s47, 262144
  v_mfma_f32_16x16x32_bf16 a[252:255], v[152:155], v[120:123], a[252:255]
  s_mov_b32 s48, 3
Lqk_44_loop:
  s_waitcnt lgkmcnt(0)
  v_mfma_f32_16x16x32_bf16 a[0:3], v[60:63], v[28:31], a[0:3]
  ds_read_b128 v[92:95], v17 offset:32768
  v_mfma_f32_16x16x32_bf16 a[4:7], v[64:67], v[28:31], a[4:7]
  ds_read_b128 v[96:99], v17 offset:34816
  v_mfma_f32_16x16x32_bf16 a[8:11], v[68:71], v[28:31], a[8:11]
  ds_read_b128 v[100:103], v17 offset:36864
  v_mfma_f32_16x16x32_bf16 a[12:15], v[72:75], v[28:31], a[12:15]
  v_mfma_f32_16x16x32_bf16 a[16:19], v[76:79], v[28:31], a[16:19]
  ds_read_b128 v[104:107], v17 offset:38912
  v_mfma_f32_16x16x32_bf16 a[20:23], v[80:83], v[28:31], a[20:23]
  ds_read_b128 v[108:111], v17 offset:40960
  v_mfma_f32_16x16x32_bf16 a[24:27], v[84:87], v[28:31], a[24:27]
  v_mfma_f32_16x16x32_bf16 a[28:31], v[88:91], v[28:31], a[28:31]
  ds_read_b128 v[112:115], v17 offset:43008
  v_mfma_f32_16x16x32_bf16 a[32:35], v[60:63], v[32:35], a[32:35]
  ds_read_b128 v[116:119], v17 offset:45056
  v_mfma_f32_16x16x32_bf16 a[36:39], v[64:67], v[32:35], a[36:39]
  v_mfma_f32_16x16x32_bf16 a[40:43], v[68:71], v[32:35], a[40:43]
  ds_read_b128 v[120:123], v17 offset:47104
  v_mfma_f32_16x16x32_bf16 a[44:47], v[72:75], v[32:35], a[44:47]
  ds_read_b64_tr_b16 v[124:125], v18 offset:49152
  v_mfma_f32_16x16x32_bf16 a[48:51], v[76:79], v[32:35], a[48:51]
  v_mfma_f32_16x16x32_bf16 a[52:55], v[80:83], v[32:35], a[52:55]
  ds_read_b64_tr_b16 v[126:127], v18 offset:51200
  v_mfma_f32_16x16x32_bf16 a[56:59], v[84:87], v[32:35], a[56:59]
  ds_read_b64_tr_b16 v[128:129], v19 offset:49152
  v_mfma_f32_16x16x32_bf16 a[60:63], v[88:91], v[32:35], a[60:63]
  v_mfma_f32_16x16x32_bf16 a[64:67], v[60:63], v[36:39], a[64:67]
  ds_read_b64_tr_b16 v[130:131], v19 offset:51200
  v_mfma_f32_16x16x32_bf16 a[68:71], v[64:67], v[36:39], a[68:71]
  ds_read_b64_tr_b16 v[132:133], v20 offset:49152
  v_mfma_f32_16x16x32_bf16 a[72:75], v[68:71], v[36:39], a[72:75]
  ds_read_b64_tr_b16 v[134:135], v20 offset:51200
  v_mfma_f32_16x16x32_bf16 a[76:79], v[72:75], v[36:39], a[76:79]
  v_mfma_f32_16x16x32_bf16 a[80:83], v[76:79], v[36:39], a[80:83]
  ds_read_b64_tr_b16 v[136:137], v21 offset:49152
  v_mfma_f32_16x16x32_bf16 a[84:87], v[80:83], v[36:39], a[84:87]
  ds_read_b64_tr_b16 v[138:139], v21 offset:51200
  v_mfma_f32_16x16x32_bf16 a[88:91], v[84:87], v[36:39], a[88:91]
  v_mfma_f32_16x16x32_bf16 a[92:95], v[88:91], v[36:39], a[92:95]
  ds_read_b64_tr_b16 v[140:141], v22 offset:49152
  v_mfma_f32_16x16x32_bf16 a[96:99], v[60:63], v[40:43], a[96:99]
  ds_read_b64_tr_b16 v[142:143], v22 offset:51200
  v_mfma_f32_16x16x32_bf16 a[100:103], v[64:67], v[40:43], a[100:103]
  v_mfma_f32_16x16x32_bf16 a[104:107], v[68:71], v[40:43], a[104:107]
  ds_read_b64_tr_b16 v[144:145], v23 offset:49152
  v_mfma_f32_16x16x32_bf16 a[108:111], v[72:75], v[40:43], a[108:111]
  ds_read_b64_tr_b16 v[146:147], v23 offset:51200
  v_mfma_f32_16x16x32_bf16 a[112:115], v[76:79], v[40:43], a[112:115]
  v_mfma_f32_16x16x32_bf16 a[116:119], v[80:83], v[40:43], a[116:119]
  ds_read_b64_tr_b16 v[148:149], v24 offset:49152
  v_mfma_f32_16x16x32_bf16 a[120:123], v[84:87], v[40:43], a[120:123]
  ds_read_b64_tr_b16 v[150:151], v24 offset:51200
  v_mfma_f32_16x16x32_bf16 a[124:127], v[88:91], v[40:43], a[124:127]
  v_mfma_f32_16x16x32_bf16 a[128:131], v[60:63], v[44:47], a[128:131]
  ds_read_b64_tr_b16 v[152:153], v25 offset:49152
  v_mfma_f32_16x16x32_bf16 a[132:135], v[64:67], v[44:47], a[132:135]
  ds_read_b64_tr_b16 v[154:155], v25 offset:51200
  v_mfma_f32_16x16x32_bf16 a[136:139], v[68:71], v[44:47], a[136:139]
  v_mfma_f32_16x16x32_bf16 a[140:143], v[72:75], v[44:47], a[140:143]
  v_mfma_f32_16x16x32_bf16 a[144:147], v[76:79], v[44:47], a[144:147]
  v_mfma_f32_16x16x32_bf16 a[148:151], v[80:83], v[44:47], a[148:151]
  v_mfma_f32_16x16x32_bf16 a[152:155], v[84:87], v[44:47], a[152:155]
  v_mfma_f32_16x16x32_bf16 a[156:159], v[88:91], v[44:47], a[156:159]
  v_mfma_f32_16x16x32_bf16 a[160:163], v[60:63], v[48:51], a[160:163]
  v_mfma_f32_16x16x32_bf16 a[164:167], v[64:67], v[48:51], a[164:167]
  v_mfma_f32_16x16x32_bf16 a[168:171], v[68:71], v[48:51], a[168:171]
  v_mfma_f32_16x16x32_bf16 a[172:175], v[72:75], v[48:51], a[172:175]
  v_mfma_f32_16x16x32_bf16 a[176:179], v[76:79], v[48:51], a[176:179]
  v_mfma_f32_16x16x32_bf16 a[180:183], v[80:83], v[48:51], a[180:183]
  v_mfma_f32_16x16x32_bf16 a[184:187], v[84:87], v[48:51], a[184:187]
  v_mfma_f32_16x16x32_bf16 a[188:191], v[88:91], v[48:51], a[188:191]
  v_mfma_f32_16x16x32_bf16 a[192:195], v[60:63], v[52:55], a[192:195]
  v_mfma_f32_16x16x32_bf16 a[196:199], v[64:67], v[52:55], a[196:199]
  v_mfma_f32_16x16x32_bf16 a[200:203], v[68:71], v[52:55], a[200:203]
  v_mfma_f32_16x16x32_bf16 a[204:207], v[72:75], v[52:55], a[204:207]
  v_mfma_f32_16x16x32_bf16 a[208:211], v[76:79], v[52:55], a[208:211]
  v_mfma_f32_16x16x32_bf16 a[212:215], v[80:83], v[52:55], a[212:215]
  v_mfma_f32_16x16x32_bf16 a[216:219], v[84:87], v[52:55], a[216:219]
  v_mfma_f32_16x16x32_bf16 a[220:223], v[88:91], v[52:55], a[220:223]
  v_mfma_f32_16x16x32_bf16 a[224:227], v[60:63], v[56:59], a[224:227]
  v_mfma_f32_16x16x32_bf16 a[228:231], v[64:67], v[56:59], a[228:231]
  v_mfma_f32_16x16x32_bf16 a[232:235], v[68:71], v[56:59], a[232:235]
  v_mfma_f32_16x16x32_bf16 a[236:239], v[72:75], v[56:59], a[236:239]
  v_mfma_f32_16x16x32_bf16 a[240:243], v[76:79], v[56:59], a[240:243]
  v_mfma_f32_16x16x32_bf16 a[244:247], v[80:83], v[56:59], a[244:247]
  v_mfma_f32_16x16x32_bf16 a[248:251], v[84:87], v[56:59], a[248:251]
  v_mfma_f32_16x16x32_bf16 a[252:255], v[88:91], v[56:59], a[252:255]
  s_waitcnt vmcnt(0) lgkmcnt(0)
  s_barrier
  v_mfma_f32_16x16x32_bf16 a[0:3], v[124:127], v[92:95], a[0:3]
  ds_read_b128 v[28:31], v16 offset:0
  s_add_u32 m0, s45, 32768
  v_mfma_f32_16x16x32_bf16 a[4:7], v[128:131], v[92:95], a[4:7]
  ds_read_b128 v[32:35], v16 offset:2048
  buffer_load_dwordx4 v4, s[12:15], s46 offen lds
  v_mfma_f32_16x16x32_bf16 a[8:11], v[132:135], v[92:95], a[8:11]
  ds_read_b128 v[36:39], v16 offset:4096
  v_mfma_f32_16x16x32_bf16 a[12:15], v[136:139], v[92:95], a[12:15]
  s_add_u32 m0, s45, 36864
  v_mfma_f32_16x16x32_bf16 a[16:19], v[140:143], v[92:95], a[16:19]
  ds_read_b128 v[40:43], v16 offset:6144
  v_mfma_f32_16x16x32_bf16 a[20:23], v[144:147], v[92:95], a[20:23]
  ds_read_b128 v[44:47], v16 offset:8192
  buffer_load_dwordx4 v5, s[12:15], s46 offen lds
  v_mfma_f32_16x16x32_bf16 a[24:27], v[148:151], v[92:95], a[24:27]
  v_mfma_f32_16x16x32_bf16 a[28:31], v[152:155], v[92:95], a[28:31]
  ds_read_b128 v[48:51], v16 offset:10240
  s_add_u32 m0, s45, 40960
  v_mfma_f32_16x16x32_bf16 a[32:35], v[124:127], v[96:99], a[32:35]
  ds_read_b128 v[52:55], v16 offset:12288
  v_mfma_f32_16x16x32_bf16 a[36:39], v[128:131], v[96:99], a[36:39]
  buffer_load_dwordx4 v6, s[12:15], s46 offen lds
  v_mfma_f32_16x16x32_bf16 a[40:43], v[132:135], v[96:99], a[40:43]
  ds_read_b128 v[56:59], v16 offset:14336
  v_mfma_f32_16x16x32_bf16 a[44:47], v[136:139], v[96:99], a[44:47]
  ds_read_b64_tr_b16 v[60:61], v18 offset:0
  s_add_u32 m0, s45, 45056
  v_mfma_f32_16x16x32_bf16 a[48:51], v[140:143], v[96:99], a[48:51]
  v_mfma_f32_16x16x32_bf16 a[52:55], v[144:147], v[96:99], a[52:55]
  ds_read_b64_tr_b16 v[62:63], v18 offset:2048
  buffer_load_dwordx4 v7, s[12:15], s46 offen lds
  v_mfma_f32_16x16x32_bf16 a[56:59], v[148:151], v[96:99], a[56:59]
  ds_read_b64_tr_b16 v[64:65], v19 offset:0
  v_mfma_f32_16x16x32_bf16 a[60:63], v[152:155], v[96:99], a[60:63]
  s_add_u32 m0, s44, 32768
  v_mfma_f32_16x16x32_bf16 a[64:67], v[124:127], v[100:103], a[64:67]
  ds_read_b64_tr_b16 v[66:67], v19 offset:2048
  buffer_load_dwordx4 v12, s[16:19], s47 offen lds
  v_mfma_f32_16x16x32_bf16 a[68:71], v[128:131], v[100:103], a[68:71]
  ds_read_b64_tr_b16 v[68:69], v20 offset:0
  v_mfma_f32_16x16x32_bf16 a[72:75], v[132:135], v[100:103], a[72:75]
  ds_read_b64_tr_b16 v[70:71], v20 offset:2048
  s_add_u32 m0, s44, 36864
  v_mfma_f32_16x16x32_bf16 a[76:79], v[136:139], v[100:103], a[76:79]
  v_mfma_f32_16x16x32_bf16 a[80:83], v[140:143], v[100:103], a[80:83]
  ds_read_b64_tr_b16 v[72:73], v21 offset:0
  buffer_load_dwordx4 v13, s[16:19], s47 offen lds
  v_mfma_f32_16x16x32_bf16 a[84:87], v[144:147], v[100:103], a[84:87]
  ds_read_b64_tr_b16 v[74:75], v21 offset:2048
  v_mfma_f32_16x16x32_bf16 a[88:91], v[148:151], v[100:103], a[88:91]
  s_add_u32 m0, s44, 40960
  v_mfma_f32_16x16x32_bf16 a[92:95], v[152:155], v[100:103], a[92:95]
  ds_read_b64_tr_b16 v[76:77], v22 offset:0
  v_mfma_f32_16x16x32_bf16 a[96:99], v[124:127], v[104:107], a[96:99]
  ds_read_b64_tr_b16 v[78:79], v22 offset:2048
  buffer_load_dwordx4 v14, s[16:19], s47 offen lds
  v_mfma_f32_16x16x32_bf16 a[100:103], v[128:131], v[104:107], a[100:103]
  v_mfma_f32_16x16x32_bf16 a[104:107], v[132:135], v[104:107], a[104:107]
  ds_read_b64_tr_b16 v[80:81], v23 offset:0
  s_add_u32 m0, s44, 45056
  v_mfma_f32_16x16x32_bf16 a[108:111], v[136:139], v[104:107], a[108:111]
  ds_read_b64_tr_b16 v[82:83], v23 offset:2048
  v_mfma_f32_16x16x32_bf16 a[112:115], v[140:143], v[104:107], a[112:115]
  buffer_load_dwordx4 v15, s[16:19], s47 offen lds
  v_mfma_f32_16x16x32_bf16 a[116:119], v[144:147], v[104:107], a[116:119]
  ds_read_b64_tr_b16 v[84:85], v24 offset:0
  v_mfma_f32_16x16x32_bf16 a[120:123], v[148:151], v[104:107], a[120:123]
  ds_read_b64_tr_b16 v[86:87], v24 offset:2048
  s_add_u32 s47, s47, 262144
  v_mfma_f32_16x16x32_bf16 a[124:127], v[152:155], v[104:107], a[124:127]
  v_mfma_f32_16x16x32_bf16 a[128:131], v[124:127], v[108:111], a[128:131]
  ds_read_b64_tr_b16 v[88:89], v25 offset:0
  s_add_u32 m0, s45, 49152
  v_mfma_f32_16x16x32_bf16 a[132:135], v[128:131], v[108:111], a[132:135]
  ds_read_b64_tr_b16 v[90:91], v25 offset:2048
  buffer_load_dwordx4 v8, s[12:15], s46 offen lds
  v_mfma_f32_16x16x32_bf16 a[136:139], v[132:135], v[108:111], a[136:139]
  v_mfma_f32_16x16x32_bf16 a[140:143], v[136:139], v[108:111], a[140:143]
  s_add_u32 m0, s45, 53248
  v_mfma_f32_16x16x32_bf16 a[144:147], v[140:143], v[108:111], a[144:147]
  v_mfma_f32_16x16x32_bf16 a[148:151], v[144:147], v[108:111], a[148:151]
  buffer_load_dwordx4 v9, s[12:15], s46 offen lds
  v_mfma_f32_16x16x32_bf16 a[152:155], v[148:151], v[108:111], a[152:155]
  v_mfma_f32_16x16x32_bf16 a[156:159], v[152:155], v[108:111], a[156:159]
  s_add_u32 m0, s45, 57344
  v_mfma_f32_16x16x32_bf16 a[160:163], v[124:127], v[112:115], a[160:163]
  v_mfma_f32_16x16x32_bf16 a[164:167], v[128:131], v[112:115], a[164:167]
  buffer_load_dwordx4 v10, s[12:15], s46 offen lds
  v_mfma_f32_16x16x32_bf16 a[168:171], v[132:135], v[112:115], a[168:171]
  v_mfma_f32_16x16x32_bf16 a[172:175], v[136:139], v[112:115], a[172:175]
  s_add_u32 m0, s45, 61440
  v_mfma_f32_16x16x32_bf16 a[176:179], v[140:143], v[112:115], a[176:179]
  v_mfma_f32_16x16x32_bf16 a[180:183], v[144:147], v[112:115], a[180:183]
  buffer_load_dwordx4 v11, s[12:15], s46 offen lds
  v_mfma_f32_16x16x32_bf16 a[184:187], v[148:151], v[112:115], a[184:187]
  v_mfma_f32_16x16x32_bf16 a[188:191], v[152:155], v[112:115], a[188:191]
  s_add_u32 m0, s44, 49152
  v_mfma_f32_16x16x32_bf16 a[192:195], v[124:127], v[116:119], a[192:195]
  buffer_load_dwordx4 v12, s[16:19], s47 offen lds
  v_mfma_f32_16x16x32_bf16 a[196:199], v[128:131], v[116:119], a[196:199]
  v_mfma_f32_16x16x32_bf16 a[200:203], v[132:135], v[116:119], a[200:203]
  s_add_u32 m0, s44, 53248
  v_mfma_f32_16x16x32_bf16 a[204:207], v[136:139], v[116:119], a[204:207]
  v_mfma_f32_16x16x32_bf16 a[208:211], v[140:143], v[116:119], a[208:211]
  buffer_load_dwordx4 v13, s[16:19], s47 offen lds
  v_mfma_f32_16x16x32_bf16 a[212:215], v[144:147], v[116:119], a[212:215]
  v_mfma_f32_16x16x32_bf16 a[216:219], v[148:151], v[116:119], a[216:219]
  s_add_u32 m0, s44, 57344
  v_mfma_f32_16x16x32_bf16 a[220:223], v[152:155], v[116:119], a[220:223]
  v_mfma_f32_16x16x32_bf16 a[224:227], v[124:127], v[120:123], a[224:227]
  buffer_load_dwordx4 v14, s[16:19], s47 offen lds
  v_mfma_f32_16x16x32_bf16 a[228:231], v[128:131], v[120:123], a[228:231]
  v_mfma_f32_16x16x32_bf16 a[232:235], v[132:135], v[120:123], a[232:235]
  s_add_u32 m0, s44, 61440
  v_mfma_f32_16x16x32_bf16 a[236:239], v[136:139], v[120:123], a[236:239]
  v_mfma_f32_16x16x32_bf16 a[240:243], v[140:143], v[120:123], a[240:243]
  buffer_load_dwordx4 v15, s[16:19], s47 offen lds
  v_mfma_f32_16x16x32_bf16 a[244:247], v[144:147], v[120:123], a[244:247]
  v_mfma_f32_16x16x32_bf16 a[248:251], v[148:151], v[120:123], a[248:251]
  s_add_u32 s46, s46, 128
  s_add_u32 s47, s47, 262144
  v_mfma_f32_16x16x32_bf16 a[252:255], v[152:155], v[120:123], a[252:255]
  s_waitcnt lgkmcnt(0)
  v_mfma_f32_16x16x32_bf16 a[0:3], v[60:63], v[28:31], a[0:3]
  ds_read_b128 v[92:95], v17 offset:0
  v_mfma_f32_16x16x32_bf16 a[4:7], v[64:67], v[28:31], a[4:7]
  ds_read_b128 v[96:99], v17 offset:2048
  v_mfma_f32_16x16x32_bf16 a[8:11], v[68:71], v[28:31], a[8:11]
  ds_read_b128 v[100:103], v17 offset:4096
  v_mfma_f32_16x16x32_bf16 a[12:15], v[72:75], v[28:31], a[12:15]
  v_mfma_f32_16x16x32_bf16 a[16:19], v[76:79], v[28:31], a[16:19]
  ds_read_b128 v[104:107], v17 offset:6144
  v_mfma_f32_16x16x32_bf16 a[20:23], v[80:83], v[28:31], a[20:23]
  ds_read_b128 v[108:111], v17 offset:8192
  v_mfma_f32_16x16x32_bf16 a[24:27], v[84:87], v[28:31], a[24:27]
  v_mfma_f32_16x16x32_bf16 a[28:31], v[88:91], v[28:31], a[28:31]
  ds_read_b128 v[112:115], v17 offset:10240
  v_mfma_f32_16x16x32_bf16 a[32:35], v[60:63], v[32:35], a[32:35]
  ds_read_b128 v[116:119], v17 offset:12288
  v_mfma_f32_16x16x32_bf16 a[36:39], v[64:67], v[32:35], a[36:39]
  v_mfma_f32_16x16x32_bf16 a[40:43], v[68:71], v[32:35], a[40:43]
  ds_read_b128 v[120:123], v17 offset:14336
  v_mfma_f32_16x16x32_bf16 a[44:47], v[72:75], v[32:35], a[44:47]
  ds_read_b64_tr_b16 v[124:125], v18 offset:16384
  v_mfma_f32_16x16x32_bf16 a[48:51], v[76:79], v[32:35], a[48:51]
  v_mfma_f32_16x16x32_bf16 a[52:55], v[80:83], v[32:35], a[52:55]
  ds_read_b64_tr_b16 v[126:127], v18 offset:18432
  v_mfma_f32_16x16x32_bf16 a[56:59], v[84:87], v[32:35], a[56:59]
  ds_read_b64_tr_b16 v[128:129], v19 offset:16384
  v_mfma_f32_16x16x32_bf16 a[60:63], v[88:91], v[32:35], a[60:63]
  v_mfma_f32_16x16x32_bf16 a[64:67], v[60:63], v[36:39], a[64:67]
  ds_read_b64_tr_b16 v[130:131], v19 offset:18432
  v_mfma_f32_16x16x32_bf16 a[68:71], v[64:67], v[36:39], a[68:71]
  ds_read_b64_tr_b16 v[132:133], v20 offset:16384
  v_mfma_f32_16x16x32_bf16 a[72:75], v[68:71], v[36:39], a[72:75]
  ds_read_b64_tr_b16 v[134:135], v20 offset:18432
  v_mfma_f32_16x16x32_bf16 a[76:79], v[72:75], v[36:39], a[76:79]
  v_mfma_f32_16x16x32_bf16 a[80:83], v[76:79], v[36:39], a[80:83]
  ds_read_b64_tr_b16 v[136:137], v21 offset:16384
  v_mfma_f32_16x16x32_bf16 a[84:87], v[80:83], v[36:39], a[84:87]
  ds_read_b64_tr_b16 v[138:139], v21 offset:18432
  v_mfma_f32_16x16x32_bf16 a[88:91], v[84:87], v[36:39], a[88:91]
  v_mfma_f32_16x16x32_bf16 a[92:95], v[88:91], v[36:39], a[92:95]
  ds_read_b64_tr_b16 v[140:141], v22 offset:16384
  v_mfma_f32_16x16x32_bf16 a[96:99], v[60:63], v[40:43], a[96:99]
  ds_read_b64_tr_b16 v[142:143], v22 offset:18432
  v_mfma_f32_16x16x32_bf16 a[100:103], v[64:67], v[40:43], a[100:103]
  v_mfma_f32_16x16x32_bf16 a[104:107], v[68:71], v[40:43], a[104:107]
  ds_read_b64_tr_b16 v[144:145], v23 offset:16384
  v_mfma_f32_16x16x32_bf16 a[108:111], v[72:75], v[40:43], a[108:111]
  ds_read_b64_tr_b16 v[146:147], v23 offset:18432
  v_mfma_f32_16x16x32_bf16 a[112:115], v[76:79], v[40:43], a[112:115]
  v_mfma_f32_16x16x32_bf16 a[116:119], v[80:83], v[40:43], a[116:119]
  ds_read_b64_tr_b16 v[148:149], v24 offset:16384
  v_mfma_f32_16x16x32_bf16 a[120:123], v[84:87], v[40:43], a[120:123]
  ds_read_b64_tr_b16 v[150:151], v24 offset:18432
  v_mfma_f32_16x16x32_bf16 a[124:127], v[88:91], v[40:43], a[124:127]
  v_mfma_f32_16x16x32_bf16 a[128:131], v[60:63], v[44:47], a[128:131]
  ds_read_b64_tr_b16 v[152:153], v25 offset:16384
  v_mfma_f32_16x16x32_bf16 a[132:135], v[64:67], v[44:47], a[132:135]
  ds_read_b64_tr_b16 v[154:155], v25 offset:18432
  v_mfma_f32_16x16x32_bf16 a[136:139], v[68:71], v[44:47], a[136:139]
  v_mfma_f32_16x16x32_bf16 a[140:143], v[72:75], v[44:47], a[140:143]
  v_mfma_f32_16x16x32_bf16 a[144:147], v[76:79], v[44:47], a[144:147]
  v_mfma_f32_16x16x32_bf16 a[148:151], v[80:83], v[44:47], a[148:151]
  v_mfma_f32_16x16x32_bf16 a[152:155], v[84:87], v[44:47], a[152:155]
  v_mfma_f32_16x16x32_bf16 a[156:159], v[88:91], v[44:47], a[156:159]
  v_mfma_f32_16x16x32_bf16 a[160:163], v[60:63], v[48:51], a[160:163]
  v_mfma_f32_16x16x32_bf16 a[164:167], v[64:67], v[48:51], a[164:167]
  v_mfma_f32_16x16x32_bf16 a[168:171], v[68:71], v[48:51], a[168:171]
  v_mfma_f32_16x16x32_bf16 a[172:175], v[72:75], v[48:51], a[172:175]
  v_mfma_f32_16x16x32_bf16 a[176:179], v[76:79], v[48:51], a[176:179]
  v_mfma_f32_16x16x32_bf16 a[180:183], v[80:83], v[48:51], a[180:183]
  v_mfma_f32_16x16x32_bf16 a[184:187], v[84:87], v[48:51], a[184:187]
  v_mfma_f32_16x16x32_bf16 a[188:191], v[88:91], v[48:51], a[188:191]
  v_mfma_f32_16x16x32_bf16 a[192:195], v[60:63], v[52:55], a[192:195]
  v_mfma_f32_16x16x32_bf16 a[196:199], v[64:67], v[52:55], a[196:199]
  v_mfma_f32_16x16x32_bf16 a[200:203], v[68:71], v[52:55], a[200:203]
  v_mfma_f32_16x16x32_bf16 a[204:207], v[72:75], v[52:55], a[204:207]
  v_mfma_f32_16x16x32_bf16 a[208:211], v[76:79], v[52:55], a[208:211]
  v_mfma_f32_16x16x32_bf16 a[212:215], v[80:83], v[52:55], a[212:215]
  v_mfma_f32_16x16x32_bf16 a[216:219], v[84:87], v[52:55], a[216:219]
  v_mfma_f32_16x16x32_bf16 a[220:223], v[88:91], v[52:55], a[220:223]
  v_mfma_f32_16x16x32_bf16 a[224:227], v[60:63], v[56:59], a[224:227]
  v_mfma_f32_16x16x32_bf16 a[228:231], v[64:67], v[56:59], a[228:231]
  v_mfma_f32_16x16x32_bf16 a[232:235], v[68:71], v[56:59], a[232:235]
  v_mfma_f32_16x16x32_bf16 a[236:239], v[72:75], v[56:59], a[236:239]
  v_mfma_f32_16x16x32_bf16 a[240:243], v[76:79], v[56:59], a[240:243]
  v_mfma_f32_16x16x32_bf16 a[244:247], v[80:83], v[56:59], a[244:247]
  v_mfma_f32_16x16x32_bf16 a[248:251], v[84:87], v[56:59], a[248:251]
  v_mfma_f32_16x16x32_bf16 a[252:255], v[88:91], v[56:59], a[252:255]
  s_waitcnt vmcnt(0) lgkmcnt(0)
  s_barrier
  v_mfma_f32_16x16x32_bf16 a[0:3], v[124:127], v[92:95], a[0:3]
  ds_read_b128 v[28:31], v16 offset:32768
  s_add_u32 m0, s45, 0
  v_mfma_f32_16x16x32_bf16 a[4:7], v[128:131], v[92:95], a[4:7]
  ds_read_b128 v[32:35], v16 offset:34816
  buffer_load_dwordx4 v4, s[12:15], s46 offen lds
  v_mfma_f32_16x16x32_bf16 a[8:11], v[132:135], v[92:95], a[8:11]
  ds_read_b128 v[36:39], v16 offset:36864
  v_mfma_f32_16x16x32_bf16 a[12:15], v[136:139], v[92:95], a[12:15]
  s_add_u32 m0, s45, 4096
  v_mfma_f32_16x16x32_bf16 a[16:19], v[140:143], v[92:95], a[16:19]
  ds_read_b128 v[40:43], v16 offset:38912
  v_mfma_f32_16x16x32_bf16 a[20:23], v[144:147], v[92:95], a[20:23]
  ds_read_b128 v[44:47], v16 offset:40960
  buffer_load_dwordx4 v5, s[12:15], s46 offen lds
  v_mfma_f32_16x16x32_bf16 a[24:27], v[148:151], v[92:95], a[24:27]
  v_mfma_f32_16x16x32_bf16 a[28:31], v[152:155], v[92:95], a[28:31]
  ds_read_b128 v[48:51], v16 offset:43008
  s_add_u32 m0, s45, 8192
  v_mfma_f32_16x16x32_bf16 a[32:35], v[124:127], v[96:99], a[32:35]
  ds_read_b128 v[52:55], v16 offset:45056
  v_mfma_f32_16x16x32_bf16 a[36:39], v[128:131], v[96:99], a[36:39]
  buffer_load_dwordx4 v6, s[12:15], s46 offen lds
  v_mfma_f32_16x16x32_bf16 a[40:43], v[132:135], v[96:99], a[40:43]
  ds_read_b128 v[56:59], v16 offset:47104
  v_mfma_f32_16x16x32_bf16 a[44:47], v[136:139], v[96:99], a[44:47]
  ds_read_b64_tr_b16 v[60:61], v18 offset:32768
  s_add_u32 m0, s45, 12288
  v_mfma_f32_16x16x32_bf16 a[48:51], v[140:143], v[96:99], a[48:51]
  v_mfma_f32_16x16x32_bf16 a[52:55], v[144:147], v[96:99], a[52:55]
  ds_read_b64_tr_b16 v[62:63], v18 offset:34816
  buffer_load_dwordx4 v7, s[12:15], s46 offen lds
  v_mfma_f32_16x16x32_bf16 a[56:59], v[148:151], v[96:99], a[56:59]
  ds_read_b64_tr_b16 v[64:65], v19 offset:32768
  v_mfma_f32_16x16x32_bf16 a[60:63], v[152:155], v[96:99], a[60:63]
  s_add_u32 m0, s44, 0
  v_mfma_f32_16x16x32_bf16 a[64:67], v[124:127], v[100:103], a[64:67]
  ds_read_b64_tr_b16 v[66:67], v19 offset:34816
  buffer_load_dwordx4 v12, s[16:19], s47 offen lds
  v_mfma_f32_16x16x32_bf16 a[68:71], v[128:131], v[100:103], a[68:71]
  ds_read_b64_tr_b16 v[68:69], v20 offset:32768
  v_mfma_f32_16x16x32_bf16 a[72:75], v[132:135], v[100:103], a[72:75]
  ds_read_b64_tr_b16 v[70:71], v20 offset:34816
  s_add_u32 m0, s44, 4096
  v_mfma_f32_16x16x32_bf16 a[76:79], v[136:139], v[100:103], a[76:79]
  v_mfma_f32_16x16x32_bf16 a[80:83], v[140:143], v[100:103], a[80:83]
  ds_read_b64_tr_b16 v[72:73], v21 offset:32768
  buffer_load_dwordx4 v13, s[16:19], s47 offen lds
  v_mfma_f32_16x16x32_bf16 a[84:87], v[144:147], v[100:103], a[84:87]
  ds_read_b64_tr_b16 v[74:75], v21 offset:34816
  v_mfma_f32_16x16x32_bf16 a[88:91], v[148:151], v[100:103], a[88:91]
  s_add_u32 m0, s44, 8192
  v_mfma_f32_16x16x32_bf16 a[92:95], v[152:155], v[100:103], a[92:95]
  ds_read_b64_tr_b16 v[76:77], v22 offset:32768
  v_mfma_f32_16x16x32_bf16 a[96:99], v[124:127], v[104:107], a[96:99]
  ds_read_b64_tr_b16 v[78:79], v22 offset:34816
  buffer_load_dwordx4 v14, s[16:19], s47 offen lds
  v_mfma_f32_16x16x32_bf16 a[100:103], v[128:131], v[104:107], a[100:103]
  v_mfma_f32_16x16x32_bf16 a[104:107], v[132:135], v[104:107], a[104:107]
  ds_read_b64_tr_b16 v[80:81], v23 offset:32768
  s_add_u32 m0, s44, 12288
  v_mfma_f32_16x16x32_bf16 a[108:111], v[136:139], v[104:107], a[108:111]
  ds_read_b64_tr_b16 v[82:83], v23 offset:34816
  v_mfma_f32_16x16x32_bf16 a[112:115], v[140:143], v[104:107], a[112:115]
  buffer_load_dwordx4 v15, s[16:19], s47 offen lds
  v_mfma_f32_16x16x32_bf16 a[116:119], v[144:147], v[104:107], a[116:119]
  ds_read_b64_tr_b16 v[84:85], v24 offset:32768
  v_mfma_f32_16x16x32_bf16 a[120:123], v[148:151], v[104:107], a[120:123]
  ds_read_b64_tr_b16 v[86:87], v24 offset:34816
  s_add_u32 s47, s47, 262144
  v_mfma_f32_16x16x32_bf16 a[124:127], v[152:155], v[104:107], a[124:127]
  v_mfma_f32_16x16x32_bf16 a[128:131], v[124:127], v[108:111], a[128:131]
  ds_read_b64_tr_b16 v[88:89], v25 offset:32768
  s_add_u32 m0, s45, 16384
  v_mfma_f32_16x16x32_bf16 a[132:135], v[128:131], v[108:111], a[132:135]
  ds_read_b64_tr_b16 v[90:91], v25 offset:34816
  buffer_load_dwordx4 v8, s[12:15], s46 offen lds
  v_mfma_f32_16x16x32_bf16 a[136:139], v[132:135], v[108:111], a[136:139]
  v_mfma_f32_16x16x32_bf16 a[140:143], v[136:139], v[108:111], a[140:143]
  s_add_u32 m0, s45, 20480
  v_mfma_f32_16x16x32_bf16 a[144:147], v[140:143], v[108:111], a[144:147]
  v_mfma_f32_16x16x32_bf16 a[148:151], v[144:147], v[108:111], a[148:151]
  buffer_load_dwordx4 v9, s[12:15], s46 offen lds
  v_mfma_f32_16x16x32_bf16 a[152:155], v[148:151], v[108:111], a[152:155]
  v_mfma_f32_16x16x32_bf16 a[156:159], v[152:155], v[108:111], a[156:159]
  s_add_u32 m0, s45, 24576
  v_mfma_f32_16x16x32_bf16 a[160:163], v[124:127], v[112:115], a[160:163]
  v_mfma_f32_16x16x32_bf16 a[164:167], v[128:131], v[112:115], a[164:167]
  buffer_load_dwordx4 v10, s[12:15], s46 offen lds
  v_mfma_f32_16x16x32_bf16 a[168:171], v[132:135], v[112:115], a[168:171]
  v_mfma_f32_16x16x32_bf16 a[172:175], v[136:139], v[112:115], a[172:175]
  s_add_u32 m0, s45, 28672
  v_mfma_f32_16x16x32_bf16 a[176:179], v[140:143], v[112:115], a[176:179]
  v_mfma_f32_16x16x32_bf16 a[180:183], v[144:147], v[112:115], a[180:183]
  buffer_load_dwordx4 v11, s[12:15], s46 offen lds
  v_mfma_f32_16x16x32_bf16 a[184:187], v[148:151], v[112:115], a[184:187]
  v_mfma_f32_16x16x32_bf16 a[188:191], v[152:155], v[112:115], a[188:191]
  s_add_u32 m0, s44, 16384
  v_mfma_f32_16x16x32_bf16 a[192:195], v[124:127], v[116:119], a[192:195]
  buffer_load_dwordx4 v12, s[16:19], s47 offen lds
  v_mfma_f32_16x16x32_bf16 a[196:199], v[128:131], v[116:119], a[196:199]
  v_mfma_f32_16x16x32_bf16 a[200:203], v[132:135], v[116:119], a[200:203]
  s_add_u32 m0, s44, 20480
  v_mfma_f32_16x16x32_bf16 a[204:207], v[136:139], v[116:119], a[204:207]
  v_mfma_f32_16x16x32_bf16 a[208:211], v[140:143], v[116:119], a[208:211]
  buffer_load_dwordx4 v13, s[16:19], s47 offen lds
  v_mfma_f32_16x16x32_bf16 a[212:215], v[144:147], v[116:119], a[212:215]
  v_mfma_f32_16x16x32_bf16 a[216:219], v[148:151], v[116:119], a[216:219]
  s_add_u32 m0, s44, 24576
  v_mfma_f32_16x16x32_bf16 a[220:223], v[152:155], v[116:119], a[220:223]
  v_mfma_f32_16x16x32_bf16 a[224:227], v[124:127], v[120:123], a[224:227]
  buffer_load_dwordx4 v14, s[16:19], s47 offen lds
  v_mfma_f32_16x16x32_bf16 a[228:231], v[128:131], v[120:123], a[228:231]
  v_mfma_f32_16x16x32_bf16 a[232:235], v[132:135], v[120:123], a[232:235]
  s_add_u32 m0, s44, 28672
  v_mfma_f32_16x16x32_bf16 a[236:239], v[136:139], v[120:123], a[236:239]
  v_mfma_f32_16x16x32_bf16 a[240:243], v[140:143], v[120:123], a[240:243]
  buffer_load_dwordx4 v15, s[16:19], s47 offen lds
  v_mfma_f32_16x16x32_bf16 a[244:247], v[144:147], v[120:123], a[244:247]
  v_mfma_f32_16x16x32_bf16 a[248:251], v[148:151], v[120:123], a[248:251]
  s_add_u32 s46, s46, 128
  s_add_u32 s47, s47, 262144
  v_mfma_f32_16x16x32_bf16 a[252:255], v[152:155], v[120:123], a[252:255]
  s_sub_u32 s48, s48, 1
  s_cmp_lg_u32 s48, 0
  s_cbranch_scc1 Lqk_44_loop
  s_waitcnt lgkmcnt(0)
  v_mfma_f32_16x16x32_bf16 a[0:3], v[60:63], v[28:31], a[0:3]
  ds_read_b128 v[92:95], v17 offset:32768
  v_mfma_f32_16x16x32_bf16 a[4:7], v[64:67], v[28:31], a[4:7]
  ds_read_b128 v[96:99], v17 offset:34816
  v_mfma_f32_16x16x32_bf16 a[8:11], v[68:71], v[28:31], a[8:11]
  ds_read_b128 v[100:103], v17 offset:36864
  v_mfma_f32_16x16x32_bf16 a[12:15], v[72:75], v[28:31], a[12:15]
  v_mfma_f32_16x16x32_bf16 a[16:19], v[76:79], v[28:31], a[16:19]
  ds_read_b128 v[104:107], v17 offset:38912
  v_mfma_f32_16x16x32_bf16 a[20:23], v[80:83], v[28:31], a[20:23]
  ds_read_b128 v[108:111], v17 offset:40960
  v_mfma_f32_16x16x32_bf16 a[24:27], v[84:87], v[28:31], a[24:27]
  v_mfma_f32_16x16x32_bf16 a[28:31], v[88:91], v[28:31], a[28:31]
  ds_read_b128 v[112:115], v17 offset:43008
  v_mfma_f32_16x16x32_bf16 a[32:35], v[60:63], v[32:35], a[32:35]
  ds_read_b128 v[116:119], v17 offset:45056
  v_mfma_f32_16x16x32_bf16 a[36:39], v[64:67], v[32:35], a[36:39]
  v_mfma_f32_16x16x32_bf16 a[40:43], v[68:71], v[32:35], a[40:43]
  ds_read_b128 v[120:123], v17 offset:47104
  v_mfma_f32_16x16x32_bf16 a[44:47], v[72:75], v[32:35], a[44:47]
  ds_read_b64_tr_b16 v[124:125], v18 offset:49152
  v_mfma_f32_16x16x32_bf16 a[48:51], v[76:79], v[32:35], a[48:51]
  v_mfma_f32_16x16x32_bf16 a[52:55], v[80:83], v[32:35], a[52:55]
  ds_read_b64_tr_b16 v[126:127], v18 offset:51200
  v_mfma_f32_16x16x32_bf16 a[56:59], v[84:87], v[32:35], a[56:59]
  ds_read_b64_tr_b16 v[128:129], v19 offset:49152
  v_mfma_f32_16x16x32_bf16 a[60:63], v[88:91], v[32:35], a[60:63]
  v_mfma_f32_16x16x32_bf16 a[64:67], v[60:63], v[36:39], a[64:67]
  ds_read_b64_tr_b16 v[130:131], v19 offset:51200
  v_mfma_f32_16x16x32_bf16 a[68:71], v[64:67], v[36:39], a[68:71]
  ds_read_b64_tr_b16 v[132:133], v20 offset:49152
  v_mfma_f32_16x16x32_bf16 a[72:75], v[68:71], v[36:39], a[72:75]
  ds_read_b64_tr_b16 v[134:135], v20 offset:51200
  v_mfma_f32_16x16x32_bf16 a[76:79], v[72:75], v[36:39], a[76:79]
  v_mfma_f32_16x16x32_bf16 a[80:83], v[76:79], v[36:39], a[80:83]
  ds_read_b64_tr_b16 v[136:137], v21 offset:49152
  v_mfma_f32_16x16x32_bf16 a[84:87], v[80:83], v[36:39], a[84:87]
  ds_read_b64_tr_b16 v[138:139], v21 offset:51200
  v_mfma_f32_16x16x32_bf16 a[88:91], v[84:87], v[36:39], a[88:91]
  v_mfma_f32_16x16x32_bf16 a[92:95], v[88:91], v[36:39], a[92:95]
  ds_read_b64_tr_b16 v[140:141], v22 offset:49152
  v_mfma_f32_16x16x32_bf16 a[96:99], v[60:63], v[40:43], a[96:99]
  ds_read_b64_tr_b16 v[142:143], v22 offset:51200
  v_mfma_f32_16x16x32_bf16 a[100:103], v[64:67], v[40:43], a[100:103]
  v_mfma_f32_16x16x32_bf16 a[104:107], v[68:71], v[40:43], a[104:107]
  ds_read_b64_tr_b16 v[144:145], v23 offset:49152
  v_mfma_f32_16x16x32_bf16 a[108:111], v[72:75], v[40:43], a[108:111]
  ds_read_b64_tr_b16 v[146:147], v23 offset:51200
  v_mfma_f32_16x16x32_bf16 a[112:115], v[76:79], v[40:43], a[112:115]
  v_mfma_f32_16x16x32_bf16 a[116:119], v[80:83], v[40:43], a[116:119]
  ds_read_b64_tr_b16 v[148:149], v24 offset:49152
  v_mfma_f32_16x16x32_bf16 a[120:123], v[84:87], v[40:43], a[120:123]
  ds_read_b64_tr_b16 v[150:151], v24 offset:51200
  v_mfma_f32_16x16x32_bf16 a[124:127], v[88:91], v[40:43], a[124:127]
  v_mfma_f32_16x16x32_bf16 a[128:131], v[60:63], v[44:47], a[128:131]
  ds_read_b64_tr_b16 v[152:153], v25 offset:49152
  v_mfma_f32_16x16x32_bf16 a[132:135], v[64:67], v[44:47], a[132:135]
  ds_read_b64_tr_b16 v[154:155], v25 offset:51200
  v_mfma_f32_16x16x32_bf16 a[136:139], v[68:71], v[44:47], a[136:139]
  v_mfma_f32_16x16x32_bf16 a[140:143], v[72:75], v[44:47], a[140:143]
  v_mfma_f32_16x16x32_bf16 a[144:147], v[76:79], v[44:47], a[144:147]
  v_mfma_f32_16x16x32_bf16 a[148:151], v[80:83], v[44:47], a[148:151]
  v_mfma_f32_16x16x32_bf16 a[152:155], v[84:87], v[44:47], a[152:155]
  v_mfma_f32_16x16x32_bf16 a[156:159], v[88:91], v[44:47], a[156:159]
  v_mfma_f32_16x16x32_bf16 a[160:163], v[60:63], v[48:51], a[160:163]
  v_mfma_f32_16x16x32_bf16 a[164:167], v[64:67], v[48:51], a[164:167]
  v_mfma_f32_16x16x32_bf16 a[168:171], v[68:71], v[48:51], a[168:171]
  v_mfma_f32_16x16x32_bf16 a[172:175], v[72:75], v[48:51], a[172:175]
  v_mfma_f32_16x16x32_bf16 a[176:179], v[76:79], v[48:51], a[176:179]
  v_mfma_f32_16x16x32_bf16 a[180:183], v[80:83], v[48:51], a[180:183]
  v_mfma_f32_16x16x32_bf16 a[184:187], v[84:87], v[48:51], a[184:187]
  v_mfma_f32_16x16x32_bf16 a[188:191], v[88:91], v[48:51], a[188:191]
  v_mfma_f32_16x16x32_bf16 a[192:195], v[60:63], v[52:55], a[192:195]
  v_mfma_f32_16x16x32_bf16 a[196:199], v[64:67], v[52:55], a[196:199]
  v_mfma_f32_16x16x32_bf16 a[200:203], v[68:71], v[52:55], a[200:203]
  v_mfma_f32_16x16x32_bf16 a[204:207], v[72:75], v[52:55], a[204:207]
  v_mfma_f32_16x16x32_bf16 a[208:211], v[76:79], v[52:55], a[208:211]
  v_mfma_f32_16x16x32_bf16 a[212:215], v[80:83], v[52:55], a[212:215]
  v_mfma_f32_16x16x32_bf16 a[216:219], v[84:87], v[52:55], a[216:219]
  v_mfma_f32_16x16x32_bf16 a[220:223], v[88:91], v[52:55], a[220:223]
  v_mfma_f32_16x16x32_bf16 a[224:227], v[60:63], v[56:59], a[224:227]
  v_mfma_f32_16x16x32_bf16 a[228:231], v[64:67], v[56:59], a[228:231]
  v_mfma_f32_16x16x32_bf16 a[232:235], v[68:71], v[56:59], a[232:235]
  v_mfma_f32_16x16x32_bf16 a[236:239], v[72:75], v[56:59], a[236:239]
  v_mfma_f32_16x16x32_bf16 a[240:243], v[76:79], v[56:59], a[240:243]
  v_mfma_f32_16x16x32_bf16 a[244:247], v[80:83], v[56:59], a[244:247]
  v_mfma_f32_16x16x32_bf16 a[248:251], v[84:87], v[56:59], a[248:251]
  v_mfma_f32_16x16x32_bf16 a[252:255], v[88:91], v[56:59], a[252:255]
  s_waitcnt vmcnt(0) lgkmcnt(0)
  s_barrier
  v_mfma_f32_16x16x32_bf16 a[0:3], v[124:127], v[92:95], a[0:3]
  ds_read_b128 v[28:31], v16 offset:0
  v_mfma_f32_16x16x32_bf16 a[4:7], v[128:131], v[92:95], a[4:7]
  ds_read_b128 v[32:35], v16 offset:2048
  v_mfma_f32_16x16x32_bf16 a[8:11], v[132:135], v[92:95], a[8:11]
  ds_read_b128 v[36:39], v16 offset:4096
  v_mfma_f32_16x16x32_bf16 a[12:15], v[136:139], v[92:95], a[12:15]
  v_mfma_f32_16x16x32_bf16 a[16:19], v[140:143], v[92:95], a[16:19]
  ds_read_b128 v[40:43], v16 offset:6144
  v_mfma_f32_16x16x32_bf16 a[20:23], v[144:147], v[92:95], a[20:23]
  ds_read_b128 v[44:47], v16 offset:8192
  v_mfma_f32_16x16x32_bf16 a[24:27], v[148:151], v[92:95], a[24:27]
  v_mfma_f32_16x16x32_bf16 a[28:31], v[152:155], v[92:95], a[28:31]
  ds_read_b128 v[48:51], v16 offset:10240
  v_mfma_f32_16x16x32_bf16 a[32:35], v[124:127], v[96:99], a[32:35]
  ds_read_b128 v[52:55], v16 offset:12288
  v_mfma_f32_16x16x32_bf16 a[36:39], v[128:131], v[96:99], a[36:39]
  v_mfma_f32_16x16x32_bf16 a[40:43], v[132:135], v[96:99], a[40:43]
  ds_read_b128 v[56:59], v16 offset:14336
  v_mfma_f32_16x16x32_bf16 a[44:47], v[136:139], v[96:99], a[44:47]
  ds_read_b64_tr_b16 v[60:61], v18 offset:0
  v_mfma_f32_16x16x32_bf16 a[48:51], v[140:143], v[96:99], a[48:51]
  v_mfma_f32_16x16x32_bf16 a[52:55], v[144:147], v[96:99], a[52:55]
  ds_read_b64_tr_b16 v[62:63], v18 offset:2048
  v_mfma_f32_16x16x32_bf16 a[56:59], v[148:151], v[96:99], a[56:59]
  ds_read_b64_tr_b16 v[64:65], v19 offset:0
  v_mfma_f32_16x16x32_bf16 a[60:63], v[152:155], v[96:99], a[60:63]
  v_mfma_f32_16x16x32_bf16 a[64:67], v[124:127], v[100:103], a[64:67]
  ds_read_b64_tr_b16 v[66:67], v19 offset:2048
  v_mfma_f32_16x16x32_bf16 a[68:71], v[128:131], v[100:103], a[68:71]
  ds_read_b64_tr_b16 v[68:69], v20 offset:0
  v_mfma_f32_16x16x32_bf16 a[72:75], v[132:135], v[100:103], a[72:75]
  ds_read_b64_tr_b16 v[70:71], v20 offset:2048
  v_mfma_f32_16x16x32_bf16 a[76:79], v[136:139], v[100:103], a[76:79]
  v_mfma_f32_16x16x32_bf16 a[80:83], v[140:143], v[100:103], a[80:83]
  ds_read_b64_tr_b16 v[72:73], v21 offset:0
  v_mfma_f32_16x16x32_bf16 a[84:87], v[144:147], v[100:103], a[84:87]
  ds_read_b64_tr_b16 v[74:75], v21 offset:2048
  v_mfma_f32_16x16x32_bf16 a[88:91], v[148:151], v[100:103], a[88:91]
  v_mfma_f32_16x16x32_bf16 a[92:95], v[152:155], v[100:103], a[92:95]
  ds_read_b64_tr_b16 v[76:77], v22 offset:0
  v_mfma_f32_16x16x32_bf16 a[96:99], v[124:127], v[104:107], a[96:99]
  ds_read_b64_tr_b16 v[78:79], v22 offset:2048
  v_mfma_f32_16x16x32_bf16 a[100:103], v[128:131], v[104:107], a[100:103]
  v_mfma_f32_16x16x32_bf16 a[104:107], v[132:135], v[104:107], a[104:107]
  ds_read_b64_tr_b16 v[80:81], v23 offset:0
  v_mfma_f32_16x16x32_bf16 a[108:111], v[136:139], v[104:107], a[108:111]
  ds_read_b64_tr_b16 v[82:83], v23 offset:2048
  v_mfma_f32_16x16x32_bf16 a[112:115], v[140:143], v[104:107], a[112:115]
  v_mfma_f32_16x16x32_bf16 a[116:119], v[144:147], v[104:107], a[116:119]
  ds_read_b64_tr_b16 v[84:85], v24 offset:0
  v_mfma_f32_16x16x32_bf16 a[120:123], v[148:151], v[104:107], a[120:123]
  ds_read_b64_tr_b16 v[86:87], v24 offset:2048
  v_mfma_f32_16x16x32_bf16 a[124:127], v[152:155], v[104:107], a[124:127]
  v_mfma_f32_16x16x32_bf16 a[128:131], v[124:127], v[108:111], a[128:131]
  ds_read_b64_tr_b16 v[88:89], v25 offset:0
  v_mfma_f32_16x16x32_bf16 a[132:135], v[128:131], v[108:111], a[132:135]
  ds_read_b64_tr_b16 v[90:91], v25 offset:2048
  v_mfma_f32_16x16x32_bf16 a[136:139], v[132:135], v[108:111], a[136:139]
  v_mfma_f32_16x16x32_bf16 a[140:143], v[136:139], v[108:111], a[140:143]
  v_mfma_f32_16x16x32_bf16 a[144:147], v[140:143], v[108:111], a[144:147]
  v_mfma_f32_16x16x32_bf16 a[148:151], v[144:147], v[108:111], a[148:151]
  v_mfma_f32_16x16x32_bf16 a[152:155], v[148:151], v[108:111], a[152:155]
  v_mfma_f32_16x16x32_bf16 a[156:159], v[152:155], v[108:111], a[156:159]
  v_mfma_f32_16x16x32_bf16 a[160:163], v[124:127], v[112:115], a[160:163]
  v_mfma_f32_16x16x32_bf16 a[164:167], v[128:131], v[112:115], a[164:167]
  v_mfma_f32_16x16x32_bf16 a[168:171], v[132:135], v[112:115], a[168:171]
  v_mfma_f32_16x16x32_bf16 a[172:175], v[136:139], v[112:115], a[172:175]
  v_mfma_f32_16x16x32_bf16 a[176:179], v[140:143], v[112:115], a[176:179]
  v_mfma_f32_16x16x32_bf16 a[180:183], v[144:147], v[112:115], a[180:183]
  v_mfma_f32_16x16x32_bf16 a[184:187], v[148:151], v[112:115], a[184:187]
  v_mfma_f32_16x16x32_bf16 a[188:191], v[152:155], v[112:115], a[188:191]
  v_mfma_f32_16x16x32_bf16 a[192:195], v[124:127], v[116:119], a[192:195]
  v_mfma_f32_16x16x32_bf16 a[196:199], v[128:131], v[116:119], a[196:199]
  v_mfma_f32_16x16x32_bf16 a[200:203], v[132:135], v[116:119], a[200:203]
  v_mfma_f32_16x16x32_bf16 a[204:207], v[136:139], v[116:119], a[204:207]
  v_mfma_f32_16x16x32_bf16 a[208:211], v[140:143], v[116:119], a[208:211]
  v_mfma_f32_16x16x32_bf16 a[212:215], v[144:147], v[116:119], a[212:215]
  v_mfma_f32_16x16x32_bf16 a[216:219], v[148:151], v[116:119], a[216:219]
  v_mfma_f32_16x16x32_bf16 a[220:223], v[152:155], v[116:119], a[220:223]
  v_mfma_f32_16x16x32_bf16 a[224:227], v[124:127], v[120:123], a[224:227]
  v_mfma_f32_16x16x32_bf16 a[228:231], v[128:131], v[120:123], a[228:231]
  v_mfma_f32_16x16x32_bf16 a[232:235], v[132:135], v[120:123], a[232:235]
  v_mfma_f32_16x16x32_bf16 a[236:239], v[136:139], v[120:123], a[236:239]
  v_mfma_f32_16x16x32_bf16 a[240:243], v[140:143], v[120:123], a[240:243]
  v_mfma_f32_16x16x32_bf16 a[244:247], v[144:147], v[120:123], a[244:247]
  v_mfma_f32_16x16x32_bf16 a[248:251], v[148:151], v[120:123], a[248:251]
  v_mfma_f32_16x16x32_bf16 a[252:255], v[152:155], v[120:123], a[252:255]
  s_waitcnt lgkmcnt(0)
  v_mfma_f32_16x16x32_bf16 a[0:3], v[60:63], v[28:31], a[0:3]
  ds_read_b128 v[92:95], v17 offset:0
  v_mfma_f32_16x16x32_bf16 a[4:7], v[64:67], v[28:31], a[4:7]
  ds_read_b128 v[96:99], v17 offset:2048
  v_mfma_f32_16x16x32_bf16 a[8:11], v[68:71], v[28:31], a[8:11]
  ds_read_b128 v[100:103], v17 offset:4096
  v_mfma_f32_16x16x32_bf16 a[12:15], v[72:75], v[28:31], a[12:15]
  v_mfma_f32_16x16x32_bf16 a[16:19], v[76:79], v[28:31], a[16:19]
  ds_read_b128 v[104:107], v17 offset:6144
  v_mfma_f32_16x16x32_bf16 a[20:23], v[80:83], v[28:31], a[20:23]
  ds_read_b128 v[108:111], v17 offset:8192
  v_mfma_f32_16x16x32_bf16 a[24:27], v[84:87], v[28:31], a[24:27]
  v_mfma_f32_16x16x32_bf16 a[28:31], v[88:91], v[28:31], a[28:31]
  ds_read_b128 v[112:115], v17 offset:10240
  v_mfma_f32_16x16x32_bf16 a[32:35], v[60:63], v[32:35], a[32:35]
  ds_read_b128 v[116:119], v17 offset:12288
  v_mfma_f32_16x16x32_bf16 a[36:39], v[64:67], v[32:35], a[36:39]
  v_mfma_f32_16x16x32_bf16 a[40:43], v[68:71], v[32:35], a[40:43]
  ds_read_b128 v[120:123], v17 offset:14336
  v_mfma_f32_16x16x32_bf16 a[44:47], v[72:75], v[32:35], a[44:47]
  ds_read_b64_tr_b16 v[124:125], v18 offset:16384
  v_mfma_f32_16x16x32_bf16 a[48:51], v[76:79], v[32:35], a[48:51]
  v_mfma_f32_16x16x32_bf16 a[52:55], v[80:83], v[32:35], a[52:55]
  ds_read_b64_tr_b16 v[126:127], v18 offset:18432
  v_mfma_f32_16x16x32_bf16 a[56:59], v[84:87], v[32:35], a[56:59]
  ds_read_b64_tr_b16 v[128:129], v19 offset:16384
  v_mfma_f32_16x16x32_bf16 a[60:63], v[88:91], v[32:35], a[60:63]
  v_mfma_f32_16x16x32_bf16 a[64:67], v[60:63], v[36:39], a[64:67]
  ds_read_b64_tr_b16 v[130:131], v19 offset:18432
  v_mfma_f32_16x16x32_bf16 a[68:71], v[64:67], v[36:39], a[68:71]
  ds_read_b64_tr_b16 v[132:133], v20 offset:16384
  v_mfma_f32_16x16x32_bf16 a[72:75], v[68:71], v[36:39], a[72:75]
  ds_read_b64_tr_b16 v[134:135], v20 offset:18432
  v_mfma_f32_16x16x32_bf16 a[76:79], v[72:75], v[36:39], a[76:79]
  v_mfma_f32_16x16x32_bf16 a[80:83], v[76:79], v[36:39], a[80:83]
  ds_read_b64_tr_b16 v[136:137], v21 offset:16384
  v_mfma_f32_16x16x32_bf16 a[84:87], v[80:83], v[36:39], a[84:87]
  ds_read_b64_tr_b16 v[138:139], v21 offset:18432
  v_mfma_f32_16x16x32_bf16 a[88:91], v[84:87], v[36:39], a[88:91]
  v_mfma_f32_16x16x32_bf16 a[92:95], v[88:91], v[36:39], a[92:95]
  ds_read_b64_tr_b16 v[140:141], v22 offset:16384
  v_mfma_f32_16x16x32_bf16 a[96:99], v[60:63], v[40:43], a[96:99]
  ds_read_b64_tr_b16 v[142:143], v22 offset:18432
  v_mfma_f32_16x16x32_bf16 a[100:103], v[64:67], v[40:43], a[100:103]
  v_mfma_f32_16x16x32_bf16 a[104:107], v[68:71], v[40:43], a[104:107]
  ds_read_b64_tr_b16 v[144:145], v23 offset:16384
  v_mfma_f32_16x16x32_bf16 a[108:111], v[72:75], v[40:43], a[108:111]
  ds_read_b64_tr_b16 v[146:147], v23 offset:18432
  v_mfma_f32_16x16x32_bf16 a[112:115], v[76:79], v[40:43], a[112:115]
  v_mfma_f32_16x16x32_bf16 a[116:119], v[80:83], v[40:43], a[116:119]
  ds_read_b64_tr_b16 v[148:149], v24 offset:16384
  v_mfma_f32_16x16x32_bf16 a[120:123], v[84:87], v[40:43], a[120:123]
  ds_read_b64_tr_b16 v[150:151], v24 offset:18432
  v_mfma_f32_16x16x32_bf16 a[124:127], v[88:91], v[40:43], a[124:127]
  v_mfma_f32_16x16x32_bf16 a[128:131], v[60:63], v[44:47], a[128:131]
  ds_read_b64_tr_b16 v[152:153], v25 offset:16384
  v_mfma_f32_16x16x32_bf16 a[132:135], v[64:67], v[44:47], a[132:135]
  ds_read_b64_tr_b16 v[154:155], v25 offset:18432
  v_mfma_f32_16x16x32_bf16 a[136:139], v[68:71], v[44:47], a[136:139]
  v_mfma_f32_16x16x32_bf16 a[140:143], v[72:75], v[44:47], a[140:143]
  v_mfma_f32_16x16x32_bf16 a[144:147], v[76:79], v[44:47], a[144:147]
  v_mfma_f32_16x16x32_bf16 a[148:151], v[80:83], v[44:47], a[148:151]
  v_mfma_f32_16x16x32_bf16 a[152:155], v[84:87], v[44:47], a[152:155]
  v_mfma_f32_16x16x32_bf16 a[156:159], v[88:91], v[44:47], a[156:159]
  v_mfma_f32_16x16x32_bf16 a[160:163], v[60:63], v[48:51], a[160:163]
  v_mfma_f32_16x16x32_bf16 a[164:167], v[64:67], v[48:51], a[164:167]
  v_mfma_f32_16x16x32_bf16 a[168:171], v[68:71], v[48:51], a[168:171]
  v_mfma_f32_16x16x32_bf16 a[172:175], v[72:75], v[48:51], a[172:175]
  v_mfma_f32_16x16x32_bf16 a[176:179], v[76:79], v[48:51], a[176:179]
  v_mfma_f32_16x16x32_bf16 a[180:183], v[80:83], v[48:51], a[180:183]
  v_mfma_f32_16x16x32_bf16 a[184:187], v[84:87], v[48:51], a[184:187]
  v_mfma_f32_16x16x32_bf16 a[188:191], v[88:91], v[48:51], a[188:191]
  v_mfma_f32_16x16x32_bf16 a[192:195], v[60:63], v[52:55], a[192:195]
  v_mfma_f32_16x16x32_bf16 a[196:199], v[64:67], v[52:55], a[196:199]
  v_mfma_f32_16x16x32_bf16 a[200:203], v[68:71], v[52:55], a[200:203]
  v_mfma_f32_16x16x32_bf16 a[204:207], v[72:75], v[52:55], a[204:207]
  v_mfma_f32_16x16x32_bf16 a[208:211], v[76:79], v[52:55], a[208:211]
  v_mfma_f32_16x16x32_bf16 a[212:215], v[80:83], v[52:55], a[212:215]
  v_mfma_f32_16x16x32_bf16 a[216:219], v[84:87], v[52:55], a[216:219]
  v_mfma_f32_16x16x32_bf16 a[220:223], v[88:91], v[52:55], a[220:223]
  v_mfma_f32_16x16x32_bf16 a[224:227], v[60:63], v[56:59], a[224:227]
  v_mfma_f32_16x16x32_bf16 a[228:231], v[64:67], v[56:59], a[228:231]
  v_mfma_f32_16x16x32_bf16 a[232:235], v[68:71], v[56:59], a[232:235]
  v_mfma_f32_16x16x32_bf16 a[236:239], v[72:75], v[56:59], a[236:239]
  v_mfma_f32_16x16x32_bf16 a[240:243], v[76:79], v[56:59], a[240:243]
  v_mfma_f32_16x16x32_bf16 a[244:247], v[80:83], v[56:59], a[244:247]
  v_mfma_f32_16x16x32_bf16 a[248:251], v[84:87], v[56:59], a[248:251]
  v_mfma_f32_16x16x32_bf16 a[252:255], v[88:91], v[56:59], a[252:255]
  s_waitcnt lgkmcnt(0)
  v_mfma_f32_16x16x32_bf16 a[0:3], v[124:127], v[92:95], a[0:3]
  v_mfma_f32_16x16x32_bf16 a[4:7], v[128:131], v[92:95], a[4:7]
  v_mfma_f32_16x16x32_bf16 a[8:11], v[132:135], v[92:95], a[8:11]
  v_mfma_f32_16x16x32_bf16 a[12:15], v[136:139], v[92:95], a[12:15]
  v_mfma_f32_16x16x32_bf16 a[16:19], v[140:143], v[92:95], a[16:19]
  v_mfma_f32_16x16x32_bf16 a[20:23], v[144:147], v[92:95], a[20:23]
  v_mfma_f32_16x16x32_bf16 a[24:27], v[148:151], v[92:95], a[24:27]
  v_mfma_f32_16x16x32_bf16 a[28:31], v[152:155], v[92:95], a[28:31]
  v_mfma_f32_16x16x32_bf16 a[32:35], v[124:127], v[96:99], a[32:35]
  v_mfma_f32_16x16x32_bf16 a[36:39], v[128:131], v[96:99], a[36:39]
  v_mfma_f32_16x16x32_bf16 a[40:43], v[132:135], v[96:99], a[40:43]
  v_mfma_f32_16x16x32_bf16 a[44:47], v[136:139], v[96:99], a[44:47]
  v_mfma_f32_16x16x32_bf16 a[48:51], v[140:143], v[96:99], a[48:51]
  v_mfma_f32_16x16x32_bf16 a[52:55], v[144:147], v[96:99], a[52:55]
  v_mfma_f32_16x16x32_bf16 a[56:59], v[148:151], v[96:99], a[56:59]
  v_mfma_f32_16x16x32_bf16 a[60:63], v[152:155], v[96:99], a[60:63]
  v_mfma_f32_16x16x32_bf16 a[64:67], v[124:127], v[100:103], a[64:67]
  v_mfma_f32_16x16x32_bf16 a[68:71], v[128:131], v[100:103], a[68:71]
  v_mfma_f32_16x16x32_bf16 a[72:75], v[132:135], v[100:103], a[72:75]
  v_mfma_f32_16x16x32_bf16 a[76:79], v[136:139], v[100:103], a[76:79]
  v_mfma_f32_16x16x32_bf16 a[80:83], v[140:143], v[100:103], a[80:83]
  v_mfma_f32_16x16x32_bf16 a[84:87], v[144:147], v[100:103], a[84:87]
  v_mfma_f32_16x16x32_bf16 a[88:91], v[148:151], v[100:103], a[88:91]
  v_mfma_f32_16x16x32_bf16 a[92:95], v[152:155], v[100:103], a[92:95]
  v_mfma_f32_16x16x32_bf16 a[96:99], v[124:127], v[104:107], a[96:99]
  v_mfma_f32_16x16x32_bf16 a[100:103], v[128:131], v[104:107], a[100:103]
  v_mfma_f32_16x16x32_bf16 a[104:107], v[132:135], v[104:107], a[104:107]
  v_mfma_f32_16x16x32_bf16 a[108:111], v[136:139], v[104:107], a[108:111]
  v_mfma_f32_16x16x32_bf16 a[112:115], v[140:143], v[104:107], a[112:115]
  v_mfma_f32_16x16x32_bf16 a[116:119], v[144:147], v[104:107], a[116:119]
  v_mfma_f32_16x16x32_bf16 a[120:123], v[148:151], v[104:107], a[120:123]
  v_mfma_f32_16x16x32_bf16 a[124:127], v[152:155], v[104:107], a[124:127]
  v_mfma_f32_16x16x32_bf16 a[128:131], v[124:127], v[108:111], a[128:131]
  v_mfma_f32_16x16x32_bf16 a[132:135], v[128:131], v[108:111], a[132:135]
  v_mfma_f32_16x16x32_bf16 a[136:139], v[132:135], v[108:111], a[136:139]
  v_mfma_f32_16x16x32_bf16 a[140:143], v[136:139], v[108:111], a[140:143]
  v_mfma_f32_16x16x32_bf16 a[144:147], v[140:143], v[108:111], a[144:147]
  v_mfma_f32_16x16x32_bf16 a[148:151], v[144:147], v[108:111], a[148:151]
  v_mfma_f32_16x16x32_bf16 a[152:155], v[148:151], v[108:111], a[152:155]
  v_mfma_f32_16x16x32_bf16 a[156:159], v[152:155], v[108:111], a[156:159]
  v_mfma_f32_16x16x32_bf16 a[160:163], v[124:127], v[112:115], a[160:163]
  v_mfma_f32_16x16x32_bf16 a[164:167], v[128:131], v[112:115], a[164:167]
  v_mfma_f32_16x16x32_bf16 a[168:171], v[132:135], v[112:115], a[168:171]
  v_mfma_f32_16x16x32_bf16 a[172:175], v[136:139], v[112:115], a[172:175]
  v_mfma_f32_16x16x32_bf16 a[176:179], v[140:143], v[112:115], a[176:179]
  v_mfma_f32_16x16x32_bf16 a[180:183], v[144:147], v[112:115], a[180:183]
  v_mfma_f32_16x16x32_bf16 a[184:187], v[148:151], v[112:115], a[184:187]
  v_mfma_f32_16x16x32_bf16 a[188:191], v[152:155], v[112:115], a[188:191]
  v_mfma_f32_16x16x32_bf16 a[192:195], v[124:127], v[116:119], a[192:195]
  v_mfma_f32_16x16x32_bf16 a[196:199], v[128:131], v[116:119], a[196:199]
  v_mfma_f32_16x16x32_bf16 a[200:203], v[132:135], v[116:119], a[200:203]
  v_mfma_f32_16x16x32_bf16 a[204:207], v[136:139], v[116:119], a[204:207]
  v_mfma_f32_16x16x32_bf16 a[208:211], v[140:143], v[116:119], a[208:211]
  v_mfma_f32_16x16x32_bf16 a[212:215], v[144:147], v[116:119], a[212:215]
  v_mfma_f32_16x16x32_bf16 a[216:219], v[148:151], v[116:119], a[216:219]
  v_mfma_f32_16x16x32_bf16 a[220:223], v[152:155], v[116:119], a[220:223]
  v_mfma_f32_16x16x32_bf16 a[224:227], v[124:127], v[120:123], a[224:227]
  v_mfma_f32_16x16x32_bf16 a[228:231], v[128:131], v[120:123], a[228:231]
  v_mfma_f32_16x16x32_bf16 a[232:235], v[132:135], v[120:123], a[232:235]
  v_mfma_f32_16x16x32_bf16 a[236:239], v[136:139], v[120:123], a[236:239]
  v_mfma_f32_16x16x32_bf16 a[240:243], v[140:143], v[120:123], a[240:243]
  v_mfma_f32_16x16x32_bf16 a[244:247], v[144:147], v[120:123], a[244:247]
  v_mfma_f32_16x16x32_bf16 a[248:251], v[148:151], v[120:123], a[248:251]
  v_mfma_f32_16x16x32_bf16 a[252:255], v[152:155], v[120:123], a[252:255]
  s_nop 7
  s_nop 7
  s_cmp_eq_u32 s35, 1
  s_mov_b32 s37, 0x252000
  s_cselect_b32 s37, 0x1252000, s37
  s_add_u32 s20, s10, s37
  s_addc_u32 s21, s11, 0
  s_mov_b32 s22, 16777216
  s_mov_b32 s23, 0x20000
  v_and_b32 v29, 15, v1
  v_lshlrev_b32 v28, 4, v29
  v_bfe_u32 v29, v1, 4, 1
  v_lshl_add_u32 v28, v29, 9, v28
  v_bfe_u32 v29, v1, 5, 1
  v_lshl_add_u32 v28, v29, 8, v28
  s_lshr_b32 s40, s3, 1
  s_lshl_b32 s40, s40, 2
  s_lshl_b32 s41, s32, 3
  s_add_u32 s40, s40, s41
  s_lshl_b32 s40, s40, 5
  s_and_b32 s41, s3, 1
  s_add_u32 s40, s40, s41
  s_lshl_b32 s41, s36, 1
  s_add_u32 s40, s40, s41
  s_lshl_b32 s38, s40, 13
  v_accvgpr_read_b32 v36, a0
  v_accvgpr_read_b32 v37, a1
  v_accvgpr_read_b32 v38, a2
  v_accvgpr_read_b32 v39, a3
  v_cvt_pk_bf16_f32 v32, v36, v37
  v_cvt_pk_bf16_f32 v33, v38, v39
  v_accvgpr_read_b32 v40, a4
  v_accvgpr_read_b32 v41, a5
  v_accvgpr_read_b32 v42, a6
  v_accvgpr_read_b32 v43, a7
  v_cvt_pk_bf16_f32 v34, v40, v41
  v_cvt_pk_bf16_f32 v35, v42, v43
  s_nop 1
  v_permlane16_swap_b32 v32, v34
  v_permlane16_swap_b32 v33, v35
  buffer_store_dwordx4 v[32:35], v28, s[20:23], s38 offen offset:0 sc1
  v_accvgpr_read_b32 v48, a8
  v_accvgpr_read_b32 v49, a9
  v_accvgpr_read_b32 v50, a10
  v_accvgpr_read_b32 v51, a11
  v_cvt_pk_bf16_f32 v44, v48, v49
  v_cvt_pk_bf16_f32 v45, v50, v51
  v_accvgpr_read_b32 v52, a12
  v_accvgpr_read_b32 v53, a13
  v_accvgpr_read_b32 v54, a14
  v_accvgpr_read_b32 v55, a15
  v_cvt_pk_bf16_f32 v46, v52, v53
  v_cvt_pk_bf16_f32 v47, v54, v55
  s_nop 1
  v_permlane16_swap_b32 v44, v46
  v_permlane16_swap_b32 v45, v47
  buffer_store_dwordx4 v[44:47], v28, s[20:23], s38 offen offset:1024 sc1
  v_accvgpr_read_b32 v60, a16
  v_accvgpr_read_b32 v61, a17
  v_accvgpr_read_b32 v62, a18
  v_accvgpr_read_b32 v63, a19
  v_cvt_pk_bf16_f32 v56, v60, v61
  v_cvt_pk_bf16_f32 v57, v62, v63
  v_accvgpr_read_b32 v64, a20
  v_accvgpr_read_b32 v65, a21
  v_accvgpr_read_b32 v66, a22
  v_accvgpr_read_b32 v67, a23
  v_cvt_pk_bf16_f32 v58, v64, v65
  v_cvt_pk_bf16_f32 v59, v66, v67
  s_nop 1
  v_permlane16_swap_b32 v56, v58
  v_permlane16_swap_b32 v57, v59
  buffer_store_dwordx4 v[56:59], v28, s[20:23], s38 offen offset:2048 sc1
  v_accvgpr_read_b32 v72, a24
  v_accvgpr_read_b32 v73, a25
  v_accvgpr_read_b32 v74, a26
  v_accvgpr_read_b32 v75, a27
  v_cvt_pk_bf16_f32 v68, v72, v73
  v_cvt_pk_bf16_f32 v69, v74, v75
  v_accvgpr_read_b32 v76, a28
  v_accvgpr_read_b32 v77, a29
  v_accvgpr_read_b32 v78, a30
  v_accvgpr_read_b32 v79, a31
  v_cvt_pk_bf16_f32 v70, v76, v77
  v_cvt_pk_bf16_f32 v71, v78, v79
  s_nop 1
  v_permlane16_swap_b32 v68, v70
  v_permlane16_swap_b32 v69, v71
  buffer_store_dwordx4 v[68:71], v28, s[20:23], s38 offen offset:3072 sc1
  s_add_u32 s38, s38, 4096
  v_accvgpr_read_b32 v36, a32
  v_accvgpr_read_b32 v37, a33
  v_accvgpr_read_b32 v38, a34
  v_accvgpr_read_b32 v39, a35
  v_cvt_pk_bf16_f32 v32, v36, v37
  v_cvt_pk_bf16_f32 v33, v38, v39
  v_accvgpr_read_b32 v40, a36
  v_accvgpr_read_b32 v41, a37
  v_accvgpr_read_b32 v42, a38
  v_accvgpr_read_b32 v43, a39
  v_cvt_pk_bf16_f32 v34, v40, v41
  v_cvt_pk_bf16_f32 v35, v42, v43
  s_nop 1
  v_permlane16_swap_b32 v32, v34
  v_permlane16_swap_b32 v33, v35
  buffer_store_dwordx4 v[32:35], v28, s[20:23], s38 offen offset:0 sc1
  v_accvgpr_read_b32 v48, a40
  v_accvgpr_read_b32 v49, a41
  v_accvgpr_read_b32 v50, a42
  v_accvgpr_read_b32 v51, a43
  v_cvt_pk_bf16_f32 v44, v48, v49
  v_cvt_pk_bf16_f32 v45, v50, v51
  v_accvgpr_read_b32 v52, a44
  v_accvgpr_read_b32 v53, a45
  v_accvgpr_read_b32 v54, a46
  v_accvgpr_read_b32 v55, a47
  v_cvt_pk_bf16_f32 v46, v52, v53
  v_cvt_pk_bf16_f32 v47, v54, v55
  s_nop 1
  v_permlane16_swap_b32 v44, v46
  v_permlane16_swap_b32 v45, v47
  buffer_store_dwordx4 v[44:47], v28, s[20:23], s38 offen offset:1024 sc1
  v_accvgpr_read_b32 v60, a48
  v_accvgpr_read_b32 v61, a49
  v_accvgpr_read_b32 v62, a50
  v_accvgpr_read_b32 v63, a51
  v_cvt_pk_bf16_f32 v56, v60, v61
  v_cvt_pk_bf16_f32 v57, v62, v63
  v_accvgpr_read_b32 v64, a52
  v_accvgpr_read_b32 v65, a53
  v_accvgpr_read_b32 v66, a54
  v_accvgpr_read_b32 v67, a55
  v_cvt_pk_bf16_f32 v58, v64, v65
  v_cvt_pk_bf16_f32 v59, v66, v67
  s_nop 1
  v_permlane16_swap_b32 v56, v58
  v_permlane16_swap_b32 v57, v59
  buffer_store_dwordx4 v[56:59], v28, s[20:23], s38 offen offset:2048 sc1
  v_accvgpr_read_b32 v72, a56
  v_accvgpr_read_b32 v73, a57
  v_accvgpr_read_b32 v74, a58
  v_accvgpr_read_b32 v75, a59
  v_cvt_pk_bf16_f32 v68, v72, v73
  v_cvt_pk_bf16_f32 v69, v74, v75
  v_accvgpr_read_b32 v76, a60
  v_accvgpr_read_b32 v77, a61
  v_accvgpr_read_b32 v78, a62
  v_accvgpr_read_b32 v79, a63
  v_cvt_pk_bf16_f32 v70, v76, v77
  v_cvt_pk_bf16_f32 v71, v78, v79
  s_nop 1
  v_permlane16_swap_b32 v68, v70
  v_permlane16_swap_b32 v69, v71
  buffer_store_dwordx4 v[68:71], v28, s[20:23], s38 offen offset:3072 sc1
  s_add_u32 s38, s38, 258048
  v_accvgpr_read_b32 v36, a64
  v_accvgpr_read_b32 v37, a65
  v_accvgpr_read_b32 v38, a66
  v_accvgpr_read_b32 v39, a67
  v_cvt_pk_bf16_f32 v32, v36, v37
  v_cvt_pk_bf16_f32 v33, v38, v39
  v_accvgpr_read_b32 v40, a68
  v_accvgpr_read_b32 v41, a69
  v_accvgpr_read_b32 v42, a70
  v_accvgpr_read_b32 v43, a71
  v_cvt_pk_bf16_f32 v34, v40, v41
  v_cvt_pk_bf16_f32 v35, v42, v43
  s_nop 1
  v_permlane16_swap_b32 v32, v34
  v_permlane16_swap_b32 v33, v35
  buffer_store_dwordx4 v[32:35], v28, s[20:23], s38 offen offset:0 sc1
  v_accvgpr_read_b32 v48, a72
  v_accvgpr_read_b32 v49, a73
  v_accvgpr_read_b32 v50, a74
  v_accvgpr_read_b32 v51, a75
  v_cvt_pk_bf16_f32 v44, v48, v49
  v_cvt_pk_bf16_f32 v45, v50, v51
  v_accvgpr_read_b32 v52, a76
  v_accvgpr_read_b32 v53, a77
  v_accvgpr_read_b32 v54, a78
  v_accvgpr_read_b32 v55, a79
  v_cvt_pk_bf16_f32 v46, v52, v53
  v_cvt_pk_bf16_f32 v47, v54, v55
  s_nop 1
  v_permlane16_swap_b32 v44, v46
  v_permlane16_swap_b32 v45, v47
  buffer_store_dwordx4 v[44:47], v28, s[20:23], s38 offen offset:1024 sc1
  v_accvgpr_read_b32 v60, a80
  v_accvgpr_read_b32 v61, a81
  v_accvgpr_read_b32 v62, a82
  v_accvgpr_read_b32 v63, a83
  v_cvt_pk_bf16_f32 v56, v60, v61
  v_cvt_pk_bf16_f32 v57, v62, v63
  v_accvgpr_read_b32 v64, a84
  v_accvgpr_read_b32 v65, a85
  v_accvgpr_read_b32 v66, a86
  v_accvgpr_read_b32 v67, a87
  v_cvt_pk_bf16_f32 v58, v64, v65
  v_cvt_pk_bf16_f32 v59, v66, v67
  s_nop 1
  v_permlane16_swap_b32 v56, v58
  v_permlane16_swap_b32 v57, v59
  buffer_store_dwordx4 v[56:59], v28, s[20:23], s38 offen offset:2048 sc1
  v_accvgpr_read_b32 v72, a88
  v_accvgpr_read_b32 v73, a89
  v_accvgpr_read_b32 v74, a90
  v_accvgpr_read_b32 v75, a91
  v_cvt_pk_bf16_f32 v68, v72, v73
  v_cvt_pk_bf16_f32 v69, v74, v75
  v_accvgpr_read_b32 v76, a92
  v_accvgpr_read_b32 v77, a93
  v_accvgpr_read_b32 v78, a94
  v_accvgpr_read_b32 v79, a95
  v_cvt_pk_bf16_f32 v70, v76, v77
  v_cvt_pk_bf16_f32 v71, v78, v79
  s_nop 1
  v_permlane16_swap_b32 v68, v70
  v_permlane16_swap_b32 v69, v71
  buffer_store_dwordx4 v[68:71], v28, s[20:23], s38 offen offset:3072 sc1
  s_add_u32 s38, s38, 4096
  v_accvgpr_read_b32 v36, a96
  v_accvgpr_read_b32 v37, a97
  v_accvgpr_read_b32 v38, a98
  v_accvgpr_read_b32 v39, a99
  v_cvt_pk_bf16_f32 v32, v36, v37
  v_cvt_pk_bf16_f32 v33, v38, v39
  v_accvgpr_read_b32 v40, a100
  v_accvgpr_read_b32 v41, a101
  v_accvgpr_read_b32 v42, a102
  v_accvgpr_read_b32 v43, a103
  v_cvt_pk_bf16_f32 v34, v40, v41
  v_cvt_pk_bf16_f32 v35, v42, v43
  s_nop 1
  v_permlane16_swap_b32 v32, v34
  v_permlane16_swap_b32 v33, v35
  buffer_store_dwordx4 v[32:35], v28, s[20:23], s38 offen offset:0 sc1
  v_accvgpr_read_b32 v48, a104
  v_accvgpr_read_b32 v49, a105
  v_accvgpr_read_b32 v50, a106
  v_accvgpr_read_b32 v51, a107
  v_cvt_pk_bf16_f32 v44, v48, v49
  v_cvt_pk_bf16_f32 v45, v50, v51
  v_accvgpr_read_b32 v52, a108
  v_accvgpr_read_b32 v53, a109
  v_accvgpr_read_b32 v54, a110
  v_accvgpr_read_b32 v55, a111
  v_cvt_pk_bf16_f32 v46, v52, v53
  v_cvt_pk_bf16_f32 v47, v54, v55
  s_nop 1
  v_permlane16_swap_b32 v44, v46
  v_permlane16_swap_b32 v45, v47
  buffer_store_dwordx4 v[44:47], v28, s[20:23], s38 offen offset:1024 sc1
  v_accvgpr_read_b32 v60, a112
  v_accvgpr_read_b32 v61, a113
  v_accvgpr_read_b32 v62, a114
  v_accvgpr_read_b32 v63, a115
  v_cvt_pk_bf16_f32 v56, v60, v61
  v_cvt_pk_bf16_f32 v57, v62, v63
  v_accvgpr_read_b32 v64, a116
  v_accvgpr_read_b32 v65, a117
  v_accvgpr_read_b32 v66, a118
  v_accvgpr_read_b32 v67, a119
  v_cvt_pk_bf16_f32 v58, v64, v65
  v_cvt_pk_bf16_f32 v59, v66, v67
  s_nop 1
  v_permlane16_swap_b32 v56, v58
  v_permlane16_swap_b32 v57, v59
  buffer_store_dwordx4 v[56:59], v28, s[20:23], s38 offen offset:2048 sc1
  v_accvgpr_read_b32 v72, a120
  v_accvgpr_read_b32 v73, a121
  v_accvgpr_read_b32 v74, a122
  v_accvgpr_read_b32 v75, a123
  v_cvt_pk_bf16_f32 v68, v72, v73
  v_cvt_pk_bf16_f32 v69, v74, v75
  v_accvgpr_read_b32 v76, a124
  v_accvgpr_read_b32 v77, a125
  v_accvgpr_read_b32 v78, a126
  v_accvgpr_read_b32 v79, a127
  v_cvt_pk_bf16_f32 v70, v76, v77
  v_cvt_pk_bf16_f32 v71, v78, v79
  s_nop 1
  v_permlane16_swap_b32 v68, v70
  v_permlane16_swap_b32 v69, v71
  buffer_store_dwordx4 v[68:71], v28, s[20:23], s38 offen offset:3072 sc1
  s_add_u32 s38, s38, 258048
  v_accvgpr_read_b32 v36, a128
  v_accvgpr_read_b32 v37, a129
  v_accvgpr_read_b32 v38, a130
  v_accvgpr_read_b32 v39, a131
  v_cvt_pk_bf16_f32 v32, v36, v37
  v_cvt_pk_bf16_f32 v33, v38, v39
  v_accvgpr_read_b32 v40, a132
  v_accvgpr_read_b32 v41, a133
  v_accvgpr_read_b32 v42, a134
  v_accvgpr_read_b32 v43, a135
  v_cvt_pk_bf16_f32 v34, v40, v41
  v_cvt_pk_bf16_f32 v35, v42, v43
  s_nop 1
  v_permlane16_swap_b32 v32, v34
  v_permlane16_swap_b32 v33, v35
  buffer_store_dwordx4 v[32:35], v28, s[20:23], s38 offen offset:0 sc1
  v_accvgpr_read_b32 v48, a136
  v_accvgpr_read_b32 v49, a137
  v_accvgpr_read_b32 v50, a138
  v_accvgpr_read_b32 v51, a139
  v_cvt_pk_bf16_f32 v44, v48, v49
  v_cvt_pk_bf16_f32 v45, v50, v51
  v_accvgpr_read_b32 v52, a140
  v_accvgpr_read_b32 v53, a141
  v_accvgpr_read_b32 v54, a142
  v_accvgpr_read_b32 v55, a143
  v_cvt_pk_bf16_f32 v46, v52, v53
  v_cvt_pk_bf16_f32 v47, v54, v55
  s_nop 1
  v_permlane16_swap_b32 v44, v46
  v_permlane16_swap_b32 v45, v47
  buffer_store_dwordx4 v[44:47], v28, s[20:23], s38 offen offset:1024 sc1
  v_accvgpr_read_b32 v60, a144
  v_accvgpr_read_b32 v61, a145
  v_accvgpr_read_b32 v62, a146
  v_accvgpr_read_b32 v63, a147
  v_cvt_pk_bf16_f32 v56, v60, v61
  v_cvt_pk_bf16_f32 v57, v62, v63
  v_accvgpr_read_b32 v64, a148
  v_accvgpr_read_b32 v65, a149
  v_accvgpr_read_b32 v66, a150
  v_accvgpr_read_b32 v67, a151
  v_cvt_pk_bf16_f32 v58, v64, v65
  v_cvt_pk_bf16_f32 v59, v66, v67
  s_nop 1
  v_permlane16_swap_b32 v56, v58
  v_permlane16_swap_b32 v57, v59
  buffer_store_dwordx4 v[56:59], v28, s[20:23], s38 offen offset:2048 sc1
  v_accvgpr_read_b32 v72, a152
  v_accvgpr_read_b32 v73, a153
  v_accvgpr_read_b32 v74, a154
  v_accvgpr_read_b32 v75, a155
  v_cvt_pk_bf16_f32 v68, v72, v73
  v_cvt_pk_bf16_f32 v69, v74, v75
  v_accvgpr_read_b32 v76, a156
  v_accvgpr_read_b32 v77, a157
  v_accvgpr_read_b32 v78, a158
  v_accvgpr_read_b32 v79, a159
  v_cvt_pk_bf16_f32 v70, v76, v77
  v_cvt_pk_bf16_f32 v71, v78, v79
  s_nop 1
  v_permlane16_swap_b32 v68, v70
  v_permlane16_swap_b32 v69, v71
  buffer_store_dwordx4 v[68:71], v28, s[20:23], s38 offen offset:3072 sc1
  s_add_u32 s38, s38, 4096
  v_accvgpr_read_b32 v36, a160
  v_accvgpr_read_b32 v37, a161
  v_accvgpr_read_b32 v38, a162
  v_accvgpr_read_b32 v39, a163
  v_cvt_pk_bf16_f32 v32, v36, v37
  v_cvt_pk_bf16_f32 v33, v38, v39
  v_accvgpr_read_b32 v40, a164
  v_accvgpr_read_b32 v41, a165
  v_accvgpr_read_b32 v42, a166
  v_accvgpr_read_b32 v43, a167
  v_cvt_pk_bf16_f32 v34, v40, v41
  v_cvt_pk_bf16_f32 v35, v42, v43
  s_nop 1
  v_permlane16_swap_b32 v32, v34
  v_permlane16_swap_b32 v33, v35
  buffer_store_dwordx4 v[32:35], v28, s[20:23], s38 offen offset:0 sc1
  v_accvgpr_read_b32 v48, a168
  v_accvgpr_read_b32 v49, a169
  v_accvgpr_read_b32 v50, a170
  v_accvgpr_read_b32 v51, a171
  v_cvt_pk_bf16_f32 v44, v48, v49
  v_cvt_pk_bf16_f32 v45, v50, v51
  v_accvgpr_read_b32 v52, a172
  v_accvgpr_read_b32 v53, a173
  v_accvgpr_read_b32 v54, a174
  v_accvgpr_read_b32 v55, a175
  v_cvt_pk_bf16_f32 v46, v52, v53
  v_cvt_pk_bf16_f32 v47, v54, v55
  s_nop 1
  v_permlane16_swap_b32 v44, v46
  v_permlane16_swap_b32 v45, v47
  buffer_store_dwordx4 v[44:47], v28, s[20:23], s38 offen offset:1024 sc1
  v_accvgpr_read_b32 v60, a176
  v_accvgpr_read_b32 v61, a177
  v_accvgpr_read_b32 v62, a178
  v_accvgpr_read_b32 v63, a179
  v_cvt_pk_bf16_f32 v56, v60, v61
  v_cvt_pk_bf16_f32 v57, v62, v63
  v_accvgpr_read_b32 v64, a180
  v_accvgpr_read_b32 v65, a181
  v_accvgpr_read_b32 v66, a182
  v_accvgpr_read_b32 v67, a183
  v_cvt_pk_bf16_f32 v58, v64, v65
  v_cvt_pk_bf16_f32 v59, v66, v67
  s_nop 1
  v_permlane16_swap_b32 v56, v58
  v_permlane16_swap_b32 v57, v59
  buffer_store_dwordx4 v[56:59], v28, s[20:23], s38 offen offset:2048 sc1
  v_accvgpr_read_b32 v72, a184
  v_accvgpr_read_b32 v73, a185
  v_accvgpr_read_b32 v74, a186
  v_accvgpr_read_b32 v75, a187
  v_cvt_pk_bf16_f32 v68, v72, v73
  v_cvt_pk_bf16_f32 v69, v74, v75
  v_accvgpr_read_b32 v76, a188
  v_accvgpr_read_b32 v77, a189
  v_accvgpr_read_b32 v78, a190
  v_accvgpr_read_b32 v79, a191
  v_cvt_pk_bf16_f32 v70, v76, v77
  v_cvt_pk_bf16_f32 v71, v78, v79
  s_nop 1
  v_permlane16_swap_b32 v68, v70
  v_permlane16_swap_b32 v69, v71
  buffer_store_dwordx4 v[68:71], v28, s[20:23], s38 offen offset:3072 sc1
  s_add_u32 s38, s38, 258048
  v_accvgpr_read_b32 v36, a192
  v_accvgpr_read_b32 v37, a193
  v_accvgpr_read_b32 v38, a194
  v_accvgpr_read_b32 v39, a195
  v_cvt_pk_bf16_f32 v32, v36, v37
  v_cvt_pk_bf16_f32 v33, v38, v39
  v_accvgpr_read_b32 v40, a196
  v_accvgpr_read_b32 v41, a197
  v_accvgpr_read_b32 v42, a198
  v_accvgpr_read_b32 v43, a199
  v_cvt_pk_bf16_f32 v34, v40, v41
  v_cvt_pk_bf16_f32 v35, v42, v43
  s_nop 1
  v_permlane16_swap_b32 v32, v34
  v_permlane16_swap_b32 v33, v35
  buffer_store_dwordx4 v[32:35], v28, s[20:23], s38 offen offset:0 sc1
  v_accvgpr_read_b32 v48, a200
  v_accvgpr_read_b32 v49, a201
  v_accvgpr_read_b32 v50, a202
  v_accvgpr_read_b32 v51, a203
  v_cvt_pk_bf16_f32 v44, v48, v49
  v_cvt_pk_bf16_f32 v45, v50, v51
  v_accvgpr_read_b32 v52, a204
  v_accvgpr_read_b32 v53, a205
  v_accvgpr_read_b32 v54, a206
  v_accvgpr_read_b32 v55, a207
  v_cvt_pk_bf16_f32 v46, v52, v53
  v_cvt_pk_bf16_f32 v47, v54, v55
  s_nop 1
  v_permlane16_swap_b32 v44, v46
  v_permlane16_swap_b32 v45, v47
  buffer_store_dwordx4 v[44:47], v28, s[20:23], s38 offen offset:1024 sc1
  v_accvgpr_read_b32 v60, a208
  v_accvgpr_read_b32 v61, a209
  v_accvgpr_read_b32 v62, a210
  v_accvgpr_read_b32 v63, a211
  v_cvt_pk_bf16_f32 v56, v60, v61
  v_cvt_pk_bf16_f32 v57, v62, v63
  v_accvgpr_read_b32 v64, a212
  v_accvgpr_read_b32 v65, a213
  v_accvgpr_read_b32 v66, a214
  v_accvgpr_read_b32 v67, a215
  v_cvt_pk_bf16_f32 v58, v64, v65
  v_cvt_pk_bf16_f32 v59, v66, v67
  s_nop 1
  v_permlane16_swap_b32 v56, v58
  v_permlane16_swap_b32 v57, v59
  buffer_store_dwordx4 v[56:59], v28, s[20:23], s38 offen offset:2048 sc1
  v_accvgpr_read_b32 v72, a216
  v_accvgpr_read_b32 v73, a217
  v_accvgpr_read_b32 v74, a218
  v_accvgpr_read_b32 v75, a219
  v_cvt_pk_bf16_f32 v68, v72, v73
  v_cvt_pk_bf16_f32 v69, v74, v75
  v_accvgpr_read_b32 v76, a220
  v_accvgpr_read_b32 v77, a221
  v_accvgpr_read_b32 v78, a222
  v_accvgpr_read_b32 v79, a223
  v_cvt_pk_bf16_f32 v70, v76, v77
  v_cvt_pk_bf16_f32 v71, v78, v79
  s_nop 1
  v_permlane16_swap_b32 v68, v70
  v_permlane16_swap_b32 v69, v71
  buffer_store_dwordx4 v[68:71], v28, s[20:23], s38 offen offset:3072 sc1
  s_add_u32 s38, s38, 4096
  v_accvgpr_read_b32 v36, a224
  v_accvgpr_read_b32 v37, a225
  v_accvgpr_read_b32 v38, a226
  v_accvgpr_read_b32 v39, a227
  v_cvt_pk_bf16_f32 v32, v36, v37
  v_cvt_pk_bf16_f32 v33, v38, v39
  v_accvgpr_read_b32 v40, a228
  v_accvgpr_read_b32 v41, a229
  v_accvgpr_read_b32 v42, a230
  v_accvgpr_read_b32 v43, a231
  v_cvt_pk_bf16_f32 v34, v40, v41
  v_cvt_pk_bf16_f32 v35, v42, v43
  s_nop 1
  v_permlane16_swap_b32 v32, v34
  v_permlane16_swap_b32 v33, v35
  buffer_store_dwordx4 v[32:35], v28, s[20:23], s38 offen offset:0 sc1
  v_accvgpr_read_b32 v48, a232
  v_accvgpr_read_b32 v49, a233
  v_accvgpr_read_b32 v50, a234
  v_accvgpr_read_b32 v51, a235
  v_cvt_pk_bf16_f32 v44, v48, v49
  v_cvt_pk_bf16_f32 v45, v50, v51
  v_accvgpr_read_b32 v52, a236
  v_accvgpr_read_b32 v53, a237
  v_accvgpr_read_b32 v54, a238
  v_accvgpr_read_b32 v55, a239
  v_cvt_pk_bf16_f32 v46, v52, v53
  v_cvt_pk_bf16_f32 v47, v54, v55
  s_nop 1
  v_permlane16_swap_b32 v44, v46
  v_permlane16_swap_b32 v45, v47
  buffer_store_dwordx4 v[44:47], v28, s[20:23], s38 offen offset:1024 sc1
  v_accvgpr_read_b32 v60, a240
  v_accvgpr_read_b32 v61, a241
  v_accvgpr_read_b32 v62, a242
  v_accvgpr_read_b32 v63, a243
  v_cvt_pk_bf16_f32 v56, v60, v61
  v_cvt_pk_bf16_f32 v57, v62, v63
  v_accvgpr_read_b32 v64, a244
  v_accvgpr_read_b32 v65, a245
  v_accvgpr_read_b32 v66, a246
  v_accvgpr_read_b32 v67, a247
  v_cvt_pk_bf16_f32 v58, v64, v65
  v_cvt_pk_bf16_f32 v59, v66, v67
  s_nop 1
  v_permlane16_swap_b32 v56, v58
  v_permlane16_swap_b32 v57, v59
  buffer_store_dwordx4 v[56:59], v28, s[20:23], s38 offen offset:2048 sc1
  v_accvgpr_read_b32 v72, a248
  v_accvgpr_read_b32 v73, a249
  v_accvgpr_read_b32 v74, a250
  v_accvgpr_read_b32 v75, a251
  v_cvt_pk_bf16_f32 v68, v72, v73
  v_cvt_pk_bf16_f32 v69, v74, v75
  v_accvgpr_read_b32 v76, a252
  v_accvgpr_read_b32 v77, a253
  v_accvgpr_read_b32 v78, a254
  v_accvgpr_read_b32 v79, a255
  v_cvt_pk_bf16_f32 v70, v76, v77
  v_cvt_pk_bf16_f32 v71, v78, v79
  s_nop 1
  v_permlane16_swap_b32 v68, v70
  v_permlane16_swap_b32 v69, v71
  buffer_store_dwordx4 v[68:71], v28, s[20:23], s38 offen offset:3072 sc1
  s_add_u32 s38, s38, 258048
  s_branch Lmg_qd_42
Lqkv_v_43:
  s_add_u32 m0, s45, 0
  s_nop 0
  buffer_load_dwordx4 v4, s[12:15], s46 offen lds
  s_add_u32 m0, s45, 4096
  s_nop 0
  buffer_load_dwordx4 v5, s[12:15], s46 offen lds
  s_add_u32 m0, s45, 8192
  s_nop 0
  buffer_load_dwordx4 v6, s[12:15], s46 offen lds
  s_add_u32 m0, s45, 12288
  s_nop 0
  buffer_load_dwordx4 v7, s[12:15], s46 offen lds
  s_add_u32 m0, s44, 0
  s_nop 0
  buffer_load_dwordx4 v12, s[16:19], s47 offen lds
  s_add_u32 m0, s44, 4096
  s_nop 0
  buffer_load_dwordx4 v13, s[16:19], s47 offen lds
  s_add_u32 m0, s44, 8192
  s_nop 0
  buffer_load_dwordx4 v14, s[16:19], s47 offen lds
  s_add_u32 m0, s44, 12288
  s_nop 0
  buffer_load_dwordx4 v15, s[16:19], s47 offen lds
  s_add_u32 s47, s47, 262144
  s_add_u32 m0, s45, 16384
  s_nop 0
  buffer_load_dwordx4 v8, s[12:15], s46 offen lds
  s_add_u32 m0, s45, 20480
  s_nop 0
  buffer_load_dwordx4 v9, s[12:15], s46 offen lds
  s_add_u32 m0, s45, 24576
  s_nop 0
  buffer_load_dwordx4 v10, s[12:15], s46 offen lds
  s_add_u32 m0, s45, 28672
  s_nop 0
  buffer_load_dwordx4 v11, s[12:15], s46 offen lds
  s_add_u32 m0, s44, 16384
  s_nop 0
  buffer_load_dwordx4 v12, s[16:19], s47 offen lds
  s_add_u32 m0, s44, 20480
  s_nop 0
  buffer_load_dwordx4 v13, s[16:19], s47 offen lds
  s_add_u32 m0, s44, 24576
  s_nop 0
  buffer_load_dwordx4 v14, s[16:19], s47 offen lds
  s_add_u32 m0, s44, 28672
  s_nop 0
  buffer_load_dwordx4 v15, s[16:19], s47 offen lds
  s_add_u32 s46, s46, 128
  s_add_u32 s47, s47, 262144
  s_add_u32 m0, s45, 32768
  s_nop 0
  buffer_load_dwordx4 v4, s[12:15], s46 offen lds
  s_add_u32 m0, s45, 36864
  s_nop 0
  buffer_load_dwordx4 v5, s[12:15], s46 offen lds
  s_add_u32 m0, s45, 40960
  s_nop 0
  buffer_load_dwordx4 v6, s[12:15], s46 offen lds
  s_add_u32 m0, s45, 45056
  s_nop 0
  buffer_load_dwordx4 v7, s[12:15], s46 offen lds
  s_add_u32 m0, s44, 32768
  s_nop 0
  buffer_load_dwordx4 v12, s[16:19], s47 offen lds
  s_add_u32 m0, s44, 36864
  s_nop 0
  buffer_load_dwordx4 v13, s[16:19], s47 offen lds
  s_add_u32 m0, s44, 40960
  s_nop 0
  buffer_load_dwordx4 v14, s[16:19], s47 offen lds
  s_add_u32 m0, s44, 45056
  s_nop 0
  buffer_load_dwordx4 v15, s[16:19], s47 offen lds
  s_add_u32 s47, s47, 262144
  s_add_u32 m0, s45, 49152
  s_nop 0
  buffer_load_dwordx4 v8, s[12:15], s46 offen lds
  s_add_u32 m0, s45, 53248
  s_nop 0
  buffer_load_dwordx4 v9, s[12:15], s46 offen lds
  s_add_u32 m0, s45, 57344
  s_nop 0
  buffer_load_dwordx4 v10, s[12:15], s46 offen lds
  s_add_u32 m0, s45, 61440
  s_nop 0
  buffer_load_dwordx4 v11, s[12:15], s46 offen lds
  s_add_u32 m0, s44, 49152
  s_nop 0
  buffer_load_dwordx4 v12, s[16:19], s47 offen lds
  s_add_u32 m0, s44, 53248
  s_nop 0
  buffer_load_dwordx4 v13, s[16:19], s47 offen lds
  s_add_u32 m0, s44, 57344
  s_nop 0
  buffer_load_dwordx4 v14, s[16:19], s47 offen lds
  s_add_u32 m0, s44, 61440
  s_nop 0
  buffer_load_dwordx4 v15, s[16:19], s47 offen lds
  s_add_u32 s46, s46, 128
  s_add_u32 s47, s47, 262144
  v_accvgpr_write_b32 a0, 0
  v_accvgpr_write_b32 a1, 0
  v_accvgpr_write_b32 a2, 0
  v_accvgpr_write_b32 a3, 0
  v_accvgpr_write_b32 a4, 0
  v_accvgpr_write_b32 a5, 0
  v_accvgpr_write_b32 a6, 0
  v_accvgpr_write_b32 a7, 0
  v_accvgpr_write_b32 a8, 0
  v_accvgpr_write_b32 a9, 0
  v_accvgpr_write_b32 a10, 0
  v_accvgpr_write_b32 a11, 0
  v_accvgpr_write_b32 a12, 0
  v_accvgpr_write_b32 a13, 0
  v_accvgpr_write_b32 a14, 0
  v_accvgpr_write_b32 a15, 0
  v_accvgpr_write_b32 a16, 0
  v_accvgpr_write_b32 a17, 0
  v_accvgpr_write_b32 a18, 0
  v_accvgpr_write_b32 a19, 0
  v_accvgpr_write_b32 a20, 0
  v_accvgpr_write_b32 a21, 0
  v_accvgpr_write_b32 a22, 0
  v_accvgpr_write_b32 a23, 0
  v_accvgpr_write_b32 a24, 0
  v_accvgpr_write_b32 a25, 0
  v_accvgpr_write_b32 a26, 0
  v_accvgpr_write_b32 a27, 0
  v_accvgpr_write_b32 a28, 0
  v_accvgpr_write_b32 a29, 0
  v_accvgpr_write_b32 a30, 0
  v_accvgpr_write_b32 a31, 0
  v_accvgpr_write_b32 a32, 0
  v_accvgpr_write_b32 a33, 0
  v_accvgpr_write_b32 a34, 0
  v_accvgpr_write_b32 a35, 0
  v_accvgpr_write_b32 a36, 0
  v_accvgpr_write_b32 a37, 0
  v_accvgpr_write_b32 a38, 0
  v_accvgpr_write_b32 a39, 0
  v_accvgpr_write_b32 a40, 0
  v_accvgpr_write_b32 a41, 0
  v_accvgpr_write_b32 a42, 0
  v_accvgpr_write_b32 a43, 0
  v_accvgpr_write_b32 a44, 0
  v_accvgpr_write_b32 a45, 0
  v_accvgpr_write_b32 a46, 0
  v_accvgpr_write_b32 a47, 0
  v_accvgpr_write_b32 a48, 0
  v_accvgpr_write_b32 a49, 0
  v_accvgpr_write_b32 a50, 0
  v_accvgpr_write_b32 a51, 0
  v_accvgpr_write_b32 a52, 0
  v_accvgpr_write_b32 a53, 0
  v_accvgpr_write_b32 a54, 0
  v_accvgpr_write_b32 a55, 0
  v_accvgpr_write_b32 a56, 0
  v_accvgpr_write_b32 a57, 0
  v_accvgpr_write_b32 a58, 0
  v_accvgpr_write_b32 a59, 0
  v_accvgpr_write_b32 a60, 0
  v_accvgpr_write_b32 a61, 0
  v_accvgpr_write_b32 a62, 0
  v_accvgpr_write_b32 a63, 0
  v_accvgpr_write_b32 a64, 0
  v_accvgpr_write_b32 a65, 0
  v_accvgpr_write_b32 a66, 0
  v_accvgpr_write_b32 a67, 0
  v_accvgpr_write_b32 a68, 0
  v_accvgpr_write_b32 a69, 0
  v_accvgpr_write_b32 a70, 0
  v_accvgpr_write_b32 a71, 0
  v_accvgpr_write_b32 a72, 0
  v_accvgpr_write_b32 a73, 0
  v_accvgpr_write_b32 a74, 0
  v_accvgpr_write_b32 a75, 0
  v_accvgpr_write_b32 a76, 0
  v_accvgpr_write_b32 a77, 0
  v_accvgpr_write_b32 a78, 0
  v_accvgpr_write_b32 a79, 0
  v_accvgpr_write_b32 a80, 0
  v_accvgpr_write_b32 a81, 0
  v_accvgpr_write_b32 a82, 0
  v_accvgpr_write_b32 a83, 0
  v_accvgpr_write_b32 a84, 0
  v_accvgpr_write_b32 a85, 0
  v_accvgpr_write_b32 a86, 0
  v_accvgpr_write_b32 a87, 0
  v_accvgpr_write_b32 a88, 0
  v_accvgpr_write_b32 a89, 0
  v_accvgpr_write_b32 a90, 0
  v_accvgpr_write_b32 a91, 0
  v_accvgpr_write_b32 a92, 0
  v_accvgpr_write_b32 a93, 0
  v_accvgpr_write_b32 a94, 0
  v_accvgpr_write_b32 a95, 0
  v_accvgpr_write_b32 a96, 0
  v_accvgpr_write_b32 a97, 0
  v_accvgpr_write_b32 a98, 0
  v_accvgpr_write_b32 a99, 0
  v_accvgpr_write_b32 a100, 0
  v_accvgpr_write_b32 a101, 0
  v_accvgpr_write_b32 a102, 0
  v_accvgpr_write_b32 a103, 0
  v_accvgpr_write_b32 a104, 0
  v_accvgpr_write_b32 a105, 0
  v_accvgpr_write_b32 a106, 0
  v_accvgpr_write_b32 a107, 0
  v_accvgpr_write_b32 a108, 0
  v_accvgpr_write_b32 a109, 0
  v_accvgpr_write_b32 a110, 0
  v_accvgpr_write_b32 a111, 0
  v_accvgpr_write_b32 a112, 0
  v_accvgpr_write_b32 a113, 0
  v_accvgpr_write_b32 a114, 0
  v_accvgpr_write_b32 a115, 0
  v_accvgpr_write_b32 a116, 0
  v_accvgpr_write_b32 a117, 0
  v_accvgpr_write_b32 a118, 0
  v_accvgpr_write_b32 a119, 0
  v_accvgpr_write_b32 a120, 0
  v_accvgpr_write_b32 a121, 0
  v_accvgpr_write_b32 a122, 0
  v_accvgpr_write_b32 a123, 0
  v_accvgpr_write_b32 a124, 0
  v_accvgpr_write_b32 a125, 0
  v_accvgpr_write_b32 a126, 0
  v_accvgpr_write_b32 a127, 0
  v_accvgpr_write_b32 a128, 0
  v_accvgpr_write_b32 a129, 0
  v_accvgpr_write_b32 a130, 0
  v_accvgpr_write_b32 a131, 0
  v_accvgpr_write_b32 a132, 0
  v_accvgpr_write_b32 a133, 0
  v_accvgpr_write_b32 a134, 0
  v_accvgpr_write_b32 a135, 0
  v_accvgpr_write_b32 a136, 0
  v_accvgpr_write_b32 a137, 0
  v_accvgpr_write_b32 a138, 0
  v_accvgpr_write_b32 a139, 0
  v_accvgpr_write_b32 a140, 0
  v_accvgpr_write_b32 a141, 0
  v_accvgpr_write_b32 a142, 0
  v_accvgpr_write_b32 a143, 0
  v_accvgpr_write_b32 a144, 0
  v_accvgpr_write_b32 a145, 0
  v_accvgpr_write_b32 a146, 0
  v_accvgpr_write_b32 a147, 0
  v_accvgpr_write_b32 a148, 0
  v_accvgpr_write_b32 a149, 0
  v_accvgpr_write_b32 a150, 0
  v_accvgpr_write_b32 a151, 0
  v_accvgpr_write_b32 a152, 0
  v_accvgpr_write_b32 a153, 0
  v_accvgpr_write_b32 a154, 0
  v_accvgpr_write_b32 a155, 0
  v_accvgpr_write_b32 a156, 0
  v_accvgpr_write_b32 a157, 0
  v_accvgpr_write_b32 a158, 0
  v_accvgpr_write_b32 a159, 0
  v_accvgpr_write_b32 a160, 0
  v_accvgpr_write_b32 a161, 0
  v_accvgpr_write_b32 a162, 0
  v_accvgpr_write_b32 a163, 0
  v_accvgpr_write_b32 a164, 0
  v_accvgpr_write_b32 a165, 0
  v_accvgpr_write_b32 a166, 0
  v_accvgpr_write_b32 a167, 0
  v_accvgpr_write_b32 a168, 0
  v_accvgpr_write_b32 a169, 0
  v_accvgpr_write_b32 a170, 0
  v_accvgpr_write_b32 a171, 0
  v_accvgpr_write_b32 a172, 0
  v_accvgpr_write_b32 a173, 0
  v_accvgpr_write_b32 a174, 0
  v_accvgpr_write_b32 a175, 0
  v_accvgpr_write_b32 a176, 0
  v_accvgpr_write_b32 a177, 0
  v_accvgpr_write_b32 a178, 0
  v_accvgpr_write_b32 a179, 0
  v_accvgpr_write_b32 a180, 0
  v_accvgpr_write_b32 a181, 0
  v_accvgpr_write_b32 a182, 0
  v_accvgpr_write_b32 a183, 0
  v_accvgpr_write_b32 a184, 0
  v_accvgpr_write_b32 a185, 0
  v_accvgpr_write_b32 a186, 0
  v_accvgpr_write_b32 a187, 0
  v_accvgpr_write_b32 a188, 0
  v_accvgpr_write_b32 a189, 0
  v_accvgpr_write_b32 a190, 0
  v_accvgpr_write_b32 a191, 0
  v_accvgpr_write_b32 a192, 0
  v_accvgpr_write_b32 a193, 0
  v_accvgpr_write_b32 a194, 0
  v_accvgpr_write_b32 a195, 0
  v_accvgpr_write_b32 a196, 0
  v_accvgpr_write_b32 a197, 0
  v_accvgpr_write_b32 a198, 0
  v_accvgpr_write_b32 a199, 0
  v_accvgpr_write_b32 a200, 0
  v_accvgpr_write_b32 a201, 0
  v_accvgpr_write_b32 a202, 0
  v_accvgpr_write_b32 a203, 0
  v_accvgpr_write_b32 a204, 0
  v_accvgpr_write_b32 a205, 0
  v_accvgpr_write_b32 a206, 0
  v_accvgpr_write_b32 a207, 0
  v_accvgpr_write_b32 a208, 0
  v_accvgpr_write_b32 a209, 0
  v_accvgpr_write_b32 a210, 0
  v_accvgpr_write_b32 a211, 0
  v_accvgpr_write_b32 a212, 0
  v_accvgpr_write_b32 a213, 0
  v_accvgpr_write_b32 a214, 0
  v_accvgpr_write_b32 a215, 0
  v_accvgpr_write_b32 a216, 0
  v_accvgpr_write_b32 a217, 0
  v_accvgpr_write_b32 a218, 0
  v_accvgpr_write_b32 a219, 0
  v_accvgpr_write_b32 a220, 0
  v_accvgpr_write_b32 a221, 0
  v_accvgpr_write_b32 a222, 0
  v_accvgpr_write_b32 a223, 0
  v_accvgpr_write_b32 a224, 0
  v_accvgpr_write_b32 a225, 0
  v_accvgpr_write_b32 a226, 0
  v_accvgpr_write_b32 a227, 0
  v_accvgpr_write_b32 a228, 0
  v_accvgpr_write_b32 a229, 0
  v_accvgpr_write_b32 a230, 0
  v_accvgpr_write_b32 a231, 0
  v_accvgpr_write_b32 a232, 0
  v_accvgpr_write_b32 a233, 0
  v_accvgpr_write_b32 a234, 0
  v_accvgpr_write_b32 a235, 0
  v_accvgpr_write_b32 a236, 0
  v_accvgpr_write_b32 a237, 0
  v_accvgpr_write_b32 a238, 0
  v_accvgpr_write_b32 a239, 0
  v_accvgpr_write_b32 a240, 0
  v_accvgpr_write_b32 a241, 0
  v_accvgpr_write_b32 a242, 0
  v_accvgpr_write_b32 a243, 0
  v_accvgpr_write_b32 a244, 0
  v_accvgpr_write_b32 a245, 0
  v_accvgpr_write_b32 a246, 0
  v_accvgpr_write_b32 a247, 0
  v_accvgpr_write_b32 a248, 0
  v_accvgpr_write_b32 a249, 0
  v_accvgpr_write_b32 a250, 0
  v_accvgpr_write_b32 a251, 0
  v_accvgpr_write_b32 a252, 0
  v_accvgpr_write_b32 a253, 0
  v_accvgpr_write_b32 a254, 0
  v_accvgpr_write_b32 a255, 0
  s_waitcnt vmcnt(16)
  s_barrier
  ds_read_b128 v[28:31], v16 offset:0
  ds_read_b128 v[32:35], v16 offset:2048
  ds_read_b128 v[36:39], v16 offset:4096
  ds_read_b128 v[40:43], v16 offset:6144
  ds_read_b128 v[44:47], v16 offset:8192
  ds_read_b128 v[48:51], v16 offset:10240
  ds_read_b128 v[52:55], v16 offset:12288
  ds_read_b128 v[56:59], v16 offset:14336
  ds_read_b64_tr_b16 v[60:61], v18 offset:0
  ds_read_b64_tr_b16 v[62:63], v18 offset:2048
  ds_read_b64_tr_b16 v[64:65], v19 offset:0
  ds_read_b64_tr_b16 v[66:67], v19 offset:2048
  ds_read_b64_tr_b16 v[68:69], v20 offset:0
  ds_read_b64_tr_b16 v[70:71], v20 offset:2048
  ds_read_b64_tr_b16 v[72:73], v21 offset:0
  ds_read_b64_tr_b16 v[74:75], v21 offset:2048
  ds_read_b64_tr_b16 v[76:77], v22 offset:0
  ds_read_b64_tr_b16 v[78:79], v22 offset:2048
  ds_read_b64_tr_b16 v[80:81], v23 offset:0
  ds_read_b64_tr_b16 v[82:83], v23 offset:2048
  ds_read_b64_tr_b16 v[84:85], v24 offset:0
  ds_read_b64_tr_b16 v[86:87], v24 offset:2048
  ds_read_b64_tr_b16 v[88:89], v25 offset:0
  ds_read_b64_tr_b16 v[90:91], v25 offset:2048
  s_waitcnt lgkmcnt(0)
  v_mfma_f32_16x16x32_bf16 a[0:3], v[28:31], v[60:63], a[0:3]
  ds_read_b128 v[92:95], v17 offset:0
  v_mfma_f32_16x16x32_bf16 a[4:7], v[28:31], v[64:67], a[4:7]
  ds_read_b128 v[96:99], v17 offset:2048
  v_mfma_f32_16x16x32_bf16 a[8:11], v[28:31], v[68:71], a[8:11]
  ds_read_b128 v[100:103], v17 offset:4096
  v_mfma_f32_16x16x32_bf16 a[12:15], v[28:31], v[72:75], a[12:15]
  v_mfma_f32_16x16x32_bf16 a[16:19], v[28:31], v[76:79], a[16:19]
  ds_read_b128 v[104:107], v17 offset:6144
  v_mfma_f32_16x16x32_bf16 a[20:23], v[28:31], v[80:83], a[20:23]
  ds_read_b128 v[108:111], v17 offset:8192
  v_mfma_f32_16x16x32_bf16 a[24:27], v[28:31], v[84:87], a[24:27]
  v_mfma_f32_16x16x32_bf16 a[28:31], v[28:31], v[88:91], a[28:31]
  ds_read_b128 v[112:115], v17 offset:10240
  v_mfma_f32_16x16x32_bf16 a[32:35], v[32:35], v[60:63], a[32:35]
  ds_read_b128 v[116:119], v17 offset:12288
  v_mfma_f32_16x16x32_bf16 a[36:39], v[32:35], v[64:67], a[36:39]
  v_mfma_f32_16x16x32_bf16 a[40:43], v[32:35], v[68:71], a[40:43]
  ds_read_b128 v[120:123], v17 offset:14336
  v_mfma_f32_16x16x32_bf16 a[44:47], v[32:35], v[72:75], a[44:47]
  ds_read_b64_tr_b16 v[124:125], v18 offset:16384
  v_mfma_f32_16x16x32_bf16 a[48:51], v[32:35], v[76:79], a[48:51]
  v_mfma_f32_16x16x32_bf16 a[52:55], v[32:35], v[80:83], a[52:55]
  ds_read_b64_tr_b16 v[126:127], v18 offset:18432
  v_mfma_f32_16x16x32_bf16 a[56:59], v[32:35], v[84:87], a[56:59]
  ds_read_b64_tr_b16 v[128:129], v19 offset:16384
  v_mfma_f32_16x16x32_bf16 a[60:63], v[32:35], v[88:91], a[60:63]
  v_mfma_f32_16x16x32_bf16 a[64:67], v[36:39], v[60:63], a[64:67]
  ds_read_b64_tr_b16 v[130:131], v19 offset:18432
  v_mfma_f32_16x16x32_bf16 a[68:71], v[36:39], v[64:67], a[68:71]
  ds_read_b64_tr_b16 v[132:133], v20 offset:16384
  v_mfma_f32_16x16x32_bf16 a[72:75], v[36:39], v[68:71], a[72:75]
  ds_read_b64_tr_b16 v[134:135], v20 offset:18432
  v_mfma_f32_16x16x32_bf16 a[76:79], v[36:39], v[72:75], a[76:79]
  v_mfma_f32_16x16x32_bf16 a[80:83], v[36:39], v[76:79], a[80:83]
  ds_read_b64_tr_b16 v[136:137], v21 offset:16384
  v_mfma_f32_16x16x32_bf16 a[84:87], v[36:39], v[80:83], a[84:87]
  ds_read_b64_tr_b16 v[138:139], v21 offset:18432
  v_mfma_f32_16x16x32_bf16 a[88:91], v[36:39], v[84:87], a[88:91]
  v_mfma_f32_16x16x32_bf16 a[92:95], v[36:39], v[88:91], a[92:95]
  ds_read_b64_tr_b16 v[140:141], v22 offset:16384
  v_mfma_f32_16x16x32_bf16 a[96:99], v[40:43], v[60:63], a[96:99]
  ds_read_b64_tr_b16 v[142:143], v22 offset:18432
  v_mfma_f32_16x16x32_bf16 a[100:103], v[40:43], v[64:67], a[100:103]
  v_mfma_f32_16x16x32_bf16 a[104:107], v[40:43], v[68:71], a[104:107]
  ds_read_b64_tr_b16 v[144:145], v23 offset:16384
  v_mfma_f32_16x16x32_bf16 a[108:111], v[40:43], v[72:75], a[108:111]
  ds_read_b64_tr_b16 v[146:147], v23 offset:18432
  v_mfma_f32_16x16x32_bf16 a[112:115], v[40:43], v[76:79], a[112:115]
  v_mfma_f32_16x16x32_bf16 a[116:119], v[40:43], v[80:83], a[116:119]
  ds_read_b64_tr_b16 v[148:149], v24 offset:16384
  v_mfma_f32_16x16x32_bf16 a[120:123], v[40:43], v[84:87], a[120:123]
  ds_read_b64_tr_b16 v[150:151], v24 offset:18432
  v_mfma_f32_16x16x32_bf16 a[124:127], v[40:43], v[88:91], a[124:127]
  v_mfma_f32_16x16x32_bf16 a[128:131], v[44:47], v[60:63], a[128:131]
  ds_read_b64_tr_b16 v[152:153], v25 offset:16384
  v_mfma_f32_16x16x32_bf16 a[132:135], v[44:47], v[64:67], a[132:135]
  ds_read_b64_tr_b16 v[154:155], v25 offset:18432
  v_mfma_f32_16x16x32_bf16 a[136:139], v[44:47], v[68:71], a[136:139]
  v_mfma_f32_16x16x32_bf16 a[140:143], v[44:47], v[72:75], a[140:143]
  v_mfma_f32_16x16x32_bf16 a[144:147], v[44:47], v[76:79], a[144:147]
  v_mfma_f32_16x16x32_bf16 a[148:151], v[44:47], v[80:83], a[148:151]
  v_mfma_f32_16x16x32_bf16 a[152:155], v[44:47], v[84:87], a[152:155]
  v_mfma_f32_16x16x32_bf16 a[156:159], v[44:47], v[88:91], a[156:159]
  v_mfma_f32_16x16x32_bf16 a[160:163], v[48:51], v[60:63], a[160:163]
  v_mfma_f32_16x16x32_bf16 a[164:167], v[48:51], v[64:67], a[164:167]
  v_mfma_f32_16x16x32_bf16 a[168:171], v[48:51], v[68:71], a[168:171]
  v_mfma_f32_16x16x32_bf16 a[172:175], v[48:51], v[72:75], a[172:175]
  v_mfma_f32_16x16x32_bf16 a[176:179], v[48:51], v[76:79], a[176:179]
  v_mfma_f32_16x16x32_bf16 a[180:183], v[48:51], v[80:83], a[180:183]
  v_mfma_f32_16x16x32_bf16 a[184:187], v[48:51], v[84:87], a[184:187]
  v_mfma_f32_16x16x32_bf16 a[188:191], v[48:51], v[88:91], a[188:191]
  v_mfma_f32_16x16x32_bf16 a[192:195], v[52:55], v[60:63], a[192:195]
  v_mfma_f32_16x16x32_bf16 a[196:199], v[52:55], v[64:67], a[196:199]
  v_mfma_f32_16x16x32_bf16 a[200:203], v[52:55], v[68:71], a[200:203]
  v_mfma_f32_16x16x32_bf16 a[204:207], v[52:55], v[72:75], a[204:207]
  v_mfma_f32_16x16x32_bf16 a[208:211], v[52:55], v[76:79], a[208:211]
  v_mfma_f32_16x16x32_bf16 a[212:215], v[52:55], v[80:83], a[212:215]
  v_mfma_f32_16x16x32_bf16 a[216:219], v[52:55], v[84:87], a[216:219]
  v_mfma_f32_16x16x32_bf16 a[220:223], v[52:55], v[88:91], a[220:223]
  v_mfma_f32_16x16x32_bf16 a[224:227], v[56:59], v[60:63], a[224:227]
  v_mfma_f32_16x16x32_bf16 a[228:231], v[56:59], v[64:67], a[228:231]
  v_mfma_f32_16x16x32_bf16 a[232:235], v[56:59], v[68:71], a[232:235]
  v_mfma_f32_16x16x32_bf16 a[236:239], v[56:59], v[72:75], a[236:239]
  v_mfma_f32_16x16x32_bf16 a[240:243], v[56:59], v[76:79], a[240:243]
  v_mfma_f32_16x16x32_bf16 a[244:247], v[56:59], v[80:83], a[244:247]
  v_mfma_f32_16x16x32_bf16 a[248:251], v[56:59], v[84:87], a[248:251]
  v_mfma_f32_16x16x32_bf16 a[252:255], v[56:59], v[88:91], a[252:255]
  s_waitcnt vmcnt(0) lgkmcnt(0)
  s_barrier
  v_mfma_f32_16x16x32_bf16 a[0:3], v[92:95], v[124:127], a[0:3]
  ds_read_b128 v[28:31], v16 offset:32768
  s_add_u32 m0, s45, 0
  v_mfma_f32_16x16x32_bf16 a[4:7], v[92:95], v[128:131], a[4:7]
  ds_read_b128 v[32:35], v16 offset:34816
  buffer_load_dwordx4 v4, s[12:15], s46 offen lds
  v_mfma_f32_16x16x32_bf16 a[8:11], v[92:95], v[132:135], a[8:11]
  ds_read_b128 v[36:39], v16 offset:36864
  v_mfma_f32_16x16x32_bf16 a[12:15], v[92:95], v[136:139], a[12:15]
  s_add_u32 m0, s45, 4096
  v_mfma_f32_16x16x32_bf16 a[16:19], v[92:95], v[140:143], a[16:19]
  ds_read_b128 v[40:43], v16 offset:38912
  v_mfma_f32_16x16x32_bf16 a[20:23], v[92:95], v[144:147], a[20:23]
  ds_read_b128 v[44:47], v16 offset:40960
  buffer_load_dwordx4 v5, s[12:15], s46 offen lds
  v_mfma_f32_16x16x32_bf16 a[24:27], v[92:95], v[148:151], a[24:27]
  v_mfma_f32_16x16x32_bf16 a[28:31], v[92:95], v[152:155], a[28:31]
  ds_read_b128 v[48:51], v16 offset:43008
  s_add_u32 m0, s45, 8192
  v_mfma_f32_16x16x32_bf16 a[32:35], v[96:99], v[124:127], a[32:35]
  ds_read_b128 v[52:55], v16 offset:45056
  v_mfma_f32_16x16x32_bf16 a[36:39], v[96:99], v[128:131], a[36:39]
  buffer_load_dwordx4 v6, s[12:15], s46 offen lds
  v_mfma_f32_16x16x32_bf16 a[40:43], v[96:99], v[132:135], a[40:43]
  ds_read_b128 v[56:59], v16 offset:47104
  v_mfma_f32_16x16x32_bf16 a[44:47], v[96:99], v[136:139], a[44:47]
  ds_read_b64_tr_b16 v[60:61], v18 offset:32768
  s_add_u32 m0, s45, 12288
  v_mfma_f32_16x16x32_bf16 a[48:51], v[96:99], v[140:143], a[48:51]
  v_mfma_f32_16x16x32_bf16 a[52:55], v[96:99], v[144:147], a[52:55]
  ds_read_b64_tr_b16 v[62:63], v18 offset:34816
  buffer_load_dwordx4 v7, s[12:15], s46 offen lds
  v_mfma_f32_16x16x32_bf16 a[56:59], v[96:99], v[148:151], a[56:59]
  ds_read_b64_tr_b16 v[64:65], v19 offset:32768
  v_mfma_f32_16x16x32_bf16 a[60:63], v[96:99], v[152:155], a[60:63]
  s_add_u32 m0, s44, 0
  v_mfma_f32_16x16x32_bf16 a[64:67], v[100:103], v[124:127], a[64:67]
  ds_read_b64_tr_b16 v[66:67], v19 offset:34816
  buffer_load_dwordx4 v12, s[16:19], s47 offen lds
  v_mfma_f32_16x16x32_bf16 a[68:71], v[100:103], v[128:131], a[68:71]
  ds_read_b64_tr_b16 v[68:69], v20 offset:32768
  v_mfma_f32_16x16x32_bf16 a[72:75], v[100:103], v[132:135], a[72:75]
  ds_read_b64_tr_b16 v[70:71], v20 offset:34816
  s_add_u32 m0, s44, 4096
  v_mfma_f32_16x16x32_bf16 a[76:79], v[100:103], v[136:139], a[76:79]
  v_mfma_f32_16x16x32_bf16 a[80:83], v[100:103], v[140:143], a[80:83]
  ds_read_b64_tr_b16 v[72:73], v21 offset:32768
  buffer_load_dwordx4 v13, s[16:19], s47 offen lds
  v_mfma_f32_16x16x32_bf16 a[84:87], v[100:103], v[144:147], a[84:87]
  ds_read_b64_tr_b16 v[74:75], v21 offset:34816
  v_mfma_f32_16x16x32_bf16 a[88:91], v[100:103], v[148:151], a[88:91]
  s_add_u32 m0, s44, 8192
  v_mfma_f32_16x16x32_bf16 a[92:95], v[100:103], v[152:155], a[92:95]
  ds_read_b64_tr_b16 v[76:77], v22 offset:32768
  v_mfma_f32_16x16x32_bf16 a[96:99], v[104:107], v[124:127], a[96:99]
  ds_read_b64_tr_b16 v[78:79], v22 offset:34816
  buffer_load_dwordx4 v14, s[16:19], s47 offen lds
  v_mfma_f32_16x16x32_bf16 a[100:103], v[104:107], v[128:131], a[100:103]
  v_mfma_f32_16x16x32_bf16 a[104:107], v[104:107], v[132:135], a[104:107]
  ds_read_b64_tr_b16 v[80:81], v23 offset:32768
  s_add_u32 m0, s44, 12288
  v_mfma_f32_16x16x32_bf16 a[108:111], v[104:107], v[136:139], a[108:111]
  ds_read_b64_tr_b16 v[82:83], v23 offset:34816
  v_mfma_f32_16x16x32_bf16 a[112:115], v[104:107], v[140:143], a[112:115]
  buffer_load_dwordx4 v15, s[16:19], s47 offen lds
  v_mfma_f32_16x16x32_bf16 a[116:119], v[104:107], v[144:147], a[116:119]
  ds_read_b64_tr_b16 v[84:85], v24 offset:32768
  v_mfma_f32_16x16x32_bf16 a[120:123], v[104:107], v[148:151], a[120:123]
  ds_read_b64_tr_b16 v[86:87], v24 offset:34816
  s_add_u32 s47, s47, 262144
  v_mfma_f32_16x16x32_bf16 a[124:127], v[104:107], v[152:155], a[124:127]
  v_mfma_f32_16x16x32_bf16 a[128:131], v[108:111], v[124:127], a[128:131]
  ds_read_b64_tr_b16 v[88:89], v25 offset:32768
  s_add_u32 m0, s45, 16384
  v_mfma_f32_16x16x32_bf16 a[132:135], v[108:111], v[128:131], a[132:135]
  ds_read_b64_tr_b16 v[90:91], v25 offset:34816
  buffer_load_dwordx4 v8, s[12:15], s46 offen lds
  v_mfma_f32_16x16x32_bf16 a[136:139], v[108:111], v[132:135], a[136:139]
  v_mfma_f32_16x16x32_bf16 a[140:143], v[108:111], v[136:139], a[140:143]
  s_add_u32 m0, s45, 20480
  v_mfma_f32_16x16x32_bf16 a[144:147], v[108:111], v[140:143], a[144:147]
  v_mfma_f32_16x16x32_bf16 a[148:151], v[108:111], v[144:147], a[148:151]
  buffer_load_dwordx4 v9, s[12:15], s46 offen lds
  v_mfma_f32_16x16x32_bf16 a[152:155], v[108:111], v[148:151], a[152:155]
  v_mfma_f32_16x16x32_bf16 a[156:159], v[108:111], v[152:155], a[156:159]
  s_add_u32 m0, s45, 24576
  v_mfma_f32_16x16x32_bf16 a[160:163], v[112:115], v[124:127], a[160:163]
  v_mfma_f32_16x16x32_bf16 a[164:167], v[112:115], v[128:131], a[164:167]
  buffer_load_dwordx4 v10, s[12:15], s46 offen lds
  v_mfma_f32_16x16x32_bf16 a[168:171], v[112:115], v[132:135], a[168:171]
  v_mfma_f32_16x16x32_bf16 a[172:175], v[112:115], v[136:139], a[172:175]
  s_add_u32 m0, s45, 28672
  v_mfma_f32_16x16x32_bf16 a[176:179], v[112:115], v[140:143], a[176:179]
  v_mfma_f32_16x16x32_bf16 a[180:183], v[112:115], v[144:147], a[180:183]
  buffer_load_dwordx4 v11, s[12:15], s46 offen lds
  v_mfma_f32_16x16x32_bf16 a[184:187], v[112:115], v[148:151], a[184:187]
  v_mfma_f32_16x16x32_bf16 a[188:191], v[112:115], v[152:155], a[188:191]
  s_add_u32 m0, s44, 16384
  v_mfma_f32_16x16x32_bf16 a[192:195], v[116:119], v[124:127], a[192:195]
  buffer_load_dwordx4 v12, s[16:19], s47 offen lds
  v_mfma_f32_16x16x32_bf16 a[196:199], v[116:119], v[128:131], a[196:199]
  v_mfma_f32_16x16x32_bf16 a[200:203], v[116:119], v[132:135], a[200:203]
  s_add_u32 m0, s44, 20480
  v_mfma_f32_16x16x32_bf16 a[204:207], v[116:119], v[136:139], a[204:207]
  v_mfma_f32_16x16x32_bf16 a[208:211], v[116:119], v[140:143], a[208:211]
  buffer_load_dwordx4 v13, s[16:19], s47 offen lds
  v_mfma_f32_16x16x32_bf16 a[212:215], v[116:119], v[144:147], a[212:215]
  v_mfma_f32_16x16x32_bf16 a[216:219], v[116:119], v[148:151], a[216:219]
  s_add_u32 m0, s44, 24576
  v_mfma_f32_16x16x32_bf16 a[220:223], v[116:119], v[152:155], a[220:223]
  v_mfma_f32_16x16x32_bf16 a[224:227], v[120:123], v[124:127], a[224:227]
  buffer_load_dwordx4 v14, s[16:19], s47 offen lds
  v_mfma_f32_16x16x32_bf16 a[228:231], v[120:123], v[128:131], a[228:231]
  v_mfma_f32_16x16x32_bf16 a[232:235], v[120:123], v[132:135], a[232:235]
  s_add_u32 m0, s44, 28672
  v_mfma_f32_16x16x32_bf16 a[236:239], v[120:123], v[136:139], a[236:239]
  v_mfma_f32_16x16x32_bf16 a[240:243], v[120:123], v[140:143], a[240:243]
  buffer_load_dwordx4 v15, s[16:19], s47 offen lds
  v_mfma_f32_16x16x32_bf16 a[244:247], v[120:123], v[144:147], a[244:247]
  v_mfma_f32_16x16x32_bf16 a[248:251], v[120:123], v[148:151], a[248:251]
  s_add_u32 s46, s46, 128
  s_add_u32 s47, s47, 262144
  v_mfma_f32_16x16x32_bf16 a[252:255], v[120:123], v[152:155], a[252:255]
  s_mov_b32 s48, 3
Lv_45_loop:
  s_waitcnt lgkmcnt(0)
  v_mfma_f32_16x16x32_bf16 a[0:3], v[28:31], v[60:63], a[0:3]
  ds_read_b128 v[92:95], v17 offset:32768
  v_mfma_f32_16x16x32_bf16 a[4:7], v[28:31], v[64:67], a[4:7]
  ds_read_b128 v[96:99], v17 offset:34816
  v_mfma_f32_16x16x32_bf16 a[8:11], v[28:31], v[68:71], a[8:11]
  ds_read_b128 v[100:103], v17 offset:36864
  v_mfma_f32_16x16x32_bf16 a[12:15], v[28:31], v[72:75], a[12:15]
  v_mfma_f32_16x16x32_bf16 a[16:19], v[28:31], v[76:79], a[16:19]
  ds_read_b128 v[104:107], v17 offset:38912
  v_mfma_f32_16x16x32_bf16 a[20:23], v[28:31], v[80:83], a[20:23]
  ds_read_b128 v[108:111], v17 offset:40960
  v_mfma_f32_16x16x32_bf16 a[24:27], v[28:31], v[84:87], a[24:27]
  v_mfma_f32_16x16x32_bf16 a[28:31], v[28:31], v[88:91], a[28:31]
  ds_read_b128 v[112:115], v17 offset:43008
  v_mfma_f32_16x16x32_bf16 a[32:35], v[32:35], v[60:63], a[32:35]
  ds_read_b128 v[116:119], v17 offset:45056
  v_mfma_f32_16x16x32_bf16 a[36:39], v[32:35], v[64:67], a[36:39]
  v_mfma_f32_16x16x32_bf16 a[40:43], v[32:35], v[68:71], a[40:43]
  ds_read_b128 v[120:123], v17 offset:47104
  v_mfma_f32_16x16x32_bf16 a[44:47], v[32:35], v[72:75], a[44:47]
  ds_read_b64_tr_b16 v[124:125], v18 offset:49152
  v_mfma_f32_16x16x32_bf16 a[48:51], v[32:35], v[76:79], a[48:51]
  v_mfma_f32_16x16x32_bf16 a[52:55], v[32:35], v[80:83], a[52:55]
  ds_read_b64_tr_b16 v[126:127], v18 offset:51200
  v_mfma_f32_16x16x32_bf16 a[56:59], v[32:35], v[84:87], a[56:59]
  ds_read_b64_tr_b16 v[128:129], v19 offset:49152
  v_mfma_f32_16x16x32_bf16 a[60:63], v[32:35], v[88:91], a[60:63]
  v_mfma_f32_16x16x32_bf16 a[64:67], v[36:39], v[60:63], a[64:67]
  ds_read_b64_tr_b16 v[130:131], v19 offset:51200
  v_mfma_f32_16x16x32_bf16 a[68:71], v[36:39], v[64:67], a[68:71]
  ds_read_b64_tr_b16 v[132:133], v20 offset:49152
  v_mfma_f32_16x16x32_bf16 a[72:75], v[36:39], v[68:71], a[72:75]
  ds_read_b64_tr_b16 v[134:135], v20 offset:51200
  v_mfma_f32_16x16x32_bf16 a[76:79], v[36:39], v[72:75], a[76:79]
  v_mfma_f32_16x16x32_bf16 a[80:83], v[36:39], v[76:79], a[80:83]
  ds_read_b64_tr_b16 v[136:137], v21 offset:49152
  v_mfma_f32_16x16x32_bf16 a[84:87], v[36:39], v[80:83], a[84:87]
  ds_read_b64_tr_b16 v[138:139], v21 offset:51200
  v_mfma_f32_16x16x32_bf16 a[88:91], v[36:39], v[84:87], a[88:91]
  v_mfma_f32_16x16x32_bf16 a[92:95], v[36:39], v[88:91], a[92:95]
  ds_read_b64_tr_b16 v[140:141], v22 offset:49152
  v_mfma_f32_16x16x32_bf16 a[96:99], v[40:43], v[60:63], a[96:99]
  ds_read_b64_tr_b16 v[142:143], v22 offset:51200
  v_mfma_f32_16x16x32_bf16 a[100:103], v[40:43], v[64:67], a[100:103]
  v_mfma_f32_16x16x32_bf16 a[104:107], v[40:43], v[68:71], a[104:107]
  ds_read_b64_tr_b16 v[144:145], v23 offset:49152
  v_mfma_f32_16x16x32_bf16 a[108:111], v[40:43], v[72:75], a[108:111]
  ds_read_b64_tr_b16 v[146:147], v23 offset:51200
  v_mfma_f32_16x16x32_bf16 a[112:115], v[40:43], v[76:79], a[112:115]
  v_mfma_f32_16x16x32_bf16 a[116:119], v[40:43], v[80:83], a[116:119]
  ds_read_b64_tr_b16 v[148:149], v24 offset:49152
  v_mfma_f32_16x16x32_bf16 a[120:123], v[40:43], v[84:87], a[120:123]
  ds_read_b64_tr_b16 v[150:151], v24 offset:51200
  v_mfma_f32_16x16x32_bf16 a[124:127], v[40:43], v[88:91], a[124:127]
  v_mfma_f32_16x16x32_bf16 a[128:131], v[44:47], v[60:63], a[128:131]
  ds_read_b64_tr_b16 v[152:153], v25 offset:49152
  v_mfma_f32_16x16x32_bf16 a[132:135], v[44:47], v[64:67], a[132:135]
  ds_read_b64_tr_b16 v[154:155], v25 offset:51200
  v_mfma_f32_16x16x32_bf16 a[136:139], v[44:47], v[68:71], a[136:139]
  v_mfma_f32_16x16x32_bf16 a[140:143], v[44:47], v[72:75], a[140:143]
  v_mfma_f32_16x16x32_bf16 a[144:147], v[44:47], v[76:79], a[144:147]
  v_mfma_f32_16x16x32_bf16 a[148:151], v[44:47], v[80:83], a[148:151]
  v_mfma_f32_16x16x32_bf16 a[152:155], v[44:47], v[84:87], a[152:155]
  v_mfma_f32_16x16x32_bf16 a[156:159], v[44:47], v[88:91], a[156:159]
  v_mfma_f32_16x16x32_bf16 a[160:163], v[48:51], v[60:63], a[160:163]
  v_mfma_f32_16x16x32_bf16 a[164:167], v[48:51], v[64:67], a[164:167]
  v_mfma_f32_16x16x32_bf16 a[168:171], v[48:51], v[68:71], a[168:171]
  v_mfma_f32_16x16x32_bf16 a[172:175], v[48:51], v[72:75], a[172:175]
  v_mfma_f32_16x16x32_bf16 a[176:179], v[48:51], v[76:79], a[176:179]
  v_mfma_f32_16x16x32_bf16 a[180:183], v[48:51], v[80:83], a[180:183]
  v_mfma_f32_16x16x32_bf16 a[184:187], v[48:51], v[84:87], a[184:187]
  v_mfma_f32_16x16x32_bf16 a[188:191], v[48:51], v[88:91], a[188:191]
  v_mfma_f32_16x16x32_bf16 a[192:195], v[52:55], v[60:63], a[192:195]
  v_mfma_f32_16x16x32_bf16 a[196:199], v[52:55], v[64:67], a[196:199]
  v_mfma_f32_16x16x32_bf16 a[200:203], v[52:55], v[68:71], a[200:203]
  v_mfma_f32_16x16x32_bf16 a[204:207], v[52:55], v[72:75], a[204:207]
  v_mfma_f32_16x16x32_bf16 a[208:211], v[52:55], v[76:79], a[208:211]
  v_mfma_f32_16x16x32_bf16 a[212:215], v[52:55], v[80:83], a[212:215]
  v_mfma_f32_16x16x32_bf16 a[216:219], v[52:55], v[84:87], a[216:219]
  v_mfma_f32_16x16x32_bf16 a[220:223], v[52:55], v[88:91], a[220:223]
  v_mfma_f32_16x16x32_bf16 a[224:227], v[56:59], v[60:63], a[224:227]
  v_mfma_f32_16x16x32_bf16 a[228:231], v[56:59], v[64:67], a[228:231]
  v_mfma_f32_16x16x32_bf16 a[232:235], v[56:59], v[68:71], a[232:235]
  v_mfma_f32_16x16x32_bf16 a[236:239], v[56:59], v[72:75], a[236:239]
  v_mfma_f32_16x16x32_bf16 a[240:243], v[56:59], v[76:79], a[240:243]
  v_mfma_f32_16x16x32_bf16 a[244:247], v[56:59], v[80:83], a[244:247]
  v_mfma_f32_16x16x32_bf16 a[248:251], v[56:59], v[84:87], a[248:251]
  v_mfma_f32_16x16x32_bf16 a[252:255], v[56:59], v[88:91], a[252:255]
  s_waitcnt vmcnt(0) lgkmcnt(0)
  s_barrier
  v_mfma_f32_16x16x32_bf16 a[0:3], v[92:95], v[124:127], a[0:3]
  ds_read_b128 v[28:31], v16 offset:0
  s_add_u32 m0, s45, 32768
  v_mfma_f32_16x16x32_bf16 a[4:7], v[92:95], v[128:131], a[4:7]
  ds_read_b128 v[32:35], v16 offset:2048
  buffer_load_dwordx4 v4, s[12:15], s46 offen lds
  v_mfma_f32_16x16x32_bf16 a[8:11], v[92:95], v[132:135], a[8:11]
  ds_read_b128 v[36:39], v16 offset:4096
  v_mfma_f32_16x16x32_bf16 a[12:15], v[92:95], v[136:139], a[12:15]
  s_add_u32 m0, s45, 36864
  v_mfma_f32_16x16x32_bf16 a[16:19], v[92:95], v[140:143], a[16:19]
  ds_read_b128 v[40:43], v16 offset:6144
  v_mfma_f32_16x16x32_bf16 a[20:23], v[92:95], v[144:147], a[20:23]
  ds_read_b128 v[44:47], v16 offset:8192
  buffer_load_dwordx4 v5, s[12:15], s46 offen lds
  v_mfma_f32_16x16x32_bf16 a[24:27], v[92:95], v[148:151], a[24:27]
  v_mfma_f32_16x16x32_bf16 a[28:31], v[92:95], v[152:155], a[28:31]
  ds_read_b128 v[48:51], v16 offset:10240
  s_add_u32 m0, s45, 40960
  v_mfma_f32_16x16x32_bf16 a[32:35], v[96:99], v[124:127], a[32:35]
  ds_read_b128 v[52:55], v16 offset:12288
  v_mfma_f32_16x16x32_bf16 a[36:39], v[96:99], v[128:131], a[36:39]
  buffer_load_dwordx4 v6, s[12:15], s46 offen lds
  v_mfma_f32_16x16x32_bf16 a[40:43], v[96:99], v[132:135], a[40:43]
  ds_read_b128 v[56:59], v16 offset:14336
  v_mfma_f32_16x16x32_bf16 a[44:47], v[96:99], v[136:139], a[44:47]
  ds_read_b64_tr_b16 v[60:61], v18 offset:0
  s_add_u32 m0, s45, 45056
  v_mfma_f32_16x16x32_bf16 a[48:51], v[96:99], v[140:143], a[48:51]
  v_mfma_f32_16x16x32_bf16 a[52:55], v[96:99], v[144:147], a[52:55]
  ds_read_b64_tr_b16 v[62:63], v18 offset:2048
  buffer_load_dwordx4 v7, s[12:15], s46 offen lds
  v_mfma_f32_16x16x32_bf16 a[56:59], v[96:99], v[148:151], a[56:59]
  ds_read_b64_tr_b16 v[64:65], v19 offset:0
  v_mfma_f32_16x16x32_bf16 a[60:63], v[96:99], v[152:155], a[60:63]
  s_add_u32 m0, s44, 32768
  v_mfma_f32_16x16x32_bf16 a[64:67], v[100:103], v[124:127], a[64:67]
  ds_read_b64_tr_b16 v[66:67], v19 offset:2048
  buffer_load_dwordx4 v12, s[16:19], s47 offen lds
  v_mfma_f32_16x16x32_bf16 a[68:71], v[100:103], v[128:131], a[68:71]
  ds_read_b64_tr_b16 v[68:69], v20 offset:0
  v_mfma_f32_16x16x32_bf16 a[72:75], v[100:103], v[132:135], a[72:75]
  ds_read_b64_tr_b16 v[70:71], v20 offset:2048
  s_add_u32 m0, s44, 36864
  v_mfma_f32_16x16x32_bf16 a[76:79], v[100:103], v[136:139], a[76:79]
  v_mfma_f32_16x16x32_bf16 a[80:83], v[100:103], v[140:143], a[80:83]
  ds_read_b64_tr_b16 v[72:73], v21 offset:0
  buffer_load_dwordx4 v13, s[16:19], s47 offen lds
  v_mfma_f32_16x16x32_bf16 a[84:87], v[100:103], v[144:147], a[84:87]
  ds_read_b64_tr_b16 v[74:75], v21 offset:2048
  v_mfma_f32_16x16x32_bf16 a[88:91], v[100:103], v[148:151], a[88:91]
  s_add_u32 m0, s44, 40960
  v_mfma_f32_16x16x32_bf16 a[92:95], v[100:103], v[152:155], a[92:95]
  ds_read_b64_tr_b16 v[76:77], v22 offset:0
  v_mfma_f32_16x16x32_bf16 a[96:99], v[104:107], v[124:127], a[96:99]
  ds_read_b64_tr_b16 v[78:79], v22 offset:2048
  buffer_load_dwordx4 v14, s[16:19], s47 offen lds
  v_mfma_f32_16x16x32_bf16 a[100:103], v[104:107], v[128:131], a[100:103]
  v_mfma_f32_16x16x32_bf16 a[104:107], v[104:107], v[132:135], a[104:107]
  ds_read_b64_tr_b16 v[80:81], v23 offset:0
  s_add_u32 m0, s44, 45056
  v_mfma_f32_16x16x32_bf16 a[108:111], v[104:107], v[136:139], a[108:111]
  ds_read_b64_tr_b16 v[82:83], v23 offset:2048
  v_mfma_f32_16x16x32_bf16 a[112:115], v[104:107], v[140:143], a[112:115]
  buffer_load_dwordx4 v15, s[16:19], s47 offen lds
  v_mfma_f32_16x16x32_bf16 a[116:119], v[104:107], v[144:147], a[116:119]
  ds_read_b64_tr_b16 v[84:85], v24 offset:0
  v_mfma_f32_16x16x32_bf16 a[120:123], v[104:107], v[148:151], a[120:123]
  ds_read_b64_tr_b16 v[86:87], v24 offset:2048
  s_add_u32 s47, s47, 262144
  v_mfma_f32_16x16x32_bf16 a[124:127], v[104:107], v[152:155], a[124:127]
  v_mfma_f32_16x16x32_bf16 a[128:131], v[108:111], v[124:127], a[128:131]
  ds_read_b64_tr_b16 v[88:89], v25 offset:0
  s_add_u32 m0, s45, 49152
  v_mfma_f32_16x16x32_bf16 a[132:135], v[108:111], v[128:131], a[132:135]
  ds_read_b64_tr_b16 v[90:91], v25 offset:2048
  buffer_load_dwordx4 v8, s[12:15], s46 offen lds
  v_mfma_f32_16x16x32_bf16 a[136:139], v[108:111], v[132:135], a[136:139]
  v_mfma_f32_16x16x32_bf16 a[140:143], v[108:111], v[136:139], a[140:143]
  s_add_u32 m0, s45, 53248
  v_mfma_f32_16x16x32_bf16 a[144:147], v[108:111], v[140:143], a[144:147]
  v_mfma_f32_16x16x32_bf16 a[148:151], v[108:111], v[144:147], a[148:151]
  buffer_load_dwordx4 v9, s[12:15], s46 offen lds
  v_mfma_f32_16x16x32_bf16 a[152:155], v[108:111], v[148:151], a[152:155]
  v_mfma_f32_16x16x32_bf16 a[156:159], v[108:111], v[152:155], a[156:159]
  s_add_u32 m0, s45, 57344
  v_mfma_f32_16x16x32_bf16 a[160:163], v[112:115], v[124:127], a[160:163]
  v_mfma_f32_16x16x32_bf16 a[164:167], v[112:115], v[128:131], a[164:167]
  buffer_load_dwordx4 v10, s[12:15], s46 offen lds
  v_mfma_f32_16x16x32_bf16 a[168:171], v[112:115], v[132:135], a[168:171]
  v_mfma_f32_16x16x32_bf16 a[172:175], v[112:115], v[136:139], a[172:175]
  s_add_u32 m0, s45, 61440
  v_mfma_f32_16x16x32_bf16 a[176:179], v[112:115], v[140:143], a[176:179]
  v_mfma_f32_16x16x32_bf16 a[180:183], v[112:115], v[144:147], a[180:183]
  buffer_load_dwordx4 v11, s[12:15], s46 offen lds
  v_mfma_f32_16x16x32_bf16 a[184:187], v[112:115], v[148:151], a[184:187]
  v_mfma_f32_16x16x32_bf16 a[188:191], v[112:115], v[152:155], a[188:191]
  s_add_u32 m0, s44, 49152
  v_mfma_f32_16x16x32_bf16 a[192:195], v[116:119], v[124:127], a[192:195]
  buffer_load_dwordx4 v12, s[16:19], s47 offen lds
  v_mfma_f32_16x16x32_bf16 a[196:199], v[116:119], v[128:131], a[196:199]
  v_mfma_f32_16x16x32_bf16 a[200:203], v[116:119], v[132:135], a[200:203]
  s_add_u32 m0, s44, 53248
  v_mfma_f32_16x16x32_bf16 a[204:207], v[116:119], v[136:139], a[204:207]
  v_mfma_f32_16x16x32_bf16 a[208:211], v[116:119], v[140:143], a[208:211]
  buffer_load_dwordx4 v13, s[16:19], s47 offen lds
  v_mfma_f32_16x16x32_bf16 a[212:215], v[116:119], v[144:147], a[212:215]
  v_mfma_f32_16x16x32_bf16 a[216:219], v[116:119], v[148:151], a[216:219]
  s_add_u32 m0, s44, 57344
  v_mfma_f32_16x16x32_bf16 a[220:223], v[116:119], v[152:155], a[220:223]
  v_mfma_f32_16x16x32_bf16 a[224:227], v[120:123], v[124:127], a[224:227]
  buffer_load_dwordx4 v14, s[16:19], s47 offen lds
  v_mfma_f32_16x16x32_bf16 a[228:231], v[120:123], v[128:131], a[228:231]
  v_mfma_f32_16x16x32_bf16 a[232:235], v[120:123], v[132:135], a[232:235]
  s_add_u32 m0, s44, 61440
  v_mfma_f32_16x16x32_bf16 a[236:239], v[120:123], v[136:139], a[236:239]
  v_mfma_f32_16x16x32_bf16 a[240:243], v[120:123], v[140:143], a[240:243]
  buffer_load_dwordx4 v15, s[16:19], s47 offen lds
  v_mfma_f32_16x16x32_bf16 a[244:247], v[120:123], v[144:147], a[244:247]
  v_mfma_f32_16x16x32_bf16 a[248:251], v[120:123], v[148:151], a[248:251]
  s_add_u32 s46, s46, 128
  s_add_u32 s47, s47, 262144
  v_mfma_f32_16x16x32_bf16 a[252:255], v[120:123], v[152:155], a[252:255]
  s_waitcnt lgkmcnt(0)
  v_mfma_f32_16x16x32_bf16 a[0:3], v[28:31], v[60:63], a[0:3]
  ds_read_b128 v[92:95], v17 offset:0
  v_mfma_f32_16x16x32_bf16 a[4:7], v[28:31], v[64:67], a[4:7]
  ds_read_b128 v[96:99], v17 offset:2048
  v_mfma_f32_16x16x32_bf16 a[8:11], v[28:31], v[68:71], a[8:11]
  ds_read_b128 v[100:103], v17 offset:4096
  v_mfma_f32_16x16x32_bf16 a[12:15], v[28:31], v[72:75], a[12:15]
  v_mfma_f32_16x16x32_bf16 a[16:19], v[28:31], v[76:79], a[16:19]
  ds_read_b128 v[104:107], v17 offset:6144
  v_mfma_f32_16x16x32_bf16 a[20:23], v[28:31], v[80:83], a[20:23]
  ds_read_b128 v[108:111], v17 offset:8192
  v_mfma_f32_16x16x32_bf16 a[24:27], v[28:31], v[84:87], a[24:27]
  v_mfma_f32_16x16x32_bf16 a[28:31], v[28:31], v[88:91], a[28:31]
  ds_read_b128 v[112:115], v17 offset:10240
  v_mfma_f32_16x16x32_bf16 a[32:35], v[32:35], v[60:63], a[32:35]
  ds_read_b128 v[116:119], v17 offset:12288
  v_mfma_f32_16x16x32_bf16 a[36:39], v[32:35], v[64:67], a[36:39]
  v_mfma_f32_16x16x32_bf16 a[40:43], v[32:35], v[68:71], a[40:43]
  ds_read_b128 v[120:123], v17 offset:14336
  v_mfma_f32_16x16x32_bf16 a[44:47], v[32:35], v[72:75], a[44:47]
  ds_read_b64_tr_b16 v[124:125], v18 offset:16384
  v_mfma_f32_16x16x32_bf16 a[48:51], v[32:35], v[76:79], a[48:51]
  v_mfma_f32_16x16x32_bf16 a[52:55], v[32:35], v[80:83], a[52:55]
  ds_read_b64_tr_b16 v[126:127], v18 offset:18432
  v_mfma_f32_16x16x32_bf16 a[56:59], v[32:35], v[84:87], a[56:59]
  ds_read_b64_tr_b16 v[128:129], v19 offset:16384
  v_mfma_f32_16x16x32_bf16 a[60:63], v[32:35], v[88:91], a[60:63]
  v_mfma_f32_16x16x32_bf16 a[64:67], v[36:39], v[60:63], a[64:67]
  ds_read_b64_tr_b16 v[130:131], v19 offset:18432
  v_mfma_f32_16x16x32_bf16 a[68:71], v[36:39], v[64:67], a[68:71]
  ds_read_b64_tr_b16 v[132:133], v20 offset:16384
  v_mfma_f32_16x16x32_bf16 a[72:75], v[36:39], v[68:71], a[72:75]
  ds_read_b64_tr_b16 v[134:135], v20 offset:18432
  v_mfma_f32_16x16x32_bf16 a[76:79], v[36:39], v[72:75], a[76:79]
  v_mfma_f32_16x16x32_bf16 a[80:83], v[36:39], v[76:79], a[80:83]
  ds_read_b64_tr_b16 v[136:137], v21 offset:16384
  v_mfma_f32_16x16x32_bf16 a[84:87], v[36:39], v[80:83], a[84:87]
  ds_read_b64_tr_b16 v[138:139], v21 offset:18432
  v_mfma_f32_16x16x32_bf16 a[88:91], v[36:39], v[84:87], a[88:91]
  v_mfma_f32_16x16x32_bf16 a[92:95], v[36:39], v[88:91], a[92:95]
  ds_read_b64_tr_b16 v[140:141], v22 offset:16384
  v_mfma_f32_16x16x32_bf16 a[96:99], v[40:43], v[60:63], a[96:99]
  ds_read_b64_tr_b16 v[142:143], v22 offset:18432
  v_mfma_f32_16x16x32_bf16 a[100:103], v[40:43], v[64:67], a[100:103]
  v_mfma_f32_16x16x32_bf16 a[104:107], v[40:43], v[68:71], a[104:107]
  ds_read_b64_tr_b16 v[144:145], v23 offset:16384
  v_mfma_f32_16x16x32_bf16 a[108:111], v[40:43], v[72:75], a[108:111]
  ds_read_b64_tr_b16 v[146:147], v23 offset:18432
  v_mfma_f32_16x16x32_bf16 a[112:115], v[40:43], v[76:79], a[112:115]
  v_mfma_f32_16x16x32_bf16 a[116:119], v[40:43], v[80:83], a[116:119]
  ds_read_b64_tr_b16 v[148:149], v24 offset:16384
  v_mfma_f32_16x16x32_bf16 a[120:123], v[40:43], v[84:87], a[120:123]
  ds_read_b64_tr_b16 v[150:151], v24 offset:18432
  v_mfma_f32_16x16x32_bf16 a[124:127], v[40:43], v[88:91], a[124:127]
  v_mfma_f32_16x16x32_bf16 a[128:131], v[44:47], v[60:63], a[128:131]
  ds_read_b64_tr_b16 v[152:153], v25 offset:16384
  v_mfma_f32_16x16x32_bf16 a[132:135], v[44:47], v[64:67], a[132:135]
  ds_read_b64_tr_b16 v[154:155], v25 offset:18432
  v_mfma_f32_16x16x32_bf16 a[136:139], v[44:47], v[68:71], a[136:139]
  v_mfma_f32_16x16x32_bf16 a[140:143], v[44:47], v[72:75], a[140:143]
  v_mfma_f32_16x16x32_bf16 a[144:147], v[44:47], v[76:79], a[144:147]
  v_mfma_f32_16x16x32_bf16 a[148:151], v[44:47], v[80:83], a[148:151]
  v_mfma_f32_16x16x32_bf16 a[152:155], v[44:47], v[84:87], a[152:155]
  v_mfma_f32_16x16x32_bf16 a[156:159], v[44:47], v[88:91], a[156:159]
  v_mfma_f32_16x16x32_bf16 a[160:163], v[48:51], v[60:63], a[160:163]
  v_mfma_f32_16x16x32_bf16 a[164:167], v[48:51], v[64:67], a[164:167]
  v_mfma_f32_16x16x32_bf16 a[168:171], v[48:51], v[68:71], a[168:171]
  v_mfma_f32_16x16x32_bf16 a[172:175], v[48:51], v[72:75], a[172:175]
  v_mfma_f32_16x16x32_bf16 a[176:179], v[48:51], v[76:79], a[176:179]
  v_mfma_f32_16x16x32_bf16 a[180:183], v[48:51], v[80:83], a[180:183]
  v_mfma_f32_16x16x32_bf16 a[184:187], v[48:51], v[84:87], a[184:187]
  v_mfma_f32_16x16x32_bf16 a[188:191], v[48:51], v[88:91], a[188:191]
  v_mfma_f32_16x16x32_bf16 a[192:195], v[52:55], v[60:63], a[192:195]
  v_mfma_f32_16x16x32_bf16 a[196:199], v[52:55], v[64:67], a[196:199]
  v_mfma_f32_16x16x32_bf16 a[200:203], v[52:55], v[68:71], a[200:203]
  v_mfma_f32_16x16x32_bf16 a[204:207], v[52:55], v[72:75], a[204:207]
  v_mfma_f32_16x16x32_bf16 a[208:211], v[52:55], v[76:79], a[208:211]
  v_mfma_f32_16x16x32_bf16 a[212:215], v[52:55], v[80:83], a[212:215]
  v_mfma_f32_16x16x32_bf16 a[216:219], v[52:55], v[84:87], a[216:219]
  v_mfma_f32_16x16x32_bf16 a[220:223], v[52:55], v[88:91], a[220:223]
  v_mfma_f32_16x16x32_bf16 a[224:227], v[56:59], v[60:63], a[224:227]
  v_mfma_f32_16x16x32_bf16 a[228:231], v[56:59], v[64:67], a[228:231]
  v_mfma_f32_16x16x32_bf16 a[232:235], v[56:59], v[68:71], a[232:235]
  v_mfma_f32_16x16x32_bf16 a[236:239], v[56:59], v[72:75], a[236:239]
  v_mfma_f32_16x16x32_bf16 a[240:243], v[56:59], v[76:79], a[240:243]
  v_mfma_f32_16x16x32_bf16 a[244:247], v[56:59], v[80:83], a[244:247]
  v_mfma_f32_16x16x32_bf16 a[248:251], v[56:59], v[84:87], a[248:251]
  v_mfma_f32_16x16x32_bf16 a[252:255], v[56:59], v[88:91], a[252:255]
  s_waitcnt vmcnt(0) lgkmcnt(0)
  s_barrier
  v_mfma_f32_16x16x32_bf16 a[0:3], v[92:95], v[124:127], a[0:3]
  ds_read_b128 v[28:31], v16 offset:32768
  s_add_u32 m0, s45, 0
  v_mfma_f32_16x16x32_bf16 a[4:7], v[92:95], v[128:131], a[4:7]
  ds_read_b128 v[32:35], v16 offset:34816
  buffer_load_dwordx4 v4, s[12:15], s46 offen lds
  v_mfma_f32_16x16x32_bf16 a[8:11], v[92:95], v[132:135], a[8:11]
  ds_read_b128 v[36:39], v16 offset:36864
  v_mfma_f32_16x16x32_bf16 a[12:15], v[92:95], v[136:139], a[12:15]
  s_add_u32 m0, s45, 4096
  v_mfma_f32_16x16x32_bf16 a[16:19], v[92:95], v[140:143], a[16:19]
  ds_read_b128 v[40:43], v16 offset:38912
  v_mfma_f32_16x16x32_bf16 a[20:23], v[92:95], v[144:147], a[20:23]
  ds_read_b128 v[44:47], v16 offset:40960
  buffer_load_dwordx4 v5, s[12:15], s46 offen lds
  v_mfma_f32_16x16x32_bf16 a[24:27], v[92:95], v[148:151], a[24:27]
  v_mfma_f32_16x16x32_bf16 a[28:31], v[92:95], v[152:155], a[28:31]
  ds_read_b128 v[48:51], v16 offset:43008
  s_add_u32 m0, s45, 8192
  v_mfma_f32_16x16x32_bf16 a[32:35], v[96:99], v[124:127], a[32:35]
  ds_read_b128 v[52:55], v16 offset:45056
  v_mfma_f32_16x16x32_bf16 a[36:39], v[96:99], v[128:131], a[36:39]
  buffer_load_dwordx4 v6, s[12:15], s46 offen lds
  v_mfma_f32_16x16x32_bf16 a[40:43], v[96:99], v[132:135], a[40:43]
  ds_read_b128 v[56:59], v16 offset:47104
  v_mfma_f32_16x16x32_bf16 a[44:47], v[96:99], v[136:139], a[44:47]
  ds_read_b64_tr_b16 v[60:61], v18 offset:32768
  s_add_u32 m0, s45, 12288
  v_mfma_f32_16x16x32_bf16 a[48:51], v[96:99], v[140:143], a[48:51]
  v_mfma_f32_16x16x32_bf16 a[52:55], v[96:99], v[144:147], a[52:55]
  ds_read_b64_tr_b16 v[62:63], v18 offset:34816
  buffer_load_dwordx4 v7, s[12:15], s46 offen lds
  v_mfma_f32_16x16x32_bf16 a[56:59], v[96:99], v[148:151], a[56:59]
  ds_read_b64_tr_b16 v[64:65], v19 offset:32768
  v_mfma_f32_16x16x32_bf16 a[60:63], v[96:99], v[152:155], a[60:63]
  s_add_u32 m0, s44, 0
  v_mfma_f32_16x16x32_bf16 a[64:67], v[100:103], v[124:127], a[64:67]
  ds_read_b64_tr_b16 v[66:67], v19 offset:34816
  buffer_load_dwordx4 v12, s[16:19], s47 offen lds
  v_mfma_f32_16x16x32_bf16 a[68:71], v[100:103], v[128:131], a[68:71]
  ds_read_b64_tr_b16 v[68:69], v20 offset:32768
  v_mfma_f32_16x16x32_bf16 a[72:75], v[100:103], v[132:135], a[72:75]
  ds_read_b64_tr_b16 v[70:71], v20 offset:34816
  s_add_u32 m0, s44, 4096
  v_mfma_f32_16x16x32_bf16 a[76:79], v[100:103], v[136:139], a[76:79]
  v_mfma_f32_16x16x32_bf16 a[80:83], v[100:103], v[140:143], a[80:83]
  ds_read_b64_tr_b16 v[72:73], v21 offset:32768
  buffer_load_dwordx4 v13, s[16:19], s47 offen lds
  v_mfma_f32_16x16x32_bf16 a[84:87], v[100:103], v[144:147], a[84:87]
  ds_read_b64_tr_b16 v[74:75], v21 offset:34816
  v_mfma_f32_16x16x32_bf16 a[88:91], v[100:103], v[148:151], a[88:91]
  s_add_u32 m0, s44, 8192
  v_mfma_f32_16x16x32_bf16 a[92:95], v[100:103], v[152:155], a[92:95]
  ds_read_b64_tr_b16 v[76:77], v22 offset:32768
  v_mfma_f32_16x16x32_bf16 a[96:99], v[104:107], v[124:127], a[96:99]
  ds_read_b64_tr_b16 v[78:79], v22 offset:34816
  buffer_load_dwordx4 v14, s[16:19], s47 offen lds
  v_mfma_f32_16x16x32_bf16 a[100:103], v[104:107], v[128:131], a[100:103]
  v_mfma_f32_16x16x32_bf16 a[104:107], v[104:107], v[132:135], a[104:107]
  ds_read_b64_tr_b16 v[80:81], v23 offset:32768
  s_add_u32 m0, s44, 12288
  v_mfma_f32_16x16x32_bf16 a[108:111], v[104:107], v[136:139], a[108:111]
  ds_read_b64_tr_b16 v[82:83], v23 offset:34816
  v_mfma_f32_16x16x32_bf16 a[112:115], v[104:107], v[140:143], a[112:115]
  buffer_load_dwordx4 v15, s[16:19], s47 offen lds
  v_mfma_f32_16x16x32_bf16 a[116:119], v[104:107], v[144:147], a[116:119]
  ds_read_b64_tr_b16 v[84:85], v24 offset:32768
  v_mfma_f32_16x16x32_bf16 a[120:123], v[104:107], v[148:151], a[120:123]
  ds_read_b64_tr_b16 v[86:87], v24 offset:34816
  s_add_u32 s47, s47, 262144
  v_mfma_f32_16x16x32_bf16 a[124:127], v[104:107], v[152:155], a[124:127]
  v_mfma_f32_16x16x32_bf16 a[128:131], v[108:111], v[124:127], a[128:131]
  ds_read_b64_tr_b16 v[88:89], v25 offset:32768
  s_add_u32 m0, s45, 16384
  v_mfma_f32_16x16x32_bf16 a[132:135], v[108:111], v[128:131], a[132:135]
  ds_read_b64_tr_b16 v[90:91], v25 offset:34816
  buffer_load_dwordx4 v8, s[12:15], s46 offen lds
  v_mfma_f32_16x16x32_bf16 a[136:139], v[108:111], v[132:135], a[136:139]
  v_mfma_f32_16x16x32_bf16 a[140:143], v[108:111], v[136:139], a[140:143]
  s_add_u32 m0, s45, 20480
  v_mfma_f32_16x16x32_bf16 a[144:147], v[108:111], v[140:143], a[144:147]
  v_mfma_f32_16x16x32_bf16 a[148:151], v[108:111], v[144:147], a[148:151]
  buffer_load_dwordx4 v9, s[12:15], s46 offen lds
  v_mfma_f32_16x16x32_bf16 a[152:155], v[108:111], v[148:151], a[152:155]
  v_mfma_f32_16x16x32_bf16 a[156:159], v[108:111], v[152:155], a[156:159]
  s_add_u32 m0, s45, 24576
  v_mfma_f32_16x16x32_bf16 a[160:163], v[112:115], v[124:127], a[160:163]
  v_mfma_f32_16x16x32_bf16 a[164:167], v[112:115], v[128:131], a[164:167]
  buffer_load_dwordx4 v10, s[12:15], s46 offen lds
  v_mfma_f32_16x16x32_bf16 a[168:171], v[112:115], v[132:135], a[168:171]
  v_mfma_f32_16x16x32_bf16 a[172:175], v[112:115], v[136:139], a[172:175]
  s_add_u32 m0, s45, 28672
  v_mfma_f32_16x16x32_bf16 a[176:179], v[112:115], v[140:143], a[176:179]
  v_mfma_f32_16x16x32_bf16 a[180:183], v[112:115], v[144:147], a[180:183]
  buffer_load_dwordx4 v11, s[12:15], s46 offen lds
  v_mfma_f32_16x16x32_bf16 a[184:187], v[112:115], v[148:151], a[184:187]
  v_mfma_f32_16x16x32_bf16 a[188:191], v[112:115], v[152:155], a[188:191]
  s_add_u32 m0, s44, 16384
  v_mfma_f32_16x16x32_bf16 a[192:195], v[116:119], v[124:127], a[192:195]
  buffer_load_dwordx4 v12, s[16:19], s47 offen lds
  v_mfma_f32_16x16x32_bf16 a[196:199], v[116:119], v[128:131], a[196:199]
  v_mfma_f32_16x16x32_bf16 a[200:203], v[116:119], v[132:135], a[200:203]
  s_add_u32 m0, s44, 20480
  v_mfma_f32_16x16x32_bf16 a[204:207], v[116:119], v[136:139], a[204:207]
  v_mfma_f32_16x16x32_bf16 a[208:211], v[116:119], v[140:143], a[208:211]
  buffer_load_dwordx4 v13, s[16:19], s47 offen lds
  v_mfma_f32_16x16x32_bf16 a[212:215], v[116:119], v[144:147], a[212:215]
  v_mfma_f32_16x16x32_bf16 a[216:219], v[116:119], v[148:151], a[216:219]
  s_add_u32 m0, s44, 24576
  v_mfma_f32_16x16x32_bf16 a[220:223], v[116:119], v[152:155], a[220:223]
  v_mfma_f32_16x16x32_bf16 a[224:227], v[120:123], v[124:127], a[224:227]
  buffer_load_dwordx4 v14, s[16:19], s47 offen lds
  v_mfma_f32_16x16x32_bf16 a[228:231], v[120:123], v[128:131], a[228:231]
  v_mfma_f32_16x16x32_bf16 a[232:235], v[120:123], v[132:135], a[232:235]
  s_add_u32 m0, s44, 28672
  v_mfma_f32_16x16x32_bf16 a[236:239], v[120:123], v[136:139], a[236:239]
  v_mfma_f32_16x16x32_bf16 a[240:243], v[120:123], v[140:143], a[240:243]
  buffer_load_dwordx4 v15, s[16:19], s47 offen lds
  v_mfma_f32_16x16x32_bf16 a[244:247], v[120:123], v[144:147], a[244:247]
  v_mfma_f32_16x16x32_bf16 a[248:251], v[120:123], v[148:151], a[248:251]
  s_add_u32 s46, s46, 128
  s_add_u32 s47, s47, 262144
  v_mfma_f32_16x16x32_bf16 a[252:255], v[120:123], v[152:155], a[252:255]
  s_sub_u32 s48, s48, 1
  s_cmp_lg_u32 s48, 0
  s_cbranch_scc1 Lv_45_loop
  s_waitcnt lgkmcnt(0)
  v_mfma_f32_16x16x32_bf16 a[0:3], v[28:31], v[60:63], a[0:3]
  ds_read_b128 v[92:95], v17 offset:32768
  v_mfma_f32_16x16x32_bf16 a[4:7], v[28:31], v[64:67], a[4:7]
  ds_read_b128 v[96:99], v17 offset:34816
  v_mfma_f32_16x16x32_bf16 a[8:11], v[28:31], v[68:71], a[8:11]
  ds_read_b128 v[100:103], v17 offset:36864
  v_mfma_f32_16x16x32_bf16 a[12:15], v[28:31], v[72:75], a[12:15]
  v_mfma_f32_16x16x32_bf16 a[16:19], v[28:31], v[76:79], a[16:19]
  ds_read_b128 v[104:107], v17 offset:38912
  v_mfma_f32_16x16x32_bf16 a[20:23], v[28:31], v[80:83], a[20:23]
  ds_read_b128 v[108:111], v17 offset:40960
  v_mfma_f32_16x16x32_bf16 a[24:27], v[28:31], v[84:87], a[24:27]
  v_mfma_f32_16x16x32_bf16 a[28:31], v[28:31], v[88:91], a[28:31]
  ds_read_b128 v[112:115], v17 offset:43008
  v_mfma_f32_16x16x32_bf16 a[32:35], v[32:35], v[60:63], a[32:35]
  ds_read_b128 v[116:119], v17 offset:45056
  v_mfma_f32_16x16x32_bf16 a[36:39], v[32:35], v[64:67], a[36:39]
  v_mfma_f32_16x16x32_bf16 a[40:43], v[32:35], v[68:71], a[40:43]
  ds_read_b128 v[120:123], v17 offset:47104
  v_mfma_f32_16x16x32_bf16 a[44:47], v[32:35], v[72:75], a[44:47]
  ds_read_b64_tr_b16 v[124:125], v18 offset:49152
  v_mfma_f32_16x16x32_bf16 a[48:51], v[32:35], v[76:79], a[48:51]
  v_mfma_f32_16x16x32_bf16 a[52:55], v[32:35], v[80:83], a[52:55]
  ds_read_b64_tr_b16 v[126:127], v18 offset:51200
  v_mfma_f32_16x16x32_bf16 a[56:59], v[32:35], v[84:87], a[56:59]
  ds_read_b64_tr_b16 v[128:129], v19 offset:49152
  v_mfma_f32_16x16x32_bf16 a[60:63], v[32:35], v[88:91], a[60:63]
  v_mfma_f32_16x16x32_bf16 a[64:67], v[36:39], v[60:63], a[64:67]
  ds_read_b64_tr_b16 v[130:131], v19 offset:51200
  v_mfma_f32_16x16x32_bf16 a[68:71], v[36:39], v[64:67], a[68:71]
  ds_read_b64_tr_b16 v[132:133], v20 offset:49152
  v_mfma_f32_16x16x32_bf16 a[72:75], v[36:39], v[68:71], a[72:75]
  ds_read_b64_tr_b16 v[134:135], v20 offset:51200
  v_mfma_f32_16x16x32_bf16 a[76:79], v[36:39], v[72:75], a[76:79]
  v_mfma_f32_16x16x32_bf16 a[80:83], v[36:39], v[76:79], a[80:83]
  ds_read_b64_tr_b16 v[136:137], v21 offset:49152
  v_mfma_f32_16x16x32_bf16 a[84:87], v[36:39], v[80:83], a[84:87]
  ds_read_b64_tr_b16 v[138:139], v21 offset:51200
  v_mfma_f32_16x16x32_bf16 a[88:91], v[36:39], v[84:87], a[88:91]
  v_mfma_f32_16x16x32_bf16 a[92:95], v[36:39], v[88:91], a[92:95]
  ds_read_b64_tr_b16 v[140:141], v22 offset:49152
  v_mfma_f32_16x16x32_bf16 a[96:99], v[40:43], v[60:63], a[96:99]
  ds_read_b64_tr_b16 v[142:143], v22 offset:51200
  v_mfma_f32_16x16x32_bf16 a[100:103], v[40:43], v[64:67], a[100:103]
  v_mfma_f32_16x16x32_bf16 a[104:107], v[40:43], v[68:71], a[104:107]
  ds_read_b64_tr_b16 v[144:145], v23 offset:49152
  v_mfma_f32_16x16x32_bf16 a[108:111], v[40:43], v[72:75], a[108:111]
  ds_read_b64_tr_b16 v[146:147], v23 offset:51200
  v_mfma_f32_16x16x32_bf16 a[112:115], v[40:43], v[76:79], a[112:115]
  v_mfma_f32_16x16x32_bf16 a[116:119], v[40:43], v[80:83], a[116:119]
  ds_read_b64_tr_b16 v[148:149], v24 offset:49152
  v_mfma_f32_16x16x32_bf16 a[120:123], v[40:43], v[84:87], a[120:123]
  ds_read_b64_tr_b16 v[150:151], v24 offset:51200
  v_mfma_f32_16x16x32_bf16 a[124:127], v[40:43], v[88:91], a[124:127]
  v_mfma_f32_16x16x32_bf16 a[128:131], v[44:47], v[60:63], a[128:131]
  ds_read_b64_tr_b16 v[152:153], v25 offset:49152
  v_mfma_f32_16x16x32_bf16 a[132:135], v[44:47], v[64:67], a[132:135]
  ds_read_b64_tr_b16 v[154:155], v25 offset:51200
  v_mfma_f32_16x16x32_bf16 a[136:139], v[44:47], v[68:71], a[136:139]
  v_mfma_f32_16x16x32_bf16 a[140:143], v[44:47], v[72:75], a[140:143]
  v_mfma_f32_16x16x32_bf16 a[144:147], v[44:47], v[76:79], a[144:147]
  v_mfma_f32_16x16x32_bf16 a[148:151], v[44:47], v[80:83], a[148:151]
  v_mfma_f32_16x16x32_bf16 a[152:155], v[44:47], v[84:87], a[152:155]
  v_mfma_f32_16x16x32_bf16 a[156:159], v[44:47], v[88:91], a[156:159]
  v_mfma_f32_16x16x32_bf16 a[160:163], v[48:51], v[60:63], a[160:163]
  v_mfma_f32_16x16x32_bf16 a[164:167], v[48:51], v[64:67], a[164:167]
  v_mfma_f32_16x16x32_bf16 a[168:171], v[48:51], v[68:71], a[168:171]
  v_mfma_f32_16x16x32_bf16 a[172:175], v[48:51], v[72:75], a[172:175]
  v_mfma_f32_16x16x32_bf16 a[176:179], v[48:51], v[76:79], a[176:179]
  v_mfma_f32_16x16x32_bf16 a[180:183], v[48:51], v[80:83], a[180:183]
  v_mfma_f32_16x16x32_bf16 a[184:187], v[48:51], v[84:87], a[184:187]
  v_mfma_f32_16x16x32_bf16 a[188:191], v[48:51], v[88:91], a[188:191]
  v_mfma_f32_16x16x32_bf16 a[192:195], v[52:55], v[60:63], a[192:195]
  v_mfma_f32_16x16x32_bf16 a[196:199], v[52:55], v[64:67], a[196:199]
  v_mfma_f32_16x16x32_bf16 a[200:203], v[52:55], v[68:71], a[200:203]
  v_mfma_f32_16x16x32_bf16 a[204:207], v[52:55], v[72:75], a[204:207]
  v_mfma_f32_16x16x32_bf16 a[208:211], v[52:55], v[76:79], a[208:211]
  v_mfma_f32_16x16x32_bf16 a[212:215], v[52:55], v[80:83], a[212:215]
  v_mfma_f32_16x16x32_bf16 a[216:219], v[52:55], v[84:87], a[216:219]
  v_mfma_f32_16x16x32_bf16 a[220:223], v[52:55], v[88:91], a[220:223]
  v_mfma_f32_16x16x32_bf16 a[224:227], v[56:59], v[60:63], a[224:227]
  v_mfma_f32_16x16x32_bf16 a[228:231], v[56:59], v[64:67], a[228:231]
  v_mfma_f32_16x16x32_bf16 a[232:235], v[56:59], v[68:71], a[232:235]
  v_mfma_f32_16x16x32_bf16 a[236:239], v[56:59], v[72:75], a[236:239]
  v_mfma_f32_16x16x32_bf16 a[240:243], v[56:59], v[76:79], a[240:243]
  v_mfma_f32_16x16x32_bf16 a[244:247], v[56:59], v[80:83], a[244:247]
  v_mfma_f32_16x16x32_bf16 a[248:251], v[56:59], v[84:87], a[248:251]
  v_mfma_f32_16x16x32_bf16 a[252:255], v[56:59], v[88:91], a[252:255]
  s_waitcnt vmcnt(0) lgkmcnt(0)
  s_barrier
  v_mfma_f32_16x16x32_bf16 a[0:3], v[92:95], v[124:127], a[0:3]
  ds_read_b128 v[28:31], v16 offset:0
  v_mfma_f32_16x16x32_bf16 a[4:7], v[92:95], v[128:131], a[4:7]
  ds_read_b128 v[32:35], v16 offset:2048
  v_mfma_f32_16x16x32_bf16 a[8:11], v[92:95], v[132:135], a[8:11]
  ds_read_b128 v[36:39], v16 offset:4096
  v_mfma_f32_16x16x32_bf16 a[12:15], v[92:95], v[136:139], a[12:15]
  v_mfma_f32_16x16x32_bf16 a[16:19], v[92:95], v[140:143], a[16:19]
  ds_read_b128 v[40:43], v16 offset:6144
  v_mfma_f32_16x16x32_bf16 a[20:23], v[92:95], v[144:147], a[20:23]
  ds_read_b128 v[44:47], v16 offset:8192
  v_mfma_f32_16x16x32_bf16 a[24:27], v[92:95], v[148:151], a[24:27]
  v_mfma_f32_16x16x32_bf16 a[28:31], v[92:95], v[152:155], a[28:31]
  ds_read_b128 v[48:51], v16 offset:10240
  v_mfma_f32_16x16x32_bf16 a[32:35], v[96:99], v[124:127], a[32:35]
  ds_read_b128 v[52:55], v16 offset:12288
  v_mfma_f32_16x16x32_bf16 a[36:39], v[96:99], v[128:131], a[36:39]
  v_mfma_f32_16x16x32_bf16 a[40:43], v[96:99], v[132:135], a[40:43]
  ds_read_b128 v[56:59], v16 offset:14336
  v_mfma_f32_16x16x32_bf16 a[44:47], v[96:99], v[136:139], a[44:47]
  ds_read_b64_tr_b16 v[60:61], v18 offset:0
  v_mfma_f32_16x16x32_bf16 a[48:51], v[96:99], v[140:143], a[48:51]
  v_mfma_f32_16x16x32_bf16 a[52:55], v[96:99], v[144:147], a[52:55]
  ds_read_b64_tr_b16 v[62:63], v18 offset:2048
  v_mfma_f32_16x16x32_bf16 a[56:59], v[96:99], v[148:151], a[56:59]
  ds_read_b64_tr_b16 v[64:65], v19 offset:0
  v_mfma_f32_16x16x32_bf16 a[60:63], v[96:99], v[152:155], a[60:63]
  v_mfma_f32_16x16x32_bf16 a[64:67], v[100:103], v[124:127], a[64:67]
  ds_read_b64_tr_b16 v[66:67], v19 offset:2048
  v_mfma_f32_16x16x32_bf16 a[68:71], v[100:103], v[128:131], a[68:71]
  ds_read_b64_tr_b16 v[68:69], v20 offset:0
  v_mfma_f32_16x16x32_bf16 a[72:75], v[100:103], v[132:135], a[72:75]
  ds_read_b64_tr_b16 v[70:71], v20 offset:2048
  v_mfma_f32_16x16x32_bf16 a[76:79], v[100:103], v[136:139], a[76:79]
  v_mfma_f32_16x16x32_bf16 a[80:83], v[100:103], v[140:143], a[80:83]
  ds_read_b64_tr_b16 v[72:73], v21 offset:0
  v_mfma_f32_16x16x32_bf16 a[84:87], v[100:103], v[144:147], a[84:87]
  ds_read_b64_tr_b16 v[74:75], v21 offset:2048
  v_mfma_f32_16x16x32_bf16 a[88:91], v[100:103], v[148:151], a[88:91]
  v_mfma_f32_16x16x32_bf16 a[92:95], v[100:103], v[152:155], a[92:95]
  ds_read_b64_tr_b16 v[76:77], v22 offset:0
  v_mfma_f32_16x16x32_bf16 a[96:99], v[104:107], v[124:127], a[96:99]
  ds_read_b64_tr_b16 v[78:79], v22 offset:2048
  v_mfma_f32_16x16x32_bf16 a[100:103], v[104:107], v[128:131], a[100:103]
  v_mfma_f32_16x16x32_bf16 a[104:107], v[104:107], v[132:135], a[104:107]
  ds_read_b64_tr_b16 v[80:81], v23 offset:0
  v_mfma_f32_16x16x32_bf16 a[108:111], v[104:107], v[136:139], a[108:111]
  ds_read_b64_tr_b16 v[82:83], v23 offset:2048
  v_mfma_f32_16x16x32_bf16 a[112:115], v[104:107], v[140:143], a[112:115]
  v_mfma_f32_16x16x32_bf16 a[116:119], v[104:107], v[144:147], a[116:119]
  ds_read_b64_tr_b16 v[84:85], v24 offset:0
  v_mfma_f32_16x16x32_bf16 a[120:123], v[104:107], v[148:151], a[120:123]
  ds_read_b64_tr_b16 v[86:87], v24 offset:2048
  v_mfma_f32_16x16x32_bf16 a[124:127], v[104:107], v[152:155], a[124:127]
  v_mfma_f32_16x16x32_bf16 a[128:131], v[108:111], v[124:127], a[128:131]
  ds_read_b64_tr_b16 v[88:89], v25 offset:0
  v_mfma_f32_16x16x32_bf16 a[132:135], v[108:111], v[128:131], a[132:135]
  ds_read_b64_tr_b16 v[90:91], v25 offset:2048
  v_mfma_f32_16x16x32_bf16 a[136:139], v[108:111], v[132:135], a[136:139]
  v_mfma_f32_16x16x32_bf16 a[140:143], v[108:111], v[136:139], a[140:143]
  v_mfma_f32_16x16x32_bf16 a[144:147], v[108:111], v[140:143], a[144:147]
  v_mfma_f32_16x16x32_bf16 a[148:151], v[108:111], v[144:147], a[148:151]
  v_mfma_f32_16x16x32_bf16 a[152:155], v[108:111], v[148:151], a[152:155]
  v_mfma_f32_16x16x32_bf16 a[156:159], v[108:111], v[152:155], a[156:159]
  v_mfma_f32_16x16x32_bf16 a[160:163], v[112:115], v[124:127], a[160:163]
  v_mfma_f32_16x16x32_bf16 a[164:167], v[112:115], v[128:131], a[164:167]
  v_mfma_f32_16x16x32_bf16 a[168:171], v[112:115], v[132:135], a[168:171]
  v_mfma_f32_16x16x32_bf16 a[172:175], v[112:115], v[136:139], a[172:175]
  v_mfma_f32_16x16x32_bf16 a[176:179], v[112:115], v[140:143], a[176:179]
  v_mfma_f32_16x16x32_bf16 a[180:183], v[112:115], v[144:147], a[180:183]
  v_mfma_f32_16x16x32_bf16 a[184:187], v[112:115], v[148:151], a[184:187]
  v_mfma_f32_16x16x32_bf16 a[188:191], v[112:115], v[152:155], a[188:191]
  v_mfma_f32_16x16x32_bf16 a[192:195], v[116:119], v[124:127], a[192:195]
  v_mfma_f32_16x16x32_bf16 a[196:199], v[116:119], v[128:131], a[196:199]
  v_mfma_f32_16x16x32_bf16 a[200:203], v[116:119], v[132:135], a[200:203]
  v_mfma_f32_16x16x32_bf16 a[204:207], v[116:119], v[136:139], a[204:207]
  v_mfma_f32_16x16x32_bf16 a[208:211], v[116:119], v[140:143], a[208:211]
  v_mfma_f32_16x16x32_bf16 a[212:215], v[116:119], v[144:147], a[212:215]
  v_mfma_f32_16x16x32_bf16 a[216:219], v[116:119], v[148:151], a[216:219]
  v_mfma_f32_16x16x32_bf16 a[220:223], v[116:119], v[152:155], a[220:223]
  v_mfma_f32_16x16x32_bf16 a[224:227], v[120:123], v[124:127], a[224:227]
  v_mfma_f32_16x16x32_bf16 a[228:231], v[120:123], v[128:131], a[228:231]
  v_mfma_f32_16x16x32_bf16 a[232:235], v[120:123], v[132:135], a[232:235]
  v_mfma_f32_16x16x32_bf16 a[236:239], v[120:123], v[136:139], a[236:239]
  v_mfma_f32_16x16x32_bf16 a[240:243], v[120:123], v[140:143], a[240:243]
  v_mfma_f32_16x16x32_bf16 a[244:247], v[120:123], v[144:147], a[244:247]
  v_mfma_f32_16x16x32_bf16 a[248:251], v[120:123], v[148:151], a[248:251]
  v_mfma_f32_16x16x32_bf16 a[252:255], v[120:123], v[152:155], a[252:255]
  s_waitcnt lgkmcnt(0)
  v_mfma_f32_16x16x32_bf16 a[0:3], v[28:31], v[60:63], a[0:3]
  ds_read_b128 v[92:95], v17 offset:0
  v_mfma_f32_16x16x32_bf16 a[4:7], v[28:31], v[64:67], a[4:7]
  ds_read_b128 v[96:99], v17 offset:2048
  v_mfma_f32_16x16x32_bf16 a[8:11], v[28:31], v[68:71], a[8:11]
  ds_read_b128 v[100:103], v17 offset:4096
  v_mfma_f32_16x16x32_bf16 a[12:15], v[28:31], v[72:75], a[12:15]
  v_mfma_f32_16x16x32_bf16 a[16:19], v[28:31], v[76:79], a[16:19]
  ds_read_b128 v[104:107], v17 offset:6144
  v_mfma_f32_16x16x32_bf16 a[20:23], v[28:31], v[80:83], a[20:23]
  ds_read_b128 v[108:111], v17 offset:8192
  v_mfma_f32_16x16x32_bf16 a[24:27], v[28:31], v[84:87], a[24:27]
  v_mfma_f32_16x16x32_bf16 a[28:31], v[28:31], v[88:91], a[28:31]
  ds_read_b128 v[112:115], v17 offset:10240
  v_mfma_f32_16x16x32_bf16 a[32:35], v[32:35], v[60:63], a[32:35]
  ds_read_b128 v[116:119], v17 offset:12288
  v_mfma_f32_16x16x32_bf16 a[36:39], v[32:35], v[64:67], a[36:39]
  v_mfma_f32_16x16x32_bf16 a[40:43], v[32:35], v[68:71], a[40:43]
  ds_read_b128 v[120:123], v17 offset:14336
  v_mfma_f32_16x16x32_bf16 a[44:47], v[32:35], v[72:75], a[44:47]
  ds_read_b64_tr_b16 v[124:125], v18 offset:16384
  v_mfma_f32_16x16x32_bf16 a[48:51], v[32:35], v[76:79], a[48:51]
  v_mfma_f32_16x16x32_bf16 a[52:55], v[32:35], v[80:83], a[52:55]
  ds_read_b64_tr_b16 v[126:127], v18 offset:18432
  v_mfma_f32_16x16x32_bf16 a[56:59], v[32:35], v[84:87], a[56:59]
  ds_read_b64_tr_b16 v[128:129], v19 offset:16384
  v_mfma_f32_16x16x32_bf16 a[60:63], v[32:35], v[88:91], a[60:63]
  v_mfma_f32_16x16x32_bf16 a[64:67], v[36:39], v[60:63], a[64:67]
  ds_read_b64_tr_b16 v[130:131], v19 offset:18432
  v_mfma_f32_16x16x32_bf16 a[68:71], v[36:39], v[64:67], a[68:71]
  ds_read_b64_tr_b16 v[132:133], v20 offset:16384
  v_mfma_f32_16x16x32_bf16 a[72:75], v[36:39], v[68:71], a[72:75]
  ds_read_b64_tr_b16 v[134:135], v20 offset:18432
  v_mfma_f32_16x16x32_bf16 a[76:79], v[36:39], v[72:75], a[76:79]
  v_mfma_f32_16x16x32_bf16 a[80:83], v[36:39], v[76:79], a[80:83]
  ds_read_b64_tr_b16 v[136:137], v21 offset:16384
  v_mfma_f32_16x16x32_bf16 a[84:87], v[36:39], v[80:83], a[84:87]
  ds_read_b64_tr_b16 v[138:139], v21 offset:18432
  v_mfma_f32_16x16x32_bf16 a[88:91], v[36:39], v[84:87], a[88:91]
  v_mfma_f32_16x16x32_bf16 a[92:95], v[36:39], v[88:91], a[92:95]
  ds_read_b64_tr_b16 v[140:141], v22 offset:16384
  v_mfma_f32_16x16x32_bf16 a[96:99], v[40:43], v[60:63], a[96:99]
  ds_read_b64_tr_b16 v[142:143], v22 offset:18432
  v_mfma_f32_16x16x32_bf16 a[100:103], v[40:43], v[64:67], a[100:103]
  v_mfma_f32_16x16x32_bf16 a[104:107], v[40:43], v[68:71], a[104:107]
  ds_read_b64_tr_b16 v[144:145], v23 offset:16384
  v_mfma_f32_16x16x32_bf16 a[108:111], v[40:43], v[72:75], a[108:111]
  ds_read_b64_tr_b16 v[146:147], v23 offset:18432
  v_mfma_f32_16x16x32_bf16 a[112:115], v[40:43], v[76:79], a[112:115]
  v_mfma_f32_16x16x32_bf16 a[116:119], v[40:43], v[80:83], a[116:119]
  ds_read_b64_tr_b16 v[148:149], v24 offset:16384
  v_mfma_f32_16x16x32_bf16 a[120:123], v[40:43], v[84:87], a[120:123]
  ds_read_b64_tr_b16 v[150:151], v24 offset:18432
  v_mfma_f32_16x16x32_bf16 a[124:127], v[40:43], v[88:91], a[124:127]
  v_mfma_f32_16x16x32_bf16 a[128:131], v[44:47], v[60:63], a[128:131]
  ds_read_b64_tr_b16 v[152:153], v25 offset:16384
  v_mfma_f32_16x16x32_bf16 a[132:135], v[44:47], v[64:67], a[132:135]
  ds_read_b64_tr_b16 v[154:155], v25 offset:18432
  v_mfma_f32_16x16x32_bf16 a[136:139], v[44:47], v[68:71], a[136:139]
  v_mfma_f32_16x16x32_bf16 a[140:143], v[44:47], v[72:75], a[140:143]
  v_mfma_f32_16x16x32_bf16 a[144:147], v[44:47], v[76:79], a[144:147]
  v_mfma_f32_16x16x32_bf16 a[148:151], v[44:47], v[80:83], a[148:151]
  v_mfma_f32_16x16x32_bf16 a[152:155], v[44:47], v[84:87], a[152:155]
  v_mfma_f32_16x16x32_bf16 a[156:159], v[44:47], v[88:91], a[156:159]
  v_mfma_f32_16x16x32_bf16 a[160:163], v[48:51], v[60:63], a[160:163]
  v_mfma_f32_16x16x32_bf16 a[164:167], v[48:51], v[64:67], a[164:167]
  v_mfma_f32_16x16x32_bf16 a[168:171], v[48:51], v[68:71], a[168:171]
  v_mfma_f32_16x16x32_bf16 a[172:175], v[48:51], v[72:75], a[172:175]
  v_mfma_f32_16x16x32_bf16 a[176:179], v[48:51], v[76:79], a[176:179]
  v_mfma_f32_16x16x32_bf16 a[180:183], v[48:51], v[80:83], a[180:183]
  v_mfma_f32_16x16x32_bf16 a[184:187], v[48:51], v[84:87], a[184:187]
  v_mfma_f32_16x16x32_bf16 a[188:191], v[48:51], v[88:91], a[188:191]
  v_mfma_f32_16x16x32_bf16 a[192:195], v[52:55], v[60:63], a[192:195]
  v_mfma_f32_16x16x32_bf16 a[196:199], v[52:55], v[64:67], a[196:199]
  v_mfma_f32_16x16x32_bf16 a[200:203], v[52:55], v[68:71], a[200:203]
  v_mfma_f32_16x16x32_bf16 a[204:207], v[52:55], v[72:75], a[204:207]
  v_mfma_f32_16x16x32_bf16 a[208:211], v[52:55], v[76:79], a[208:211]
  v_mfma_f32_16x16x32_bf16 a[212:215], v[52:55], v[80:83], a[212:215]
  v_mfma_f32_16x16x32_bf16 a[216:219], v[52:55], v[84:87], a[216:219]
  v_mfma_f32_16x16x32_bf16 a[220:223], v[52:55], v[88:91], a[220:223]
  v_mfma_f32_16x16x32_bf16 a[224:227], v[56:59], v[60:63], a[224:227]
  v_mfma_f32_16x16x32_bf16 a[228:231], v[56:59], v[64:67], a[228:231]
  v_mfma_f32_16x16x32_bf16 a[232:235], v[56:59], v[68:71], a[232:235]
  v_mfma_f32_16x16x32_bf16 a[236:239], v[56:59], v[72:75], a[236:239]
  v_mfma_f32_16x16x32_bf16 a[240:243], v[56:59], v[76:79], a[240:243]
  v_mfma_f32_16x16x32_bf16 a[244:247], v[56:59], v[80:83], a[244:247]
  v_mfma_f32_16x16x32_bf16 a[248:251], v[56:59], v[84:87], a[248:251]
  v_mfma_f32_16x16x32_bf16 a[252:255], v[56:59], v[88:91], a[252:255]
  s_waitcnt lgkmcnt(0)
  v_mfma_f32_16x16x32_bf16 a[0:3], v[92:95], v[124:127], a[0:3]
  v_mfma_f32_16x16x32_bf16 a[4:7], v[92:95], v[128:131], a[4:7]
  v_mfma_f32_16x16x32_bf16 a[8:11], v[92:95], v[132:135], a[8:11]
  v_mfma_f32_16x16x32_bf16 a[12:15], v[92:95], v[136:139], a[12:15]
  v_mfma_f32_16x16x32_bf16 a[16:19], v[92:95], v[140:143], a[16:19]
  v_mfma_f32_16x16x32_bf16 a[20:23], v[92:95], v[144:147], a[20:23]
  v_mfma_f32_16x16x32_bf16 a[24:27], v[92:95], v[148:151], a[24:27]
  v_mfma_f32_16x16x32_bf16 a[28:31], v[92:95], v[152:155], a[28:31]
  v_mfma_f32_16x16x32_bf16 a[32:35], v[96:99], v[124:127], a[32:35]
  v_mfma_f32_16x16x32_bf16 a[36:39], v[96:99], v[128:131], a[36:39]
  v_mfma_f32_16x16x32_bf16 a[40:43], v[96:99], v[132:135], a[40:43]
  v_mfma_f32_16x16x32_bf16 a[44:47], v[96:99], v[136:139], a[44:47]
  v_mfma_f32_16x16x32_bf16 a[48:51], v[96:99], v[140:143], a[48:51]
  v_mfma_f32_16x16x32_bf16 a[52:55], v[96:99], v[144:147], a[52:55]
  v_mfma_f32_16x16x32_bf16 a[56:59], v[96:99], v[148:151], a[56:59]
  v_mfma_f32_16x16x32_bf16 a[60:63], v[96:99], v[152:155], a[60:63]
  v_mfma_f32_16x16x32_bf16 a[64:67], v[100:103], v[124:127], a[64:67]
  v_mfma_f32_16x16x32_bf16 a[68:71], v[100:103], v[128:131], a[68:71]
  v_mfma_f32_16x16x32_bf16 a[72:75], v[100:103], v[132:135], a[72:75]
  v_mfma_f32_16x16x32_bf16 a[76:79], v[100:103], v[136:139], a[76:79]
  v_mfma_f32_16x16x32_bf16 a[80:83], v[100:103], v[140:143], a[80:83]
  v_mfma_f32_16x16x32_bf16 a[84:87], v[100:103], v[144:147], a[84:87]
  v_mfma_f32_16x16x32_bf16 a[88:91], v[100:103], v[148:151], a[88:91]
  v_mfma_f32_16x16x32_bf16 a[92:95], v[100:103], v[152:155], a[92:95]
  v_mfma_f32_16x16x32_bf16 a[96:99], v[104:107], v[124:127], a[96:99]
  v_mfma_f32_16x16x32_bf16 a[100:103], v[104:107], v[128:131], a[100:103]
  v_mfma_f32_16x16x32_bf16 a[104:107], v[104:107], v[132:135], a[104:107]
  v_mfma_f32_16x16x32_bf16 a[108:111], v[104:107], v[136:139], a[108:111]
  v_mfma_f32_16x16x32_bf16 a[112:115], v[104:107], v[140:143], a[112:115]
  v_mfma_f32_16x16x32_bf16 a[116:119], v[104:107], v[144:147], a[116:119]
  v_mfma_f32_16x16x32_bf16 a[120:123], v[104:107], v[148:151], a[120:123]
  v_mfma_f32_16x16x32_bf16 a[124:127], v[104:107], v[152:155], a[124:127]
  v_mfma_f32_16x16x32_bf16 a[128:131], v[108:111], v[124:127], a[128:131]
  v_mfma_f32_16x16x32_bf16 a[132:135], v[108:111], v[128:131], a[132:135]
  v_mfma_f32_16x16x32_bf16 a[136:139], v[108:111], v[132:135], a[136:139]
  v_mfma_f32_16x16x32_bf16 a[140:143], v[108:111], v[136:139], a[140:143]
  v_mfma_f32_16x16x32_bf16 a[144:147], v[108:111], v[140:143], a[144:147]
  v_mfma_f32_16x16x32_bf16 a[148:151], v[108:111], v[144:147], a[148:151]
  v_mfma_f32_16x16x32_bf16 a[152:155], v[108:111], v[148:151], a[152:155]
  v_mfma_f32_16x16x32_bf16 a[156:159], v[108:111], v[152:155], a[156:159]
  v_mfma_f32_16x16x32_bf16 a[160:163], v[112:115], v[124:127], a[160:163]
  v_mfma_f32_16x16x32_bf16 a[164:167], v[112:115], v[128:131], a[164:167]
  v_mfma_f32_16x16x32_bf16 a[168:171], v[112:115], v[132:135], a[168:171]
  v_mfma_f32_16x16x32_bf16 a[172:175], v[112:115], v[136:139], a[172:175]
  v_mfma_f32_16x16x32_bf16 a[176:179], v[112:115], v[140:143], a[176:179]
  v_mfma_f32_16x16x32_bf16 a[180:183], v[112:115], v[144:147], a[180:183]
  v_mfma_f32_16x16x32_bf16 a[184:187], v[112:115], v[148:151], a[184:187]
  v_mfma_f32_16x16x32_bf16 a[188:191], v[112:115], v[152:155], a[188:191]
  v_mfma_f32_16x16x32_bf16 a[192:195], v[116:119], v[124:127], a[192:195]
  v_mfma_f32_16x16x32_bf16 a[196:199], v[116:119], v[128:131], a[196:199]
  v_mfma_f32_16x16x32_bf16 a[200:203], v[116:119], v[132:135], a[200:203]
  v_mfma_f32_16x16x32_bf16 a[204:207], v[116:119], v[136:139], a[204:207]
  v_mfma_f32_16x16x32_bf16 a[208:211], v[116:119], v[140:143], a[208:211]
  v_mfma_f32_16x16x32_bf16 a[212:215], v[116:119], v[144:147], a[212:215]
  v_mfma_f32_16x16x32_bf16 a[216:219], v[116:119], v[148:151], a[216:219]
  v_mfma_f32_16x16x32_bf16 a[220:223], v[116:119], v[152:155], a[220:223]
  v_mfma_f32_16x16x32_bf16 a[224:227], v[120:123], v[124:127], a[224:227]
  v_mfma_f32_16x16x32_bf16 a[228:231], v[120:123], v[128:131], a[228:231]
  v_mfma_f32_16x16x32_bf16 a[232:235], v[120:123], v[132:135], a[232:235]
  v_mfma_f32_16x16x32_bf16 a[236:239], v[120:123], v[136:139], a[236:239]
  v_mfma_f32_16x16x32_bf16 a[240:243], v[120:123], v[140:143], a[240:243]
  v_mfma_f32_16x16x32_bf16 a[244:247], v[120:123], v[144:147], a[244:247]
  v_mfma_f32_16x16x32_bf16 a[248:251], v[120:123], v[148:151], a[248:251]
  v_mfma_f32_16x16x32_bf16 a[252:255], v[120:123], v[152:155], a[252:255]
  s_nop 7
  s_nop 7
  s_add_u32 s20, s10, 0x2252000
  s_addc_u32 s21, s11, 0
  s_mov_b32 s22, 0x1000000
  s_mov_b32 s23, 0x20000
  v_lshlrev_b32 v28, 4, v1
  s_lshr_b32 s40, s3, 1
  s_lshl_b32 s40, s40, 2
  s_lshl_b32 s41, s32, 3
  s_add_u32 s40, s40, s41
  s_lshl_b32 s40, s40, 5
  s_and_b32 s41, s3, 1
  s_add_u32 s40, s40, s41
  s_lshl_b32 s41, s36, 1
  s_add_u32 s40, s40, s41
  s_lshl_b32 s38, s40, 13
  v_accvgpr_read_b32 v36, a0
  v_accvgpr_read_b32 v37, a1
  v_accvgpr_read_b32 v38, a2
  v_accvgpr_read_b32 v39, a3
  v_cvt_pk_bf16_f32 v32, v36, v37
  v_cvt_pk_bf16_f32 v33, v38, v39
  v_accvgpr_read_b32 v40, a32
  v_accvgpr_read_b32 v41, a33
  v_accvgpr_read_b32 v42, a34
  v_accvgpr_read_b32 v43, a35
  v_cvt_pk_bf16_f32 v34, v40, v41
  v_cvt_pk_bf16_f32 v35, v42, v43
  buffer_store_dwordx4 v[32:35], v28, s[20:23], s38 offen offset:0 sc1
  v_accvgpr_read_b32 v48, a4
  v_accvgpr_read_b32 v49, a5
  v_accvgpr_read_b32 v50, a6
  v_accvgpr_read_b32 v51, a7
  v_cvt_pk_bf16_f32 v44, v48, v49
  v_cvt_pk_bf16_f32 v45, v50, v51
  v_accvgpr_read_b32 v52, a36
  v_accvgpr_read_b32 v53, a37
  v_accvgpr_read_b32 v54, a38
  v_accvgpr_read_b32 v55, a39
  v_cvt_pk_bf16_f32 v46, v52, v53
  v_cvt_pk_bf16_f32 v47, v54, v55
  buffer_store_dwordx4 v[44:47], v28, s[20:23], s38 offen offset:1024 sc1
  v_accvgpr_read_b32 v60, a8
  v_accvgpr_read_b32 v61, a9
  v_accvgpr_read_b32 v62, a10
  v_accvgpr_read_b32 v63, a11
  v_cvt_pk_bf16_f32 v56, v60, v61
  v_cvt_pk_bf16_f32 v57, v62, v63
  v_accvgpr_read_b32 v64, a40
  v_accvgpr_read_b32 v65, a41
  v_accvgpr_read_b32 v66, a42
  v_accvgpr_read_b32 v67, a43
  v_cvt_pk_bf16_f32 v58, v64, v65
  v_cvt_pk_bf16_f32 v59, v66, v67
  buffer_store_dwordx4 v[56:59], v28, s[20:23], s38 offen offset:2048 sc1
  v_accvgpr_read_b32 v72, a12
  v_accvgpr_read_b32 v73, a13
  v_accvgpr_read_b32 v74, a14
  v_accvgpr_read_b32 v75, a15
  v_cvt_pk_bf16_f32 v68, v72, v73
  v_cvt_pk_bf16_f32 v69, v74, v75
  v_accvgpr_read_b32 v76, a44
  v_accvgpr_read_b32 v77, a45
  v_accvgpr_read_b32 v78, a46
  v_accvgpr_read_b32 v79, a47
  v_cvt_pk_bf16_f32 v70, v76, v77
  v_cvt_pk_bf16_f32 v71, v78, v79
  buffer_store_dwordx4 v[68:71], v28, s[20:23], s38 offen offset:3072 sc1
  v_accvgpr_read_b32 v36, a16
  v_accvgpr_read_b32 v37, a17
  v_accvgpr_read_b32 v38, a18
  v_accvgpr_read_b32 v39, a19
  v_cvt_pk_bf16_f32 v32, v36, v37
  v_cvt_pk_bf16_f32 v33, v38, v39
  v_accvgpr_read_b32 v40, a48
  v_accvgpr_read_b32 v41, a49
  v_accvgpr_read_b32 v42, a50
  v_accvgpr_read_b32 v43, a51
  v_cvt_pk_bf16_f32 v34, v40, v41
  v_cvt_pk_bf16_f32 v35, v42, v43
  s_add_u32 s38, s38, 4096
  buffer_store_dwordx4 v[32:35], v28, s[20:23], s38 offen offset:0 sc1
  v_accvgpr_read_b32 v48, a20
  v_accvgpr_read_b32 v49, a21
  v_accvgpr_read_b32 v50, a22
  v_accvgpr_read_b32 v51, a23
  v_cvt_pk_bf16_f32 v44, v48, v49
  v_cvt_pk_bf16_f32 v45, v50, v51
  v_accvgpr_read_b32 v52, a52
  v_accvgpr_read_b32 v53, a53
  v_accvgpr_read_b32 v54, a54
  v_accvgpr_read_b32 v55, a55
  v_cvt_pk_bf16_f32 v46, v52, v53
  v_cvt_pk_bf16_f32 v47, v54, v55
  buffer_store_dwordx4 v[44:47], v28, s[20:23], s38 offen offset:1024 sc1
  v_accvgpr_read_b32 v60, a24
  v_accvgpr_read_b32 v61, a25
  v_accvgpr_read_b32 v62, a26
  v_accvgpr_read_b32 v63, a27
  v_cvt_pk_bf16_f32 v56, v60, v61
  v_cvt_pk_bf16_f32 v57, v62, v63
  v_accvgpr_read_b32 v64, a56
  v_accvgpr_read_b32 v65, a57
  v_accvgpr_read_b32 v66, a58
  v_accvgpr_read_b32 v67, a59
  v_cvt_pk_bf16_f32 v58, v64, v65
  v_cvt_pk_bf16_f32 v59, v66, v67
  buffer_store_dwordx4 v[56:59], v28, s[20:23], s38 offen offset:2048 sc1
  v_accvgpr_read_b32 v72, a28
  v_accvgpr_read_b32 v73, a29
  v_accvgpr_read_b32 v74, a30
  v_accvgpr_read_b32 v75, a31
  v_cvt_pk_bf16_f32 v68, v72, v73
  v_cvt_pk_bf16_f32 v69, v74, v75
  v_accvgpr_read_b32 v76, a60
  v_accvgpr_read_b32 v77, a61
  v_accvgpr_read_b32 v78, a62
  v_accvgpr_read_b32 v79, a63
  v_cvt_pk_bf16_f32 v70, v76, v77
  v_cvt_pk_bf16_f32 v71, v78, v79
  buffer_store_dwordx4 v[68:71], v28, s[20:23], s38 offen offset:3072 sc1
  s_add_u32 s38, s38, 258048
  v_accvgpr_read_b32 v36, a64
  v_accvgpr_read_b32 v37, a65
  v_accvgpr_read_b32 v38, a66
  v_accvgpr_read_b32 v39, a67
  v_cvt_pk_bf16_f32 v32, v36, v37
  v_cvt_pk_bf16_f32 v33, v38, v39
  v_accvgpr_read_b32 v40, a96
  v_accvgpr_read_b32 v41, a97
  v_accvgpr_read_b32 v42, a98
  v_accvgpr_read_b32 v43, a99
  v_cvt_pk_bf16_f32 v34, v40, v41
  v_cvt_pk_bf16_f32 v35, v42, v43
  buffer_store_dwordx4 v[32:35], v28, s[20:23], s38 offen offset:0 sc1
  v_accvgpr_read_b32 v48, a68
  v_accvgpr_read_b32 v49, a69
  v_accvgpr_read_b32 v50, a70
  v_accvgpr_read_b32 v51, a71
  v_cvt_pk_bf16_f32 v44, v48, v49
  v_cvt_pk_bf16_f32 v45, v50, v51
  v_accvgpr_read_b32 v52, a100
  v_accvgpr_read_b32 v53, a101
  v_accvgpr_read_b32 v54, a102
  v_accvgpr_read_b32 v55, a103
  v_cvt_pk_bf16_f32 v46, v52, v53
  v_cvt_pk_bf16_f32 v47, v54, v55
  buffer_store_dwordx4 v[44:47], v28, s[20:23], s38 offen offset:1024 sc1
  v_accvgpr_read_b32 v60, a72
  v_accvgpr_read_b32 v61, a73
  v_accvgpr_read_b32 v62, a74
  v_accvgpr_read_b32 v63, a75
  v_cvt_pk_bf16_f32 v56, v60, v61
  v_cvt_pk_bf16_f32 v57, v62, v63
  v_accvgpr_read_b32 v64, a104
  v_accvgpr_read_b32 v65, a105
  v_accvgpr_read_b32 v66, a106
  v_accvgpr_read_b32 v67, a107
  v_cvt_pk_bf16_f32 v58, v64, v65
  v_cvt_pk_bf16_f32 v59, v66, v67
  buffer_store_dwordx4 v[56:59], v28, s[20:23], s38 offen offset:2048 sc1
  v_accvgpr_read_b32 v72, a76
  v_accvgpr_read_b32 v73, a77
  v_accvgpr_read_b32 v74, a78
  v_accvgpr_read_b32 v75, a79
  v_cvt_pk_bf16_f32 v68, v72, v73
  v_cvt_pk_bf16_f32 v69, v74, v75
  v_accvgpr_read_b32 v76, a108
  v_accvgpr_read_b32 v77, a109
  v_accvgpr_read_b32 v78, a110
  v_accvgpr_read_b32 v79, a111
  v_cvt_pk_bf16_f32 v70, v76, v77
  v_cvt_pk_bf16_f32 v71, v78, v79
  buffer_store_dwordx4 v[68:71], v28, s[20:23], s38 offen offset:3072 sc1
  v_accvgpr_read_b32 v36, a80
  v_accvgpr_read_b32 v37, a81
  v_accvgpr_read_b32 v38, a82
  v_accvgpr_read_b32 v39, a83
  v_cvt_pk_bf16_f32 v32, v36, v37
  v_cvt_pk_bf16_f32 v33, v38, v39
  v_accvgpr_read_b32 v40, a112
  v_accvgpr_read_b32 v41, a113
  v_accvgpr_read_b32 v42, a114
  v_accvgpr_read_b32 v43, a115
  v_cvt_pk_bf16_f32 v34, v40, v41
  v_cvt_pk_bf16_f32 v35, v42, v43
  s_add_u32 s38, s38, 4096
  buffer_store_dwordx4 v[32:35], v28, s[20:23], s38 offen offset:0 sc1
  v_accvgpr_read_b32 v48, a84
  v_accvgpr_read_b32 v49, a85
  v_accvgpr_read_b32 v50, a86
  v_accvgpr_read_b32 v51, a87
  v_cvt_pk_bf16_f32 v44, v48, v49
  v_cvt_pk_bf16_f32 v45, v50, v51
  v_accvgpr_read_b32 v52, a116
  v_accvgpr_read_b32 v53, a117
  v_accvgpr_read_b32 v54, a118
  v_accvgpr_read_b32 v55, a119
  v_cvt_pk_bf16_f32 v46, v52, v53
  v_cvt_pk_bf16_f32 v47, v54, v55
  buffer_store_dwordx4 v[44:47], v28, s[20:23], s38 offen offset:1024 sc1
  v_accvgpr_read_b32 v60, a88
  v_accvgpr_read_b32 v61, a89
  v_accvgpr_read_b32 v62, a90
  v_accvgpr_read_b32 v63, a91
  v_cvt_pk_bf16_f32 v56, v60, v61
  v_cvt_pk_bf16_f32 v57, v62, v63
  v_accvgpr_read_b32 v64, a120
  v_accvgpr_read_b32 v65, a121
  v_accvgpr_read_b32 v66, a122
  v_accvgpr_read_b32 v67, a123
  v_cvt_pk_bf16_f32 v58, v64, v65
  v_cvt_pk_bf16_f32 v59, v66, v67
  buffer_store_dwordx4 v[56:59], v28, s[20:23], s38 offen offset:2048 sc1
  v_accvgpr_read_b32 v72, a92
  v_accvgpr_read_b32 v73, a93
  v_accvgpr_read_b32 v74, a94
  v_accvgpr_read_b32 v75, a95
  v_cvt_pk_bf16_f32 v68, v72, v73
  v_cvt_pk_bf16_f32 v69, v74, v75
  v_accvgpr_read_b32 v76, a124
  v_accvgpr_read_b32 v77, a125
  v_accvgpr_read_b32 v78, a126
  v_accvgpr_read_b32 v79, a127
  v_cvt_pk_bf16_f32 v70, v76, v77
  v_cvt_pk_bf16_f32 v71, v78, v79
  buffer_store_dwordx4 v[68:71], v28, s[20:23], s38 offen offset:3072 sc1
  s_add_u32 s38, s38, 258048
  v_accvgpr_read_b32 v36, a128
  v_accvgpr_read_b32 v37, a129
  v_accvgpr_read_b32 v38, a130
  v_accvgpr_read_b32 v39, a131
  v_cvt_pk_bf16_f32 v32, v36, v37
  v_cvt_pk_bf16_f32 v33, v38, v39
  v_accvgpr_read_b32 v40, a160
  v_accvgpr_read_b32 v41, a161
  v_accvgpr_read_b32 v42, a162
  v_accvgpr_read_b32 v43, a163
  v_cvt_pk_bf16_f32 v34, v40, v41
  v_cvt_pk_bf16_f32 v35, v42, v43
  buffer_store_dwordx4 v[32:35], v28, s[20:23], s38 offen offset:0 sc1
  v_accvgpr_read_b32 v48, a132
  v_accvgpr_read_b32 v49, a133
  v_accvgpr_read_b32 v50, a134
  v_accvgpr_read_b32 v51, a135
  v_cvt_pk_bf16_f32 v44, v48, v49
  v_cvt_pk_bf16_f32 v45, v50, v51
  v_accvgpr_read_b32 v52, a164
  v_accvgpr_read_b32 v53, a165
  v_accvgpr_read_b32 v54, a166
  v_accvgpr_read_b32 v55, a167
  v_cvt_pk_bf16_f32 v46, v52, v53
  v_cvt_pk_bf16_f32 v47, v54, v55
  buffer_store_dwordx4 v[44:47], v28, s[20:23], s38 offen offset:1024 sc1
  v_accvgpr_read_b32 v60, a136
  v_accvgpr_read_b32 v61, a137
  v_accvgpr_read_b32 v62, a138
  v_accvgpr_read_b32 v63, a139
  v_cvt_pk_bf16_f32 v56, v60, v61
  v_cvt_pk_bf16_f32 v57, v62, v63
  v_accvgpr_read_b32 v64, a168
  v_accvgpr_read_b32 v65, a169
  v_accvgpr_read_b32 v66, a170
  v_accvgpr_read_b32 v67, a171
  v_cvt_pk_bf16_f32 v58, v64, v65
  v_cvt_pk_bf16_f32 v59, v66, v67
  buffer_store_dwordx4 v[56:59], v28, s[20:23], s38 offen offset:2048 sc1
  v_accvgpr_read_b32 v72, a140
  v_accvgpr_read_b32 v73, a141
  v_accvgpr_read_b32 v74, a142
  v_accvgpr_read_b32 v75, a143
  v_cvt_pk_bf16_f32 v68, v72, v73
  v_cvt_pk_bf16_f32 v69, v74, v75
  v_accvgpr_read_b32 v76, a172
  v_accvgpr_read_b32 v77, a173
  v_accvgpr_read_b32 v78, a174
  v_accvgpr_read_b32 v79, a175
  v_cvt_pk_bf16_f32 v70, v76, v77
  v_cvt_pk_bf16_f32 v71, v78, v79
  buffer_store_dwordx4 v[68:71], v28, s[20:23], s38 offen offset:3072 sc1
  v_accvgpr_read_b32 v36, a144
  v_accvgpr_read_b32 v37, a145
  v_accvgpr_read_b32 v38, a146
  v_accvgpr_read_b32 v39, a147
  v_cvt_pk_bf16_f32 v32, v36, v37
  v_cvt_pk_bf16_f32 v33, v38, v39
  v_accvgpr_read_b32 v40, a176
  v_accvgpr_read_b32 v41, a177
  v_accvgpr_read_b32 v42, a178
  v_accvgpr_read_b32 v43, a179
  v_cvt_pk_bf16_f32 v34, v40, v41
  v_cvt_pk_bf16_f32 v35, v42, v43
  s_add_u32 s38, s38, 4096
  buffer_store_dwordx4 v[32:35], v28, s[20:23], s38 offen offset:0 sc1
  v_accvgpr_read_b32 v48, a148
  v_accvgpr_read_b32 v49, a149
  v_accvgpr_read_b32 v50, a150
  v_accvgpr_read_b32 v51, a151
  v_cvt_pk_bf16_f32 v44, v48, v49
  v_cvt_pk_bf16_f32 v45, v50, v51
  v_accvgpr_read_b32 v52, a180
  v_accvgpr_read_b32 v53, a181
  v_accvgpr_read_b32 v54, a182
  v_accvgpr_read_b32 v55, a183
  v_cvt_pk_bf16_f32 v46, v52, v53
  v_cvt_pk_bf16_f32 v47, v54, v55
  buffer_store_dwordx4 v[44:47], v28, s[20:23], s38 offen offset:1024 sc1
  v_accvgpr_read_b32 v60, a152
  v_accvgpr_read_b32 v61, a153
  v_accvgpr_read_b32 v62, a154
  v_accvgpr_read_b32 v63, a155
  v_cvt_pk_bf16_f32 v56, v60, v61
  v_cvt_pk_bf16_f32 v57, v62, v63
  v_accvgpr_read_b32 v64, a184
  v_accvgpr_read_b32 v65, a185
  v_accvgpr_read_b32 v66, a186
  v_accvgpr_read_b32 v67, a187
  v_cvt_pk_bf16_f32 v58, v64, v65
  v_cvt_pk_bf16_f32 v59, v66, v67
  buffer_store_dwordx4 v[56:59], v28, s[20:23], s38 offen offset:2048 sc1
  v_accvgpr_read_b32 v72, a156
  v_accvgpr_read_b32 v73, a157
  v_accvgpr_read_b32 v74, a158
  v_accvgpr_read_b32 v75, a159
  v_cvt_pk_bf16_f32 v68, v72, v73
  v_cvt_pk_bf16_f32 v69, v74, v75
  v_accvgpr_read_b32 v76, a188
  v_accvgpr_read_b32 v77, a189
  v_accvgpr_read_b32 v78, a190
  v_accvgpr_read_b32 v79, a191
  v_cvt_pk_bf16_f32 v70, v76, v77
  v_cvt_pk_bf16_f32 v71, v78, v79
  buffer_store_dwordx4 v[68:71], v28, s[20:23], s38 offen offset:3072 sc1
  s_add_u32 s38, s38, 258048
  v_accvgpr_read_b32 v36, a192
  v_accvgpr_read_b32 v37, a193
  v_accvgpr_read_b32 v38, a194
  v_accvgpr_read_b32 v39, a195
  v_cvt_pk_bf16_f32 v32, v36, v37
  v_cvt_pk_bf16_f32 v33, v38, v39
  v_accvgpr_read_b32 v40, a224
  v_accvgpr_read_b32 v41, a225
  v_accvgpr_read_b32 v42, a226
  v_accvgpr_read_b32 v43, a227
  v_cvt_pk_bf16_f32 v34, v40, v41
  v_cvt_pk_bf16_f32 v35, v42, v43
  buffer_store_dwordx4 v[32:35], v28, s[20:23], s38 offen offset:0 sc1
  v_accvgpr_read_b32 v48, a196
  v_accvgpr_read_b32 v49, a197
  v_accvgpr_read_b32 v50, a198
  v_accvgpr_read_b32 v51, a199
  v_cvt_pk_bf16_f32 v44, v48, v49
  v_cvt_pk_bf16_f32 v45, v50, v51
  v_accvgpr_read_b32 v52, a228
  v_accvgpr_read_b32 v53, a229
  v_accvgpr_read_b32 v54, a230
  v_accvgpr_read_b32 v55, a231
  v_cvt_pk_bf16_f32 v46, v52, v53
  v_cvt_pk_bf16_f32 v47, v54, v55
  buffer_store_dwordx4 v[44:47], v28, s[20:23], s38 offen offset:1024 sc1
  v_accvgpr_read_b32 v60, a200
  v_accvgpr_read_b32 v61, a201
  v_accvgpr_read_b32 v62, a202
  v_accvgpr_read_b32 v63, a203
  v_cvt_pk_bf16_f32 v56, v60, v61
  v_cvt_pk_bf16_f32 v57, v62, v63
  v_accvgpr_read_b32 v64, a232
  v_accvgpr_read_b32 v65, a233
  v_accvgpr_read_b32 v66, a234
  v_accvgpr_read_b32 v67, a235
  v_cvt_pk_bf16_f32 v58, v64, v65
  v_cvt_pk_bf16_f32 v59, v66, v67
  buffer_store_dwordx4 v[56:59], v28, s[20:23], s38 offen offset:2048 sc1
  v_accvgpr_read_b32 v72, a204
  v_accvgpr_read_b32 v73, a205
  v_accvgpr_read_b32 v74, a206
  v_accvgpr_read_b32 v75, a207
  v_cvt_pk_bf16_f32 v68, v72, v73
  v_cvt_pk_bf16_f32 v69, v74, v75
  v_accvgpr_read_b32 v76, a236
  v_accvgpr_read_b32 v77, a237
  v_accvgpr_read_b32 v78, a238
  v_accvgpr_read_b32 v79, a239
  v_cvt_pk_bf16_f32 v70, v76, v77
  v_cvt_pk_bf16_f32 v71, v78, v79
  buffer_store_dwordx4 v[68:71], v28, s[20:23], s38 offen offset:3072 sc1
  v_accvgpr_read_b32 v36, a208
  v_accvgpr_read_b32 v37, a209
  v_accvgpr_read_b32 v38, a210
  v_accvgpr_read_b32 v39, a211
  v_cvt_pk_bf16_f32 v32, v36, v37
  v_cvt_pk_bf16_f32 v33, v38, v39
  v_accvgpr_read_b32 v40, a240
  v_accvgpr_read_b32 v41, a241
  v_accvgpr_read_b32 v42, a242
  v_accvgpr_read_b32 v43, a243
  v_cvt_pk_bf16_f32 v34, v40, v41
  v_cvt_pk_bf16_f32 v35, v42, v43
  s_add_u32 s38, s38, 4096
  buffer_store_dwordx4 v[32:35], v28, s[20:23], s38 offen offset:0 sc1
  v_accvgpr_read_b32 v48, a212
  v_accvgpr_read_b32 v49, a213
  v_accvgpr_read_b32 v50, a214
  v_accvgpr_read_b32 v51, a215
  v_cvt_pk_bf16_f32 v44, v48, v49
  v_cvt_pk_bf16_f32 v45, v50, v51
  v_accvgpr_read_b32 v52, a244
  v_accvgpr_read_b32 v53, a245
  v_accvgpr_read_b32 v54, a246
  v_accvgpr_read_b32 v55, a247
  v_cvt_pk_bf16_f32 v46, v52, v53
  v_cvt_pk_bf16_f32 v47, v54, v55
  buffer_store_dwordx4 v[44:47], v28, s[20:23], s38 offen offset:1024 sc1
  v_accvgpr_read_b32 v60, a216
  v_accvgpr_read_b32 v61, a217
  v_accvgpr_read_b32 v62, a218
  v_accvgpr_read_b32 v63, a219
  v_cvt_pk_bf16_f32 v56, v60, v61
  v_cvt_pk_bf16_f32 v57, v62, v63
  v_accvgpr_read_b32 v64, a248
  v_accvgpr_read_b32 v65, a249
  v_accvgpr_read_b32 v66, a250
  v_accvgpr_read_b32 v67, a251
  v_cvt_pk_bf16_f32 v58, v64, v65
  v_cvt_pk_bf16_f32 v59, v66, v67
  buffer_store_dwordx4 v[56:59], v28, s[20:23], s38 offen offset:2048 sc1
  v_accvgpr_read_b32 v72, a220
  v_accvgpr_read_b32 v73, a221
  v_accvgpr_read_b32 v74, a222
  v_accvgpr_read_b32 v75, a223
  v_cvt_pk_bf16_f32 v68, v72, v73
  v_cvt_pk_bf16_f32 v69, v74, v75
  v_accvgpr_read_b32 v76, a252
  v_accvgpr_read_b32 v77, a253
  v_accvgpr_read_b32 v78, a254
  v_accvgpr_read_b32 v79, a255
  v_cvt_pk_bf16_f32 v70, v76, v77
  v_cvt_pk_bf16_f32 v71, v78, v79
  buffer_store_dwordx4 v[68:71], v28, s[20:23], s38 offen offset:3072 sc1
  s_add_u32 s38, s38, 258048
  s_branch Lmg_qd_42
Lmg_qd_42:
  s_add_u32 s30, s92, 8
  s_add_u32 s31, s92, 16
  s_cmp_ge_u32 s93, 16
  s_cselect_b32 s30, s30, s31
  s_waitcnt vmcnt(0)
  s_barrier
  s_cmp_lg_u32 s3, 0
  s_cbranch_scc1 Ls_skip_46
  s_lshl_b32 s50, s30, 7
  s_add_u32 s50, s50, 8192
  v_mov_b32 v2, 1
  s_mov_b64 exec, 1
  buffer_atomic_add v2, off, s[88:91], s50
  s_mov_b64 exec, -1
Ls_skip_46:
  s_branch Lmg_next_3
Lmg_t2_28:
  s_mov_b32 s85, 0
Lmg_rb_47:
  s_mov_b32 s92, s85
  s_barrier
  s_lshr_b32 s30, s92, 1
  s_cmp_lg_u32 s3, 0
  s_cbranch_scc1 Lw_skip_48
  s_mov_b64 exec, 1
  s_lshl_b32 s50, s30, 7
  s_add_u32 s50, s50, 10240
  s_mov_b32 s52, 0
Lw_lp_49:
  buffer_load_dword v2, off, s[88:91], s50 sc1
  s_waitcnt vmcnt(0)
  v_readfirstlane_b32 s51, v2
  s_add_u32 s52, s52, 1
  s_cmp_gt_u32 s52, 2000000
  s_cbranch_scc1 Lw_lp_49_x
  s_cmp_ge_u32 s51, 16
  s_cbranch_scc1 Lw_lp_49_x
  s_sleep 4
  s_branch Lw_lp_49
Lw_lp_49_x:
  s_lshl_b32 s50, s30, 7
  s_add_u32 s50, s50, 9216
  s_mov_b32 s52, 0
Lw_lp_50:
  buffer_load_dword v2, off, s[88:91], s50 sc1
  s_waitcnt vmcnt(0)
  v_readfirstlane_b32 s51, v2
  s_add_u32 s52, s52, 1
  s_cmp_gt_u32 s52, 2000000
  s_cbranch_scc1 Lw_lp_50_x
  s_cmp_ge_u32 s51, 32
  s_cbranch_scc1 Lw_lp_50_x
  s_sleep 4
  s_branch Lw_lp_50
Lw_lp_50_x:
  s_mov_b64 exec, -1
Lw_skip_48:
  s_barrier
  v_and_b32 v1, 63, v0
  s_lshl_b32 s30, s92, 2
  s_lshr_b32 s31, s93, 3
  s_add_u32 s30, s30, s31
  s_and_b32 s31, s93, 7
  s_lshl_b32 s31, s31, 2
  s_add_u32 s31, s31, s3
  s_add_u32 s12, s98, 0x252000
  s_addc_u32 s13, s99, 0
  s_mov_b32 s14, 0x1000000
  s_mov_b32 s15, 0x20000
  s_add_u32 s16, s98, 0x1252000
  s_addc_u32 s17, s99, 0
  s_mov_b32 s18, 0x1000000
  s_mov_b32 s19, 0x20000
  s_add_u32 s20, s98, 0x2252000
  s_addc_u32 s21, s99, 0
  s_mov_b32 s22, 0x1000000
  s_mov_b32 s23, 0x20000
  s_add_u32 s24, s98, 0x3252000
  s_addc_u32 s25, s99, 0
  s_mov_b32 s26, 0x400000
  s_mov_b32 s27, 0x20000
  s_add_u32 s52, s98, 0x3652000
  s_addc_u32 s53, s99, 0
  s_mov_b32 s54, 0x400000
  s_mov_b32 s55, 0x20000
  s_add_u32 s56, s98, 0x3a52000
  s_addc_u32 s57, s99, 0
  s_mov_b32 s58, 0x1000000
  s_mov_b32 s59, 0x20000
  v_and_b32 v2, 15, v1
  v_lshrrev_b32 v3, 4, v1
  v_lshlrev_b32 v4, 4, v1
  v_add_u32 v5, 4096, v4
  v_and_b32 v6, 7, v1
  v_lshlrev_b32 v6, 4, v6
  v_lshl_add_u32 v6, v3, 7, v6
  v_and_b32 v8, 1, v3
  v_lshlrev_b32 v8, 6, v8
  v_lshl_add_u32 v8, v2, 2, v8
  s_lshl_b32 s34, s30, 18
  s_lshl_b32 s35, s31, 8
  s_add_u32 s34, s34, s35
  s_lshl_b32 s35, s30, 5
  s_add_u32 s35, s35, s31
  s_lshl_b32 s36, s35, 11
  s_lshl_b32 s37, s35, 13
  s_add_u32 s38, s37, 4096
  buffer_load_dwordx4 v[16:19], v4, s[12:15], s37 offen offset:0
  buffer_load_dwordx4 v[20:23], v4, s[12:15], s37 offen offset:1024
  buffer_load_dwordx4 v[24:27], v4, s[12:15], s37 offen offset:2048
  buffer_load_dwordx4 v[28:31], v4, s[12:15], s37 offen offset:3072
  buffer_load_dwordx4 v[32:35], v5, s[12:15], s37 offen offset:0
  buffer_load_dwordx4 v[36:39], v5, s[12:15], s37 offen offset:1024
  buffer_load_dwordx4 v[40:43], v5, s[12:15], s37 offen offset:2048
  buffer_load_dwordx4 v[44:47], v5, s[12:15], s37 offen offset:3072
  buffer_load_dwordx4 v[48:51], v4, s[16:19], s37 offen offset:0
  buffer_load_dwordx4 v[52:55], v4, s[16:19], s37 offen offset:1024
  buffer_load_dwordx4 v[56:59], v4, s[16:19], s37 offen offset:2048
  buffer_load_dwordx4 v[60:63], v4, s[16:19], s37 offen offset:3072
  buffer_load_dwordx4 v[64:67], v5, s[16:19], s37 offen offset:0
  buffer_load_dwordx4 v[68:71], v5, s[16:19], s37 offen offset:1024
  buffer_load_dwordx4 v[72:75], v5, s[16:19], s37 offen offset:2048
  buffer_load_dwordx4 v[76:79], v5, s[16:19], s37 offen offset:3072
  buffer_load_dwordx4 v[96:99], v4, s[20:23], s37 offen offset:0
  buffer_load_dwordx4 v[100:103], v4, s[20:23], s37 offen offset:1024
  buffer_load_dwordx4 v[104:107], v4, s[20:23], s37 offen offset:2048
  buffer_load_dwordx4 v[108:111], v4, s[20:23], s37 offen offset:3072
  buffer_load_dwordx4 v[112:115], v5, s[20:23], s37 offen offset:0
  buffer_load_dwordx4 v[116:119], v5, s[20:23], s37 offen offset:1024
  buffer_load_dwordx4 v[120:123], v5, s[20:23], s37 offen offset:2048
  buffer_load_dwordx4 v[124:127], v5, s[20:23], s37 offen offset:3072
  s_cmp_lg_u32 s3, 0
  s_cbranch_scc1 Lw_skip_51
  s_mov_b64 exec, 1
  s_lshl_b32 s50, s92, 7
  s_add_u32 s50, s50, 11264
  s_mov_b32 s52, 0
Lw_lp_52:
  buffer_load_dword v2, off, s[88:91], s50 sc1
  s_waitcnt vmcnt(0)
  v_readfirstlane_b32 s51, v2
  s_add_u32 s52, s52, 1
  s_cmp_gt_u32 s52, 2000000
  s_cbranch_scc1 Lw_lp_52_x
  s_cmp_ge_u32 s51, 32
  s_cbranch_scc1 Lw_lp_52_x
  s_sleep 4
  s_branch Lw_lp_52
Lw_lp_52_x:
  s_mov_b64 exec, -1
Lw_skip_51:
  s_barrier
  s_add_u32 s52, s98, 0x3652000
  s_addc_u32 s53, s99, 0
  s_mov_b32 s54, 0x400000
  s_mov_b32 s55, 0x20000
  v_and_b32 v2, 15, v1
  buffer_load_dwordx4 v[80:83], v6, s[24:27], s36 offen offset:0
  buffer_load_dwordx4 v[84:87], v6, s[24:27], s36 offen offset:512
  buffer_load_dwordx4 v[88:91], v6, s[24:27], s36 offen offset:1024
  buffer_load_dwordx4 v[92:95], v6, s[24:27], s36 offen offset:1536
  buffer_load_dword v128, v8, s[52:55], s36 offen offset:0
  buffer_load_dword v129, v8, s[52:55], s36 offen offset:128
  buffer_load_dword v130, v8, s[52:55], s36 offen offset:256
  buffer_load_dword v131, v8, s[52:55], s36 offen offset:384
  buffer_load_dword v132, v8, s[52:55], s36 offen offset:512
  buffer_load_dword v133, v8, s[52:55], s36 offen offset:640
  buffer_load_dword v134, v8, s[52:55], s36 offen offset:768
  buffer_load_dword v135, v8, s[52:55], s36 offen offset:896
  buffer_load_dword v136, v8, s[52:55], s36 offen offset:1024
  buffer_load_dword v137, v8, s[52:55], s36 offen offset:1152
  buffer_load_dword v138, v8, s[52:55], s36 offen offset:1280
  buffer_load_dword v139, v8, s[52:55], s36 offen offset:1408
  buffer_load_dword v140, v8, s[52:55], s36 offen offset:1536
  buffer_load_dword v141, v8, s[52:55], s36 offen offset:1664
  buffer_load_dword v142, v8, s[52:55], s36 offen offset:1792
  buffer_load_dword v143, v8, s[52:55], s36 offen offset:1920
  v_lshlrev_b32 v9, 2, v3
  v_add_u32 v10, 0, v9
  v_cmp_le_u32 s[60:61], v10, v2
  v_add_u32 v10, 1, v9
  v_cmp_le_u32 s[62:63], v10, v2
  v_add_u32 v10, 2, v9
  v_cmp_le_u32 s[64:65], v10, v2
  v_add_u32 v10, 3, v9
  v_cmp_le_u32 s[66:67], v10, v2
  v_cmp_gt_u32 s[68:69], 2, v3
  v_mov_b32 v11, 0xff800000
  s_mov_b32 s70, 0x3db504f3
  s_mov_b32 s71, 0x3fb8aa3b
  v_and_b32 v13, 15, v1
  s_mov_b32 s40, 8192
  v_mul_lo_u32 v12, v13, s40
  v_bfe_u32 v13, v1, 4, 1
  v_lshl_add_u32 v12, v13, 5, v12
  v_bfe_u32 v13, v1, 5, 1
  v_lshl_add_u32 v12, v13, 4, v12
  v_add_u32 v13, 0x20000, v12
  s_waitcnt vmcnt(16)
  v_mfma_f32_16x16x32_bf16 v[144:147], v[80:83], v[16:19], 0
  v_mfma_f32_16x16x32_bf16 v[148:151], v[48:51], v[16:19], 0
  v_mfma_f32_16x16x32_bf16 v[144:147], v[84:87], v[20:23], v[144:147]
  v_mfma_f32_16x16x32_bf16 v[148:151], v[52:55], v[20:23], v[148:151]
  v_mfma_f32_16x16x32_bf16 v[144:147], v[88:91], v[24:27], v[144:147]
  v_mfma_f32_16x16x32_bf16 v[148:151], v[56:59], v[24:27], v[148:151]
  v_mfma_f32_16x16x32_bf16 v[144:147], v[92:95], v[28:31], v[144:147]
  v_mfma_f32_16x16x32_bf16 v[148:151], v[60:63], v[28:31], v[148:151]
  s_nop 7
  v_cvt_pk_bf16_f32 v156, v144, v145
  v_lshlrev_b32 v144, 16, v156
  v_and_b32 v145, 0xffff0000, v156
  v_cvt_pk_bf16_f32 v156, v146, v147
  v_lshlrev_b32 v146, 16, v156
  v_and_b32 v147, 0xffff0000, v156
  v_cvt_pk_bf16_f32 v156, v148, v149
  v_lshlrev_b32 v148, 16, v156
  v_and_b32 v149, 0xffff0000, v156
  v_cvt_pk_bf16_f32 v156, v150, v151
  v_lshlrev_b32 v150, 16, v156
  v_and_b32 v151, 0xffff0000, v156
  v_mul_f32 v144, s70, v144
  v_mul_f32 v145, s70, v145
  v_mul_f32 v146, s70, v146
  v_mul_f32 v147, s70, v147
  v_mul_f32 v148, s70, v148
  v_mul_f32 v149, s70, v149
  v_mul_f32 v150, s70, v150
  v_mul_f32 v151, s70, v151
  v_cvt_pk_bf16_f32 v156, v144, v145
  v_lshlrev_b32 v144, 16, v156
  v_and_b32 v145, 0xffff0000, v156
  v_cvt_pk_bf16_f32 v156, v146, v147
  v_lshlrev_b32 v146, 16, v156
  v_and_b32 v147, 0xffff0000, v156
  v_cvt_pk_bf16_f32 v156, v148, v149
  v_lshlrev_b32 v148, 16, v156
  v_and_b32 v149, 0xffff0000, v156
  v_cvt_pk_bf16_f32 v156, v150, v151
  v_lshlrev_b32 v150, 16, v156
  v_and_b32 v151, 0xffff0000, v156
  v_cndmask_b32 v144, v11, v144, s[68:69]
  v_cndmask_b32 v148, v11, v148, s[60:61]
  v_cndmask_b32 v145, v11, v145, s[68:69]
  v_cndmask_b32 v149, v11, v149, s[62:63]
  v_cndmask_b32 v146, v11, v146, s[68:69]
  v_cndmask_b32 v150, v11, v150, s[64:65]
  v_cndmask_b32 v147, v11, v147, s[68:69]
  v_cndmask_b32 v151, v11, v151, s[66:67]
  v_max3_f32 v156, v144, v145, v146
  v_max3_f32 v156, v156, v147, v148
  v_max3_f32 v156, v156, v149, v150
  v_max_f32 v156, v156, v151
  v_mov_b32 v157, v156
  s_nop 1
  v_permlane16_swap_b32 v156, v157
  s_nop 0
  v_max_f32 v156, v156, v157
  v_mov_b32 v157, v156
  s_nop 1
  v_permlane32_swap_b32 v156, v157
  s_nop 0
  v_max_f32 v156, v156, v157
  v_mul_f32 v156, s71, v156
  v_fma_f32 v144, v144, s71, -v156
  v_fma_f32 v145, v145, s71, -v156
  v_fma_f32 v146, v146, s71, -v156
  v_fma_f32 v147, v147, s71, -v156
  v_fma_f32 v148, v148, s71, -v156
  v_fma_f32 v149, v149, s71, -v156
  v_fma_f32 v150, v150, s71, -v156
  v_fma_f32 v151, v151, s71, -v156
  v_exp_f32 v144, v144
  v_exp_f32 v145, v145
  v_exp_f32 v146, v146
  v_exp_f32 v147, v147
  v_exp_f32 v148, v148
  v_exp_f32 v149, v149
  v_exp_f32 v150, v150
  v_exp_f32 v151, v151
  s_nop 0
  v_add_f32 v156, v144, v145
  v_add_f32 v156, v156, v146
  v_add_f32 v156, v156, v147
  v_add_f32 v156, v156, v148
  v_add_f32 v156, v156, v149
  v_add_f32 v156, v156, v150
  v_add_f32 v156, v156, v151
  v_mov_b32 v157, v156
  s_nop 1
  v_permlane16_swap_b32 v156, v157
  s_nop 0
  v_add_f32 v156, v156, v157
  v_mov_b32 v157, v156
  s_nop 1
  v_permlane32_swap_b32 v156, v157
  s_nop 0
  v_add_f32 v156, v156, v157
  v_rcp_f32 v156, v156
  s_nop 0
  v_mul_f32 v144, v144, v156
  v_mul_f32 v145, v145, v156
  v_mul_f32 v146, v146, v156
  v_mul_f32 v147, v147, v156
  v_mul_f32 v148, v148, v156
  v_mul_f32 v149, v149, v156
  v_mul_f32 v150, v150, v156
  v_mul_f32 v151, v151, v156
  v_cvt_pk_bf16_f32 v158, v144, v145
  v_cvt_pk_bf16_f32 v159, v146, v147
  v_cvt_pk_bf16_f32 v160, v148, v149
  v_cvt_pk_bf16_f32 v161, v150, v151
  v_mov_b32 v162, 0
  v_mov_b32 v163, 0
  s_waitcnt vmcnt(0)
  s_nop 1
  v_mfma_f32_16x16x16_bf16 v[176:179], v[128:129], v[158:159], 0
  v_mfma_f32_16x16x16_bf16 v[180:183], v[130:131], v[158:159], 0
  v_mfma_f32_16x16x16_bf16 v[184:187], v[132:133], v[158:159], 0
  v_mfma_f32_16x16x16_bf16 v[188:191], v[134:135], v[158:159], 0
  v_mfma_f32_16x16x16_bf16 v[192:195], v[136:137], v[158:159], 0
  v_mfma_f32_16x16x16_bf16 v[196:199], v[138:139], v[158:159], 0
  v_mfma_f32_16x16x16_bf16 v[200:203], v[140:141], v[158:159], 0
  v_mfma_f32_16x16x16_bf16 v[204:207], v[142:143], v[158:159], 0
  v_mfma_f32_16x16x32_bf16 v[176:179], v[96:99], v[160:163], v[176:179]
  v_mfma_f32_16x16x32_bf16 v[180:183], v[100:103], v[160:163], v[180:183]
  v_mfma_f32_16x16x32_bf16 v[184:187], v[104:107], v[160:163], v[184:187]
  v_mfma_f32_16x16x32_bf16 v[188:191], v[108:111], v[160:163], v[188:191]
  v_mfma_f32_16x16x32_bf16 v[192:195], v[112:115], v[160:163], v[192:195]
  v_mfma_f32_16x16x32_bf16 v[196:199], v[116:119], v[160:163], v[196:199]
  v_mfma_f32_16x16x32_bf16 v[200:203], v[120:123], v[160:163], v[200:203]
  v_mfma_f32_16x16x32_bf16 v[204:207], v[124:127], v[160:163], v[204:207]
  s_nop 7
  v_cvt_pk_bf16_f32 v208, v176, v177
  v_cvt_pk_bf16_f32 v209, v178, v179
  v_cvt_pk_bf16_f32 v210, v180, v181
  v_cvt_pk_bf16_f32 v211, v182, v183
  s_nop 1
  v_permlane16_swap_b32 v208, v210
  v_permlane16_swap_b32 v209, v211
  buffer_store_dwordx4 v[208:211], v12, s[56:59], s34 offen offset:0 sc1
  v_cvt_pk_bf16_f32 v212, v184, v185
  v_cvt_pk_bf16_f32 v213, v186, v187
  v_cvt_pk_bf16_f32 v214, v188, v189
  v_cvt_pk_bf16_f32 v215, v190, v191
  s_nop 1
  v_permlane16_swap_b32 v212, v214
  v_permlane16_swap_b32 v213, v215
  buffer_store_dwordx4 v[212:215], v12, s[56:59], s34 offen offset:64 sc1
  v_cvt_pk_bf16_f32 v216, v192, v193
  v_cvt_pk_bf16_f32 v217, v194, v195
  v_cvt_pk_bf16_f32 v218, v196, v197
  v_cvt_pk_bf16_f32 v219, v198, v199
  s_nop 1
  v_permlane16_swap_b32 v216, v218
  v_permlane16_swap_b32 v217, v219
  buffer_store_dwordx4 v[216:219], v12, s[56:59], s34 offen offset:128 sc1
  v_cvt_pk_bf16_f32 v220, v200, v201
  v_cvt_pk_bf16_f32 v221, v202, v203
  v_cvt_pk_bf16_f32 v222, v204, v205
  v_cvt_pk_bf16_f32 v223, v206, v207
  s_nop 1
  v_permlane16_swap_b32 v220, v222
  v_permlane16_swap_b32 v221, v223
  buffer_store_dwordx4 v[220:223], v12, s[56:59], s34 offen offset:192 sc1
  v_mfma_f32_16x16x32_bf16 v[144:147], v[80:83], v[32:35], 0
  v_mfma_f32_16x16x32_bf16 v[148:151], v[48:51], v[32:35], 0
  v_mfma_f32_16x16x32_bf16 v[152:155], v[64:67], v[32:35], 0
  v_mfma_f32_16x16x32_bf16 v[144:147], v[84:87], v[36:39], v[144:147]
  v_mfma_f32_16x16x32_bf16 v[148:151], v[52:55], v[36:39], v[148:151]
  v_mfma_f32_16x16x32_bf16 v[152:155], v[68:71], v[36:39], v[152:155]
  v_mfma_f32_16x16x32_bf16 v[144:147], v[88:91], v[40:43], v[144:147]
  v_mfma_f32_16x16x32_bf16 v[148:151], v[56:59], v[40:43], v[148:151]
  v_mfma_f32_16x16x32_bf16 v[152:155], v[72:75], v[40:43], v[152:155]
  v_mfma_f32_16x16x32_bf16 v[144:147], v[92:95], v[44:47], v[144:147]
  v_mfma_f32_16x16x32_bf16 v[148:151], v[60:63], v[44:47], v[148:151]
  v_mfma_f32_16x16x32_bf16 v[152:155], v[76:79], v[44:47], v[152:155]
  s_nop 7
  v_cvt_pk_bf16_f32 v156, v144, v145
  v_lshlrev_b32 v144, 16, v156
  v_and_b32 v145, 0xffff0000, v156
  v_cvt_pk_bf16_f32 v156, v146, v147
  v_lshlrev_b32 v146, 16, v156
  v_and_b32 v147, 0xffff0000, v156
  v_cvt_pk_bf16_f32 v156, v148, v149
  v_lshlrev_b32 v148, 16, v156
  v_and_b32 v149, 0xffff0000, v156
  v_cvt_pk_bf16_f32 v156, v150, v151
  v_lshlrev_b32 v150, 16, v156
  v_and_b32 v151, 0xffff0000, v156
  v_cvt_pk_bf16_f32 v156, v152, v153
  v_lshlrev_b32 v152, 16, v156
  v_and_b32 v153, 0xffff0000, v156
  v_cvt_pk_bf16_f32 v156, v154, v155
  v_lshlrev_b32 v154, 16, v156
  v_and_b32 v155, 0xffff0000, v156
  v_mul_f32 v144, s70, v144
  v_mul_f32 v145, s70, v145
  v_mul_f32 v146, s70, v146
  v_mul_f32 v147, s70, v147
  v_mul_f32 v148, s70, v148
  v_mul_f32 v149, s70, v149
  v_mul_f32 v150, s70, v150
  v_mul_f32 v151, s70, v151
  v_mul_f32 v152, s70, v152
  v_mul_f32 v153, s70, v153
  v_mul_f32 v154, s70, v154
  v_mul_f32 v155, s70, v155
  v_cvt_pk_bf16_f32 v156, v144, v145
  v_lshlrev_b32 v144, 16, v156
  v_and_b32 v145, 0xffff0000, v156
  v_cvt_pk_bf16_f32 v156, v146, v147
  v_lshlrev_b32 v146, 16, v156
  v_and_b32 v147, 0xffff0000, v156
  v_cvt_pk_bf16_f32 v156, v148, v149
  v_lshlrev_b32 v148, 16, v156
  v_and_b32 v149, 0xffff0000, v156
  v_cvt_pk_bf16_f32 v156, v150, v151
  v_lshlrev_b32 v150, 16, v156
  v_and_b32 v151, 0xffff0000, v156
  v_cvt_pk_bf16_f32 v156, v152, v153
  v_lshlrev_b32 v152, 16, v156
  v_and_b32 v153, 0xffff0000, v156
  v_cvt_pk_bf16_f32 v156, v154, v155
  v_lshlrev_b32 v154, 16, v156
  v_and_b32 v155, 0xffff0000, v156
  v_cndmask_b32 v144, v11, v144, s[68:69]
  v_cndmask_b32 v152, v11, v152, s[60:61]
  v_cndmask_b32 v145, v11, v145, s[68:69]
  v_cndmask_b32 v153, v11, v153, s[62:63]
  v_cndmask_b32 v146, v11, v146, s[68:69]
  v_cndmask_b32 v154, v11, v154, s[64:65]
  v_cndmask_b32 v147, v11, v147, s[68:69]
  v_cndmask_b32 v155, v11, v155, s[66:67]
  v_max3_f32 v156, v144, v145, v146
  v_max3_f32 v156, v156, v147, v148
  v_max3_f32 v156, v156, v149, v150
  v_max3_f32 v156, v156, v151, v152
  v_max3_f32 v156, v156, v153, v154
  v_max_f32 v156, v156, v155
  v_mov_b32 v157, v156
  s_nop 1
  v_permlane16_swap_b32 v156, v157
  s_nop 0
  v_max_f32 v156, v156, v157
  v_mov_b32 v157, v156
  s_nop 1
  v_permlane32_swap_b32 v156, v157
  s_nop 0
  v_max_f32 v156, v156, v157
  v_mul_f32 v156, s71, v156
  v_fma_f32 v144, v144, s71, -v156
  v_fma_f32 v145, v145, s71, -v156
  v_fma_f32 v146, v146, s71, -v156
  v_fma_f32 v147, v147, s71, -v156
  v_fma_f32 v148, v148, s71, -v156
  v_fma_f32 v149, v149, s71, -v156
  v_fma_f32 v150, v150, s71, -v156
  v_fma_f32 v151, v151, s71, -v156
  v_fma_f32 v152, v152, s71, -v156
  v_fma_f32 v153, v153, s71, -v156
  v_fma_f32 v154, v154, s71, -v156
  v_fma_f32 v155, v155, s71, -v156
  v_exp_f32 v144, v144
  v_exp_f32 v145, v145
  v_exp_f32 v146, v146
  v_exp_f32 v147, v147
  v_exp_f32 v148, v148
  v_exp_f32 v149, v149
  v_exp_f32 v150, v150
  v_exp_f32 v151, v151
  v_exp_f32 v152, v152
  v_exp_f32 v153, v153
  v_exp_f32 v154, v154
  v_exp_f32 v155, v155
  s_nop 0
  v_add_f32 v156, v144, v145
  v_add_f32 v156, v156, v146
  v_add_f32 v156, v156, v147
  v_add_f32 v156, v156, v148
  v_add_f32 v156, v156, v149
  v_add_f32 v156, v156, v150
  v_add_f32 v156, v156, v151
  v_add_f32 v156, v156, v152
  v_add_f32 v156, v156, v153
  v_add_f32 v156, v156, v154
  v_add_f32 v156, v156, v155
  v_mov_b32 v157, v156
  s_nop 1
  v_permlane16_swap_b32 v156, v157
  s_nop 0
  v_add_f32 v156, v156, v157
  v_mov_b32 v157, v156
  s_nop 1
  v_permlane32_swap_b32 v156, v157
  s_nop 0
  v_add_f32 v156, v156, v157
  v_rcp_f32 v156, v156
  s_nop 0
  v_mul_f32 v144, v144, v156
  v_mul_f32 v145, v145, v156
  v_mul_f32 v146, v146, v156
  v_mul_f32 v147, v147, v156
  v_mul_f32 v148, v148, v156
  v_mul_f32 v149, v149, v156
  v_mul_f32 v150, v150, v156
  v_mul_f32 v151, v151, v156
  v_mul_f32 v152, v152, v156
  v_mul_f32 v153, v153, v156
  v_mul_f32 v154, v154, v156
  v_mul_f32 v155, v155, v156
  v_cvt_pk_bf16_f32 v158, v144, v145
  v_cvt_pk_bf16_f32 v159, v146, v147
  v_cvt_pk_bf16_f32 v160, v148, v149
  v_cvt_pk_bf16_f32 v161, v150, v151
  v_cvt_pk_bf16_f32 v162, v152, v153
  v_cvt_pk_bf16_f32 v163, v154, v155
  s_nop 1
  v_mfma_f32_16x16x16_bf16 v[176:179], v[128:129], v[158:159], 0
  v_mfma_f32_16x16x16_bf16 v[180:183], v[130:131], v[158:159], 0
  v_mfma_f32_16x16x16_bf16 v[184:187], v[132:133], v[158:159], 0
  v_mfma_f32_16x16x16_bf16 v[188:191], v[134:135], v[158:159], 0
  v_mfma_f32_16x16x16_bf16 v[192:195], v[136:137], v[158:159], 0
  v_mfma_f32_16x16x16_bf16 v[196:199], v[138:139], v[158:159], 0
  v_mfma_f32_16x16x16_bf16 v[200:203], v[140:141], v[158:159], 0
  v_mfma_f32_16x16x16_bf16 v[204:207], v[142:143], v[158:159], 0
  v_mfma_f32_16x16x32_bf16 v[176:179], v[96:99], v[160:163], v[176:179]
  v_mfma_f32_16x16x32_bf16 v[180:183], v[100:103], v[160:163], v[180:183]
  v_mfma_f32_16x16x32_bf16 v[184:187], v[104:107], v[160:163], v[184:187]
  v_mfma_f32_16x16x32_bf16 v[188:191], v[108:111], v[160:163], v[188:191]
  v_mfma_f32_16x16x32_bf16 v[192:195], v[112:115], v[160:163], v[192:195]
  v_mfma_f32_16x16x32_bf16 v[196:199], v[116:119], v[160:163], v[196:199]
  v_mfma_f32_16x16x32_bf16 v[200:203], v[120:123], v[160:163], v[200:203]
  v_mfma_f32_16x16x32_bf16 v[204:207], v[124:127], v[160:163], v[204:207]
  s_nop 7
  v_cvt_pk_bf16_f32 v224, v176, v177
  v_cvt_pk_bf16_f32 v225, v178, v179
  v_cvt_pk_bf16_f32 v226, v180, v181
  v_cvt_pk_bf16_f32 v227, v182, v183
  s_nop 1
  v_permlane16_swap_b32 v224, v226
  v_permlane16_swap_b32 v225, v227
  buffer_store_dwordx4 v[224:227], v13, s[56:59], s34 offen offset:0 sc1
  v_cvt_pk_bf16_f32 v228, v184, v185
  v_cvt_pk_bf16_f32 v229, v186, v187
  v_cvt_pk_bf16_f32 v230, v188, v189
  v_cvt_pk_bf16_f32 v231, v190, v191
  s_nop 1
  v_permlane16_swap_b32 v228, v230
  v_permlane16_swap_b32 v229, v231
  buffer_store_dwordx4 v[228:231], v13, s[56:59], s34 offen offset:64 sc1
  v_cvt_pk_bf16_f32 v232, v192, v193
  v_cvt_pk_bf16_f32 v233, v194, v195
  v_cvt_pk_bf16_f32 v234, v196, v197
  v_cvt_pk_bf16_f32 v235, v198, v199
  s_nop 1
  v_permlane16_swap_b32 v232, v234
  v_permlane16_swap_b32 v233, v235
  buffer_store_dwordx4 v[232:235], v13, s[56:59], s34 offen offset:128 sc1
  v_cvt_pk_bf16_f32 v236, v200, v201
  v_cvt_pk_bf16_f32 v237, v202, v203
  v_cvt_pk_bf16_f32 v238, v204, v205
  v_cvt_pk_bf16_f32 v239, v206, v207
  s_nop 1
  v_permlane16_swap_b32 v236, v238
  v_permlane16_swap_b32 v237, v239
  buffer_store_dwordx4 v[236:239], v13, s[56:59], s34 offen offset:192 sc1
  s_waitcnt vmcnt(0)
  s_barrier
  s_cmp_lg_u32 s3, 0
  s_cbranch_scc1 Ls_skip_53
  s_lshl_b32 s50, s92, 7
  s_add_u32 s50, s50, 13312
  v_mov_b32 v2, 1
  s_mov_b64 exec, 1
  buffer_atomic_add v2, off, s[88:91], s50
  s_mov_b64 exec, -1
Ls_skip_53:
  s_add_u32 s85, s85, 1
  s_cmp_lt_u32 s85, 16
  s_cbranch_scc1 Lmg_rb_47
  s_branch Lmg_next_3
Lmg_t3_29:
  s_mov_b32 s10, s98
  s_mov_b32 s11, s99
  s_mov_b32 s36, s93
  s_mov_b32 s33, s87
  s_load_dwordx2 s[4:5], s[0:1], 40
  s_waitcnt lgkmcnt(0)
  s_add_u32 s12, s10, 0x3a52000
  s_addc_u32 s13, s11, 0
  s_mov_b32 s14, 0x1000000
  s_mov_b32 s15, 0x20000
  s_mov_b32 s16, s4
  s_mov_b32 s17, s5
  s_mov_b32 s18, 0x480000
  s_mov_b32 s19, 0x20000
  s_add_u32 s20, s10, 0x72d2000
  s_addc_u32 s21, s11, 0
  s_mov_b32 s22, 0x1200000
  s_mov_b32 s23, 0x20000
  v_and_b32 v1, 63, v0
  v_lshrrev_b32 v2, 3, v1
  v_xor_b32 v3, v2, v1
  v_and_b32 v3, 7, v3
  s_mov_b32 s40, 8192
  v_mul_lo_u32 v2, v2, s40
  v_lshl_add_u32 v2, v3, 4, v2
  s_add_u32 s41, s3, 0
  s_mul_i32 s41, s41, 65536
  v_add_u32 v4, s41, v2
  s_add_u32 s41, s3, 4
  s_mul_i32 s41, s41, 65536
  v_add_u32 v5, s41, v2
  s_add_u32 s41, s3, 8
  s_mul_i32 s41, s41, 65536
  v_add_u32 v6, s41, v2
  s_add_u32 s41, s3, 12
  s_mul_i32 s41, s41, 65536
  v_add_u32 v7, s41, v2
  s_add_u32 s41, s3, 0
  s_min_u32 s41, s41, 3
  s_lshl_b32 s41, s41, 6
  v_add_u32 v48, s41, v1
  s_mov_b32 s42, 0x20000000
  v_mul_hi_u32 v49, v48, s42
  v_mul_u32_u24 v50, 8, v49
  v_sub_u32 v50, v48, v50
  v_bfe_u32 v51, v49, 1, 1
  v_bfe_u32 v52, v49, 3, 1
  v_lshl_add_u32 v51, v52, 1, v51
  v_lshrrev_b32 v52, 1, v50
  v_sub_u32 v52, v52, v51
  v_add_u32 v51, 4, v52
  v_cmp_gt_i32 vcc, 0, v52
  s_nop 1
  v_cndmask_b32 v52, v52, v51, vcc
  v_and_b32 v50, 1, v50
  v_lshlrev_b32 v50, 4, v50
  v_lshl_add_u32 v50, v52, 5, v50
  s_mov_b32 s42, 1152
  v_mul_lo_u32 v49, v49, s42
  v_add_u32 v8, v49, v50
  v_and_b32 v2, 15, v1
  v_lshrrev_b32 v48, 4, v1
  v_and_b32 v3, 7, v2
  v_xor_b32 v3, v3, v48
  v_lshlrev_b32 v3, 4, v3
  v_lshl_add_u32 v3, v2, 7, v3
  s_lshr_b32 s41, s3, 1
  s_mul_i32 s41, s41, 8192
  s_add_u32 s41, s41, 32768
  v_add_u32 v9, s41, v3
  v_xor_b32 v10, 64, v9
  v_bfe_u32 v2, v1, 2, 2
  v_lshl_add_u32 v2, v48, 3, v2
  v_bfe_u32 v51, v2, 1, 1
  v_bfe_u32 v52, v2, 3, 1
  v_lshl_add_u32 v51, v52, 1, v51
  v_mul_u32_u24 v2, 128, v2
  v_and_b32 v3, 3, v1
  v_lshl_add_u32 v2, v3, 3, v2
  s_and_b32 s41, s3, 1
  s_mul_i32 s41, s41, 2
  s_add_u32 s42, s41, 0
  v_add_u32 v49, s42, v51
  v_subrev_u32 v50, 4, v49
  v_cmp_le_u32 vcc, 4, v49
  s_nop 1
  v_cndmask_b32 v49, v49, v50, vcc
  v_lshl_add_u32 v11, v49, 5, v2
  s_add_u32 s42, s41, 1
  v_add_u32 v49, s42, v51
  v_subrev_u32 v50, 4, v49
  v_cmp_le_u32 vcc, 4, v49
  s_nop 1
  v_cndmask_b32 v49, v49, v50, vcc
  v_lshl_add_u32 v12, v49, 5, v2
  s_lshl_b32 s44, s3, 10
  s_add_u32 s45, s44, 32768
  s_mov_b32 s85, 0
Lmg_rb_54:
  s_mov_b32 s92, s85
  s_cmp_lg_u32 s3, 0
  s_cbranch_scc1 Lw_skip_55
  s_mov_b64 exec, 1
  s_lshl_b32 s50, s92, 7
  s_add_u32 s50, s50, 13312
  s_mov_b32 s52, 0
Lw_lp_56:
  buffer_load_dword v2, off, s[88:91], s50 sc1
  s_waitcnt vmcnt(0)
  v_readfirstlane_b32 s51, v2
  s_add_u32 s52, s52, 1
  s_cmp_gt_u32 s52, 2000000
  s_cbranch_scc1 Lw_lp_56_x
  s_cmp_ge_u32 s51, 32
  s_cbranch_scc1 Lw_lp_56_x
  s_sleep 4
  s_branch Lw_lp_56
Lw_lp_56_x:
  s_mov_b64 exec, -1
Lw_skip_55:
  s_barrier
  s_mov_b32 s32, s92
  s_mul_i32 s46, s32, 1048576
  s_lshl_b32 s40, s33, 11
  s_add_u32 s46, s46, s40
  s_mul_i32 s47, s33, 1179648
  s_lshl_b32 s40, s36, 7
  s_add_u32 s47, s47, s40
  s_add_u32 m0, s45, 0
  s_nop 0
  buffer_load_dwordx4 v4, s[12:15], s46 offen lds
  s_add_u32 m0, s45, 4096
  s_nop 0
  buffer_load_dwordx4 v5, s[12:15], s46 offen lds
  s_add_u32 m0, s44, 0
  s_nop 0
  buffer_load_dwordx4 v8, s[16:19], s47 offen lds
  s_add_u32 s47, s47, 36864
  s_add_u32 m0, s45, 8192
  s_nop 0
  buffer_load_dwordx4 v6, s[12:15], s46 offen lds
  s_add_u32 m0, s45, 12288
  s_nop 0
  buffer_load_dwordx4 v7, s[12:15], s46 offen lds
  s_add_u32 m0, s44, 4096
  s_nop 0
  buffer_load_dwordx4 v8, s[16:19], s47 offen lds
  s_add_u32 s46, s46, 128
  s_add_u32 s47, s47, 36864
  s_add_u32 m0, s45, 16384
  s_nop 0
  buffer_load_dwordx4 v4, s[12:15], s46 offen lds
  s_add_u32 m0, s45, 20480
  s_nop 0
  buffer_load_dwordx4 v5, s[12:15], s46 offen lds
  s_add_u32 m0, s44, 8192
  s_nop 0
  buffer_load_dwordx4 v8, s[16:19], s47 offen lds
  s_add_u32 s47, s47, 36864
  s_add_u32 m0, s45, 24576
  s_nop 0
  buffer_load_dwordx4 v6, s[12:15], s46 offen lds
  s_add_u32 m0, s45, 28672
  s_nop 0
  buffer_load_dwordx4 v7, s[12:15], s46 offen lds
  s_add_u32 m0, s44, 12288
  s_nop 0
  buffer_load_dwordx4 v8, s[16:19], s47 offen lds
  s_add_u32 s46, s46, 128
  s_add_u32 s47, s47, 36864
  s_add_u32 m0, s45, 32768
  s_nop 0
  buffer_load_dwordx4 v4, s[12:15], s46 offen lds
  s_add_u32 m0, s45, 36864
  s_nop 0
  buffer_load_dwordx4 v5, s[12:15], s46 offen lds
  s_add_u32 m0, s44, 16384
  s_nop 0
  buffer_load_dwordx4 v8, s[16:19], s47 offen lds
  s_add_u32 s47, s47, 36864
  s_add_u32 m0, s45, 40960
  s_nop 0
  buffer_load_dwordx4 v6, s[12:15], s46 offen lds
  s_add_u32 m0, s45, 45056
  s_nop 0
  buffer_load_dwordx4 v7, s[12:15], s46 offen lds
  s_add_u32 m0, s44, 20480
  s_nop 0
  buffer_load_dwordx4 v8, s[16:19], s47 offen lds
  s_add_u32 s46, s46, 128
  s_add_u32 s47, s47, 36864
  s_add_u32 m0, s45, 49152
  s_nop 0
  buffer_load_dwordx4 v4, s[12:15], s46 offen lds
  s_add_u32 m0, s45, 53248
  s_nop 0
  buffer_load_dwordx4 v5, s[12:15], s46 offen lds
  s_add_u32 m0, s44, 24576
  s_nop 0
  buffer_load_dwordx4 v8, s[16:19], s47 offen lds
  s_add_u32 s47, s47, 36864
  s_add_u32 m0, s45, 57344
  s_nop 0
  buffer_load_dwordx4 v6, s[12:15], s46 offen lds
  s_add_u32 m0, s45, 61440
  s_nop 0
  buffer_load_dwordx4 v7, s[12:15], s46 offen lds
  s_add_u32 m0, s44, 28672
  s_nop 0
  buffer_load_dwordx4 v8, s[16:19], s47 offen lds
  s_add_u32 s46, s46, 128
  s_add_u32 s47, s47, 36864
  v_mov_b32 v16, 0
  v_mov_b32 v17, 0
  v_mov_b32 v18, 0
  v_mov_b32 v19, 0
  v_mov_b32 v20, 0
  v_mov_b32 v21, 0
  v_mov_b32 v22, 0
  v_mov_b32 v23, 0
  v_mov_b32 v24, 0
  v_mov_b32 v25, 0
  v_mov_b32 v26, 0
  v_mov_b32 v27, 0
  v_mov_b32 v28, 0
  v_mov_b32 v29, 0
  v_mov_b32 v30, 0
  v_mov_b32 v31, 0
  v_mov_b32 v32, 0
  v_mov_b32 v33, 0
  v_mov_b32 v34, 0
  v_mov_b32 v35, 0
  v_mov_b32 v36, 0
  v_mov_b32 v37, 0
  v_mov_b32 v38, 0
  v_mov_b32 v39, 0
  v_mov_b32 v40, 0
  v_mov_b32 v41, 0
  v_mov_b32 v42, 0
  v_mov_b32 v43, 0
  v_mov_b32 v44, 0
  v_mov_b32 v45, 0
  v_mov_b32 v46, 0
  v_mov_b32 v47, 0
  s_waitcnt vmcnt(18)
  s_barrier
  ds_read_b128 a[0:3], v9 offset:0
  ds_read_b128 a[4:7], v9 offset:2048
  ds_read_b128 a[8:11], v9 offset:4096
  ds_read_b128 a[12:15], v9 offset:6144
  ds_read_b64_tr_b16 a[16:17], v11 offset:0
  ds_read_b64_tr_b16 a[18:19], v11 offset:512
  ds_read_b64_tr_b16 a[20:21], v12 offset:0
  ds_read_b64_tr_b16 a[22:23], v12 offset:512
  s_waitcnt lgkmcnt(0)
  v_mfma_f32_16x16x32_bf16 v[16:19], a[16:19], a[0:3], v[16:19]
  ds_read_b128 a[24:27], v10 offset:0
  ds_read_b128 a[28:31], v10 offset:2048
  v_mfma_f32_16x16x32_bf16 v[20:23], a[20:23], a[0:3], v[20:23]
  ds_read_b128 a[32:35], v10 offset:4096
  ds_read_b128 a[36:39], v10 offset:6144
  v_mfma_f32_16x16x32_bf16 v[24:27], a[16:19], a[4:7], v[24:27]
  ds_read_b64_tr_b16 a[40:41], v11 offset:4096
  ds_read_b64_tr_b16 a[42:43], v11 offset:4608
  v_mfma_f32_16x16x32_bf16 v[28:31], a[20:23], a[4:7], v[28:31]
  ds_read_b64_tr_b16 a[44:45], v12 offset:4096
  ds_read_b64_tr_b16 a[46:47], v12 offset:4608
  v_mfma_f32_16x16x32_bf16 v[32:35], a[16:19], a[8:11], v[32:35]
  v_mfma_f32_16x16x32_bf16 v[36:39], a[20:23], a[8:11], v[36:39]
  v_mfma_f32_16x16x32_bf16 v[40:43], a[16:19], a[12:15], v[40:43]
  v_mfma_f32_16x16x32_bf16 v[44:47], a[20:23], a[12:15], v[44:47]
  s_waitcnt vmcnt(12) lgkmcnt(0)
  s_barrier
  v_mfma_f32_16x16x32_bf16 v[16:19], a[40:43], a[24:27], v[16:19]
  ds_read_b128 a[0:3], v9 offset:16384
  ds_read_b128 a[4:7], v9 offset:18432
  s_add_u32 m0, s45, 0
  v_mfma_f32_16x16x32_bf16 v[20:23], a[44:47], a[24:27], v[20:23]
  ds_read_b128 a[8:11], v9 offset:20480
  ds_read_b128 a[12:15], v9 offset:22528
  buffer_load_dwordx4 v4, s[12:15], s46 offen lds
  v_mfma_f32_16x16x32_bf16 v[24:27], a[40:43], a[28:31], v[24:27]
  ds_read_b64_tr_b16 a[16:17], v11 offset:8192
  ds_read_b64_tr_b16 a[18:19], v11 offset:8704
  s_add_u32 m0, s45, 4096
  v_mfma_f32_16x16x32_bf16 v[28:31], a[44:47], a[28:31], v[28:31]
  ds_read_b64_tr_b16 a[20:21], v12 offset:8192
  ds_read_b64_tr_b16 a[22:23], v12 offset:8704
  buffer_load_dwordx4 v5, s[12:15], s46 offen lds
  v_mfma_f32_16x16x32_bf16 v[32:35], a[40:43], a[32:35], v[32:35]
  s_add_u32 m0, s44, 0
  v_mfma_f32_16x16x32_bf16 v[36:39], a[44:47], a[32:35], v[36:39]
  buffer_load_dwordx4 v8, s[16:19], s47 offen lds
  v_mfma_f32_16x16x32_bf16 v[40:43], a[40:43], a[36:39], v[40:43]
  s_add_u32 s47, s47, 36864
  v_mfma_f32_16x16x32_bf16 v[44:47], a[44:47], a[36:39], v[44:47]
  s_mov_b32 s48, 2
Lwos_57_loop:
  s_waitcnt lgkmcnt(0)
  v_mfma_f32_16x16x32_bf16 v[16:19], a[16:19], a[0:3], v[16:19]
  ds_read_b128 a[24:27], v10 offset:16384
  ds_read_b128 a[28:31], v10 offset:18432
  s_add_u32 m0, s45, 8192
  v_mfma_f32_16x16x32_bf16 v[20:23], a[20:23], a[0:3], v[20:23]
  ds_read_b128 a[32:35], v10 offset:20480
  ds_read_b128 a[36:39], v10 offset:22528
  buffer_load_dwordx4 v6, s[12:15], s46 offen lds
  v_mfma_f32_16x16x32_bf16 v[24:27], a[16:19], a[4:7], v[24:27]
  ds_read_b64_tr_b16 a[40:41], v11 offset:12288
  ds_read_b64_tr_b16 a[42:43], v11 offset:12800
  s_add_u32 m0, s45, 12288
  v_mfma_f32_16x16x32_bf16 v[28:31], a[20:23], a[4:7], v[28:31]
  ds_read_b64_tr_b16 a[44:45], v12 offset:12288
  ds_read_b64_tr_b16 a[46:47], v12 offset:12800
  buffer_load_dwordx4 v7, s[12:15], s46 offen lds
  v_mfma_f32_16x16x32_bf16 v[32:35], a[16:19], a[8:11], v[32:35]
  s_add_u32 m0, s44, 4096
  v_mfma_f32_16x16x32_bf16 v[36:39], a[20:23], a[8:11], v[36:39]
  buffer_load_dwordx4 v8, s[16:19], s47 offen lds
  v_mfma_f32_16x16x32_bf16 v[40:43], a[16:19], a[12:15], v[40:43]
  s_add_u32 s46, s46, 128
  s_add_u32 s47, s47, 36864
  v_mfma_f32_16x16x32_bf16 v[44:47], a[20:23], a[12:15], v[44:47]
  s_waitcnt vmcnt(12) lgkmcnt(0)
  s_barrier
  v_mfma_f32_16x16x32_bf16 v[16:19], a[40:43], a[24:27], v[16:19]
  ds_read_b128 a[0:3], v9 offset:32768
  ds_read_b128 a[4:7], v9 offset:34816
  s_add_u32 m0, s45, 16384
  v_mfma_f32_16x16x32_bf16 v[20:23], a[44:47], a[24:27], v[20:23]
  ds_read_b128 a[8:11], v9 offset:36864
  ds_read_b128 a[12:15], v9 offset:38912
  buffer_load_dwordx4 v4, s[12:15], s46 offen lds
  v_mfma_f32_16x16x32_bf16 v[24:27], a[40:43], a[28:31], v[24:27]
  ds_read_b64_tr_b16 a[16:17], v11 offset:16384
  ds_read_b64_tr_b16 a[18:19], v11 offset:16896
  s_add_u32 m0, s45, 20480
  v_mfma_f32_16x16x32_bf16 v[28:31], a[44:47], a[28:31], v[28:31]
  ds_read_b64_tr_b16 a[20:21], v12 offset:16384
  ds_read_b64_tr_b16 a[22:23], v12 offset:16896
  buffer_load_dwordx4 v5, s[12:15], s46 offen lds
  v_mfma_f32_16x16x32_bf16 v[32:35], a[40:43], a[32:35], v[32:35]
  s_add_u32 m0, s44, 8192
  v_mfma_f32_16x16x32_bf16 v[36:39], a[44:47], a[32:35], v[36:39]
  buffer_load_dwordx4 v8, s[16:19], s47 offen lds
  v_mfma_f32_16x16x32_bf16 v[40:43], a[40:43], a[36:39], v[40:43]
  s_add_u32 s47, s47, 36864
  v_mfma_f32_16x16x32_bf16 v[44:47], a[44:47], a[36:39], v[44:47]
  s_waitcnt lgkmcnt(0)
  v_mfma_f32_16x16x32_bf16 v[16:19], a[16:19], a[0:3], v[16:19]
  ds_read_b128 a[24:27], v10 offset:32768
  ds_read_b128 a[28:31], v10 offset:34816
  s_add_u32 m0, s45, 24576
  v_mfma_f32_16x16x32_bf16 v[20:23], a[20:23], a[0:3], v[20:23]
  ds_read_b128 a[32:35], v10 offset:36864
  ds_read_b128 a[36:39], v10 offset:38912
  buffer_load_dwordx4 v6, s[12:15], s46 offen lds
  v_mfma_f32_16x16x32_bf16 v[24:27], a[16:19], a[4:7], v[24:27]
  ds_read_b64_tr_b16 a[40:41], v11 offset:20480
  ds_read_b64_tr_b16 a[42:43], v11 offset:20992
  s_add_u32 m0, s45, 28672
  v_mfma_f32_16x16x32_bf16 v[28:31], a[20:23], a[4:7], v[28:31]
  ds_read_b64_tr_b16 a[44:45], v12 offset:20480
  ds_read_b64_tr_b16 a[46:47], v12 offset:20992
  buffer_load_dwordx4 v7, s[12:15], s46 offen lds
  v_mfma_f32_16x16x32_bf16 v[32:35], a[16:19], a[8:11], v[32:35]
  s_add_u32 m0, s44, 12288
  v_mfma_f32_16x16x32_bf16 v[36:39], a[20:23], a[8:11], v[36:39]
  buffer_load_dwordx4 v8, s[16:19], s47 offen lds
  v_mfma_f32_16x16x32_bf16 v[40:43], a[16:19], a[12:15], v[40:43]
  s_add_u32 s46, s46, 128
  s_add_u32 s47, s47, 36864
  v_mfma_f32_16x16x32_bf16 v[44:47], a[20:23], a[12:15], v[44:47]
  s_waitcnt vmcnt(12) lgkmcnt(0)
  s_barrier
  v_mfma_f32_16x16x32_bf16 v[16:19], a[40:43], a[24:27], v[16:19]
  ds_read_b128 a[0:3], v9 offset:49152
  ds_read_b128 a[4:7], v9 offset:51200
  s_add_u32 m0, s45, 32768
  v_mfma_f32_16x16x32_bf16 v[20:23], a[44:47], a[24:27], v[20:23]
  ds_read_b128 a[8:11], v9 offset:53248
  ds_read_b128 a[12:15], v9 offset:55296
  buffer_load_dwordx4 v4, s[12:15], s46 offen lds
  v_mfma_f32_16x16x32_bf16 v[24:27], a[40:43], a[28:31], v[24:27]
  ds_read_b64_tr_b16 a[16:17], v11 offset:24576
  ds_read_b64_tr_b16 a[18:19], v11 offset:25088
  s_add_u32 m0, s45, 36864
  v_mfma_f32_16x16x32_bf16 v[28:31], a[44:47], a[28:31], v[28:31]
  ds_read_b64_tr_b16 a[20:21], v12 offset:24576
  ds_read_b64_tr_b16 a[22:23], v12 offset:25088
  buffer_load_dwordx4 v5, s[12:15], s46 offen lds
  v_mfma_f32_16x16x32_bf16 v[32:35], a[40:43], a[32:35], v[32:35]
  s_add_u32 m0, s44, 16384
  v_mfma_f32_16x16x32_bf16 v[36:39], a[44:47], a[32:35], v[36:39]
  buffer_load_dwordx4 v8, s[16:19], s47 offen lds
  v_mfma_f32_16x16x32_bf16 v[40:43], a[40:43], a[36:39], v[40:43]
  s_add_u32 s47, s47, 36864
  v_mfma_f32_16x16x32_bf16 v[44:47], a[44:47], a[36:39], v[44:47]
  s_waitcnt lgkmcnt(0)
  v_mfma_f32_16x16x32_bf16 v[16:19], a[16:19], a[0:3], v[16:19]
  ds_read_b128 a[24:27], v10 offset:49152
  ds_read_b128 a[28:31], v10 offset:51200
  s_add_u32 m0, s45, 40960
  v_mfma_f32_16x16x32_bf16 v[20:23], a[20:23], a[0:3], v[20:23]
  ds_read_b128 a[32:35], v10 offset:53248
  ds_read_b128 a[36:39], v10 offset:55296
  buffer_load_dwordx4 v6, s[12:15], s46 offen lds
  v_mfma_f32_16x16x32_bf16 v[24:27], a[16:19], a[4:7], v[24:27]
  ds_read_b64_tr_b16 a[40:41], v11 offset:28672
  ds_read_b64_tr_b16 a[42:43], v11 offset:29184
  s_add_u32 m0, s45, 45056
  v_mfma_f32_16x16x32_bf16 v[28:31], a[20:23], a[4:7], v[28:31]
  ds_read_b64_tr_b16 a[44:45], v12 offset:28672
  ds_read_b64_tr_b16 a[46:47], v12 offset:29184
  buffer_load_dwordx4 v7, s[12:15], s46 offen lds
  v_mfma_f32_16x16x32_bf16 v[32:35], a[16:19], a[8:11], v[32:35]
  s_add_u32 m0, s44, 20480
  v_mfma_f32_16x16x32_bf16 v[36:39], a[20:23], a[8:11], v[36:39]
  buffer_load_dwordx4 v8, s[16:19], s47 offen lds
  v_mfma_f32_16x16x32_bf16 v[40:43], a[16:19], a[12:15], v[40:43]
  s_add_u32 s46, s46, 128
  s_add_u32 s47, s47, 36864
  v_mfma_f32_16x16x32_bf16 v[44:47], a[20:23], a[12:15], v[44:47]
  s_waitcnt vmcnt(12) lgkmcnt(0)
  s_barrier
  v_mfma_f32_16x16x32_bf16 v[16:19], a[40:43], a[24:27], v[16:19]
  ds_read_b128 a[0:3], v9 offset:0
  ds_read_b128 a[4:7], v9 offset:2048
  s_add_u32 m0, s45, 49152
  v_mfma_f32_16x16x32_bf16 v[20:23], a[44:47], a[24:27], v[20:23]
  ds_read_b128 a[8:11], v9 offset:4096
  ds_read_b128 a[12:15], v9 offset:6144
  buffer_load_dwordx4 v4, s[12:15], s46 offen lds
  v_mfma_f32_16x16x32_bf16 v[24:27], a[40:43], a[28:31], v[24:27]
  ds_read_b64_tr_b16 a[16:17], v11 offset:0
  ds_read_b64_tr_b16 a[18:19], v11 offset:512
  s_add_u32 m0, s45, 53248
  v_mfma_f32_16x16x32_bf16 v[28:31], a[44:47], a[28:31], v[28:31]
  ds_read_b64_tr_b16 a[20:21], v12 offset:0
  ds_read_b64_tr_b16 a[22:23], v12 offset:512
  buffer_load_dwordx4 v5, s[12:15], s46 offen lds
  v_mfma_f32_16x16x32_bf16 v[32:35], a[40:43], a[32:35], v[32:35]
  s_add_u32 m0, s44, 24576
  v_mfma_f32_16x16x32_bf16 v[36:39], a[44:47], a[32:35], v[36:39]
  buffer_load_dwordx4 v8, s[16:19], s47 offen lds
  v_mfma_f32_16x16x32_bf16 v[40:43], a[40:43], a[36:39], v[40:43]
  s_add_u32 s47, s47, 36864
  v_mfma_f32_16x16x32_bf16 v[44:47], a[44:47], a[36:39], v[44:47]
  s_waitcnt lgkmcnt(0)
  v_mfma_f32_16x16x32_bf16 v[16:19], a[16:19], a[0:3], v[16:19]
  ds_read_b128 a[24:27], v10 offset:0
  ds_read_b128 a[28:31], v10 offset:2048
  s_add_u32 m0, s45, 57344
  v_mfma_f32_16x16x32_bf16 v[20:23], a[20:23], a[0:3], v[20:23]
  ds_read_b128 a[32:35], v10 offset:4096
  ds_read_b128 a[36:39], v10 offset:6144
  buffer_load_dwordx4 v6, s[12:15], s46 offen lds
  v_mfma_f32_16x16x32_bf16 v[24:27], a[16:19], a[4:7], v[24:27]
  ds_read_b64_tr_b16 a[40:41], v11 offset:4096
  ds_read_b64_tr_b16 a[42:43], v11 offset:4608
  s_add_u32 m0, s45, 61440
  v_mfma_f32_16x16x32_bf16 v[28:31], a[20:23], a[4:7], v[28:31]
  ds_read_b64_tr_b16 a[44:45], v12 offset:4096
  ds_read_b64_tr_b16 a[46:47], v12 offset:4608
  buffer_load_dwordx4 v7, s[12:15], s46 offen lds
  v_mfma_f32_16x16x32_bf16 v[32:35], a[16:19], a[8:11], v[32:35]
  s_add_u32 m0, s44, 28672
  v_mfma_f32_16x16x32_bf16 v[36:39], a[20:23], a[8:11], v[36:39]
  buffer_load_dwordx4 v8, s[16:19], s47 offen lds
  v_mfma_f32_16x16x32_bf16 v[40:43], a[16:19], a[12:15], v[40:43]
  s_add_u32 s46, s46, 128
  s_add_u32 s47, s47, 36864
  v_mfma_f32_16x16x32_bf16 v[44:47], a[20:23], a[12:15], v[44:47]
  s_waitcnt vmcnt(12) lgkmcnt(0)
  s_barrier
  v_mfma_f32_16x16x32_bf16 v[16:19], a[40:43], a[24:27], v[16:19]
  ds_read_b128 a[0:3], v9 offset:16384
  ds_read_b128 a[4:7], v9 offset:18432
  s_add_u32 m0, s45, 0
  v_mfma_f32_16x16x32_bf16 v[20:23], a[44:47], a[24:27], v[20:23]
  ds_read_b128 a[8:11], v9 offset:20480
  ds_read_b128 a[12:15], v9 offset:22528
  buffer_load_dwordx4 v4, s[12:15], s46 offen lds
  v_mfma_f32_16x16x32_bf16 v[24:27], a[40:43], a[28:31], v[24:27]
  ds_read_b64_tr_b16 a[16:17], v11 offset:8192
  ds_read_b64_tr_b16 a[18:19], v11 offset:8704
  s_add_u32 m0, s45, 4096
  v_mfma_f32_16x16x32_bf16 v[28:31], a[44:47], a[28:31], v[28:31]
  ds_read_b64_tr_b16 a[20:21], v12 offset:8192
  ds_read_b64_tr_b16 a[22:23], v12 offset:8704
  buffer_load_dwordx4 v5, s[12:15], s46 offen lds
  v_mfma_f32_16x16x32_bf16 v[32:35], a[40:43], a[32:35], v[32:35]
  s_add_u32 m0, s44, 0
  v_mfma_f32_16x16x32_bf16 v[36:39], a[44:47], a[32:35], v[36:39]
  buffer_load_dwordx4 v8, s[16:19], s47 offen lds
  v_mfma_f32_16x16x32_bf16 v[40:43], a[40:43], a[36:39], v[40:43]
  s_add_u32 s47, s47, 36864
  v_mfma_f32_16x16x32_bf16 v[44:47], a[44:47], a[36:39], v[44:47]
  s_sub_u32 s48, s48, 1
  s_cmp_lg_u32 s48, 0
  s_cbranch_scc1 Lwos_57_loop
  s_waitcnt lgkmcnt(0)
  v_mfma_f32_16x16x32_bf16 v[16:19], a[16:19], a[0:3], v[16:19]
  ds_read_b128 a[24:27], v10 offset:16384
  ds_read_b128 a[28:31], v10 offset:18432
  s_add_u32 m0, s45, 8192
  v_mfma_f32_16x16x32_bf16 v[20:23], a[20:23], a[0:3], v[20:23]
  ds_read_b128 a[32:35], v10 offset:20480
  ds_read_b128 a[36:39], v10 offset:22528
  buffer_load_dwordx4 v6, s[12:15], s46 offen lds
  v_mfma_f32_16x16x32_bf16 v[24:27], a[16:19], a[4:7], v[24:27]
  ds_read_b64_tr_b16 a[40:41], v11 offset:12288
  ds_read_b64_tr_b16 a[42:43], v11 offset:12800
  s_add_u32 m0, s45, 12288
  v_mfma_f32_16x16x32_bf16 v[28:31], a[20:23], a[4:7], v[28:31]
  ds_read_b64_tr_b16 a[44:45], v12 offset:12288
  ds_read_b64_tr_b16 a[46:47], v12 offset:12800
  buffer_load_dwordx4 v7, s[12:15], s46 offen lds
  v_mfma_f32_16x16x32_bf16 v[32:35], a[16:19], a[8:11], v[32:35]
  s_add_u32 m0, s44, 4096
  v_mfma_f32_16x16x32_bf16 v[36:39], a[20:23], a[8:11], v[36:39]
  buffer_load_dwordx4 v8, s[16:19], s47 offen lds
  v_mfma_f32_16x16x32_bf16 v[40:43], a[16:19], a[12:15], v[40:43]
  s_add_u32 s46, s46, 128
  s_add_u32 s47, s47, 36864
  v_mfma_f32_16x16x32_bf16 v[44:47], a[20:23], a[12:15], v[44:47]
  s_waitcnt vmcnt(12) lgkmcnt(0)
  s_barrier
  v_mfma_f32_16x16x32_bf16 v[16:19], a[40:43], a[24:27], v[16:19]
  ds_read_b128 a[0:3], v9 offset:32768
  ds_read_b128 a[4:7], v9 offset:34816
  s_add_u32 m0, s45, 16384
  v_mfma_f32_16x16x32_bf16 v[20:23], a[44:47], a[24:27], v[20:23]
  ds_read_b128 a[8:11], v9 offset:36864
  ds_read_b128 a[12:15], v9 offset:38912
  buffer_load_dwordx4 v4, s[12:15], s46 offen lds
  v_mfma_f32_16x16x32_bf16 v[24:27], a[40:43], a[28:31], v[24:27]
  ds_read_b64_tr_b16 a[16:17], v11 offset:16384
  ds_read_b64_tr_b16 a[18:19], v11 offset:16896
  s_add_u32 m0, s45, 20480
  v_mfma_f32_16x16x32_bf16 v[28:31], a[44:47], a[28:31], v[28:31]
  ds_read_b64_tr_b16 a[20:21], v12 offset:16384
  ds_read_b64_tr_b16 a[22:23], v12 offset:16896
  buffer_load_dwordx4 v5, s[12:15], s46 offen lds
  v_mfma_f32_16x16x32_bf16 v[32:35], a[40:43], a[32:35], v[32:35]
  s_add_u32 m0, s44, 8192
  v_mfma_f32_16x16x32_bf16 v[36:39], a[44:47], a[32:35], v[36:39]
  buffer_load_dwordx4 v8, s[16:19], s47 offen lds
  v_mfma_f32_16x16x32_bf16 v[40:43], a[40:43], a[36:39], v[40:43]
  s_add_u32 s47, s47, 36864
  v_mfma_f32_16x16x32_bf16 v[44:47], a[44:47], a[36:39], v[44:47]
  s_waitcnt lgkmcnt(0)
  v_mfma_f32_16x16x32_bf16 v[16:19], a[16:19], a[0:3], v[16:19]
  ds_read_b128 a[24:27], v10 offset:32768
  ds_read_b128 a[28:31], v10 offset:34816
  s_add_u32 m0, s45, 24576
  v_mfma_f32_16x16x32_bf16 v[20:23], a[20:23], a[0:3], v[20:23]
  ds_read_b128 a[32:35], v10 offset:36864
  ds_read_b128 a[36:39], v10 offset:38912
  buffer_load_dwordx4 v6, s[12:15], s46 offen lds
  v_mfma_f32_16x16x32_bf16 v[24:27], a[16:19], a[4:7], v[24:27]
  ds_read_b64_tr_b16 a[40:41], v11 offset:20480
  ds_read_b64_tr_b16 a[42:43], v11 offset:20992
  s_add_u32 m0, s45, 28672
  v_mfma_f32_16x16x32_bf16 v[28:31], a[20:23], a[4:7], v[28:31]
  ds_read_b64_tr_b16 a[44:45], v12 offset:20480
  ds_read_b64_tr_b16 a[46:47], v12 offset:20992
  buffer_load_dwordx4 v7, s[12:15], s46 offen lds
  v_mfma_f32_16x16x32_bf16 v[32:35], a[16:19], a[8:11], v[32:35]
  s_add_u32 m0, s44, 12288
  v_mfma_f32_16x16x32_bf16 v[36:39], a[20:23], a[8:11], v[36:39]
  buffer_load_dwordx4 v8, s[16:19], s47 offen lds
  v_mfma_f32_16x16x32_bf16 v[40:43], a[16:19], a[12:15], v[40:43]
  s_add_u32 s46, s46, 128
  s_add_u32 s47, s47, 36864
  v_mfma_f32_16x16x32_bf16 v[44:47], a[20:23], a[12:15], v[44:47]
  s_waitcnt vmcnt(12) lgkmcnt(0)
  s_barrier
  v_mfma_f32_16x16x32_bf16 v[16:19], a[40:43], a[24:27], v[16:19]
  ds_read_b128 a[0:3], v9 offset:49152
  ds_read_b128 a[4:7], v9 offset:51200
  s_add_u32 m0, s45, 32768
  v_mfma_f32_16x16x32_bf16 v[20:23], a[44:47], a[24:27], v[20:23]
  ds_read_b128 a[8:11], v9 offset:53248
  ds_read_b128 a[12:15], v9 offset:55296
  buffer_load_dwordx4 v4, s[12:15], s46 offen lds
  v_mfma_f32_16x16x32_bf16 v[24:27], a[40:43], a[28:31], v[24:27]
  ds_read_b64_tr_b16 a[16:17], v11 offset:24576
  ds_read_b64_tr_b16 a[18:19], v11 offset:25088
  s_add_u32 m0, s45, 36864
  v_mfma_f32_16x16x32_bf16 v[28:31], a[44:47], a[28:31], v[28:31]
  ds_read_b64_tr_b16 a[20:21], v12 offset:24576
  ds_read_b64_tr_b16 a[22:23], v12 offset:25088
  buffer_load_dwordx4 v5, s[12:15], s46 offen lds
  v_mfma_f32_16x16x32_bf16 v[32:35], a[40:43], a[32:35], v[32:35]
  s_add_u32 m0, s44, 16384
  v_mfma_f32_16x16x32_bf16 v[36:39], a[44:47], a[32:35], v[36:39]
  buffer_load_dwordx4 v8, s[16:19], s47 offen lds
  v_mfma_f32_16x16x32_bf16 v[40:43], a[40:43], a[36:39], v[40:43]
  s_add_u32 s47, s47, 36864
  v_mfma_f32_16x16x32_bf16 v[44:47], a[44:47], a[36:39], v[44:47]
  s_waitcnt lgkmcnt(0)
  v_mfma_f32_16x16x32_bf16 v[16:19], a[16:19], a[0:3], v[16:19]
  ds_read_b128 a[24:27], v10 offset:49152
  ds_read_b128 a[28:31], v10 offset:51200
  s_add_u32 m0, s45, 40960
  v_mfma_f32_16x16x32_bf16 v[20:23], a[20:23], a[0:3], v[20:23]
  ds_read_b128 a[32:35], v10 offset:53248
  ds_read_b128 a[36:39], v10 offset:55296
  buffer_load_dwordx4 v6, s[12:15], s46 offen lds
  v_mfma_f32_16x16x32_bf16 v[24:27], a[16:19], a[4:7], v[24:27]
  ds_read_b64_tr_b16 a[40:41], v11 offset:28672
  ds_read_b64_tr_b16 a[42:43], v11 offset:29184
  s_add_u32 m0, s45, 45056
  v_mfma_f32_16x16x32_bf16 v[28:31], a[20:23], a[4:7], v[28:31]
  ds_read_b64_tr_b16 a[44:45], v12 offset:28672
  ds_read_b64_tr_b16 a[46:47], v12 offset:29184
  buffer_load_dwordx4 v7, s[12:15], s46 offen lds
  v_mfma_f32_16x16x32_bf16 v[32:35], a[16:19], a[8:11], v[32:35]
  s_add_u32 m0, s44, 20480
  v_mfma_f32_16x16x32_bf16 v[36:39], a[20:23], a[8:11], v[36:39]
  buffer_load_dwordx4 v8, s[16:19], s47 offen lds
  v_mfma_f32_16x16x32_bf16 v[40:43], a[16:19], a[12:15], v[40:43]
  s_add_u32 s46, s46, 128
  s_add_u32 s47, s47, 36864
  v_mfma_f32_16x16x32_bf16 v[44:47], a[20:23], a[12:15], v[44:47]
  s_waitcnt vmcnt(12) lgkmcnt(0)
  s_barrier
  v_mfma_f32_16x16x32_bf16 v[16:19], a[40:43], a[24:27], v[16:19]
  ds_read_b128 a[0:3], v9 offset:0
  ds_read_b128 a[4:7], v9 offset:2048
  s_add_u32 m0, s45, 49152
  v_mfma_f32_16x16x32_bf16 v[20:23], a[44:47], a[24:27], v[20:23]
  ds_read_b128 a[8:11], v9 offset:4096
  ds_read_b128 a[12:15], v9 offset:6144
  buffer_load_dwordx4 v4, s[12:15], s46 offen lds
  v_mfma_f32_16x16x32_bf16 v[24:27], a[40:43], a[28:31], v[24:27]
  ds_read_b64_tr_b16 a[16:17], v11 offset:0
  ds_read_b64_tr_b16 a[18:19], v11 offset:512
  s_add_u32 m0, s45, 53248
  v_mfma_f32_16x16x32_bf16 v[28:31], a[44:47], a[28:31], v[28:31]
  ds_read_b64_tr_b16 a[20:21], v12 offset:0
  ds_read_b64_tr_b16 a[22:23], v12 offset:512
  buffer_load_dwordx4 v5, s[12:15], s46 offen lds
  v_mfma_f32_16x16x32_bf16 v[32:35], a[40:43], a[32:35], v[32:35]
  s_add_u32 m0, s44, 24576
  v_mfma_f32_16x16x32_bf16 v[36:39], a[44:47], a[32:35], v[36:39]
  buffer_load_dwordx4 v8, s[16:19], s47 offen lds
  v_mfma_f32_16x16x32_bf16 v[40:43], a[40:43], a[36:39], v[40:43]
  s_add_u32 s47, s47, 36864
  v_mfma_f32_16x16x32_bf16 v[44:47], a[44:47], a[36:39], v[44:47]
  s_waitcnt lgkmcnt(0)
  v_mfma_f32_16x16x32_bf16 v[16:19], a[16:19], a[0:3], v[16:19]
  ds_read_b128 a[24:27], v10 offset:0
  ds_read_b128 a[28:31], v10 offset:2048
  s_add_u32 m0, s45, 57344
  v_mfma_f32_16x16x32_bf16 v[20:23], a[20:23], a[0:3], v[20:23]
  ds_read_b128 a[32:35], v10 offset:4096
  ds_read_b128 a[36:39], v10 offset:6144
  buffer_load_dwordx4 v6, s[12:15], s46 offen lds
  v_mfma_f32_16x16x32_bf16 v[24:27], a[16:19], a[4:7], v[24:27]
  ds_read_b64_tr_b16 a[40:41], v11 offset:4096
  ds_read_b64_tr_b16 a[42:43], v11 offset:4608
  s_add_u32 m0, s45, 61440
  v_mfma_f32_16x16x32_bf16 v[28:31], a[20:23], a[4:7], v[28:31]
  ds_read_b64_tr_b16 a[44:45], v12 offset:4096
  ds_read_b64_tr_b16 a[46:47], v12 offset:4608
  buffer_load_dwordx4 v7, s[12:15], s46 offen lds
  v_mfma_f32_16x16x32_bf16 v[32:35], a[16:19], a[8:11], v[32:35]
  s_add_u32 m0, s44, 28672
  v_mfma_f32_16x16x32_bf16 v[36:39], a[20:23], a[8:11], v[36:39]
  buffer_load_dwordx4 v8, s[16:19], s47 offen lds
  v_mfma_f32_16x16x32_bf16 v[40:43], a[16:19], a[12:15], v[40:43]
  s_add_u32 s46, s46, 128
  s_add_u32 s47, s47, 36864
  v_mfma_f32_16x16x32_bf16 v[44:47], a[20:23], a[12:15], v[44:47]
  s_waitcnt vmcnt(12) lgkmcnt(0)
  s_barrier
  v_mfma_f32_16x16x32_bf16 v[16:19], a[40:43], a[24:27], v[16:19]
  ds_read_b128 a[0:3], v9 offset:16384
  ds_read_b128 a[4:7], v9 offset:18432
  v_mfma_f32_16x16x32_bf16 v[20:23], a[44:47], a[24:27], v[20:23]
  ds_read_b128 a[8:11], v9 offset:20480
  ds_read_b128 a[12:15], v9 offset:22528
  v_mfma_f32_16x16x32_bf16 v[24:27], a[40:43], a[28:31], v[24:27]
  ds_read_b64_tr_b16 a[16:17], v11 offset:8192
  ds_read_b64_tr_b16 a[18:19], v11 offset:8704
  v_mfma_f32_16x16x32_bf16 v[28:31], a[44:47], a[28:31], v[28:31]
  ds_read_b64_tr_b16 a[20:21], v12 offset:8192
  ds_read_b64_tr_b16 a[22:23], v12 offset:8704
  v_mfma_f32_16x16x32_bf16 v[32:35], a[40:43], a[32:35], v[32:35]
  v_mfma_f32_16x16x32_bf16 v[36:39], a[44:47], a[32:35], v[36:39]
  v_mfma_f32_16x16x32_bf16 v[40:43], a[40:43], a[36:39], v[40:43]
  v_mfma_f32_16x16x32_bf16 v[44:47], a[44:47], a[36:39], v[44:47]
  s_waitcnt lgkmcnt(0)
  v_mfma_f32_16x16x32_bf16 v[16:19], a[16:19], a[0:3], v[16:19]
  ds_read_b128 a[24:27], v10 offset:16384
  ds_read_b128 a[28:31], v10 offset:18432
  v_mfma_f32_16x16x32_bf16 v[20:23], a[20:23], a[0:3], v[20:23]
  ds_read_b128 a[32:35], v10 offset:20480
  ds_read_b128 a[36:39], v10 offset:22528
  v_mfma_f32_16x16x32_bf16 v[24:27], a[16:19], a[4:7], v[24:27]
  ds_read_b64_tr_b16 a[40:41], v11 offset:12288
  ds_read_b64_tr_b16 a[42:43], v11 offset:12800
  v_mfma_f32_16x16x32_bf16 v[28:31], a[20:23], a[4:7], v[28:31]
  ds_read_b64_tr_b16 a[44:45], v12 offset:12288
  ds_read_b64_tr_b16 a[46:47], v12 offset:12800
  v_mfma_f32_16x16x32_bf16 v[32:35], a[16:19], a[8:11], v[32:35]
  v_mfma_f32_16x16x32_bf16 v[36:39], a[20:23], a[8:11], v[36:39]
  v_mfma_f32_16x16x32_bf16 v[40:43], a[16:19], a[12:15], v[40:43]
  v_mfma_f32_16x16x32_bf16 v[44:47], a[20:23], a[12:15], v[44:47]
  s_waitcnt vmcnt(6) lgkmcnt(0)
  s_barrier
  v_mfma_f32_16x16x32_bf16 v[16:19], a[40:43], a[24:27], v[16:19]
  ds_read_b128 a[0:3], v9 offset:32768
  ds_read_b128 a[4:7], v9 offset:34816
  v_mfma_f32_16x16x32_bf16 v[20:23], a[44:47], a[24:27], v[20:23]
  ds_read_b128 a[8:11], v9 offset:36864
  ds_read_b128 a[12:15], v9 offset:38912
  v_mfma_f32_16x16x32_bf16 v[24:27], a[40:43], a[28:31], v[24:27]
  ds_read_b64_tr_b16 a[16:17], v11 offset:16384
  ds_read_b64_tr_b16 a[18:19], v11 offset:16896
  v_mfma_f32_16x16x32_bf16 v[28:31], a[44:47], a[28:31], v[28:31]
  ds_read_b64_tr_b16 a[20:21], v12 offset:16384
  ds_read_b64_tr_b16 a[22:23], v12 offset:16896
  v_mfma_f32_16x16x32_bf16 v[32:35], a[40:43], a[32:35], v[32:35]
  v_mfma_f32_16x16x32_bf16 v[36:39], a[44:47], a[32:35], v[36:39]
  v_mfma_f32_16x16x32_bf16 v[40:43], a[40:43], a[36:39], v[40:43]
  v_mfma_f32_16x16x32_bf16 v[44:47], a[44:47], a[36:39], v[44:47]
  s_waitcnt lgkmcnt(0)
  v_mfma_f32_16x16x32_bf16 v[16:19], a[16:19], a[0:3], v[16:19]
  ds_read_b128 a[24:27], v10 offset:32768
  ds_read_b128 a[28:31], v10 offset:34816
  v_mfma_f32_16x16x32_bf16 v[20:23], a[20:23], a[0:3], v[20:23]
  ds_read_b128 a[32:35], v10 offset:36864
  ds_read_b128 a[36:39], v10 offset:38912
  v_mfma_f32_16x16x32_bf16 v[24:27], a[16:19], a[4:7], v[24:27]
  ds_read_b64_tr_b16 a[40:41], v11 offset:20480
  ds_read_b64_tr_b16 a[42:43], v11 offset:20992
  v_mfma_f32_16x16x32_bf16 v[28:31], a[20:23], a[4:7], v[28:31]
  ds_read_b64_tr_b16 a[44:45], v12 offset:20480
  ds_read_b64_tr_b16 a[46:47], v12 offset:20992
  v_mfma_f32_16x16x32_bf16 v[32:35], a[16:19], a[8:11], v[32:35]
  v_mfma_f32_16x16x32_bf16 v[36:39], a[20:23], a[8:11], v[36:39]
  v_mfma_f32_16x16x32_bf16 v[40:43], a[16:19], a[12:15], v[40:43]
  v_mfma_f32_16x16x32_bf16 v[44:47], a[20:23], a[12:15], v[44:47]
  s_waitcnt vmcnt(0) lgkmcnt(0)
  s_barrier
  v_mfma_f32_16x16x32_bf16 v[16:19], a[40:43], a[24:27], v[16:19]
  ds_read_b128 a[0:3], v9 offset:49152
  ds_read_b128 a[4:7], v9 offset:51200
  v_mfma_f32_16x16x32_bf16 v[20:23], a[44:47], a[24:27], v[20:23]
  ds_read_b128 a[8:11], v9 offset:53248
  ds_read_b128 a[12:15], v9 offset:55296
  v_mfma_f32_16x16x32_bf16 v[24:27], a[40:43], a[28:31], v[24:27]
  ds_read_b64_tr_b16 a[16:17], v11 offset:24576
  ds_read_b64_tr_b16 a[18:19], v11 offset:25088
  v_mfma_f32_16x16x32_bf16 v[28:31], a[44:47], a[28:31], v[28:31]
  ds_read_b64_tr_b16 a[20:21], v12 offset:24576
  ds_read_b64_tr_b16 a[22:23], v12 offset:25088
  v_mfma_f32_16x16x32_bf16 v[32:35], a[40:43], a[32:35], v[32:35]
  v_mfma_f32_16x16x32_bf16 v[36:39], a[44:47], a[32:35], v[36:39]
  v_mfma_f32_16x16x32_bf16 v[40:43], a[40:43], a[36:39], v[40:43]
  v_mfma_f32_16x16x32_bf16 v[44:47], a[44:47], a[36:39], v[44:47]
  s_waitcnt lgkmcnt(0)
  v_mfma_f32_16x16x32_bf16 v[16:19], a[16:19], a[0:3], v[16:19]
  ds_read_b128 a[24:27], v10 offset:49152
  ds_read_b128 a[28:31], v10 offset:51200
  v_mfma_f32_16x16x32_bf16 v[20:23], a[20:23], a[0:3], v[20:23]
  ds_read_b128 a[32:35], v10 offset:53248
  ds_read_b128 a[36:39], v10 offset:55296
  v_mfma_f32_16x16x32_bf16 v[24:27], a[16:19], a[4:7], v[24:27]
  ds_read_b64_tr_b16 a[40:41], v11 offset:28672
  ds_read_b64_tr_b16 a[42:43], v11 offset:29184
  v_mfma_f32_16x16x32_bf16 v[28:31], a[20:23], a[4:7], v[28:31]
  ds_read_b64_tr_b16 a[44:45], v12 offset:28672
  ds_read_b64_tr_b16 a[46:47], v12 offset:29184
  v_mfma_f32_16x16x32_bf16 v[32:35], a[16:19], a[8:11], v[32:35]
  v_mfma_f32_16x16x32_bf16 v[36:39], a[20:23], a[8:11], v[36:39]
  v_mfma_f32_16x16x32_bf16 v[40:43], a[16:19], a[12:15], v[40:43]
  v_mfma_f32_16x16x32_bf16 v[44:47], a[20:23], a[12:15], v[44:47]
  s_waitcnt lgkmcnt(0)
  v_mfma_f32_16x16x32_bf16 v[16:19], a[40:43], a[24:27], v[16:19]
  v_mfma_f32_16x16x32_bf16 v[20:23], a[44:47], a[24:27], v[20:23]
  v_mfma_f32_16x16x32_bf16 v[24:27], a[40:43], a[28:31], v[24:27]
  v_mfma_f32_16x16x32_bf16 v[28:31], a[44:47], a[28:31], v[28:31]
  v_mfma_f32_16x16x32_bf16 v[32:35], a[40:43], a[32:35], v[32:35]
  v_mfma_f32_16x16x32_bf16 v[36:39], a[44:47], a[32:35], v[36:39]
  v_mfma_f32_16x16x32_bf16 v[40:43], a[40:43], a[36:39], v[40:43]
  v_mfma_f32_16x16x32_bf16 v[44:47], a[44:47], a[36:39], v[44:47]
  s_nop 7
  s_nop 7
  v_and_b32 v49, 15, v1
  s_mov_b32 s40, 2304
  v_mul_lo_u32 v48, v49, s40
  v_lshrrev_b32 v49, 4, v1
  v_lshl_add_u32 v48, v49, 4, v48
  s_lshr_b32 s40, s3, 1
  s_lshl_b32 s40, s40, 6
  s_lshl_b32 s41, s32, 7
  s_add_u32 s40, s40, s41
  s_mul_i32 s40, s40, 2304
  s_and_b32 s41, s3, 1
  s_lshl_b32 s41, s41, 5
  s_lshl_b32 s42, s36, 6
  s_add_u32 s41, s41, s42
  s_lshl_b32 s41, s41, 2
  s_add_u32 s38, s40, s41
  s_mul_i32 s40, s33, 4718592
  s_add_u32 s38, s38, s40
  buffer_store_dwordx4 v[16:19], v48, s[20:23], s38 offen offset:0 sc1
  buffer_store_dwordx4 v[20:23], v48, s[20:23], s38 offen offset:64 sc1
  s_add_u32 s38, s38, 36864
  buffer_store_dwordx4 v[24:27], v48, s[20:23], s38 offen offset:0 sc1
  buffer_store_dwordx4 v[28:31], v48, s[20:23], s38 offen offset:64 sc1
  s_add_u32 s38, s38, 36864
  buffer_store_dwordx4 v[32:35], v48, s[20:23], s38 offen offset:0 sc1
  buffer_store_dwordx4 v[36:39], v48, s[20:23], s38 offen offset:64 sc1
  s_add_u32 s38, s38, 36864
  buffer_store_dwordx4 v[40:43], v48, s[20:23], s38 offen offset:0 sc1
  buffer_store_dwordx4 v[44:47], v48, s[20:23], s38 offen offset:64 sc1
  s_add_u32 s38, s38, 36864
  s_waitcnt vmcnt(0)
  s_barrier
  s_cmp_lg_u32 s3, 0
  s_cbranch_scc1 Ls_skip_58
  s_lshl_b32 s50, s92, 7
  s_add_u32 s50, s50, 15360
  v_mov_b32 v2, 1
  s_mov_b64 exec, 1
  buffer_atomic_add v2, off, s[88:91], s50
  s_mov_b64 exec, -1
Ls_skip_58:
  s_add_u32 s85, s85, 1
  s_cmp_lt_u32 s85, 16
  s_cbranch_scc1 Lmg_rb_54
  s_branch Lmg_next_3
Lmg_t4_30:
  s_mov_b32 s85, 0
Lmg_rb_59:
  s_mov_b32 s92, s85
  s_barrier
  s_cmp_lg_u32 s3, 0
  s_cbranch_scc1 Lw_skip_60
  s_mov_b64 exec, 1
  s_lshl_b32 s50, s92, 7
  s_add_u32 s50, s50, 15360
  s_mov_b32 s52, 0
Lw_lp_61:
  buffer_load_dword v2, off, s[88:91], s50 sc1
  s_waitcnt vmcnt(0)
  v_readfirstlane_b32 s51, v2
  s_add_u32 s52, s52, 1
  s_cmp_gt_u32 s52, 2000000
  s_cbranch_scc1 Lw_lp_61_x
  s_cmp_ge_u32 s51, 36
  s_cbranch_scc1 Lw_lp_61_x
  s_sleep 4
  s_branch Lw_lp_61
Lw_lp_61_x:
  s_mov_b64 exec, -1
Lw_skip_60:
  s_barrier
  s_load_dwordx2 s[4:5], s[0:1], 0
  s_waitcnt lgkmcnt(0)
  s_mov_b32 s12, s4
  s_mov_b32 s13, s5
  s_mov_b32 s14, 0x240000
  s_mov_b32 s15, 0x20000
  s_add_u32 s16, s98, 0x4c92000
  s_addc_u32 s17, s99, 0
  s_mov_b32 s18, 0x240000
  s_mov_b32 s19, 0x20000
  s_add_u32 s20, s98, 0x10000
  s_addc_u32 s21, s99, 0
  s_mov_b32 s22, 0x1b00
  s_mov_b32 s23, 0x20000
  s_add_u32 s24, s98, 0x72d2000
  s_addc_u32 s25, s99, 0
  s_mov_b32 s26, 0x1200000
  s_mov_b32 s27, 0x20000
  s_add_u32 s52, s98, 0x4a52000
  s_addc_u32 s53, s99, 0
  s_mov_b32 s54, 0x240000
  s_mov_b32 s55, 0x20000
  s_lshl_b32 s30, s92, 3
  s_add_u32 s30, s30, s93
  v_and_b32 v1, 15, v0
  v_lshrrev_b32 v2, 4, v0
  s_lshl_b32 s28, s30, 4
  v_add_u32 v2, s28, v2
  s_movk_i32 s29, 1152
  v_mul_lo_u32 v2, v2, s29
  v_lshl_add_u32 v3, v1, 4, v2
  v_lshlrev_b32 v4, 4, v1
  v_cmp_gt_u32 vcc, 8, v1
  v_mov_b32 v5, 0x7ffffff0
  s_nop 0
  v_cndmask_b32 v6, v5, v3, vcc
  v_cndmask_b32 v7, v5, v4, vcc
  v_cndmask_b32 v9, 0, 1.0, vcc
  buffer_load_dwordx4 v[12:15], v3, s[12:15], 0 offen offset:0
  buffer_load_dwordx4 v[16:19], v3, s[12:15], 0 offen offset:256
  buffer_load_dwordx4 v[20:23], v3, s[12:15], 0 offen offset:512
  buffer_load_dwordx4 v[24:27], v3, s[12:15], 0 offen offset:768
  buffer_load_dwordx4 v[28:31], v6, s[12:15], 0 offen offset:1024
  s_mov_b32 s29, 2304
  buffer_load_dwordx4 v[32:35], v4, s[20:23], s29 offen offset:0
  buffer_load_dwordx4 v[36:39], v4, s[20:23], s29 offen offset:256
  buffer_load_dwordx4 v[40:43], v4, s[20:23], s29 offen offset:512
  buffer_load_dwordx4 v[44:47], v4, s[20:23], s29 offen offset:768
  buffer_load_dwordx4 v[48:51], v7, s[20:23], s29 offen offset:1024
  v_lshlrev_b32 v94, 1, v3
  v_cndmask_b32 v95, v5, v94, vcc
  s_mov_b32 s29, 0
  buffer_load_dwordx4 v[96:99], v94, s[24:27], s29 offen
  buffer_load_dwordx4 v[100:103], v94, s[24:27], s29 offen offset:16
  s_mov_b32 s29, 4718592
  buffer_load_dwordx4 v[104:107], v94, s[24:27], s29 offen
  buffer_load_dwordx4 v[108:111], v94, s[24:27], s29 offen offset:16
  s_mov_b32 s29, 9437184
  buffer_load_dwordx4 v[112:115], v94, s[24:27], s29 offen
  buffer_load_dwordx4 v[116:119], v94, s[24:27], s29 offen offset:16
  s_mov_b32 s29, 14155776
  buffer_load_dwordx4 v[120:123], v94, s[24:27], s29 offen
  buffer_load_dwordx4 v[124:127], v94, s[24:27], s29 offen offset:16
  s_mov_b32 s29, 512
  buffer_load_dwordx4 v[128:131], v94, s[24:27], s29 offen
  buffer_load_dwordx4 v[132:135], v94, s[24:27], s29 offen offset:16
  s_mov_b32 s29, 4719104
  buffer_load_dwordx4 v[136:139], v94, s[24:27], s29 offen
  buffer_load_dwordx4 v[140:143], v94, s[24:27], s29 offen offset:16
  s_mov_b32 s29, 9437696
  buffer_load_dwordx4 v[144:147], v94, s[24:27], s29 offen
  buffer_load_dwordx4 v[148:151], v94, s[24:27], s29 offen offset:16
  s_mov_b32 s29, 14156288
  buffer_load_dwordx4 v[152:155], v94, s[24:27], s29 offen
  buffer_load_dwordx4 v[156:159], v94, s[24:27], s29 offen offset:16
  s_mov_b32 s29, 1024
  buffer_load_dwordx4 v[160:163], v94, s[24:27], s29 offen
  buffer_load_dwordx4 v[164:167], v94, s[24:27], s29 offen offset:16
  s_mov_b32 s29, 4719616
  buffer_load_dwordx4 v[168:171], v94, s[24:27], s29 offen
  buffer_load_dwordx4 v[172:175], v94, s[24:27], s29 offen offset:16
  s_mov_b32 s29, 9438208
  buffer_load_dwordx4 v[176:179], v94, s[24:27], s29 offen
  buffer_load_dwordx4 v[180:183], v94, s[24:27], s29 offen offset:16
  s_mov_b32 s29, 14156800
  buffer_load_dwordx4 v[184:187], v94, s[24:27], s29 offen
  buffer_load_dwordx4 v[188:191], v94, s[24:27], s29 offen offset:16
  s_mov_b32 s29, 1536
  buffer_load_dwordx4 v[192:195], v94, s[24:27], s29 offen
  buffer_load_dwordx4 v[196:199], v94, s[24:27], s29 offen offset:16
  s_mov_b32 s29, 4720128
  buffer_load_dwordx4 v[200:203], v94, s[24:27], s29 offen
  buffer_load_dwordx4 v[204:207], v94, s[24:27], s29 offen offset:16
  s_mov_b32 s29, 9438720
  buffer_load_dwordx4 v[208:211], v94, s[24:27], s29 offen
  buffer_load_dwordx4 v[212:215], v94, s[24:27], s29 offen offset:16
  s_mov_b32 s29, 14157312
  buffer_load_dwordx4 v[216:219], v94, s[24:27], s29 offen
  buffer_load_dwordx4 v[220:223], v94, s[24:27], s29 offen offset:16
  s_mov_b32 s29, 2048
  buffer_load_dwordx4 v[224:227], v95, s[24:27], s29 offen
  buffer_load_dwordx4 v[228:231], v95, s[24:27], s29 offen offset:16
  s_mov_b32 s29, 4720640
  buffer_load_dwordx4 v[232:235], v95, s[24:27], s29 offen
  buffer_load_dwordx4 v[236:239], v95, s[24:27], s29 offen offset:16
  s_mov_b32 s29, 9439232
  buffer_load_dwordx4 v[240:243], v95, s[24:27], s29 offen
  buffer_load_dwordx4 v[244:247], v95, s[24:27], s29 offen offset:16
  s_mov_b32 s29, 14157824
  buffer_load_dwordx4 v[248:251], v95, s[24:27], s29 offen
  buffer_load_dwordx4 v[252:255], v95, s[24:27], s29 offen offset:16
  s_waitcnt vmcnt(32)
  v_pk_add_f32 v[96:97], v[96:97], v[104:105]
  v_pk_add_f32 v[98:99], v[98:99], v[106:107]
  v_pk_add_f32 v[100:101], v[100:101], v[108:109]
  v_pk_add_f32 v[102:103], v[102:103], v[110:111]
  v_pk_add_f32 v[96:97], v[96:97], v[112:113]
  v_pk_add_f32 v[98:99], v[98:99], v[114:115]
  v_pk_add_f32 v[100:101], v[100:101], v[116:117]
  v_pk_add_f32 v[102:103], v[102:103], v[118:119]
  v_pk_add_f32 v[96:97], v[96:97], v[120:121]
  v_pk_add_f32 v[98:99], v[98:99], v[122:123]
  v_pk_add_f32 v[100:101], v[100:101], v[124:125]
  v_pk_add_f32 v[102:103], v[102:103], v[126:127]
  v_cvt_pk_bf16_f32 v11, v96, v97
  v_lshlrev_b32 v96, 16, v11
  v_and_b32 v97, 0xffff0000, v11
  v_lshlrev_b32 v92, 16, v32
  v_and_b32 v93, 0xffff0000, v32
  v_mul_f32 v96, v96, v92
  v_mul_f32 v97, v97, v93
  v_cvt_pk_bf16_f32 v11, v96, v97
  v_lshlrev_b32 v96, 16, v11
  v_and_b32 v97, 0xffff0000, v11
  v_lshlrev_b32 v92, 16, v12
  v_and_b32 v93, 0xffff0000, v12
  v_add_f32 v96, v96, v92
  v_add_f32 v97, v97, v93
  v_cvt_pk_bf16_f32 v12, v96, v97
  v_cvt_pk_bf16_f32 v11, v98, v99
  v_lshlrev_b32 v98, 16, v11
  v_and_b32 v99, 0xffff0000, v11
  v_lshlrev_b32 v92, 16, v33
  v_and_b32 v93, 0xffff0000, v33
  v_mul_f32 v98, v98, v92
  v_mul_f32 v99, v99, v93
  v_cvt_pk_bf16_f32 v11, v98, v99
  v_lshlrev_b32 v98, 16, v11
  v_and_b32 v99, 0xffff0000, v11
  v_lshlrev_b32 v92, 16, v13
  v_and_b32 v93, 0xffff0000, v13
  v_add_f32 v98, v98, v92
  v_add_f32 v99, v99, v93
  v_cvt_pk_bf16_f32 v13, v98, v99
  v_cvt_pk_bf16_f32 v11, v100, v101
  v_lshlrev_b32 v100, 16, v11
  v_and_b32 v101, 0xffff0000, v11
  v_lshlrev_b32 v92, 16, v34
  v_and_b32 v93, 0xffff0000, v34
  v_mul_f32 v100, v100, v92
  v_mul_f32 v101, v101, v93
  v_cvt_pk_bf16_f32 v11, v100, v101
  v_lshlrev_b32 v100, 16, v11
  v_and_b32 v101, 0xffff0000, v11
  v_lshlrev_b32 v92, 16, v14
  v_and_b32 v93, 0xffff0000, v14
  v_add_f32 v100, v100, v92
  v_add_f32 v101, v101, v93
  v_cvt_pk_bf16_f32 v14, v100, v101
  v_cvt_pk_bf16_f32 v11, v102, v103
  v_lshlrev_b32 v102, 16, v11
  v_and_b32 v103, 0xffff0000, v11
  v_lshlrev_b32 v92, 16, v35
  v_and_b32 v93, 0xffff0000, v35
  v_mul_f32 v102, v102, v92
  v_mul_f32 v103, v103, v93
  v_cvt_pk_bf16_f32 v11, v102, v103
  v_lshlrev_b32 v102, 16, v11
  v_and_b32 v103, 0xffff0000, v11
  v_lshlrev_b32 v92, 16, v15
  v_and_b32 v93, 0xffff0000, v15
  v_add_f32 v102, v102, v92
  v_add_f32 v103, v103, v93
  v_cvt_pk_bf16_f32 v15, v102, v103
  s_waitcnt vmcnt(24)
  v_pk_add_f32 v[128:129], v[128:129], v[136:137]
  v_pk_add_f32 v[130:131], v[130:131], v[138:139]
  v_pk_add_f32 v[132:133], v[132:133], v[140:141]
  v_pk_add_f32 v[134:135], v[134:135], v[142:143]
  v_pk_add_f32 v[128:129], v[128:129], v[144:145]
  v_pk_add_f32 v[130:131], v[130:131], v[146:147]
  v_pk_add_f32 v[132:133], v[132:133], v[148:149]
  v_pk_add_f32 v[134:135], v[134:135], v[150:151]
  v_pk_add_f32 v[128:129], v[128:129], v[152:153]
  v_pk_add_f32 v[130:131], v[130:131], v[154:155]
  v_pk_add_f32 v[132:133], v[132:133], v[156:157]
  v_pk_add_f32 v[134:135], v[134:135], v[158:159]
  v_cvt_pk_bf16_f32 v11, v128, v129
  v_lshlrev_b32 v128, 16, v11
  v_and_b32 v129, 0xffff0000, v11
  v_lshlrev_b32 v92, 16, v36
  v_and_b32 v93, 0xffff0000, v36
  v_mul_f32 v128, v128, v92
  v_mul_f32 v129, v129, v93
  v_cvt_pk_bf16_f32 v11, v128, v129
  v_lshlrev_b32 v128, 16, v11
  v_and_b32 v129, 0xffff0000, v11
  v_lshlrev_b32 v92, 16, v16
  v_and_b32 v93, 0xffff0000, v16
  v_add_f32 v128, v128, v92
  v_add_f32 v129, v129, v93
  v_cvt_pk_bf16_f32 v16, v128, v129
  v_cvt_pk_bf16_f32 v11, v130, v131
  v_lshlrev_b32 v130, 16, v11
  v_and_b32 v131, 0xffff0000, v11
  v_lshlrev_b32 v92, 16, v37
  v_and_b32 v93, 0xffff0000, v37
  v_mul_f32 v130, v130, v92
  v_mul_f32 v131, v131, v93
  v_cvt_pk_bf16_f32 v11, v130, v131
  v_lshlrev_b32 v130, 16, v11
  v_and_b32 v131, 0xffff0000, v11
  v_lshlrev_b32 v92, 16, v17
  v_and_b32 v93, 0xffff0000, v17
  v_add_f32 v130, v130, v92
  v_add_f32 v131, v131, v93
  v_cvt_pk_bf16_f32 v17, v130, v131
  v_cvt_pk_bf16_f32 v11, v132, v133
  v_lshlrev_b32 v132, 16, v11
  v_and_b32 v133, 0xffff0000, v11
  v_lshlrev_b32 v92, 16, v38
  v_and_b32 v93, 0xffff0000, v38
  v_mul_f32 v132, v132, v92
  v_mul_f32 v133, v133, v93
  v_cvt_pk_bf16_f32 v11, v132, v133
  v_lshlrev_b32 v132, 16, v11
  v_and_b32 v133, 0xffff0000, v11
  v_lshlrev_b32 v92, 16, v18
  v_and_b32 v93, 0xffff0000, v18
  v_add_f32 v132, v132, v92
  v_add_f32 v133, v133, v93
  v_cvt_pk_bf16_f32 v18, v132, v133
  v_cvt_pk_bf16_f32 v11, v134, v135
  v_lshlrev_b32 v134, 16, v11
  v_and_b32 v135, 0xffff0000, v11
  v_lshlrev_b32 v92, 16, v39
  v_and_b32 v93, 0xffff0000, v39
  v_mul_f32 v134, v134, v92
  v_mul_f32 v135, v135, v93
  v_cvt_pk_bf16_f32 v11, v134, v135
  v_lshlrev_b32 v134, 16, v11
  v_and_b32 v135, 0xffff0000, v11
  v_lshlrev_b32 v92, 16, v19
  v_and_b32 v93, 0xffff0000, v19
  v_add_f32 v134, v134, v92
  v_add_f32 v135, v135, v93
  v_cvt_pk_bf16_f32 v19, v134, v135
  s_waitcnt vmcnt(16)
  v_pk_add_f32 v[160:161], v[160:161], v[168:169]
  v_pk_add_f32 v[162:163], v[162:163], v[170:171]
  v_pk_add_f32 v[164:165], v[164:165], v[172:173]
  v_pk_add_f32 v[166:167], v[166:167], v[174:175]
  v_pk_add_f32 v[160:161], v[160:161], v[176:177]
  v_pk_add_f32 v[162:163], v[162:163], v[178:179]
  v_pk_add_f32 v[164:165], v[164:165], v[180:181]
  v_pk_add_f32 v[166:167], v[166:167], v[182:183]
  v_pk_add_f32 v[160:161], v[160:161], v[184:185]
  v_pk_add_f32 v[162:163], v[162:163], v[186:187]
  v_pk_add_f32 v[164:165], v[164:165], v[188:189]
  v_pk_add_f32 v[166:167], v[166:167], v[190:191]
  v_cvt_pk_bf16_f32 v11, v160, v161
  v_lshlrev_b32 v160, 16, v11
  v_and_b32 v161, 0xffff0000, v11
  v_lshlrev_b32 v92, 16, v40
  v_and_b32 v93, 0xffff0000, v40
  v_mul_f32 v160, v160, v92
  v_mul_f32 v161, v161, v93
  v_cvt_pk_bf16_f32 v11, v160, v161
  v_lshlrev_b32 v160, 16, v11
  v_and_b32 v161, 0xffff0000, v11
  v_lshlrev_b32 v92, 16, v20
  v_and_b32 v93, 0xffff0000, v20
  v_add_f32 v160, v160, v92
  v_add_f32 v161, v161, v93
  v_cvt_pk_bf16_f32 v20, v160, v161
  v_cvt_pk_bf16_f32 v11, v162, v163
  v_lshlrev_b32 v162, 16, v11
  v_and_b32 v163, 0xffff0000, v11
  v_lshlrev_b32 v92, 16, v41
  v_and_b32 v93, 0xffff0000, v41
  v_mul_f32 v162, v162, v92
  v_mul_f32 v163, v163, v93
  v_cvt_pk_bf16_f32 v11, v162, v163
  v_lshlrev_b32 v162, 16, v11
  v_and_b32 v163, 0xffff0000, v11
  v_lshlrev_b32 v92, 16, v21
  v_and_b32 v93, 0xffff0000, v21
  v_add_f32 v162, v162, v92
  v_add_f32 v163, v163, v93
  v_cvt_pk_bf16_f32 v21, v162, v163
  v_cvt_pk_bf16_f32 v11, v164, v165
  v_lshlrev_b32 v164, 16, v11
  v_and_b32 v165, 0xffff0000, v11
  v_lshlrev_b32 v92, 16, v42
  v_and_b32 v93, 0xffff0000, v42
  v_mul_f32 v164, v164, v92
  v_mul_f32 v165, v165, v93
  v_cvt_pk_bf16_f32 v11, v164, v165
  v_lshlrev_b32 v164, 16, v11
  v_and_b32 v165, 0xffff0000, v11
  v_lshlrev_b32 v92, 16, v22
  v_and_b32 v93, 0xffff0000, v22
  v_add_f32 v164, v164, v92
  v_add_f32 v165, v165, v93
  v_cvt_pk_bf16_f32 v22, v164, v165
  v_cvt_pk_bf16_f32 v11, v166, v167
  v_lshlrev_b32 v166, 16, v11
  v_and_b32 v167, 0xffff0000, v11
  v_lshlrev_b32 v92, 16, v43
  v_and_b32 v93, 0xffff0000, v43
  v_mul_f32 v166, v166, v92
  v_mul_f32 v167, v167, v93
  v_cvt_pk_bf16_f32 v11, v166, v167
  v_lshlrev_b32 v166, 16, v11
  v_and_b32 v167, 0xffff0000, v11
  v_lshlrev_b32 v92, 16, v23
  v_and_b32 v93, 0xffff0000, v23
  v_add_f32 v166, v166, v92
  v_add_f32 v167, v167, v93
  v_cvt_pk_bf16_f32 v23, v166, v167
  s_waitcnt vmcnt(8)
  v_pk_add_f32 v[192:193], v[192:193], v[200:201]
  v_pk_add_f32 v[194:195], v[194:195], v[202:203]
  v_pk_add_f32 v[196:197], v[196:197], v[204:205]
  v_pk_add_f32 v[198:199], v[198:199], v[206:207]
  v_pk_add_f32 v[192:193], v[192:193], v[208:209]
  v_pk_add_f32 v[194:195], v[194:195], v[210:211]
  v_pk_add_f32 v[196:197], v[196:197], v[212:213]
  v_pk_add_f32 v[198:199], v[198:199], v[214:215]
  v_pk_add_f32 v[192:193], v[192:193], v[216:217]
  v_pk_add_f32 v[194:195], v[194:195], v[218:219]
  v_pk_add_f32 v[196:197], v[196:197], v[220:221]
  v_pk_add_f32 v[198:199], v[198:199], v[222:223]
  v_cvt_pk_bf16_f32 v11, v192, v193
  v_lshlrev_b32 v192, 16, v11
  v_and_b32 v193, 0xffff0000, v11
  v_lshlrev_b32 v92, 16, v44
  v_and_b32 v93, 0xffff0000, v44
  v_mul_f32 v192, v192, v92
  v_mul_f32 v193, v193, v93
  v_cvt_pk_bf16_f32 v11, v192, v193
  v_lshlrev_b32 v192, 16, v11
  v_and_b32 v193, 0xffff0000, v11
  v_lshlrev_b32 v92, 16, v24
  v_and_b32 v93, 0xffff0000, v24
  v_add_f32 v192, v192, v92
  v_add_f32 v193, v193, v93
  v_cvt_pk_bf16_f32 v24, v192, v193
  v_cvt_pk_bf16_f32 v11, v194, v195
  v_lshlrev_b32 v194, 16, v11
  v_and_b32 v195, 0xffff0000, v11
  v_lshlrev_b32 v92, 16, v45
  v_and_b32 v93, 0xffff0000, v45
  v_mul_f32 v194, v194, v92
  v_mul_f32 v195, v195, v93
  v_cvt_pk_bf16_f32 v11, v194, v195
  v_lshlrev_b32 v194, 16, v11
  v_and_b32 v195, 0xffff0000, v11
  v_lshlrev_b32 v92, 16, v25
  v_and_b32 v93, 0xffff0000, v25
  v_add_f32 v194, v194, v92
  v_add_f32 v195, v195, v93
  v_cvt_pk_bf16_f32 v25, v194, v195
  v_cvt_pk_bf16_f32 v11, v196, v197
  v_lshlrev_b32 v196, 16, v11
  v_and_b32 v197, 0xffff0000, v11
  v_lshlrev_b32 v92, 16, v46
  v_and_b32 v93, 0xffff0000, v46
  v_mul_f32 v196, v196, v92
  v_mul_f32 v197, v197, v93
  v_cvt_pk_bf16_f32 v11, v196, v197
  v_lshlrev_b32 v196, 16, v11
  v_and_b32 v197, 0xffff0000, v11
  v_lshlrev_b32 v92, 16, v26
  v_and_b32 v93, 0xffff0000, v26
  v_add_f32 v196, v196, v92
  v_add_f32 v197, v197, v93
  v_cvt_pk_bf16_f32 v26, v196, v197
  v_cvt_pk_bf16_f32 v11, v198, v199
  v_lshlrev_b32 v198, 16, v11
  v_and_b32 v199, 0xffff0000, v11
  v_lshlrev_b32 v92, 16, v47
  v_and_b32 v93, 0xffff0000, v47
  v_mul_f32 v198, v198, v92
  v_mul_f32 v199, v199, v93
  v_cvt_pk_bf16_f32 v11, v198, v199
  v_lshlrev_b32 v198, 16, v11
  v_and_b32 v199, 0xffff0000, v11
  v_lshlrev_b32 v92, 16, v27
  v_and_b32 v93, 0xffff0000, v27
  v_add_f32 v198, v198, v92
  v_add_f32 v199, v199, v93
  v_cvt_pk_bf16_f32 v27, v198, v199
  s_waitcnt vmcnt(0)
  v_pk_add_f32 v[224:225], v[224:225], v[232:233]
  v_pk_add_f32 v[226:227], v[226:227], v[234:235]
  v_pk_add_f32 v[228:229], v[228:229], v[236:237]
  v_pk_add_f32 v[230:231], v[230:231], v[238:239]
  v_pk_add_f32 v[224:225], v[224:225], v[240:241]
  v_pk_add_f32 v[226:227], v[226:227], v[242:243]
  v_pk_add_f32 v[228:229], v[228:229], v[244:245]
  v_pk_add_f32 v[230:231], v[230:231], v[246:247]
  v_pk_add_f32 v[224:225], v[224:225], v[248:249]
  v_pk_add_f32 v[226:227], v[226:227], v[250:251]
  v_pk_add_f32 v[228:229], v[228:229], v[252:253]
  v_pk_add_f32 v[230:231], v[230:231], v[254:255]
  v_cvt_pk_bf16_f32 v11, v224, v225
  v_lshlrev_b32 v224, 16, v11
  v_and_b32 v225, 0xffff0000, v11
  v_lshlrev_b32 v92, 16, v48
  v_and_b32 v93, 0xffff0000, v48
  v_mul_f32 v224, v224, v92
  v_mul_f32 v225, v225, v93
  v_cvt_pk_bf16_f32 v11, v224, v225
  v_lshlrev_b32 v224, 16, v11
  v_and_b32 v225, 0xffff0000, v11
  v_lshlrev_b32 v92, 16, v28
  v_and_b32 v93, 0xffff0000, v28
  v_add_f32 v224, v224, v92
  v_add_f32 v225, v225, v93
  v_cvt_pk_bf16_f32 v28, v224, v225
  v_cvt_pk_bf16_f32 v11, v226, v227
  v_lshlrev_b32 v226, 16, v11
  v_and_b32 v227, 0xffff0000, v11
  v_lshlrev_b32 v92, 16, v49
  v_and_b32 v93, 0xffff0000, v49
  v_mul_f32 v226, v226, v92
  v_mul_f32 v227, v227, v93
  v_cvt_pk_bf16_f32 v11, v226, v227
  v_lshlrev_b32 v226, 16, v11
  v_and_b32 v227, 0xffff0000, v11
  v_lshlrev_b32 v92, 16, v29
  v_and_b32 v93, 0xffff0000, v29
  v_add_f32 v226, v226, v92
  v_add_f32 v227, v227, v93
  v_cvt_pk_bf16_f32 v29, v226, v227
  v_cvt_pk_bf16_f32 v11, v228, v229
  v_lshlrev_b32 v228, 16, v11
  v_and_b32 v229, 0xffff0000, v11
  v_lshlrev_b32 v92, 16, v50
  v_and_b32 v93, 0xffff0000, v50
  v_mul_f32 v228, v228, v92
  v_mul_f32 v229, v229, v93
  v_cvt_pk_bf16_f32 v11, v228, v229
  v_lshlrev_b32 v228, 16, v11
  v_and_b32 v229, 0xffff0000, v11
  v_lshlrev_b32 v92, 16, v30
  v_and_b32 v93, 0xffff0000, v30
  v_add_f32 v228, v228, v92
  v_add_f32 v229, v229, v93
  v_cvt_pk_bf16_f32 v30, v228, v229
  v_cvt_pk_bf16_f32 v11, v230, v231
  v_lshlrev_b32 v230, 16, v11
  v_and_b32 v231, 0xffff0000, v11
  v_lshlrev_b32 v92, 16, v51
  v_and_b32 v93, 0xffff0000, v51
  v_mul_f32 v230, v230, v92
  v_mul_f32 v231, v231, v93
  v_cvt_pk_bf16_f32 v11, v230, v231
  v_lshlrev_b32 v230, 16, v11
  v_and_b32 v231, 0xffff0000, v11
  v_lshlrev_b32 v92, 16, v31
  v_and_b32 v93, 0xffff0000, v31
  v_add_f32 v230, v230, v92
  v_add_f32 v231, v231, v93
  v_cvt_pk_bf16_f32 v31, v230, v231
  s_mov_b32 s29, 4608
  buffer_load_dwordx4 v[52:55], v4, s[20:23], s29 offen offset:0
  buffer_load_dwordx4 v[56:59], v4, s[20:23], s29 offen offset:256
  buffer_load_dwordx4 v[60:63], v4, s[20:23], s29 offen offset:512
  buffer_load_dwordx4 v[64:67], v4, s[20:23], s29 offen offset:768
  buffer_load_dwordx4 v[68:71], v7, s[20:23], s29 offen offset:1024
  s_mov_b32 s29, 3456
  buffer_load_dwordx4 v[72:75], v4, s[20:23], s29 offen offset:0
  buffer_load_dwordx4 v[76:79], v4, s[20:23], s29 offen offset:256
  buffer_load_dwordx4 v[80:83], v4, s[20:23], s29 offen offset:512
  buffer_load_dwordx4 v[84:87], v4, s[20:23], s29 offen offset:768
  buffer_load_dwordx4 v[88:91], v7, s[20:23], s29 offen offset:1024
  buffer_store_dwordx4 v[12:15], v3, s[52:55], 0 offen offset:0 sc1
  buffer_store_dwordx4 v[16:19], v3, s[52:55], 0 offen offset:256 sc1
  buffer_store_dwordx4 v[20:23], v3, s[52:55], 0 offen offset:512 sc1
  buffer_store_dwordx4 v[24:27], v3, s[52:55], 0 offen offset:768 sc1
  buffer_store_dwordx4 v[28:31], v6, s[52:55], 0 offen offset:1024 sc1
  v_lshlrev_b32 v96, 16, v12
  v_and_b32 v97, 0xffff0000, v12
  v_lshlrev_b32 v98, 16, v13
  v_and_b32 v99, 0xffff0000, v13
  v_lshlrev_b32 v100, 16, v14
  v_and_b32 v101, 0xffff0000, v14
  v_lshlrev_b32 v102, 16, v15
  v_and_b32 v103, 0xffff0000, v15
  v_lshlrev_b32 v104, 16, v16
  v_and_b32 v105, 0xffff0000, v16
  v_lshlrev_b32 v106, 16, v17
  v_and_b32 v107, 0xffff0000, v17
  v_lshlrev_b32 v108, 16, v18
  v_and_b32 v109, 0xffff0000, v18
  v_lshlrev_b32 v110, 16, v19
  v_and_b32 v111, 0xffff0000, v19
  v_lshlrev_b32 v112, 16, v20
  v_and_b32 v113, 0xffff0000, v20
  v_lshlrev_b32 v114, 16, v21
  v_and_b32 v115, 0xffff0000, v21
  v_lshlrev_b32 v116, 16, v22
  v_and_b32 v117, 0xffff0000, v22
  v_lshlrev_b32 v118, 16, v23
  v_and_b32 v119, 0xffff0000, v23
  v_lshlrev_b32 v120, 16, v24
  v_and_b32 v121, 0xffff0000, v24
  v_lshlrev_b32 v122, 16, v25
  v_and_b32 v123, 0xffff0000, v25
  v_lshlrev_b32 v124, 16, v26
  v_and_b32 v125, 0xffff0000, v26
  v_lshlrev_b32 v126, 16, v27
  v_and_b32 v127, 0xffff0000, v27
  v_lshlrev_b32 v128, 16, v28
  v_and_b32 v129, 0xffff0000, v28
  v_lshlrev_b32 v130, 16, v29
  v_and_b32 v131, 0xffff0000, v29
  v_lshlrev_b32 v132, 16, v30
  v_and_b32 v133, 0xffff0000, v30
  v_lshlrev_b32 v134, 16, v31
  v_and_b32 v135, 0xffff0000, v31
  v_add_f32 v8, v96, v97
  v_add_f32 v8, v8, v98
  v_add_f32 v8, v8, v99
  v_add_f32 v8, v8, v100
  v_add_f32 v8, v8, v101
  v_add_f32 v8, v8, v102
  v_add_f32 v8, v8, v103
  v_add_f32 v8, v8, v104
  v_add_f32 v8, v8, v105
  v_add_f32 v8, v8, v106
  v_add_f32 v8, v8, v107
  v_add_f32 v8, v8, v108
  v_add_f32 v8, v8, v109
  v_add_f32 v8, v8, v110
  v_add_f32 v8, v8, v111
  v_add_f32 v8, v8, v112
  v_add_f32 v8, v8, v113
  v_add_f32 v8, v8, v114
  v_add_f32 v8, v8, v115
  v_add_f32 v8, v8, v116
  v_add_f32 v8, v8, v117
  v_add_f32 v8, v8, v118
  v_add_f32 v8, v8, v119
  v_add_f32 v8, v8, v120
  v_add_f32 v8, v8, v121
  v_add_f32 v8, v8, v122
  v_add_f32 v8, v8, v123
  v_add_f32 v8, v8, v124
  v_add_f32 v8, v8, v125
  v_add_f32 v8, v8, v126
  v_add_f32 v8, v8, v127
  v_add_f32 v8, v8, v128
  v_add_f32 v8, v8, v129
  v_add_f32 v8, v8, v130
  v_add_f32 v8, v8, v131
  v_add_f32 v8, v8, v132
  v_add_f32 v8, v8, v133
  v_add_f32 v8, v8, v134
  v_add_f32 v8, v8, v135
  s_nop 1
  v_add_f32_dpp v8, v8, v8 row_ror:8 row_mask:0xf bank_mask:0xf
  s_nop 1
  v_add_f32_dpp v8, v8, v8 row_ror:4 row_mask:0xf bank_mask:0xf
  s_nop 1
  v_add_f32_dpp v8, v8, v8 row_ror:2 row_mask:0xf bank_mask:0xf
  s_nop 1
  v_add_f32_dpp v8, v8, v8 row_ror:1 row_mask:0xf bank_mask:0xf
  s_mov_b32 s31, 0x3ae38e39
  v_mul_f32 v8, s31, v8
  v_mov_b32 v10, 0
  v_mov_b32 v2, 0
  v_sub_f32 v11, v96, v8
  v_fmac_f32 v10, v11, v11
  v_sub_f32 v11, v97, v8
  v_fmac_f32 v10, v11, v11
  v_sub_f32 v11, v98, v8
  v_fmac_f32 v10, v11, v11
  v_sub_f32 v11, v99, v8
  v_fmac_f32 v10, v11, v11
  v_sub_f32 v11, v100, v8
  v_fmac_f32 v10, v11, v11
  v_sub_f32 v11, v101, v8
  v_fmac_f32 v10, v11, v11
  v_sub_f32 v11, v102, v8
  v_fmac_f32 v10, v11, v11
  v_sub_f32 v11, v103, v8
  v_fmac_f32 v10, v11, v11
  v_sub_f32 v11, v104, v8
  v_fmac_f32 v10, v11, v11
  v_sub_f32 v11, v105, v8
  v_fmac_f32 v10, v11, v11
  v_sub_f32 v11, v106, v8
  v_fmac_f32 v10, v11, v11
  v_sub_f32 v11, v107, v8
  v_fmac_f32 v10, v11, v11
  v_sub_f32 v11, v108, v8
  v_fmac_f32 v10, v11, v11
  v_sub_f32 v11, v109, v8
  v_fmac_f32 v10, v11, v11
  v_sub_f32 v11, v110, v8
  v_fmac_f32 v10, v11, v11
  v_sub_f32 v11, v111, v8
  v_fmac_f32 v10, v11, v11
  v_sub_f32 v11, v112, v8
  v_fmac_f32 v10, v11, v11
  v_sub_f32 v11, v113, v8
  v_fmac_f32 v10, v11, v11
  v_sub_f32 v11, v114, v8
  v_fmac_f32 v10, v11, v11
  v_sub_f32 v11, v115, v8
  v_fmac_f32 v10, v11, v11
  v_sub_f32 v11, v116, v8
  v_fmac_f32 v10, v11, v11
  v_sub_f32 v11, v117, v8
  v_fmac_f32 v10, v11, v11
  v_sub_f32 v11, v118, v8
  v_fmac_f32 v10, v11, v11
  v_sub_f32 v11, v119, v8
  v_fmac_f32 v10, v11, v11
  v_sub_f32 v11, v120, v8
  v_fmac_f32 v10, v11, v11
  v_sub_f32 v11, v121, v8
  v_fmac_f32 v10, v11, v11
  v_sub_f32 v11, v122, v8
  v_fmac_f32 v10, v11, v11
  v_sub_f32 v11, v123, v8
  v_fmac_f32 v10, v11, v11
  v_sub_f32 v11, v124, v8
  v_fmac_f32 v10, v11, v11
  v_sub_f32 v11, v125, v8
  v_fmac_f32 v10, v11, v11
  v_sub_f32 v11, v126, v8
  v_fmac_f32 v10, v11, v11
  v_sub_f32 v11, v127, v8
  v_fmac_f32 v10, v11, v11
  v_sub_f32 v11, v128, v8
  v_fmac_f32 v2, v11, v11
  v_sub_f32 v11, v129, v8
  v_fmac_f32 v2, v11, v11
  v_sub_f32 v11, v130, v8
  v_fmac_f32 v2, v11, v11
  v_sub_f32 v11, v131, v8
  v_fmac_f32 v2, v11, v11
  v_sub_f32 v11, v132, v8
  v_fmac_f32 v2, v11, v11
  v_sub_f32 v11, v133, v8
  v_fmac_f32 v2, v11, v11
  v_sub_f32 v11, v134, v8
  v_fmac_f32 v2, v11, v11
  v_sub_f32 v11, v135, v8
  v_fmac_f32 v2, v11, v11
  v_fmac_f32 v10, v2, v9
  s_nop 1
  v_add_f32_dpp v10, v10, v10 row_ror:8 row_mask:0xf bank_mask:0xf
  s_nop 1
  v_add_f32_dpp v10, v10, v10 row_ror:4 row_mask:0xf bank_mask:0xf
  s_nop 1
  v_add_f32_dpp v10, v10, v10 row_ror:2 row_mask:0xf bank_mask:0xf
  s_nop 1
  v_add_f32_dpp v10, v10, v10 row_ror:1 row_mask:0xf bank_mask:0xf
  v_mul_f32 v10, s31, v10
  v_cvt_pk_bf16_f32 v11, v10, v10
  v_lshlrev_b32 v10, 16, v11
  v_cvt_pk_bf16_f32 v11, v8, v8
  v_lshlrev_b32 v8, 16, v11
  v_add_f32 v10, 0x3727c5ac, v10
  v_cvt_pk_bf16_f32 v11, v10, v10
  v_lshlrev_b32 v10, 16, v11
  v_sqrt_f32 v10, v10
  s_nop 0
  v_cvt_pk_bf16_f32 v11, v10, v10
  v_lshlrev_b32 v10, 16, v11
  v_rcp_f32 v10, v10
  s_waitcnt vmcnt(5)
  v_sub_f32 v96, v96, v8
  v_sub_f32 v97, v97, v8
  v_cvt_pk_bf16_f32 v11, v96, v97
  v_lshlrev_b32 v96, 16, v11
  v_and_b32 v97, 0xffff0000, v11
  v_mul_f32 v96, v96, v10
  v_mul_f32 v97, v97, v10
  v_cvt_pk_bf16_f32 v11, v96, v97
  v_lshlrev_b32 v96, 16, v11
  v_and_b32 v97, 0xffff0000, v11
  v_lshlrev_b32 v92, 16, v52
  v_and_b32 v93, 0xffff0000, v52
  v_mul_f32 v96, v96, v92
  v_mul_f32 v97, v97, v93
  v_cvt_pk_bf16_f32 v11, v96, v97
  v_lshlrev_b32 v96, 16, v11
  v_and_b32 v97, 0xffff0000, v11
  v_lshlrev_b32 v92, 16, v72
  v_and_b32 v93, 0xffff0000, v72
  v_add_f32 v96, v96, v92
  v_add_f32 v97, v97, v93
  v_cvt_pk_bf16_f32 v12, v96, v97
  v_sub_f32 v98, v98, v8
  v_sub_f32 v99, v99, v8
  v_cvt_pk_bf16_f32 v11, v98, v99
  v_lshlrev_b32 v98, 16, v11
  v_and_b32 v99, 0xffff0000, v11
  v_mul_f32 v98, v98, v10
  v_mul_f32 v99, v99, v10
  v_cvt_pk_bf16_f32 v11, v98, v99
  v_lshlrev_b32 v98, 16, v11
  v_and_b32 v99, 0xffff0000, v11
  v_lshlrev_b32 v92, 16, v53
  v_and_b32 v93, 0xffff0000, v53
  v_mul_f32 v98, v98, v92
  v_mul_f32 v99, v99, v93
  v_cvt_pk_bf16_f32 v11, v98, v99
  v_lshlrev_b32 v98, 16, v11
  v_and_b32 v99, 0xffff0000, v11
  v_lshlrev_b32 v92, 16, v73
  v_and_b32 v93, 0xffff0000, v73
  v_add_f32 v98, v98, v92
  v_add_f32 v99, v99, v93
  v_cvt_pk_bf16_f32 v13, v98, v99
  v_sub_f32 v100, v100, v8
  v_sub_f32 v101, v101, v8
  v_cvt_pk_bf16_f32 v11, v100, v101
  v_lshlrev_b32 v100, 16, v11
  v_and_b32 v101, 0xffff0000, v11
  v_mul_f32 v100, v100, v10
  v_mul_f32 v101, v101, v10
  v_cvt_pk_bf16_f32 v11, v100, v101
  v_lshlrev_b32 v100, 16, v11
  v_and_b32 v101, 0xffff0000, v11
  v_lshlrev_b32 v92, 16, v54
  v_and_b32 v93, 0xffff0000, v54
  v_mul_f32 v100, v100, v92
  v_mul_f32 v101, v101, v93
  v_cvt_pk_bf16_f32 v11, v100, v101
  v_lshlrev_b32 v100, 16, v11
  v_and_b32 v101, 0xffff0000, v11
  v_lshlrev_b32 v92, 16, v74
  v_and_b32 v93, 0xffff0000, v74
  v_add_f32 v100, v100, v92
  v_add_f32 v101, v101, v93
  v_cvt_pk_bf16_f32 v14, v100, v101
  v_sub_f32 v102, v102, v8
  v_sub_f32 v103, v103, v8
  v_cvt_pk_bf16_f32 v11, v102, v103
  v_lshlrev_b32 v102, 16, v11
  v_and_b32 v103, 0xffff0000, v11
  v_mul_f32 v102, v102, v10
  v_mul_f32 v103, v103, v10
  v_cvt_pk_bf16_f32 v11, v102, v103
  v_lshlrev_b32 v102, 16, v11
  v_and_b32 v103, 0xffff0000, v11
  v_lshlrev_b32 v92, 16, v55
  v_and_b32 v93, 0xffff0000, v55
  v_mul_f32 v102, v102, v92
  v_mul_f32 v103, v103, v93
  v_cvt_pk_bf16_f32 v11, v102, v103
  v_lshlrev_b32 v102, 16, v11
  v_and_b32 v103, 0xffff0000, v11
  v_lshlrev_b32 v92, 16, v75
  v_and_b32 v93, 0xffff0000, v75
  v_add_f32 v102, v102, v92
  v_add_f32 v103, v103, v93
  v_cvt_pk_bf16_f32 v15, v102, v103
  v_sub_f32 v104, v104, v8
  v_sub_f32 v105, v105, v8
  v_cvt_pk_bf16_f32 v11, v104, v105
  v_lshlrev_b32 v104, 16, v11
  v_and_b32 v105, 0xffff0000, v11
  v_mul_f32 v104, v104, v10
  v_mul_f32 v105, v105, v10
  v_cvt_pk_bf16_f32 v11, v104, v105
  v_lshlrev_b32 v104, 16, v11
  v_and_b32 v105, 0xffff0000, v11
  v_lshlrev_b32 v92, 16, v56
  v_and_b32 v93, 0xffff0000, v56
  v_mul_f32 v104, v104, v92
  v_mul_f32 v105, v105, v93
  v_cvt_pk_bf16_f32 v11, v104, v105
  v_lshlrev_b32 v104, 16, v11
  v_and_b32 v105, 0xffff0000, v11
  v_lshlrev_b32 v92, 16, v76
  v_and_b32 v93, 0xffff0000, v76
  v_add_f32 v104, v104, v92
  v_add_f32 v105, v105, v93
  v_cvt_pk_bf16_f32 v16, v104, v105
  v_sub_f32 v106, v106, v8
  v_sub_f32 v107, v107, v8
  v_cvt_pk_bf16_f32 v11, v106, v107
  v_lshlrev_b32 v106, 16, v11
  v_and_b32 v107, 0xffff0000, v11
  v_mul_f32 v106, v106, v10
  v_mul_f32 v107, v107, v10
  v_cvt_pk_bf16_f32 v11, v106, v107
  v_lshlrev_b32 v106, 16, v11
  v_and_b32 v107, 0xffff0000, v11
  v_lshlrev_b32 v92, 16, v57
  v_and_b32 v93, 0xffff0000, v57
  v_mul_f32 v106, v106, v92
  v_mul_f32 v107, v107, v93
  v_cvt_pk_bf16_f32 v11, v106, v107
  v_lshlrev_b32 v106, 16, v11
  v_and_b32 v107, 0xffff0000, v11
  v_lshlrev_b32 v92, 16, v77
  v_and_b32 v93, 0xffff0000, v77
  v_add_f32 v106, v106, v92
  v_add_f32 v107, v107, v93
  v_cvt_pk_bf16_f32 v17, v106, v107
  v_sub_f32 v108, v108, v8
  v_sub_f32 v109, v109, v8
  v_cvt_pk_bf16_f32 v11, v108, v109
  v_lshlrev_b32 v108, 16, v11
  v_and_b32 v109, 0xffff0000, v11
  v_mul_f32 v108, v108, v10
  v_mul_f32 v109, v109, v10
  v_cvt_pk_bf16_f32 v11, v108, v109
  v_lshlrev_b32 v108, 16, v11
  v_and_b32 v109, 0xffff0000, v11
  v_lshlrev_b32 v92, 16, v58
  v_and_b32 v93, 0xffff0000, v58
  v_mul_f32 v108, v108, v92
  v_mul_f32 v109, v109, v93
  v_cvt_pk_bf16_f32 v11, v108, v109
  v_lshlrev_b32 v108, 16, v11
  v_and_b32 v109, 0xffff0000, v11
  v_lshlrev_b32 v92, 16, v78
  v_and_b32 v93, 0xffff0000, v78
  v_add_f32 v108, v108, v92
  v_add_f32 v109, v109, v93
  v_cvt_pk_bf16_f32 v18, v108, v109
  v_sub_f32 v110, v110, v8
  v_sub_f32 v111, v111, v8
  v_cvt_pk_bf16_f32 v11, v110, v111
  v_lshlrev_b32 v110, 16, v11
  v_and_b32 v111, 0xffff0000, v11
  v_mul_f32 v110, v110, v10
  v_mul_f32 v111, v111, v10
  v_cvt_pk_bf16_f32 v11, v110, v111
  v_lshlrev_b32 v110, 16, v11
  v_and_b32 v111, 0xffff0000, v11
  v_lshlrev_b32 v92, 16, v59
  v_and_b32 v93, 0xffff0000, v59
  v_mul_f32 v110, v110, v92
  v_mul_f32 v111, v111, v93
  v_cvt_pk_bf16_f32 v11, v110, v111
  v_lshlrev_b32 v110, 16, v11
  v_and_b32 v111, 0xffff0000, v11
  v_lshlrev_b32 v92, 16, v79
  v_and_b32 v93, 0xffff0000, v79
  v_add_f32 v110, v110, v92
  v_add_f32 v111, v111, v93
  v_cvt_pk_bf16_f32 v19, v110, v111
  v_sub_f32 v112, v112, v8
  v_sub_f32 v113, v113, v8
  v_cvt_pk_bf16_f32 v11, v112, v113
  v_lshlrev_b32 v112, 16, v11
  v_and_b32 v113, 0xffff0000, v11
  v_mul_f32 v112, v112, v10
  v_mul_f32 v113, v113, v10
  v_cvt_pk_bf16_f32 v11, v112, v113
  v_lshlrev_b32 v112, 16, v11
  v_and_b32 v113, 0xffff0000, v11
  v_lshlrev_b32 v92, 16, v60
  v_and_b32 v93, 0xffff0000, v60
  v_mul_f32 v112, v112, v92
  v_mul_f32 v113, v113, v93
  v_cvt_pk_bf16_f32 v11, v112, v113
  v_lshlrev_b32 v112, 16, v11
  v_and_b32 v113, 0xffff0000, v11
  v_lshlrev_b32 v92, 16, v80
  v_and_b32 v93, 0xffff0000, v80
  v_add_f32 v112, v112, v92
  v_add_f32 v113, v113, v93
  v_cvt_pk_bf16_f32 v20, v112, v113
  v_sub_f32 v114, v114, v8
  v_sub_f32 v115, v115, v8
  v_cvt_pk_bf16_f32 v11, v114, v115
  v_lshlrev_b32 v114, 16, v11
  v_and_b32 v115, 0xffff0000, v11
  v_mul_f32 v114, v114, v10
  v_mul_f32 v115, v115, v10
  v_cvt_pk_bf16_f32 v11, v114, v115
  v_lshlrev_b32 v114, 16, v11
  v_and_b32 v115, 0xffff0000, v11
  v_lshlrev_b32 v92, 16, v61
  v_and_b32 v93, 0xffff0000, v61
  v_mul_f32 v114, v114, v92
  v_mul_f32 v115, v115, v93
  v_cvt_pk_bf16_f32 v11, v114, v115
  v_lshlrev_b32 v114, 16, v11
  v_and_b32 v115, 0xffff0000, v11
  v_lshlrev_b32 v92, 16, v81
  v_and_b32 v93, 0xffff0000, v81
  v_add_f32 v114, v114, v92
  v_add_f32 v115, v115, v93
  v_cvt_pk_bf16_f32 v21, v114, v115
  v_sub_f32 v116, v116, v8
  v_sub_f32 v117, v117, v8
  v_cvt_pk_bf16_f32 v11, v116, v117
  v_lshlrev_b32 v116, 16, v11
  v_and_b32 v117, 0xffff0000, v11
  v_mul_f32 v116, v116, v10
  v_mul_f32 v117, v117, v10
  v_cvt_pk_bf16_f32 v11, v116, v117
  v_lshlrev_b32 v116, 16, v11
  v_and_b32 v117, 0xffff0000, v11
  v_lshlrev_b32 v92, 16, v62
  v_and_b32 v93, 0xffff0000, v62
  v_mul_f32 v116, v116, v92
  v_mul_f32 v117, v117, v93
  v_cvt_pk_bf16_f32 v11, v116, v117
  v_lshlrev_b32 v116, 16, v11
  v_and_b32 v117, 0xffff0000, v11
  v_lshlrev_b32 v92, 16, v82
  v_and_b32 v93, 0xffff0000, v82
  v_add_f32 v116, v116, v92
  v_add_f32 v117, v117, v93
  v_cvt_pk_bf16_f32 v22, v116, v117
  v_sub_f32 v118, v118, v8
  v_sub_f32 v119, v119, v8
  v_cvt_pk_bf16_f32 v11, v118, v119
  v_lshlrev_b32 v118, 16, v11
  v_and_b32 v119, 0xffff0000, v11
  v_mul_f32 v118, v118, v10
  v_mul_f32 v119, v119, v10
  v_cvt_pk_bf16_f32 v11, v118, v119
  v_lshlrev_b32 v118, 16, v11
  v_and_b32 v119, 0xffff0000, v11
  v_lshlrev_b32 v92, 16, v63
  v_and_b32 v93, 0xffff0000, v63
  v_mul_f32 v118, v118, v92
  v_mul_f32 v119, v119, v93
  v_cvt_pk_bf16_f32 v11, v118, v119
  v_lshlrev_b32 v118, 16, v11
  v_and_b32 v119, 0xffff0000, v11
  v_lshlrev_b32 v92, 16, v83
  v_and_b32 v93, 0xffff0000, v83
  v_add_f32 v118, v118, v92
  v_add_f32 v119, v119, v93
  v_cvt_pk_bf16_f32 v23, v118, v119
  v_sub_f32 v120, v120, v8
  v_sub_f32 v121, v121, v8
  v_cvt_pk_bf16_f32 v11, v120, v121
  v_lshlrev_b32 v120, 16, v11
  v_and_b32 v121, 0xffff0000, v11
  v_mul_f32 v120, v120, v10
  v_mul_f32 v121, v121, v10
  v_cvt_pk_bf16_f32 v11, v120, v121
  v_lshlrev_b32 v120, 16, v11
  v_and_b32 v121, 0xffff0000, v11
  v_lshlrev_b32 v92, 16, v64
  v_and_b32 v93, 0xffff0000, v64
  v_mul_f32 v120, v120, v92
  v_mul_f32 v121, v121, v93
  v_cvt_pk_bf16_f32 v11, v120, v121
  v_lshlrev_b32 v120, 16, v11
  v_and_b32 v121, 0xffff0000, v11
  v_lshlrev_b32 v92, 16, v84
  v_and_b32 v93, 0xffff0000, v84
  v_add_f32 v120, v120, v92
  v_add_f32 v121, v121, v93
  v_cvt_pk_bf16_f32 v24, v120, v121
  v_sub_f32 v122, v122, v8
  v_sub_f32 v123, v123, v8
  v_cvt_pk_bf16_f32 v11, v122, v123
  v_lshlrev_b32 v122, 16, v11
  v_and_b32 v123, 0xffff0000, v11
  v_mul_f32 v122, v122, v10
  v_mul_f32 v123, v123, v10
  v_cvt_pk_bf16_f32 v11, v122, v123
  v_lshlrev_b32 v122, 16, v11
  v_and_b32 v123, 0xffff0000, v11
  v_lshlrev_b32 v92, 16, v65
  v_and_b32 v93, 0xffff0000, v65
  v_mul_f32 v122, v122, v92
  v_mul_f32 v123, v123, v93
  v_cvt_pk_bf16_f32 v11, v122, v123
  v_lshlrev_b32 v122, 16, v11
  v_and_b32 v123, 0xffff0000, v11
  v_lshlrev_b32 v92, 16, v85
  v_and_b32 v93, 0xffff0000, v85
  v_add_f32 v122, v122, v92
  v_add_f32 v123, v123, v93
  v_cvt_pk_bf16_f32 v25, v122, v123
  v_sub_f32 v124, v124, v8
  v_sub_f32 v125, v125, v8
  v_cvt_pk_bf16_f32 v11, v124, v125
  v_lshlrev_b32 v124, 16, v11
  v_and_b32 v125, 0xffff0000, v11
  v_mul_f32 v124, v124, v10
  v_mul_f32 v125, v125, v10
  v_cvt_pk_bf16_f32 v11, v124, v125
  v_lshlrev_b32 v124, 16, v11
  v_and_b32 v125, 0xffff0000, v11
  v_lshlrev_b32 v92, 16, v66
  v_and_b32 v93, 0xffff0000, v66
  v_mul_f32 v124, v124, v92
  v_mul_f32 v125, v125, v93
  v_cvt_pk_bf16_f32 v11, v124, v125
  v_lshlrev_b32 v124, 16, v11
  v_and_b32 v125, 0xffff0000, v11
  v_lshlrev_b32 v92, 16, v86
  v_and_b32 v93, 0xffff0000, v86
  v_add_f32 v124, v124, v92
  v_add_f32 v125, v125, v93
  v_cvt_pk_bf16_f32 v26, v124, v125
  v_sub_f32 v126, v126, v8
  v_sub_f32 v127, v127, v8
  v_cvt_pk_bf16_f32 v11, v126, v127
  v_lshlrev_b32 v126, 16, v11
  v_and_b32 v127, 0xffff0000, v11
  v_mul_f32 v126, v126, v10
  v_mul_f32 v127, v127, v10
  v_cvt_pk_bf16_f32 v11, v126, v127
  v_lshlrev_b32 v126, 16, v11
  v_and_b32 v127, 0xffff0000, v11
  v_lshlrev_b32 v92, 16, v67
  v_and_b32 v93, 0xffff0000, v67
  v_mul_f32 v126, v126, v92
  v_mul_f32 v127, v127, v93
  v_cvt_pk_bf16_f32 v11, v126, v127
  v_lshlrev_b32 v126, 16, v11
  v_and_b32 v127, 0xffff0000, v11
  v_lshlrev_b32 v92, 16, v87
  v_and_b32 v93, 0xffff0000, v87
  v_add_f32 v126, v126, v92
  v_add_f32 v127, v127, v93
  v_cvt_pk_bf16_f32 v27, v126, v127
  v_sub_f32 v128, v128, v8
  v_sub_f32 v129, v129, v8
  v_cvt_pk_bf16_f32 v11, v128, v129
  v_lshlrev_b32 v128, 16, v11
  v_and_b32 v129, 0xffff0000, v11
  v_mul_f32 v128, v128, v10
  v_mul_f32 v129, v129, v10
  v_cvt_pk_bf16_f32 v11, v128, v129
  v_lshlrev_b32 v128, 16, v11
  v_and_b32 v129, 0xffff0000, v11
  v_lshlrev_b32 v92, 16, v68
  v_and_b32 v93, 0xffff0000, v68
  v_mul_f32 v128, v128, v92
  v_mul_f32 v129, v129, v93
  v_cvt_pk_bf16_f32 v11, v128, v129
  v_lshlrev_b32 v128, 16, v11
  v_and_b32 v129, 0xffff0000, v11
  v_lshlrev_b32 v92, 16, v88
  v_and_b32 v93, 0xffff0000, v88
  v_add_f32 v128, v128, v92
  v_add_f32 v129, v129, v93
  v_cvt_pk_bf16_f32 v28, v128, v129
  v_sub_f32 v130, v130, v8
  v_sub_f32 v131, v131, v8
  v_cvt_pk_bf16_f32 v11, v130, v131
  v_lshlrev_b32 v130, 16, v11
  v_and_b32 v131, 0xffff0000, v11
  v_mul_f32 v130, v130, v10
  v_mul_f32 v131, v131, v10
  v_cvt_pk_bf16_f32 v11, v130, v131
  v_lshlrev_b32 v130, 16, v11
  v_and_b32 v131, 0xffff0000, v11
  v_lshlrev_b32 v92, 16, v69
  v_and_b32 v93, 0xffff0000, v69
  v_mul_f32 v130, v130, v92
  v_mul_f32 v131, v131, v93
  v_cvt_pk_bf16_f32 v11, v130, v131
  v_lshlrev_b32 v130, 16, v11
  v_and_b32 v131, 0xffff0000, v11
  v_lshlrev_b32 v92, 16, v89
  v_and_b32 v93, 0xffff0000, v89
  v_add_f32 v130, v130, v92
  v_add_f32 v131, v131, v93
  v_cvt_pk_bf16_f32 v29, v130, v131
  v_sub_f32 v132, v132, v8
  v_sub_f32 v133, v133, v8
  v_cvt_pk_bf16_f32 v11, v132, v133
  v_lshlrev_b32 v132, 16, v11
  v_and_b32 v133, 0xffff0000, v11
  v_mul_f32 v132, v132, v10
  v_mul_f32 v133, v133, v10
  v_cvt_pk_bf16_f32 v11, v132, v133
  v_lshlrev_b32 v132, 16, v11
  v_and_b32 v133, 0xffff0000, v11
  v_lshlrev_b32 v92, 16, v70
  v_and_b32 v93, 0xffff0000, v70
  v_mul_f32 v132, v132, v92
  v_mul_f32 v133, v133, v93
  v_cvt_pk_bf16_f32 v11, v132, v133
  v_lshlrev_b32 v132, 16, v11
  v_and_b32 v133, 0xffff0000, v11
  v_lshlrev_b32 v92, 16, v90
  v_and_b32 v93, 0xffff0000, v90
  v_add_f32 v132, v132, v92
  v_add_f32 v133, v133, v93
  v_cvt_pk_bf16_f32 v30, v132, v133
  v_sub_f32 v134, v134, v8
  v_sub_f32 v135, v135, v8
  v_cvt_pk_bf16_f32 v11, v134, v135
  v_lshlrev_b32 v134, 16, v11
  v_and_b32 v135, 0xffff0000, v11
  v_mul_f32 v134, v134, v10
  v_mul_f32 v135, v135, v10
  v_cvt_pk_bf16_f32 v11, v134, v135
  v_lshlrev_b32 v134, 16, v11
  v_and_b32 v135, 0xffff0000, v11
  v_lshlrev_b32 v92, 16, v71
  v_and_b32 v93, 0xffff0000, v71
  v_mul_f32 v134, v134, v92
  v_mul_f32 v135, v135, v93
  v_cvt_pk_bf16_f32 v11, v134, v135
  v_lshlrev_b32 v134, 16, v11
  v_and_b32 v135, 0xffff0000, v11
  v_lshlrev_b32 v92, 16, v91
  v_and_b32 v93, 0xffff0000, v91
  v_add_f32 v134, v134, v92
  v_add_f32 v135, v135, v93
  v_cvt_pk_bf16_f32 v31, v134, v135
  s_nop 1
  buffer_store_dwordx4 v[12:15], v3, s[16:19], 0 offen offset:0 sc1
  buffer_store_dwordx4 v[16:19], v3, s[16:19], 0 offen offset:256 sc1
  buffer_store_dwordx4 v[20:23], v3, s[16:19], 0 offen offset:512 sc1
  buffer_store_dwordx4 v[24:27], v3, s[16:19], 0 offen offset:768 sc1
  buffer_store_dwordx4 v[28:31], v6, s[16:19], 0 offen offset:1024 sc1
  s_waitcnt vmcnt(0)
  s_barrier
  s_cmp_lg_u32 s3, 0
  s_cbranch_scc1 Ls_skip_62
  s_lshl_b32 s50, s92, 7
  s_add_u32 s50, s50, 17408
  v_mov_b32 v2, 1
  s_mov_b64 exec, 1
  buffer_atomic_add v2, off, s[88:91], s50
  s_mov_b64 exec, -1
Ls_skip_62:
  s_add_u32 s85, s85, 1
  s_cmp_lt_u32 s85, 16
  s_cbranch_scc1 Lmg_rb_59
  s_branch Lmg_next_3
Lmg_t5_31:
  s_mov_b32 s10, s98
  s_mov_b32 s11, s99
  s_mov_b32 s36, s93
  s_load_dwordx2 s[4:5], s[0:1], 64
  s_waitcnt lgkmcnt(0)
  s_add_u32 s12, s10, 0x4c92000
  s_addc_u32 s13, s11, 0
  s_mov_b32 s14, 0x240000
  s_mov_b32 s15, 0x20000
  s_mov_b32 s16, s4
  s_mov_b32 s17, s5
  s_mov_b32 s18, 0x510000
  s_mov_b32 s19, 0x20000
  s_cmp_ge_u32 s36, 12
  s_mov_b32 s37, 0x4ed2000
  s_cselect_b32 s37, 0x57d2000, s37
  s_add_u32 s20, s10, s37
  s_addc_u32 s21, s11, 0
  s_mov_b32 s22, 9437184
  s_mov_b32 s23, 0x20000
  s_sub_u32 s35, s36, 12
  s_cmp_ge_u32 s36, 12
  s_cselect_b32 s35, s35, s36
  v_and_b32 v1, 63, v0
  v_lshrrev_b32 v2, 3, v1
  v_xor_b32 v3, v2, v1
  v_and_b32 v3, 7, v3
  s_mov_b32 s40, 1152
  v_mul_lo_u32 v2, v2, s40
  v_lshl_add_u32 v2, v3, 4, v2
  s_add_u32 s41, s3, 0
  s_mul_i32 s41, s41, 9216
  v_add_u32 v4, s41, v2
  s_add_u32 s41, s3, 4
  s_mul_i32 s41, s41, 9216
  v_add_u32 v5, s41, v2
  s_add_u32 s41, s3, 0
  s_min_u32 s41, s41, 11
  s_lshl_b32 s41, s41, 6
  v_add_u32 v72, s41, v1
  s_mov_b32 s42, 0xaaaaaab
  v_mul_hi_u32 v73, v72, s42
  v_mul_u32_u24 v74, 24, v73
  v_sub_u32 v74, v72, v74
  v_bfe_u32 v75, v73, 1, 1
  v_bfe_u32 v76, v73, 3, 1
  v_lshl_add_u32 v75, v76, 1, v75
  v_lshrrev_b32 v76, 1, v74
  v_sub_u32 v76, v76, v75
  v_add_u32 v75, 12, v76
  v_cmp_gt_i32 vcc, 0, v76
  s_nop 1
  v_cndmask_b32 v76, v76, v75, vcc
  v_and_b32 v74, 1, v74
  v_lshlrev_b32 v74, 4, v74
  v_lshl_add_u32 v74, v76, 5, v74
  s_mov_b32 s42, 9216
  v_mul_lo_u32 v73, v73, s42
  v_add_u32 v6, v73, v74
  s_add_u32 s41, s3, 4
  s_min_u32 s41, s41, 11
  s_lshl_b32 s41, s41, 6
  v_add_u32 v72, s41, v1
  s_mov_b32 s42, 0xaaaaaab
  v_mul_hi_u32 v73, v72, s42
  v_mul_u32_u24 v74, 24, v73
  v_sub_u32 v74, v72, v74
  v_bfe_u32 v75, v73, 1, 1
  v_bfe_u32 v76, v73, 3, 1
  v_lshl_add_u32 v75, v76, 1, v75
  v_lshrrev_b32 v76, 1, v74
  v_sub_u32 v76, v76, v75
  v_add_u32 v75, 12, v76
  v_cmp_gt_i32 vcc, 0, v76
  s_nop 1
  v_cndmask_b32 v76, v76, v75, vcc
  v_and_b32 v74, 1, v74
  v_lshlrev_b32 v74, 4, v74
  v_lshl_add_u32 v74, v76, 5, v74
  s_mov_b32 s42, 9216
  v_mul_lo_u32 v73, v73, s42
  v_add_u32 v7, v73, v74
  s_add_u32 s41, s3, 8
  s_min_u32 s41, s41, 11
  s_lshl_b32 s41, s41, 6
  v_add_u32 v72, s41, v1
  s_mov_b32 s42, 0xaaaaaab
  v_mul_hi_u32 v73, v72, s42
  v_mul_u32_u24 v74, 24, v73
  v_sub_u32 v74, v72, v74
  v_bfe_u32 v75, v73, 1, 1
  v_bfe_u32 v76, v73, 3, 1
  v_lshl_add_u32 v75, v76, 1, v75
  v_lshrrev_b32 v76, 1, v74
  v_sub_u32 v76, v76, v75
  v_add_u32 v75, 12, v76
  v_cmp_gt_i32 vcc, 0, v76
  s_nop 1
  v_cndmask_b32 v76, v76, v75, vcc
  v_and_b32 v74, 1, v74
  v_lshlrev_b32 v74, 4, v74
  v_lshl_add_u32 v74, v76, 5, v74
  s_mov_b32 s42, 9216
  v_mul_lo_u32 v73, v73, s42
  v_add_u32 v8, v73, v74
  v_and_b32 v2, 15, v1
  v_lshrrev_b32 v72, 4, v1
  v_and_b32 v3, 7, v2
  v_xor_b32 v3, v3, v72
  v_lshlrev_b32 v3, 4, v3
  v_lshl_add_u32 v3, v2, 7, v3
  s_lshr_b32 s41, s3, 1
  s_mul_i32 s41, s41, 4096
  s_add_u32 s41, s41, 98304
  v_add_u32 v9, s41, v3
  v_xor_b32 v10, 64, v9
  v_bfe_u32 v2, v1, 2, 2
  v_lshl_add_u32 v2, v72, 3, v2
  v_bfe_u32 v75, v2, 1, 1
  v_bfe_u32 v76, v2, 3, 1
  v_lshl_add_u32 v75, v76, 1, v75
  v_mul_u32_u24 v2, 384, v2
  v_and_b32 v3, 3, v1
  v_lshl_add_u32 v2, v3, 3, v2
  s_and_b32 s41, s3, 1
  s_mul_i32 s41, s41, 6
  s_add_u32 s42, s41, 0
  v_add_u32 v73, s42, v75
  v_subrev_u32 v74, 12, v73
  v_cmp_le_u32 vcc, 12, v73
  s_nop 1
  v_cndmask_b32 v73, v73, v74, vcc
  v_lshl_add_u32 v11, v73, 5, v2
  v_add_u32 v17, 49152, v11
  s_add_u32 s42, s41, 1
  v_add_u32 v73, s42, v75
  v_subrev_u32 v74, 12, v73
  v_cmp_le_u32 vcc, 12, v73
  s_nop 1
  v_cndmask_b32 v73, v73, v74, vcc
  v_lshl_add_u32 v12, v73, 5, v2
  v_add_u32 v18, 49152, v12
  s_add_u32 s42, s41, 2
  v_add_u32 v73, s42, v75
  v_subrev_u32 v74, 12, v73
  v_cmp_le_u32 vcc, 12, v73
  s_nop 1
  v_cndmask_b32 v73, v73, v74, vcc
  v_lshl_add_u32 v13, v73, 5, v2
  v_add_u32 v19, 49152, v13
  s_add_u32 s42, s41, 3
  v_add_u32 v73, s42, v75
  v_subrev_u32 v74, 12, v73
  v_cmp_le_u32 vcc, 12, v73
  s_nop 1
  v_cndmask_b32 v73, v73, v74, vcc
  v_lshl_add_u32 v14, v73, 5, v2
  v_add_u32 v20, 49152, v14
  s_add_u32 s42, s41, 4
  v_add_u32 v73, s42, v75
  v_subrev_u32 v74, 12, v73
  v_cmp_le_u32 vcc, 12, v73
  s_nop 1
  v_cndmask_b32 v73, v73, v74, vcc
  v_lshl_add_u32 v15, v73, 5, v2
  v_add_u32 v21, 49152, v15
  s_add_u32 s42, s41, 5
  v_add_u32 v73, s42, v75
  v_subrev_u32 v74, 12, v73
  v_cmp_le_u32 vcc, 12, v73
  s_nop 1
  v_cndmask_b32 v73, v73, v74, vcc
  v_lshl_add_u32 v16, v73, 5, v2
  v_add_u32 v22, 49152, v16
  s_lshl_b32 s44, s3, 10
  s_add_u32 s45, s44, 98304
  s_mov_b32 s85, 0
Lmg_rb_63:
  s_mov_b32 s92, s85
  s_cmp_lg_u32 s3, 0
  s_cbranch_scc1 Lw_skip_64
  s_mov_b64 exec, 1
  s_lshl_b32 s50, s92, 7
  s_add_u32 s50, s50, 17408
  s_mov_b32 s52, 0
Lw_lp_65:
  buffer_load_dword v2, off, s[88:91], s50 sc1
  s_waitcnt vmcnt(0)
  v_readfirstlane_b32 s51, v2
  s_add_u32 s52, s52, 1
  s_cmp_gt_u32 s52, 2000000
  s_cbranch_scc1 Lw_lp_65_x
  s_cmp_ge_u32 s51, 8
  s_cbranch_scc1 Lw_lp_65_x
  s_sleep 4
  s_branch Lw_lp_65
Lw_lp_65_x:
  s_mov_b64 exec, -1
Lw_skip_64:
  s_barrier
  s_lshl_b32 s32, s92, 1
  s_add_u32 s32, s32, s87
  s_mul_i32 s46, s32, 73728
  s_mul_i32 s47, s36, 384
  s_add_u32 m0, s45, 0
  s_nop 0
  buffer_load_dwordx4 v4, s[12:15], s46 offen lds
  s_add_u32 m0, s44, 0
  s_nop 0
  buffer_load_dwordx4 v6, s[16:19], s47 offen lds
  s_add_u32 m0, s44, 4096
  s_nop 0
  buffer_load_dwordx4 v7, s[16:19], s47 offen lds
  s_add_u32 m0, s44, 8192
  s_nop 0
  buffer_load_dwordx4 v8, s[16:19], s47 offen lds
  s_add_u32 s47, s47, 294912
  s_add_u32 m0, s45, 4096
  s_nop 0
  buffer_load_dwordx4 v5, s[12:15], s46 offen lds
  s_add_u32 m0, s44, 12288
  s_nop 0
  buffer_load_dwordx4 v6, s[16:19], s47 offen lds
  s_add_u32 m0, s44, 16384
  s_nop 0
  buffer_load_dwordx4 v7, s[16:19], s47 offen lds
  s_add_u32 m0, s44, 20480
  s_nop 0
  buffer_load_dwordx4 v8, s[16:19], s47 offen lds
  s_add_u32 s46, s46, 128
  s_add_u32 s47, s47, 294912
  s_add_u32 m0, s45, 8192
  s_nop 0
  buffer_load_dwordx4 v4, s[12:15], s46 offen lds
  s_add_u32 m0, s44, 24576
  s_nop 0
  buffer_load_dwordx4 v6, s[16:19], s47 offen lds
  s_add_u32 m0, s44, 28672
  s_nop 0
  buffer_load_dwordx4 v7, s[16:19], s47 offen lds
  s_add_u32 m0, s44, 32768
  s_nop 0
  buffer_load_dwordx4 v8, s[16:19], s47 offen lds
  s_add_u32 s47, s47, 294912
  s_add_u32 m0, s45, 12288
  s_nop 0
  buffer_load_dwordx4 v5, s[12:15], s46 offen lds
  s_add_u32 m0, s44, 36864
  s_nop 0
  buffer_load_dwordx4 v6, s[16:19], s47 offen lds
  s_add_u32 m0, s44, 40960
  s_nop 0
  buffer_load_dwordx4 v7, s[16:19], s47 offen lds
  s_add_u32 m0, s44, 45056
  s_nop 0
  buffer_load_dwordx4 v8, s[16:19], s47 offen lds
  s_add_u32 s46, s46, 128
  s_add_u32 s47, s47, 294912
  s_add_u32 m0, s45, 16384
  s_nop 0
  buffer_load_dwordx4 v4, s[12:15], s46 offen lds
  s_add_u32 m0, s44, 49152
  s_nop 0
  buffer_load_dwordx4 v6, s[16:19], s47 offen lds
  s_add_u32 m0, s44, 53248
  s_nop 0
  buffer_load_dwordx4 v7, s[16:19], s47 offen lds
  s_add_u32 m0, s44, 57344
  s_nop 0
  buffer_load_dwordx4 v8, s[16:19], s47 offen lds
  s_add_u32 s47, s47, 294912
  s_add_u32 m0, s45, 20480
  s_nop 0
  buffer_load_dwordx4 v5, s[12:15], s46 offen lds
  s_add_u32 m0, s44, 61440
  s_nop 0
  buffer_load_dwordx4 v6, s[16:19], s47 offen lds
  s_add_u32 m0, s44, 65536
  s_nop 0
  buffer_load_dwordx4 v7, s[16:19], s47 offen lds
  s_add_u32 m0, s44, 69632
  s_nop 0
  buffer_load_dwordx4 v8, s[16:19], s47 offen lds
  s_add_u32 s46, s46, 128
  s_add_u32 s47, s47, 294912
  s_add_u32 m0, s45, 24576
  s_nop 0
  buffer_load_dwordx4 v4, s[12:15], s46 offen lds
  s_add_u32 m0, s44, 73728
  s_nop 0
  buffer_load_dwordx4 v6, s[16:19], s47 offen lds
  s_add_u32 m0, s44, 77824
  s_nop 0
  buffer_load_dwordx4 v7, s[16:19], s47 offen lds
  s_add_u32 m0, s44, 81920
  s_nop 0
  buffer_load_dwordx4 v8, s[16:19], s47 offen lds
  s_add_u32 s47, s47, 294912
  s_add_u32 m0, s45, 28672
  s_nop 0
  buffer_load_dwordx4 v5, s[12:15], s46 offen lds
  s_add_u32 m0, s44, 86016
  s_nop 0
  buffer_load_dwordx4 v6, s[16:19], s47 offen lds
  s_add_u32 m0, s44, 90112
  s_nop 0
  buffer_load_dwordx4 v7, s[16:19], s47 offen lds
  s_add_u32 m0, s44, 94208
  s_nop 0
  buffer_load_dwordx4 v8, s[16:19], s47 offen lds
  s_add_u32 s46, s46, 128
  s_add_u32 s47, s47, 294912
  v_mov_b32 v24, 0
  v_mov_b32 v25, 0
  v_mov_b32 v26, 0
  v_mov_b32 v27, 0
  v_mov_b32 v28, 0
  v_mov_b32 v29, 0
  v_mov_b32 v30, 0
  v_mov_b32 v31, 0
  v_mov_b32 v32, 0
  v_mov_b32 v33, 0
  v_mov_b32 v34, 0
  v_mov_b32 v35, 0
  v_mov_b32 v36, 0
  v_mov_b32 v37, 0
  v_mov_b32 v38, 0
  v_mov_b32 v39, 0
  v_mov_b32 v40, 0
  v_mov_b32 v41, 0
  v_mov_b32 v42, 0
  v_mov_b32 v43, 0
  v_mov_b32 v44, 0
  v_mov_b32 v45, 0
  v_mov_b32 v46, 0
  v_mov_b32 v47, 0
  v_mov_b32 v48, 0
  v_mov_b32 v49, 0
  v_mov_b32 v50, 0
  v_mov_b32 v51, 0
  v_mov_b32 v52, 0
  v_mov_b32 v53, 0
  v_mov_b32 v54, 0
  v_mov_b32 v55, 0
  v_mov_b32 v56, 0
  v_mov_b32 v57, 0
  v_mov_b32 v58, 0
  v_mov_b32 v59, 0
  v_mov_b32 v60, 0
  v_mov_b32 v61, 0
  v_mov_b32 v62, 0
  v_mov_b32 v63, 0
  v_mov_b32 v64, 0
  v_mov_b32 v65, 0
  v_mov_b32 v66, 0
  v_mov_b32 v67, 0
  v_mov_b32 v68, 0
  v_mov_b32 v69, 0
  v_mov_b32 v70, 0
  v_mov_b32 v71, 0
  s_waitcnt vmcnt(24)
  s_barrier
  ds_read_b128 a[0:3], v9 offset:0
  ds_read_b128 a[4:7], v9 offset:2048
  ds_read_b64_tr_b16 a[8:9], v11 offset:0
  ds_read_b64_tr_b16 a[10:11], v11 offset:1536
  ds_read_b64_tr_b16 a[12:13], v12 offset:0
  ds_read_b64_tr_b16 a[14:15], v12 offset:1536
  ds_read_b64_tr_b16 a[16:17], v13 offset:0
  ds_read_b64_tr_b16 a[18:19], v13 offset:1536
  ds_read_b64_tr_b16 a[20:21], v14 offset:0
  ds_read_b64_tr_b16 a[22:23], v14 offset:1536
  ds_read_b64_tr_b16 a[24:25], v15 offset:0
  ds_read_b64_tr_b16 a[26:27], v15 offset:1536
  ds_read_b64_tr_b16 a[28:29], v16 offset:0
  ds_read_b64_tr_b16 a[30:31], v16 offset:1536
  s_waitcnt lgkmcnt(0)
  v_mfma_f32_16x16x32_bf16 v[24:27], a[8:11], a[0:3], v[24:27]
  ds_read_b128 a[32:35], v10 offset:0
  ds_read_b128 a[36:39], v10 offset:2048
  ds_read_b64_tr_b16 a[40:41], v11 offset:12288
  v_mfma_f32_16x16x32_bf16 v[28:31], a[12:15], a[0:3], v[28:31]
  ds_read_b64_tr_b16 a[42:43], v11 offset:13824
  ds_read_b64_tr_b16 a[44:45], v12 offset:12288
  v_mfma_f32_16x16x32_bf16 v[32:35], a[16:19], a[0:3], v[32:35]
  ds_read_b64_tr_b16 a[46:47], v12 offset:13824
  ds_read_b64_tr_b16 a[48:49], v13 offset:12288
  v_mfma_f32_16x16x32_bf16 v[36:39], a[20:23], a[0:3], v[36:39]
  ds_read_b64_tr_b16 a[50:51], v13 offset:13824
  ds_read_b64_tr_b16 a[52:53], v14 offset:12288
  ds_read_b64_tr_b16 a[54:55], v14 offset:13824
  v_mfma_f32_16x16x32_bf16 v[40:43], a[24:27], a[0:3], v[40:43]
  ds_read_b64_tr_b16 a[56:57], v15 offset:12288
  ds_read_b64_tr_b16 a[58:59], v15 offset:13824
  v_mfma_f32_16x16x32_bf16 v[44:47], a[28:31], a[0:3], v[44:47]
  ds_read_b64_tr_b16 a[60:61], v16 offset:12288
  ds_read_b64_tr_b16 a[62:63], v16 offset:13824
  v_mfma_f32_16x16x32_bf16 v[48:51], a[8:11], a[4:7], v[48:51]
  v_mfma_f32_16x16x32_bf16 v[52:55], a[12:15], a[4:7], v[52:55]
  v_mfma_f32_16x16x32_bf16 v[56:59], a[16:19], a[4:7], v[56:59]
  v_mfma_f32_16x16x32_bf16 v[60:63], a[20:23], a[4:7], v[60:63]
  v_mfma_f32_16x16x32_bf16 v[64:67], a[24:27], a[4:7], v[64:67]
  v_mfma_f32_16x16x32_bf16 v[68:71], a[28:31], a[4:7], v[68:71]
  s_waitcnt vmcnt(16) lgkmcnt(0)
  s_barrier
  v_mfma_f32_16x16x32_bf16 v[24:27], a[40:43], a[32:35], v[24:27]
  ds_read_b128 a[0:3], v9 offset:8192
  ds_read_b128 a[4:7], v9 offset:10240
  ds_read_b64_tr_b16 a[8:9], v11 offset:24576
  s_add_u32 m0, s45, 0
  v_mfma_f32_16x16x32_bf16 v[28:31], a[44:47], a[32:35], v[28:31]
  ds_read_b64_tr_b16 a[10:11], v11 offset:26112
  ds_read_b64_tr_b16 a[12:13], v12 offset:24576
  buffer_load_dwordx4 v4, s[12:15], s46 offen lds
  v_mfma_f32_16x16x32_bf16 v[32:35], a[48:51], a[32:35], v[32:35]
  ds_read_b64_tr_b16 a[14:15], v12 offset:26112
  ds_read_b64_tr_b16 a[16:17], v13 offset:24576
  s_add_u32 m0, s44, 0
  v_mfma_f32_16x16x32_bf16 v[36:39], a[52:55], a[32:35], v[36:39]
  ds_read_b64_tr_b16 a[18:19], v13 offset:26112
  ds_read_b64_tr_b16 a[20:21], v14 offset:24576
  ds_read_b64_tr_b16 a[22:23], v14 offset:26112
  v_mfma_f32_16x16x32_bf16 v[40:43], a[56:59], a[32:35], v[40:43]
  ds_read_b64_tr_b16 a[24:25], v15 offset:24576
  ds_read_b64_tr_b16 a[26:27], v15 offset:26112
  buffer_load_dwordx4 v6, s[16:19], s47 offen lds
  v_mfma_f32_16x16x32_bf16 v[44:47], a[60:63], a[32:35], v[44:47]
  ds_read_b64_tr_b16 a[28:29], v16 offset:24576
  ds_read_b64_tr_b16 a[30:31], v16 offset:26112
  s_add_u32 m0, s44, 4096
  v_mfma_f32_16x16x32_bf16 v[48:51], a[40:43], a[36:39], v[48:51]
  buffer_load_dwordx4 v7, s[16:19], s47 offen lds
  v_mfma_f32_16x16x32_bf16 v[52:55], a[44:47], a[36:39], v[52:55]
  v_mfma_f32_16x16x32_bf16 v[56:59], a[48:51], a[36:39], v[56:59]
  s_add_u32 m0, s44, 8192
  v_mfma_f32_16x16x32_bf16 v[60:63], a[52:55], a[36:39], v[60:63]
  buffer_load_dwordx4 v8, s[16:19], s47 offen lds
  v_mfma_f32_16x16x32_bf16 v[64:67], a[56:59], a[36:39], v[64:67]
  s_add_u32 s47, s47, 294912
  v_mfma_f32_16x16x32_bf16 v[68:71], a[60:63], a[36:39], v[68:71]
  s_waitcnt lgkmcnt(0)
  v_mfma_f32_16x16x32_bf16 v[24:27], a[8:11], a[0:3], v[24:27]
  ds_read_b128 a[32:35], v10 offset:8192
  ds_read_b128 a[36:39], v10 offset:10240
  ds_read_b64_tr_b16 a[40:41], v11 offset:36864
  s_add_u32 m0, s45, 4096
  v_mfma_f32_16x16x32_bf16 v[28:31], a[12:15], a[0:3], v[28:31]
  ds_read_b64_tr_b16 a[42:43], v11 offset:38400
  ds_read_b64_tr_b16 a[44:45], v12 offset:36864
  buffer_load_dwordx4 v5, s[12:15], s46 offen lds
  v_mfma_f32_16x16x32_bf16 v[32:35], a[16:19], a[0:3], v[32:35]
  ds_read_b64_tr_b16 a[46:47], v12 offset:38400
  ds_read_b64_tr_b16 a[48:49], v13 offset:36864
  s_add_u32 m0, s44, 12288
  v_mfma_f32_16x16x32_bf16 v[36:39], a[20:23], a[0:3], v[36:39]
  ds_read_b64_tr_b16 a[50:51], v13 offset:38400
  ds_read_b64_tr_b16 a[52:53], v14 offset:36864
  ds_read_b64_tr_b16 a[54:55], v14 offset:38400
  v_mfma_f32_16x16x32_bf16 v[40:43], a[24:27], a[0:3], v[40:43]
  ds_read_b64_tr_b16 a[56:57], v15 offset:36864
  ds_read_b64_tr_b16 a[58:59], v15 offset:38400
  buffer_load_dwordx4 v6, s[16:19], s47 offen lds
  v_mfma_f32_16x16x32_bf16 v[44:47], a[28:31], a[0:3], v[44:47]
  ds_read_b64_tr_b16 a[60:61], v16 offset:36864
  ds_read_b64_tr_b16 a[62:63], v16 offset:38400
  s_add_u32 m0, s44, 16384
  v_mfma_f32_16x16x32_bf16 v[48:51], a[8:11], a[4:7], v[48:51]
  buffer_load_dwordx4 v7, s[16:19], s47 offen lds
  v_mfma_f32_16x16x32_bf16 v[52:55], a[12:15], a[4:7], v[52:55]
  v_mfma_f32_16x16x32_bf16 v[56:59], a[16:19], a[4:7], v[56:59]
  s_add_u32 m0, s44, 20480
  v_mfma_f32_16x16x32_bf16 v[60:63], a[20:23], a[4:7], v[60:63]
  buffer_load_dwordx4 v8, s[16:19], s47 offen lds
  v_mfma_f32_16x16x32_bf16 v[64:67], a[24:27], a[4:7], v[64:67]
  s_add_u32 s46, s46, 128
  s_add_u32 s47, s47, 294912
  v_mfma_f32_16x16x32_bf16 v[68:71], a[28:31], a[4:7], v[68:71]
  s_waitcnt vmcnt(16) lgkmcnt(0)
  s_barrier
  v_mfma_f32_16x16x32_bf16 v[24:27], a[40:43], a[32:35], v[24:27]
  ds_read_b128 a[0:3], v9 offset:16384
  ds_read_b128 a[4:7], v9 offset:18432
  ds_read_b64_tr_b16 a[8:9], v17 offset:0
  s_add_u32 m0, s45, 8192
  v_mfma_f32_16x16x32_bf16 v[28:31], a[44:47], a[32:35], v[28:31]
  ds_read_b64_tr_b16 a[10:11], v17 offset:1536
  ds_read_b64_tr_b16 a[12:13], v18 offset:0
  buffer_load_dwordx4 v4, s[12:15], s46 offen lds
  v_mfma_f32_16x16x32_bf16 v[32:35], a[48:51], a[32:35], v[32:35]
  ds_read_b64_tr_b16 a[14:15], v18 offset:1536
  ds_read_b64_tr_b16 a[16:17], v19 offset:0
  s_add_u32 m0, s44, 24576
  v_mfma_f32_16x16x32_bf16 v[36:39], a[52:55], a[32:35], v[36:39]
  ds_read_b64_tr_b16 a[18:19], v19 offset:1536
  ds_read_b64_tr_b16 a[20:21], v20 offset:0
  ds_read_b64_tr_b16 a[22:23], v20 offset:1536
  v_mfma_f32_16x16x32_bf16 v[40:43], a[56:59], a[32:35], v[40:43]
  ds_read_b64_tr_b16 a[24:25], v21 offset:0
  ds_read_b64_tr_b16 a[26:27], v21 offset:1536
  buffer_load_dwordx4 v6, s[16:19], s47 offen lds
  v_mfma_f32_16x16x32_bf16 v[44:47], a[60:63], a[32:35], v[44:47]
  ds_read_b64_tr_b16 a[28:29], v22 offset:0
  ds_read_b64_tr_b16 a[30:31], v22 offset:1536
  s_add_u32 m0, s44, 28672
  v_mfma_f32_16x16x32_bf16 v[48:51], a[40:43], a[36:39], v[48:51]
  buffer_load_dwordx4 v7, s[16:19], s47 offen lds
  v_mfma_f32_16x16x32_bf16 v[52:55], a[44:47], a[36:39], v[52:55]
  v_mfma_f32_16x16x32_bf16 v[56:59], a[48:51], a[36:39], v[56:59]
  s_add_u32 m0, s44, 32768
  v_mfma_f32_16x16x32_bf16 v[60:63], a[52:55], a[36:39], v[60:63]
  buffer_load_dwordx4 v8, s[16:19], s47 offen lds
  v_mfma_f32_16x16x32_bf16 v[64:67], a[56:59], a[36:39], v[64:67]
  s_add_u32 s47, s47, 294912
  v_mfma_f32_16x16x32_bf16 v[68:71], a[60:63], a[36:39], v[68:71]
  s_waitcnt lgkmcnt(0)
  v_mfma_f32_16x16x32_bf16 v[24:27], a[8:11], a[0:3], v[24:27]
  ds_read_b128 a[32:35], v10 offset:16384
  ds_read_b128 a[36:39], v10 offset:18432
  ds_read_b64_tr_b16 a[40:41], v17 offset:12288
  s_add_u32 m0, s45, 12288
  v_mfma_f32_16x16x32_bf16 v[28:31], a[12:15], a[0:3], v[28:31]
  ds_read_b64_tr_b16 a[42:43], v17 offset:13824
  ds_read_b64_tr_b16 a[44:45], v18 offset:12288
  buffer_load_dwordx4 v5, s[12:15], s46 offen lds
  v_mfma_f32_16x16x32_bf16 v[32:35], a[16:19], a[0:3], v[32:35]
  ds_read_b64_tr_b16 a[46:47], v18 offset:13824
  ds_read_b64_tr_b16 a[48:49], v19 offset:12288
  s_add_u32 m0, s44, 36864
  v_mfma_f32_16x16x32_bf16 v[36:39], a[20:23], a[0:3], v[36:39]
  ds_read_b64_tr_b16 a[50:51], v19 offset:13824
  ds_read_b64_tr_b16 a[52:53], v20 offset:12288
  ds_read_b64_tr_b16 a[54:55], v20 offset:13824
  v_mfma_f32_16x16x32_bf16 v[40:43], a[24:27], a[0:3], v[40:43]
  ds_read_b64_tr_b16 a[56:57], v21 offset:12288
  ds_read_b64_tr_b16 a[58:59], v21 offset:13824
  buffer_load_dwordx4 v6, s[16:19], s47 offen lds
  v_mfma_f32_16x16x32_bf16 v[44:47], a[28:31], a[0:3], v[44:47]
  ds_read_b64_tr_b16 a[60:61], v22 offset:12288
  ds_read_b64_tr_b16 a[62:63], v22 offset:13824
  s_add_u32 m0, s44, 40960
  v_mfma_f32_16x16x32_bf16 v[48:51], a[8:11], a[4:7], v[48:51]
  buffer_load_dwordx4 v7, s[16:19], s47 offen lds
  v_mfma_f32_16x16x32_bf16 v[52:55], a[12:15], a[4:7], v[52:55]
  v_mfma_f32_16x16x32_bf16 v[56:59], a[16:19], a[4:7], v[56:59]
  s_add_u32 m0, s44, 45056
  v_mfma_f32_16x16x32_bf16 v[60:63], a[20:23], a[4:7], v[60:63]
  buffer_load_dwordx4 v8, s[16:19], s47 offen lds
  v_mfma_f32_16x16x32_bf16 v[64:67], a[24:27], a[4:7], v[64:67]
  s_add_u32 s46, s46, 128
  s_add_u32 s47, s47, 294912
  v_mfma_f32_16x16x32_bf16 v[68:71], a[28:31], a[4:7], v[68:71]
  s_waitcnt vmcnt(16) lgkmcnt(0)
  s_barrier
  v_mfma_f32_16x16x32_bf16 v[24:27], a[40:43], a[32:35], v[24:27]
  ds_read_b128 a[0:3], v9 offset:24576
  ds_read_b128 a[4:7], v9 offset:26624
  ds_read_b64_tr_b16 a[8:9], v17 offset:24576
  s_add_u32 m0, s45, 16384
  v_mfma_f32_16x16x32_bf16 v[28:31], a[44:47], a[32:35], v[28:31]
  ds_read_b64_tr_b16 a[10:11], v17 offset:26112
  ds_read_b64_tr_b16 a[12:13], v18 offset:24576
  buffer_load_dwordx4 v4, s[12:15], s46 offen lds
  v_mfma_f32_16x16x32_bf16 v[32:35], a[48:51], a[32:35], v[32:35]
  ds_read_b64_tr_b16 a[14:15], v18 offset:26112
  ds_read_b64_tr_b16 a[16:17], v19 offset:24576
  s_add_u32 m0, s44, 49152
  v_mfma_f32_16x16x32_bf16 v[36:39], a[52:55], a[32:35], v[36:39]
  ds_read_b64_tr_b16 a[18:19], v19 offset:26112
  ds_read_b64_tr_b16 a[20:21], v20 offset:24576
  ds_read_b64_tr_b16 a[22:23], v20 offset:26112
  v_mfma_f32_16x16x32_bf16 v[40:43], a[56:59], a[32:35], v[40:43]
  ds_read_b64_tr_b16 a[24:25], v21 offset:24576
  ds_read_b64_tr_b16 a[26:27], v21 offset:26112
  buffer_load_dwordx4 v6, s[16:19], s47 offen lds
  v_mfma_f32_16x16x32_bf16 v[44:47], a[60:63], a[32:35], v[44:47]
  ds_read_b64_tr_b16 a[28:29], v22 offset:24576
  ds_read_b64_tr_b16 a[30:31], v22 offset:26112
  s_add_u32 m0, s44, 53248
  v_mfma_f32_16x16x32_bf16 v[48:51], a[40:43], a[36:39], v[48:51]
  buffer_load_dwordx4 v7, s[16:19], s47 offen lds
  v_mfma_f32_16x16x32_bf16 v[52:55], a[44:47], a[36:39], v[52:55]
  v_mfma_f32_16x16x32_bf16 v[56:59], a[48:51], a[36:39], v[56:59]
  s_add_u32 m0, s44, 57344
  v_mfma_f32_16x16x32_bf16 v[60:63], a[52:55], a[36:39], v[60:63]
  buffer_load_dwordx4 v8, s[16:19], s47 offen lds
  v_mfma_f32_16x16x32_bf16 v[64:67], a[56:59], a[36:39], v[64:67]
  s_add_u32 s47, s47, 294912
  v_mfma_f32_16x16x32_bf16 v[68:71], a[60:63], a[36:39], v[68:71]
  s_waitcnt lgkmcnt(0)
  v_mfma_f32_16x16x32_bf16 v[24:27], a[8:11], a[0:3], v[24:27]
  ds_read_b128 a[32:35], v10 offset:24576
  ds_read_b128 a[36:39], v10 offset:26624
  ds_read_b64_tr_b16 a[40:41], v17 offset:36864
  s_add_u32 m0, s45, 20480
  v_mfma_f32_16x16x32_bf16 v[28:31], a[12:15], a[0:3], v[28:31]
  ds_read_b64_tr_b16 a[42:43], v17 offset:38400
  ds_read_b64_tr_b16 a[44:45], v18 offset:36864
  buffer_load_dwordx4 v5, s[12:15], s46 offen lds
  v_mfma_f32_16x16x32_bf16 v[32:35], a[16:19], a[0:3], v[32:35]
  ds_read_b64_tr_b16 a[46:47], v18 offset:38400
  ds_read_b64_tr_b16 a[48:49], v19 offset:36864
  s_add_u32 m0, s44, 61440
  v_mfma_f32_16x16x32_bf16 v[36:39], a[20:23], a[0:3], v[36:39]
  ds_read_b64_tr_b16 a[50:51], v19 offset:38400
  ds_read_b64_tr_b16 a[52:53], v20 offset:36864
  ds_read_b64_tr_b16 a[54:55], v20 offset:38400
  v_mfma_f32_16x16x32_bf16 v[40:43], a[24:27], a[0:3], v[40:43]
  ds_read_b64_tr_b16 a[56:57], v21 offset:36864
  ds_read_b64_tr_b16 a[58:59], v21 offset:38400
  buffer_load_dwordx4 v6, s[16:19], s47 offen lds
  v_mfma_f32_16x16x32_bf16 v[44:47], a[28:31], a[0:3], v[44:47]
  ds_read_b64_tr_b16 a[60:61], v22 offset:36864
  ds_read_b64_tr_b16 a[62:63], v22 offset:38400
  s_add_u32 m0, s44, 65536
  v_mfma_f32_16x16x32_bf16 v[48:51], a[8:11], a[4:7], v[48:51]
  buffer_load_dwordx4 v7, s[16:19], s47 offen lds
  v_mfma_f32_16x16x32_bf16 v[52:55], a[12:15], a[4:7], v[52:55]
  v_mfma_f32_16x16x32_bf16 v[56:59], a[16:19], a[4:7], v[56:59]
  s_add_u32 m0, s44, 69632
  v_mfma_f32_16x16x32_bf16 v[60:63], a[20:23], a[4:7], v[60:63]
  buffer_load_dwordx4 v8, s[16:19], s47 offen lds
  v_mfma_f32_16x16x32_bf16 v[64:67], a[24:27], a[4:7], v[64:67]
  s_add_u32 s46, s46, 128
  s_add_u32 s47, s47, 294912
  v_mfma_f32_16x16x32_bf16 v[68:71], a[28:31], a[4:7], v[68:71]
  s_waitcnt vmcnt(16) lgkmcnt(0)
  s_barrier
  v_mfma_f32_16x16x32_bf16 v[24:27], a[40:43], a[32:35], v[24:27]
  ds_read_b128 a[0:3], v9 offset:0
  ds_read_b128 a[4:7], v9 offset:2048
  ds_read_b64_tr_b16 a[8:9], v11 offset:0
  s_add_u32 m0, s45, 24576
  v_mfma_f32_16x16x32_bf16 v[28:31], a[44:47], a[32:35], v[28:31]
  ds_read_b64_tr_b16 a[10:11], v11 offset:1536
  ds_read_b64_tr_b16 a[12:13], v12 offset:0
  buffer_load_dwordx4 v4, s[12:15], s46 offen lds
  v_mfma_f32_16x16x32_bf16 v[32:35], a[48:51], a[32:35], v[32:35]
  ds_read_b64_tr_b16 a[14:15], v12 offset:1536
  ds_read_b64_tr_b16 a[16:17], v13 offset:0
  s_add_u32 m0, s44, 73728
  v_mfma_f32_16x16x32_bf16 v[36:39], a[52:55], a[32:35], v[36:39]
  ds_read_b64_tr_b16 a[18:19], v13 offset:1536
  ds_read_b64_tr_b16 a[20:21], v14 offset:0
  ds_read_b64_tr_b16 a[22:23], v14 offset:1536
  v_mfma_f32_16x16x32_bf16 v[40:43], a[56:59], a[32:35], v[40:43]
  ds_read_b64_tr_b16 a[24:25], v15 offset:0
  ds_read_b64_tr_b16 a[26:27], v15 offset:1536
  buffer_load_dwordx4 v6, s[16:19], s47 offen lds
  v_mfma_f32_16x16x32_bf16 v[44:47], a[60:63], a[32:35], v[44:47]
  ds_read_b64_tr_b16 a[28:29], v16 offset:0
  ds_read_b64_tr_b16 a[30:31], v16 offset:1536
  s_add_u32 m0, s44, 77824
  v_mfma_f32_16x16x32_bf16 v[48:51], a[40:43], a[36:39], v[48:51]
  buffer_load_dwordx4 v7, s[16:19], s47 offen lds
  v_mfma_f32_16x16x32_bf16 v[52:55], a[44:47], a[36:39], v[52:55]
  v_mfma_f32_16x16x32_bf16 v[56:59], a[48:51], a[36:39], v[56:59]
  s_add_u32 m0, s44, 81920
  v_mfma_f32_16x16x32_bf16 v[60:63], a[52:55], a[36:39], v[60:63]
  buffer_load_dwordx4 v8, s[16:19], s47 offen lds
  v_mfma_f32_16x16x32_bf16 v[64:67], a[56:59], a[36:39], v[64:67]
  s_add_u32 s47, s47, 294912
  v_mfma_f32_16x16x32_bf16 v[68:71], a[60:63], a[36:39], v[68:71]
  s_waitcnt lgkmcnt(0)
  v_mfma_f32_16x16x32_bf16 v[24:27], a[8:11], a[0:3], v[24:27]
  ds_read_b128 a[32:35], v10 offset:0
  ds_read_b128 a[36:39], v10 offset:2048
  ds_read_b64_tr_b16 a[40:41], v11 offset:12288
  s_add_u32 m0, s45, 28672
  v_mfma_f32_16x16x32_bf16 v[28:31], a[12:15], a[0:3], v[28:31]
  ds_read_b64_tr_b16 a[42:43], v11 offset:13824
  ds_read_b64_tr_b16 a[44:45], v12 offset:12288
  buffer_load_dwordx4 v5, s[12:15], s46 offen lds
  v_mfma_f32_16x16x32_bf16 v[32:35], a[16:19], a[0:3], v[32:35]
  ds_read_b64_tr_b16 a[46:47], v12 offset:13824
  ds_read_b64_tr_b16 a[48:49], v13 offset:12288
  s_add_u32 m0, s44, 86016
  v_mfma_f32_16x16x32_bf16 v[36:39], a[20:23], a[0:3], v[36:39]
  ds_read_b64_tr_b16 a[50:51], v13 offset:13824
  ds_read_b64_tr_b16 a[52:53], v14 offset:12288
  ds_read_b64_tr_b16 a[54:55], v14 offset:13824
  v_mfma_f32_16x16x32_bf16 v[40:43], a[24:27], a[0:3], v[40:43]
  ds_read_b64_tr_b16 a[56:57], v15 offset:12288
  ds_read_b64_tr_b16 a[58:59], v15 offset:13824
  buffer_load_dwordx4 v6, s[16:19], s47 offen lds
  v_mfma_f32_16x16x32_bf16 v[44:47], a[28:31], a[0:3], v[44:47]
  ds_read_b64_tr_b16 a[60:61], v16 offset:12288
  ds_read_b64_tr_b16 a[62:63], v16 offset:13824
  s_add_u32 m0, s44, 90112
  v_mfma_f32_16x16x32_bf16 v[48:51], a[8:11], a[4:7], v[48:51]
  buffer_load_dwordx4 v7, s[16:19], s47 offen lds
  v_mfma_f32_16x16x32_bf16 v[52:55], a[12:15], a[4:7], v[52:55]
  v_mfma_f32_16x16x32_bf16 v[56:59], a[16:19], a[4:7], v[56:59]
  s_add_u32 m0, s44, 94208
  v_mfma_f32_16x16x32_bf16 v[60:63], a[20:23], a[4:7], v[60:63]
  buffer_load_dwordx4 v8, s[16:19], s47 offen lds
  v_mfma_f32_16x16x32_bf16 v[64:67], a[24:27], a[4:7], v[64:67]
  s_add_u32 s46, s46, 128
  s_add_u32 s47, s47, 294912
  v_mfma_f32_16x16x32_bf16 v[68:71], a[28:31], a[4:7], v[68:71]
  s_waitcnt vmcnt(16) lgkmcnt(0)
  s_barrier
  v_mfma_f32_16x16x32_bf16 v[24:27], a[40:43], a[32:35], v[24:27]
  ds_read_b128 a[0:3], v9 offset:8192
  ds_read_b128 a[4:7], v9 offset:10240
  ds_read_b64_tr_b16 a[8:9], v11 offset:24576
  s_add_u32 m0, s45, 0
  v_mfma_f32_16x16x32_bf16 v[28:31], a[44:47], a[32:35], v[28:31]
  ds_read_b64_tr_b16 a[10:11], v11 offset:26112
  ds_read_b64_tr_b16 a[12:13], v12 offset:24576
  buffer_load_dwordx4 v4, s[12:15], s46 offen lds
  v_mfma_f32_16x16x32_bf16 v[32:35], a[48:51], a[32:35], v[32:35]
  ds_read_b64_tr_b16 a[14:15], v12 offset:26112
  ds_read_b64_tr_b16 a[16:17], v13 offset:24576
  s_add_u32 m0, s44, 0
  v_mfma_f32_16x16x32_bf16 v[36:39], a[52:55], a[32:35], v[36:39]
  ds_read_b64_tr_b16 a[18:19], v13 offset:26112
  ds_read_b64_tr_b16 a[20:21], v14 offset:24576
  ds_read_b64_tr_b16 a[22:23], v14 offset:26112
  v_mfma_f32_16x16x32_bf16 v[40:43], a[56:59], a[32:35], v[40:43]
  ds_read_b64_tr_b16 a[24:25], v15 offset:24576
  ds_read_b64_tr_b16 a[26:27], v15 offset:26112
  buffer_load_dwordx4 v6, s[16:19], s47 offen lds
  v_mfma_f32_16x16x32_bf16 v[44:47], a[60:63], a[32:35], v[44:47]
  ds_read_b64_tr_b16 a[28:29], v16 offset:24576
  ds_read_b64_tr_b16 a[30:31], v16 offset:26112
  s_add_u32 m0, s44, 4096
  v_mfma_f32_16x16x32_bf16 v[48:51], a[40:43], a[36:39], v[48:51]
  buffer_load_dwordx4 v7, s[16:19], s47 offen lds
  v_mfma_f32_16x16x32_bf16 v[52:55], a[44:47], a[36:39], v[52:55]
  v_mfma_f32_16x16x32_bf16 v[56:59], a[48:51], a[36:39], v[56:59]
  s_add_u32 m0, s44, 8192
  v_mfma_f32_16x16x32_bf16 v[60:63], a[52:55], a[36:39], v[60:63]
  buffer_load_dwordx4 v8, s[16:19], s47 offen lds
  v_mfma_f32_16x16x32_bf16 v[64:67], a[56:59], a[36:39], v[64:67]
  s_add_u32 s47, s47, 294912
  v_mfma_f32_16x16x32_bf16 v[68:71], a[60:63], a[36:39], v[68:71]
  s_waitcnt lgkmcnt(0)
  v_mfma_f32_16x16x32_bf16 v[24:27], a[8:11], a[0:3], v[24:27]
  ds_read_b128 a[32:35], v10 offset:8192
  ds_read_b128 a[36:39], v10 offset:10240
  ds_read_b64_tr_b16 a[40:41], v11 offset:36864
  s_add_u32 m0, s45, 4096
  v_mfma_f32_16x16x32_bf16 v[28:31], a[12:15], a[0:3], v[28:31]
  ds_read_b64_tr_b16 a[42:43], v11 offset:38400
  ds_read_b64_tr_b16 a[44:45], v12 offset:36864
  buffer_load_dwordx4 v5, s[12:15], s46 offen lds
  v_mfma_f32_16x16x32_bf16 v[32:35], a[16:19], a[0:3], v[32:35]
  ds_read_b64_tr_b16 a[46:47], v12 offset:38400
  ds_read_b64_tr_b16 a[48:49], v13 offset:36864
  s_add_u32 m0, s44, 12288
  v_mfma_f32_16x16x32_bf16 v[36:39], a[20:23], a[0:3], v[36:39]
  ds_read_b64_tr_b16 a[50:51], v13 offset:38400
  ds_read_b64_tr_b16 a[52:53], v14 offset:36864
  ds_read_b64_tr_b16 a[54:55], v14 offset:38400
  v_mfma_f32_16x16x32_bf16 v[40:43], a[24:27], a[0:3], v[40:43]
  ds_read_b64_tr_b16 a[56:57], v15 offset:36864
  ds_read_b64_tr_b16 a[58:59], v15 offset:38400
  buffer_load_dwordx4 v6, s[16:19], s47 offen lds
  v_mfma_f32_16x16x32_bf16 v[44:47], a[28:31], a[0:3], v[44:47]
  ds_read_b64_tr_b16 a[60:61], v16 offset:36864
  ds_read_b64_tr_b16 a[62:63], v16 offset:38400
  s_add_u32 m0, s44, 16384
  v_mfma_f32_16x16x32_bf16 v[48:51], a[8:11], a[4:7], v[48:51]
  buffer_load_dwordx4 v7, s[16:19], s47 offen lds
  v_mfma_f32_16x16x32_bf16 v[52:55], a[12:15], a[4:7], v[52:55]
  v_mfma_f32_16x16x32_bf16 v[56:59], a[16:19], a[4:7], v[56:59]
  s_add_u32 m0, s44, 20480
  v_mfma_f32_16x16x32_bf16 v[60:63], a[20:23], a[4:7], v[60:63]
  buffer_load_dwordx4 v8, s[16:19], s47 offen lds
  v_mfma_f32_16x16x32_bf16 v[64:67], a[24:27], a[4:7], v[64:67]
  s_add_u32 s46, s46, 128
  s_add_u32 s47, s47, 294912
  v_mfma_f32_16x16x32_bf16 v[68:71], a[28:31], a[4:7], v[68:71]
  s_waitcnt vmcnt(16) lgkmcnt(0)
  s_barrier
  v_mfma_f32_16x16x32_bf16 v[24:27], a[40:43], a[32:35], v[24:27]
  ds_read_b128 a[0:3], v9 offset:16384
  ds_read_b128 a[4:7], v9 offset:18432
  ds_read_b64_tr_b16 a[8:9], v17 offset:0
  v_mfma_f32_16x16x32_bf16 v[28:31], a[44:47], a[32:35], v[28:31]
  ds_read_b64_tr_b16 a[10:11], v17 offset:1536
  ds_read_b64_tr_b16 a[12:13], v18 offset:0
  v_mfma_f32_16x16x32_bf16 v[32:35], a[48:51], a[32:35], v[32:35]
  ds_read_b64_tr_b16 a[14:15], v18 offset:1536
  ds_read_b64_tr_b16 a[16:17], v19 offset:0
  v_mfma_f32_16x16x32_bf16 v[36:39], a[52:55], a[32:35], v[36:39]
  ds_read_b64_tr_b16 a[18:19], v19 offset:1536
  ds_read_b64_tr_b16 a[20:21], v20 offset:0
  ds_read_b64_tr_b16 a[22:23], v20 offset:1536
  v_mfma_f32_16x16x32_bf16 v[40:43], a[56:59], a[32:35], v[40:43]
  ds_read_b64_tr_b16 a[24:25], v21 offset:0
  ds_read_b64_tr_b16 a[26:27], v21 offset:1536
  v_mfma_f32_16x16x32_bf16 v[44:47], a[60:63], a[32:35], v[44:47]
  ds_read_b64_tr_b16 a[28:29], v22 offset:0
  ds_read_b64_tr_b16 a[30:31], v22 offset:1536
  v_mfma_f32_16x16x32_bf16 v[48:51], a[40:43], a[36:39], v[48:51]
  v_mfma_f32_16x16x32_bf16 v[52:55], a[44:47], a[36:39], v[52:55]
  v_mfma_f32_16x16x32_bf16 v[56:59], a[48:51], a[36:39], v[56:59]
  v_mfma_f32_16x16x32_bf16 v[60:63], a[52:55], a[36:39], v[60:63]
  v_mfma_f32_16x16x32_bf16 v[64:67], a[56:59], a[36:39], v[64:67]
  v_mfma_f32_16x16x32_bf16 v[68:71], a[60:63], a[36:39], v[68:71]
  s_waitcnt lgkmcnt(0)
  v_mfma_f32_16x16x32_bf16 v[24:27], a[8:11], a[0:3], v[24:27]
  ds_read_b128 a[32:35], v10 offset:16384
  ds_read_b128 a[36:39], v10 offset:18432
  ds_read_b64_tr_b16 a[40:41], v17 offset:12288
  v_mfma_f32_16x16x32_bf16 v[28:31], a[12:15], a[0:3], v[28:31]
  ds_read_b64_tr_b16 a[42:43], v17 offset:13824
  ds_read_b64_tr_b16 a[44:45], v18 offset:12288
  v_mfma_f32_16x16x32_bf16 v[32:35], a[16:19], a[0:3], v[32:35]
  ds_read_b64_tr_b16 a[46:47], v18 offset:13824
  ds_read_b64_tr_b16 a[48:49], v19 offset:12288
  v_mfma_f32_16x16x32_bf16 v[36:39], a[20:23], a[0:3], v[36:39]
  ds_read_b64_tr_b16 a[50:51], v19 offset:13824
  ds_read_b64_tr_b16 a[52:53], v20 offset:12288
  ds_read_b64_tr_b16 a[54:55], v20 offset:13824
  v_mfma_f32_16x16x32_bf16 v[40:43], a[24:27], a[0:3], v[40:43]
  ds_read_b64_tr_b16 a[56:57], v21 offset:12288
  ds_read_b64_tr_b16 a[58:59], v21 offset:13824
  v_mfma_f32_16x16x32_bf16 v[44:47], a[28:31], a[0:3], v[44:47]
  ds_read_b64_tr_b16 a[60:61], v22 offset:12288
  ds_read_b64_tr_b16 a[62:63], v22 offset:13824
  v_mfma_f32_16x16x32_bf16 v[48:51], a[8:11], a[4:7], v[48:51]
  v_mfma_f32_16x16x32_bf16 v[52:55], a[12:15], a[4:7], v[52:55]
  v_mfma_f32_16x16x32_bf16 v[56:59], a[16:19], a[4:7], v[56:59]
  v_mfma_f32_16x16x32_bf16 v[60:63], a[20:23], a[4:7], v[60:63]
  v_mfma_f32_16x16x32_bf16 v[64:67], a[24:27], a[4:7], v[64:67]
  v_mfma_f32_16x16x32_bf16 v[68:71], a[28:31], a[4:7], v[68:71]
  s_waitcnt vmcnt(8) lgkmcnt(0)
  s_barrier
  v_mfma_f32_16x16x32_bf16 v[24:27], a[40:43], a[32:35], v[24:27]
  ds_read_b128 a[0:3], v9 offset:24576
  ds_read_b128 a[4:7], v9 offset:26624
  ds_read_b64_tr_b16 a[8:9], v17 offset:24576
  v_mfma_f32_16x16x32_bf16 v[28:31], a[44:47], a[32:35], v[28:31]
  ds_read_b64_tr_b16 a[10:11], v17 offset:26112
  ds_read_b64_tr_b16 a[12:13], v18 offset:24576
  v_mfma_f32_16x16x32_bf16 v[32:35], a[48:51], a[32:35], v[32:35]
  ds_read_b64_tr_b16 a[14:15], v18 offset:26112
  ds_read_b64_tr_b16 a[16:17], v19 offset:24576
  v_mfma_f32_16x16x32_bf16 v[36:39], a[52:55], a[32:35], v[36:39]
  ds_read_b64_tr_b16 a[18:19], v19 offset:26112
  ds_read_b64_tr_b16 a[20:21], v20 offset:24576
  ds_read_b64_tr_b16 a[22:23], v20 offset:26112
  v_mfma_f32_16x16x32_bf16 v[40:43], a[56:59], a[32:35], v[40:43]
  ds_read_b64_tr_b16 a[24:25], v21 offset:24576
  ds_read_b64_tr_b16 a[26:27], v21 offset:26112
  v_mfma_f32_16x16x32_bf16 v[44:47], a[60:63], a[32:35], v[44:47]
  ds_read_b64_tr_b16 a[28:29], v22 offset:24576
  ds_read_b64_tr_b16 a[30:31], v22 offset:26112
  v_mfma_f32_16x16x32_bf16 v[48:51], a[40:43], a[36:39], v[48:51]
  v_mfma_f32_16x16x32_bf16 v[52:55], a[44:47], a[36:39], v[52:55]
  v_mfma_f32_16x16x32_bf16 v[56:59], a[48:51], a[36:39], v[56:59]
  v_mfma_f32_16x16x32_bf16 v[60:63], a[52:55], a[36:39], v[60:63]
  v_mfma_f32_16x16x32_bf16 v[64:67], a[56:59], a[36:39], v[64:67]
  v_mfma_f32_16x16x32_bf16 v[68:71], a[60:63], a[36:39], v[68:71]
  s_waitcnt lgkmcnt(0)
  v_mfma_f32_16x16x32_bf16 v[24:27], a[8:11], a[0:3], v[24:27]
  ds_read_b128 a[32:35], v10 offset:24576
  ds_read_b128 a[36:39], v10 offset:26624
  ds_read_b64_tr_b16 a[40:41], v17 offset:36864
  v_mfma_f32_16x16x32_bf16 v[28:31], a[12:15], a[0:3], v[28:31]
  ds_read_b64_tr_b16 a[42:43], v17 offset:38400
  ds_read_b64_tr_b16 a[44:45], v18 offset:36864
  v_mfma_f32_16x16x32_bf16 v[32:35], a[16:19], a[0:3], v[32:35]
  ds_read_b64_tr_b16 a[46:47], v18 offset:38400
  ds_read_b64_tr_b16 a[48:49], v19 offset:36864
  v_mfma_f32_16x16x32_bf16 v[36:39], a[20:23], a[0:3], v[36:39]
  ds_read_b64_tr_b16 a[50:51], v19 offset:38400
  ds_read_b64_tr_b16 a[52:53], v20 offset:36864
  ds_read_b64_tr_b16 a[54:55], v20 offset:38400
  v_mfma_f32_16x16x32_bf16 v[40:43], a[24:27], a[0:3], v[40:43]
  ds_read_b64_tr_b16 a[56:57], v21 offset:36864
  ds_read_b64_tr_b16 a[58:59], v21 offset:38400
  v_mfma_f32_16x16x32_bf16 v[44:47], a[28:31], a[0:3], v[44:47]
  ds_read_b64_tr_b16 a[60:61], v22 offset:36864
  ds_read_b64_tr_b16 a[62:63], v22 offset:38400
  v_mfma_f32_16x16x32_bf16 v[48:51], a[8:11], a[4:7], v[48:51]
  v_mfma_f32_16x16x32_bf16 v[52:55], a[12:15], a[4:7], v[52:55]
  v_mfma_f32_16x16x32_bf16 v[56:59], a[16:19], a[4:7], v[56:59]
  v_mfma_f32_16x16x32_bf16 v[60:63], a[20:23], a[4:7], v[60:63]
  v_mfma_f32_16x16x32_bf16 v[64:67], a[24:27], a[4:7], v[64:67]
  v_mfma_f32_16x16x32_bf16 v[68:71], a[28:31], a[4:7], v[68:71]
  s_waitcnt vmcnt(0) lgkmcnt(0)
  s_barrier
  v_mfma_f32_16x16x32_bf16 v[24:27], a[40:43], a[32:35], v[24:27]
  ds_read_b128 a[0:3], v9 offset:0
  ds_read_b128 a[4:7], v9 offset:2048
  ds_read_b64_tr_b16 a[8:9], v11 offset:0
  v_mfma_f32_16x16x32_bf16 v[28:31], a[44:47], a[32:35], v[28:31]
  ds_read_b64_tr_b16 a[10:11], v11 offset:1536
  ds_read_b64_tr_b16 a[12:13], v12 offset:0
  v_mfma_f32_16x16x32_bf16 v[32:35], a[48:51], a[32:35], v[32:35]
  ds_read_b64_tr_b16 a[14:15], v12 offset:1536
  ds_read_b64_tr_b16 a[16:17], v13 offset:0
  v_mfma_f32_16x16x32_bf16 v[36:39], a[52:55], a[32:35], v[36:39]
  ds_read_b64_tr_b16 a[18:19], v13 offset:1536
  ds_read_b64_tr_b16 a[20:21], v14 offset:0
  ds_read_b64_tr_b16 a[22:23], v14 offset:1536
  v_mfma_f32_16x16x32_bf16 v[40:43], a[56:59], a[32:35], v[40:43]
  ds_read_b64_tr_b16 a[24:25], v15 offset:0
  ds_read_b64_tr_b16 a[26:27], v15 offset:1536
  v_mfma_f32_16x16x32_bf16 v[44:47], a[60:63], a[32:35], v[44:47]
  ds_read_b64_tr_b16 a[28:29], v16 offset:0
  ds_read_b64_tr_b16 a[30:31], v16 offset:1536
  v_mfma_f32_16x16x32_bf16 v[48:51], a[40:43], a[36:39], v[48:51]
  v_mfma_f32_16x16x32_bf16 v[52:55], a[44:47], a[36:39], v[52:55]
  v_mfma_f32_16x16x32_bf16 v[56:59], a[48:51], a[36:39], v[56:59]
  v_mfma_f32_16x16x32_bf16 v[60:63], a[52:55], a[36:39], v[60:63]
  v_mfma_f32_16x16x32_bf16 v[64:67], a[56:59], a[36:39], v[64:67]
  v_mfma_f32_16x16x32_bf16 v[68:71], a[60:63], a[36:39], v[68:71]
  s_waitcnt lgkmcnt(0)
  v_mfma_f32_16x16x32_bf16 v[24:27], a[8:11], a[0:3], v[24:27]
  ds_read_b128 a[32:35], v10 offset:0
  ds_read_b128 a[36:39], v10 offset:2048
  ds_read_b64_tr_b16 a[40:41], v11 offset:12288
  v_mfma_f32_16x16x32_bf16 v[28:31], a[12:15], a[0:3], v[28:31]
  ds_read_b64_tr_b16 a[42:43], v11 offset:13824
  ds_read_b64_tr_b16 a[44:45], v12 offset:12288
  v_mfma_f32_16x16x32_bf16 v[32:35], a[16:19], a[0:3], v[32:35]
  ds_read_b64_tr_b16 a[46:47], v12 offset:13824
  ds_read_b64_tr_b16 a[48:49], v13 offset:12288
  v_mfma_f32_16x16x32_bf16 v[36:39], a[20:23], a[0:3], v[36:39]
  ds_read_b64_tr_b16 a[50:51], v13 offset:13824
  ds_read_b64_tr_b16 a[52:53], v14 offset:12288
  ds_read_b64_tr_b16 a[54:55], v14 offset:13824
  v_mfma_f32_16x16x32_bf16 v[40:43], a[24:27], a[0:3], v[40:43]
  ds_read_b64_tr_b16 a[56:57], v15 offset:12288
  ds_read_b64_tr_b16 a[58:59], v15 offset:13824
  v_mfma_f32_16x16x32_bf16 v[44:47], a[28:31], a[0:3], v[44:47]
  ds_read_b64_tr_b16 a[60:61], v16 offset:12288
  ds_read_b64_tr_b16 a[62:63], v16 offset:13824
  v_mfma_f32_16x16x32_bf16 v[48:51], a[8:11], a[4:7], v[48:51]
  v_mfma_f32_16x16x32_bf16 v[52:55], a[12:15], a[4:7], v[52:55]
  v_mfma_f32_16x16x32_bf16 v[56:59], a[16:19], a[4:7], v[56:59]
  v_mfma_f32_16x16x32_bf16 v[60:63], a[20:23], a[4:7], v[60:63]
  v_mfma_f32_16x16x32_bf16 v[64:67], a[24:27], a[4:7], v[64:67]
  v_mfma_f32_16x16x32_bf16 v[68:71], a[28:31], a[4:7], v[68:71]
  s_waitcnt lgkmcnt(0)
  v_mfma_f32_16x16x32_bf16 v[24:27], a[40:43], a[32:35], v[24:27]
  v_mfma_f32_16x16x32_bf16 v[28:31], a[44:47], a[32:35], v[28:31]
  v_mfma_f32_16x16x32_bf16 v[32:35], a[48:51], a[32:35], v[32:35]
  v_mfma_f32_16x16x32_bf16 v[36:39], a[52:55], a[32:35], v[36:39]
  v_mfma_f32_16x16x32_bf16 v[40:43], a[56:59], a[32:35], v[40:43]
  v_mfma_f32_16x16x32_bf16 v[44:47], a[60:63], a[32:35], v[44:47]
  v_mfma_f32_16x16x32_bf16 v[48:51], a[40:43], a[36:39], v[48:51]
  v_mfma_f32_16x16x32_bf16 v[52:55], a[44:47], a[36:39], v[52:55]
  v_mfma_f32_16x16x32_bf16 v[56:59], a[48:51], a[36:39], v[56:59]
  v_mfma_f32_16x16x32_bf16 v[60:63], a[52:55], a[36:39], v[60:63]
  v_mfma_f32_16x16x32_bf16 v[64:67], a[56:59], a[36:39], v[64:67]
  v_mfma_f32_16x16x32_bf16 v[68:71], a[60:63], a[36:39], v[68:71]
  s_nop 7
  s_nop 7
  v_and_b32 v74, 15, v1
  s_mov_b32 s40, 4608
  v_mul_lo_u32 v72, v74, s40
  v_bfe_u32 v74, v1, 4, 1
  v_lshl_add_u32 v72, v74, 5, v72
  v_bfe_u32 v74, v1, 5, 1
  v_lshl_add_u32 v72, v74, 4, v72
  v_and_b32 v74, 15, v1
  s_mov_b32 s40, 4608
  v_mul_lo_u32 v73, v74, s40
  v_lshrrev_b32 v74, 4, v1
  v_lshl_add_u32 v73, v74, 3, v73
  s_lshr_b32 s40, s3, 1
  s_mul_i32 s40, s40, 32
  s_mul_i32 s41, s32, 64
  s_add_u32 s40, s40, s41
  s_mul_i32 s40, s40, 4608
  s_and_b32 s41, s3, 1
  s_mul_i32 s41, s41, 96
  s_mul_i32 s42, s35, 192
  s_add_u32 s41, s41, s42
  s_lshl_b32 s41, s41, 1
  s_add_u32 s38, s40, s41
  v_mov_b32 v74, 0xc0135761
  v_mov_b32 v75, 0xc0135761
  s_mov_b32 s56, 0xbdd2d3e8
  s_mov_b32 s57, 0xbdd2d3e8
  s_mov_b32 s58, 1.0
  s_mov_b32 s59, 1.0
  v_cvt_pk_bf16_f32 v76, v24, v25
  v_lshlrev_b32 v24, 16, v76
  v_and_b32 v25, 0xffff0000, v76
  v_cvt_pk_bf16_f32 v77, v26, v27
  v_lshlrev_b32 v26, 16, v77
  v_and_b32 v27, 0xffff0000, v77
  v_pk_mul_f32 v[76:77], v[24:25], v[24:25]
  v_pk_mul_f32 v[78:79], v[26:27], v[26:27]
  v_pk_fma_f32 v[76:77], v[76:77], s[56:57], v[74:75]
  v_pk_fma_f32 v[78:79], v[78:79], s[56:57], v[74:75]
  v_pk_mul_f32 v[76:77], v[76:77], v[24:25]
  v_pk_mul_f32 v[78:79], v[78:79], v[26:27]
  v_exp_f32 v76, v76
  v_exp_f32 v77, v77
  v_exp_f32 v78, v78
  v_exp_f32 v79, v79
  v_pk_add_f32 v[76:77], v[76:77], s[58:59]
  v_pk_add_f32 v[78:79], v[78:79], s[58:59]
  v_rcp_f32 v76, v76
  v_rcp_f32 v77, v77
  v_rcp_f32 v78, v78
  v_rcp_f32 v79, v79
  v_pk_mul_f32 v[24:25], v[24:25], v[76:77]
  v_pk_mul_f32 v[26:27], v[26:27], v[78:79]
  v_cvt_pk_bf16_f32 v76, v28, v29
  v_lshlrev_b32 v28, 16, v76
  v_and_b32 v29, 0xffff0000, v76
  v_cvt_pk_bf16_f32 v77, v30, v31
  v_lshlrev_b32 v30, 16, v77
  v_and_b32 v31, 0xffff0000, v77
  v_pk_mul_f32 v[76:77], v[28:29], v[28:29]
  v_pk_mul_f32 v[78:79], v[30:31], v[30:31]
  v_pk_fma_f32 v[76:77], v[76:77], s[56:57], v[74:75]
  v_pk_fma_f32 v[78:79], v[78:79], s[56:57], v[74:75]
  v_pk_mul_f32 v[76:77], v[76:77], v[28:29]
  v_pk_mul_f32 v[78:79], v[78:79], v[30:31]
  v_exp_f32 v76, v76
  v_exp_f32 v77, v77
  v_exp_f32 v78, v78
  v_exp_f32 v79, v79
  v_pk_add_f32 v[76:77], v[76:77], s[58:59]
  v_pk_add_f32 v[78:79], v[78:79], s[58:59]
  v_rcp_f32 v76, v76
  v_rcp_f32 v77, v77
  v_rcp_f32 v78, v78
  v_rcp_f32 v79, v79
  v_pk_mul_f32 v[28:29], v[28:29], v[76:77]
  v_pk_mul_f32 v[30:31], v[30:31], v[78:79]
  v_cvt_pk_bf16_f32 v76, v32, v33
  v_lshlrev_b32 v32, 16, v76
  v_and_b32 v33, 0xffff0000, v76
  v_cvt_pk_bf16_f32 v77, v34, v35
  v_lshlrev_b32 v34, 16, v77
  v_and_b32 v35, 0xffff0000, v77
  v_pk_mul_f32 v[76:77], v[32:33], v[32:33]
  v_pk_mul_f32 v[78:79], v[34:35], v[34:35]
  v_pk_fma_f32 v[76:77], v[76:77], s[56:57], v[74:75]
  v_pk_fma_f32 v[78:79], v[78:79], s[56:57], v[74:75]
  v_pk_mul_f32 v[76:77], v[76:77], v[32:33]
  v_pk_mul_f32 v[78:79], v[78:79], v[34:35]
  v_exp_f32 v76, v76
  v_exp_f32 v77, v77
  v_exp_f32 v78, v78
  v_exp_f32 v79, v79
  v_pk_add_f32 v[76:77], v[76:77], s[58:59]
  v_pk_add_f32 v[78:79], v[78:79], s[58:59]
  v_rcp_f32 v76, v76
  v_rcp_f32 v77, v77
  v_rcp_f32 v78, v78
  v_rcp_f32 v79, v79
  v_pk_mul_f32 v[32:33], v[32:33], v[76:77]
  v_pk_mul_f32 v[34:35], v[34:35], v[78:79]
  v_cvt_pk_bf16_f32 v76, v36, v37
  v_lshlrev_b32 v36, 16, v76
  v_and_b32 v37, 0xffff0000, v76
  v_cvt_pk_bf16_f32 v77, v38, v39
  v_lshlrev_b32 v38, 16, v77
  v_and_b32 v39, 0xffff0000, v77
  v_pk_mul_f32 v[76:77], v[36:37], v[36:37]
  v_pk_mul_f32 v[78:79], v[38:39], v[38:39]
  v_pk_fma_f32 v[76:77], v[76:77], s[56:57], v[74:75]
  v_pk_fma_f32 v[78:79], v[78:79], s[56:57], v[74:75]
  v_pk_mul_f32 v[76:77], v[76:77], v[36:37]
  v_pk_mul_f32 v[78:79], v[78:79], v[38:39]
  v_exp_f32 v76, v76
  v_exp_f32 v77, v77
  v_exp_f32 v78, v78
  v_exp_f32 v79, v79
  v_pk_add_f32 v[76:77], v[76:77], s[58:59]
  v_pk_add_f32 v[78:79], v[78:79], s[58:59]
  v_rcp_f32 v76, v76
  v_rcp_f32 v77, v77
  v_rcp_f32 v78, v78
  v_rcp_f32 v79, v79
  v_pk_mul_f32 v[36:37], v[36:37], v[76:77]
  v_pk_mul_f32 v[38:39], v[38:39], v[78:79]
  v_cvt_pk_bf16_f32 v76, v40, v41
  v_lshlrev_b32 v40, 16, v76
  v_and_b32 v41, 0xffff0000, v76
  v_cvt_pk_bf16_f32 v77, v42, v43
  v_lshlrev_b32 v42, 16, v77
  v_and_b32 v43, 0xffff0000, v77
  v_pk_mul_f32 v[76:77], v[40:41], v[40:41]
  v_pk_mul_f32 v[78:79], v[42:43], v[42:43]
  v_pk_fma_f32 v[76:77], v[76:77], s[56:57], v[74:75]
  v_pk_fma_f32 v[78:79], v[78:79], s[56:57], v[74:75]
  v_pk_mul_f32 v[76:77], v[76:77], v[40:41]
  v_pk_mul_f32 v[78:79], v[78:79], v[42:43]
  v_exp_f32 v76, v76
  v_exp_f32 v77, v77
  v_exp_f32 v78, v78
  v_exp_f32 v79, v79
  v_pk_add_f32 v[76:77], v[76:77], s[58:59]
  v_pk_add_f32 v[78:79], v[78:79], s[58:59]
  v_rcp_f32 v76, v76
  v_rcp_f32 v77, v77
  v_rcp_f32 v78, v78
  v_rcp_f32 v79, v79
  v_pk_mul_f32 v[40:41], v[40:41], v[76:77]
  v_pk_mul_f32 v[42:43], v[42:43], v[78:79]
  v_cvt_pk_bf16_f32 v76, v44, v45
  v_lshlrev_b32 v44, 16, v76
  v_and_b32 v45, 0xffff0000, v76
  v_cvt_pk_bf16_f32 v77, v46, v47
  v_lshlrev_b32 v46, 16, v77
  v_and_b32 v47, 0xffff0000, v77
  v_pk_mul_f32 v[76:77], v[44:45], v[44:45]
  v_pk_mul_f32 v[78:79], v[46:47], v[46:47]
  v_pk_fma_f32 v[76:77], v[76:77], s[56:57], v[74:75]
  v_pk_fma_f32 v[78:79], v[78:79], s[56:57], v[74:75]
  v_pk_mul_f32 v[76:77], v[76:77], v[44:45]
  v_pk_mul_f32 v[78:79], v[78:79], v[46:47]
  v_exp_f32 v76, v76
  v_exp_f32 v77, v77
  v_exp_f32 v78, v78
  v_exp_f32 v79, v79
  v_pk_add_f32 v[76:77], v[76:77], s[58:59]
  v_pk_add_f32 v[78:79], v[78:79], s[58:59]
  v_rcp_f32 v76, v76
  v_rcp_f32 v77, v77
  v_rcp_f32 v78, v78
  v_rcp_f32 v79, v79
  v_pk_mul_f32 v[44:45], v[44:45], v[76:77]
  v_pk_mul_f32 v[46:47], v[46:47], v[78:79]
  v_cvt_pk_bf16_f32 v80, v24, v25
  v_cvt_pk_bf16_f32 v81, v26, v27
  v_cvt_pk_bf16_f32 v82, v28, v29
  v_cvt_pk_bf16_f32 v83, v30, v31
  s_nop 1
  v_permlane16_swap_b32 v80, v82
  v_permlane16_swap_b32 v81, v83
  buffer_store_dwordx4 v[80:83], v72, s[20:23], s38 offen offset:0 sc1
  v_cvt_pk_bf16_f32 v84, v32, v33
  v_cvt_pk_bf16_f32 v85, v34, v35
  v_cvt_pk_bf16_f32 v86, v36, v37
  v_cvt_pk_bf16_f32 v87, v38, v39
  s_nop 1
  v_permlane16_swap_b32 v84, v86
  v_permlane16_swap_b32 v85, v87
  buffer_store_dwordx4 v[84:87], v72, s[20:23], s38 offen offset:64 sc1
  v_cvt_pk_bf16_f32 v88, v40, v41
  v_cvt_pk_bf16_f32 v89, v42, v43
  v_cvt_pk_bf16_f32 v90, v44, v45
  v_cvt_pk_bf16_f32 v91, v46, v47
  s_nop 1
  v_permlane16_swap_b32 v88, v90
  v_permlane16_swap_b32 v89, v91
  buffer_store_dwordx4 v[88:91], v72, s[20:23], s38 offen offset:128 sc1
  s_add_u32 s38, s38, 73728
  v_cvt_pk_bf16_f32 v76, v48, v49
  v_lshlrev_b32 v48, 16, v76
  v_and_b32 v49, 0xffff0000, v76
  v_cvt_pk_bf16_f32 v77, v50, v51
  v_lshlrev_b32 v50, 16, v77
  v_and_b32 v51, 0xffff0000, v77
  v_pk_mul_f32 v[76:77], v[48:49], v[48:49]
  v_pk_mul_f32 v[78:79], v[50:51], v[50:51]
  v_pk_fma_f32 v[76:77], v[76:77], s[56:57], v[74:75]
  v_pk_fma_f32 v[78:79], v[78:79], s[56:57], v[74:75]
  v_pk_mul_f32 v[76:77], v[76:77], v[48:49]
  v_pk_mul_f32 v[78:79], v[78:79], v[50:51]
  v_exp_f32 v76, v76
  v_exp_f32 v77, v77
  v_exp_f32 v78, v78
  v_exp_f32 v79, v79
  v_pk_add_f32 v[76:77], v[76:77], s[58:59]
  v_pk_add_f32 v[78:79], v[78:79], s[58:59]
  v_rcp_f32 v76, v76
  v_rcp_f32 v77, v77
  v_rcp_f32 v78, v78
  v_rcp_f32 v79, v79
  v_pk_mul_f32 v[48:49], v[48:49], v[76:77]
  v_pk_mul_f32 v[50:51], v[50:51], v[78:79]
  v_cvt_pk_bf16_f32 v76, v52, v53
  v_lshlrev_b32 v52, 16, v76
  v_and_b32 v53, 0xffff0000, v76
  v_cvt_pk_bf16_f32 v77, v54, v55
  v_lshlrev_b32 v54, 16, v77
  v_and_b32 v55, 0xffff0000, v77
  v_pk_mul_f32 v[76:77], v[52:53], v[52:53]
  v_pk_mul_f32 v[78:79], v[54:55], v[54:55]
  v_pk_fma_f32 v[76:77], v[76:77], s[56:57], v[74:75]
  v_pk_fma_f32 v[78:79], v[78:79], s[56:57], v[74:75]
  v_pk_mul_f32 v[76:77], v[76:77], v[52:53]
  v_pk_mul_f32 v[78:79], v[78:79], v[54:55]
  v_exp_f32 v76, v76
  v_exp_f32 v77, v77
  v_exp_f32 v78, v78
  v_exp_f32 v79, v79
  v_pk_add_f32 v[76:77], v[76:77], s[58:59]
  v_pk_add_f32 v[78:79], v[78:79], s[58:59]
  v_rcp_f32 v76, v76
  v_rcp_f32 v77, v77
  v_rcp_f32 v78, v78
  v_rcp_f32 v79, v79
  v_pk_mul_f32 v[52:53], v[52:53], v[76:77]
  v_pk_mul_f32 v[54:55], v[54:55], v[78:79]
  v_cvt_pk_bf16_f32 v76, v56, v57
  v_lshlrev_b32 v56, 16, v76
  v_and_b32 v57, 0xffff0000, v76
  v_cvt_pk_bf16_f32 v77, v58, v59
  v_lshlrev_b32 v58, 16, v77
  v_and_b32 v59, 0xffff0000, v77
  v_pk_mul_f32 v[76:77], v[56:57], v[56:57]
  v_pk_mul_f32 v[78:79], v[58:59], v[58:59]
  v_pk_fma_f32 v[76:77], v[76:77], s[56:57], v[74:75]
  v_pk_fma_f32 v[78:79], v[78:79], s[56:57], v[74:75]
  v_pk_mul_f32 v[76:77], v[76:77], v[56:57]
  v_pk_mul_f32 v[78:79], v[78:79], v[58:59]
  v_exp_f32 v76, v76
  v_exp_f32 v77, v77
  v_exp_f32 v78, v78
  v_exp_f32 v79, v79
  v_pk_add_f32 v[76:77], v[76:77], s[58:59]
  v_pk_add_f32 v[78:79], v[78:79], s[58:59]
  v_rcp_f32 v76, v76
  v_rcp_f32 v77, v77
  v_rcp_f32 v78, v78
  v_rcp_f32 v79, v79
  v_pk_mul_f32 v[56:57], v[56:57], v[76:77]
  v_pk_mul_f32 v[58:59], v[58:59], v[78:79]
  v_cvt_pk_bf16_f32 v76, v60, v61
  v_lshlrev_b32 v60, 16, v76
  v_and_b32 v61, 0xffff0000, v76
  v_cvt_pk_bf16_f32 v77, v62, v63
  v_lshlrev_b32 v62, 16, v77
  v_and_b32 v63, 0xffff0000, v77
  v_pk_mul_f32 v[76:77], v[60:61], v[60:61]
  v_pk_mul_f32 v[78:79], v[62:63], v[62:63]
  v_pk_fma_f32 v[76:77], v[76:77], s[56:57], v[74:75]
  v_pk_fma_f32 v[78:79], v[78:79], s[56:57], v[74:75]
  v_pk_mul_f32 v[76:77], v[76:77], v[60:61]
  v_pk_mul_f32 v[78:79], v[78:79], v[62:63]
  v_exp_f32 v76, v76
  v_exp_f32 v77, v77
  v_exp_f32 v78, v78
  v_exp_f32 v79, v79
  v_pk_add_f32 v[76:77], v[76:77], s[58:59]
  v_pk_add_f32 v[78:79], v[78:79], s[58:59]
  v_rcp_f32 v76, v76
  v_rcp_f32 v77, v77
  v_rcp_f32 v78, v78
  v_rcp_f32 v79, v79
  v_pk_mul_f32 v[60:61], v[60:61], v[76:77]
  v_pk_mul_f32 v[62:63], v[62:63], v[78:79]
  v_cvt_pk_bf16_f32 v76, v64, v65
  v_lshlrev_b32 v64, 16, v76
  v_and_b32 v65, 0xffff0000, v76
  v_cvt_pk_bf16_f32 v77, v66, v67
  v_lshlrev_b32 v66, 16, v77
  v_and_b32 v67, 0xffff0000, v77
  v_pk_mul_f32 v[76:77], v[64:65], v[64:65]
  v_pk_mul_f32 v[78:79], v[66:67], v[66:67]
  v_pk_fma_f32 v[76:77], v[76:77], s[56:57], v[74:75]
  v_pk_fma_f32 v[78:79], v[78:79], s[56:57], v[74:75]
  v_pk_mul_f32 v[76:77], v[76:77], v[64:65]
  v_pk_mul_f32 v[78:79], v[78:79], v[66:67]
  v_exp_f32 v76, v76
  v_exp_f32 v77, v77
  v_exp_f32 v78, v78
  v_exp_f32 v79, v79
  v_pk_add_f32 v[76:77], v[76:77], s[58:59]
  v_pk_add_f32 v[78:79], v[78:79], s[58:59]
  v_rcp_f32 v76, v76
  v_rcp_f32 v77, v77
  v_rcp_f32 v78, v78
  v_rcp_f32 v79, v79
  v_pk_mul_f32 v[64:65], v[64:65], v[76:77]
  v_pk_mul_f32 v[66:67], v[66:67], v[78:79]
  v_cvt_pk_bf16_f32 v76, v68, v69
  v_lshlrev_b32 v68, 16, v76
  v_and_b32 v69, 0xffff0000, v76
  v_cvt_pk_bf16_f32 v77, v70, v71
  v_lshlrev_b32 v70, 16, v77
  v_and_b32 v71, 0xffff0000, v77
  v_pk_mul_f32 v[76:77], v[68:69], v[68:69]
  v_pk_mul_f32 v[78:79], v[70:71], v[70:71]
  v_pk_fma_f32 v[76:77], v[76:77], s[56:57], v[74:75]
  v_pk_fma_f32 v[78:79], v[78:79], s[56:57], v[74:75]
  v_pk_mul_f32 v[76:77], v[76:77], v[68:69]
  v_pk_mul_f32 v[78:79], v[78:79], v[70:71]
  v_exp_f32 v76, v76
  v_exp_f32 v77, v77
  v_exp_f32 v78, v78
  v_exp_f32 v79, v79
  v_pk_add_f32 v[76:77], v[76:77], s[58:59]
  v_pk_add_f32 v[78:79], v[78:79], s[58:59]
  v_rcp_f32 v76, v76
  v_rcp_f32 v77, v77
  v_rcp_f32 v78, v78
  v_rcp_f32 v79, v79
  v_pk_mul_f32 v[68:69], v[68:69], v[76:77]
  v_pk_mul_f32 v[70:71], v[70:71], v[78:79]
  v_cvt_pk_bf16_f32 v92, v48, v49
  v_cvt_pk_bf16_f32 v93, v50, v51
  v_cvt_pk_bf16_f32 v94, v52, v53
  v_cvt_pk_bf16_f32 v95, v54, v55
  s_nop 1
  v_permlane16_swap_b32 v92, v94
  v_permlane16_swap_b32 v93, v95
  buffer_store_dwordx4 v[92:95], v72, s[20:23], s38 offen offset:0 sc1
  v_cvt_pk_bf16_f32 v80, v56, v57
  v_cvt_pk_bf16_f32 v81, v58, v59
  v_cvt_pk_bf16_f32 v82, v60, v61
  v_cvt_pk_bf16_f32 v83, v62, v63
  s_nop 1
  v_permlane16_swap_b32 v80, v82
  v_permlane16_swap_b32 v81, v83
  buffer_store_dwordx4 v[80:83], v72, s[20:23], s38 offen offset:64 sc1
  v_cvt_pk_bf16_f32 v84, v64, v65
  v_cvt_pk_bf16_f32 v85, v66, v67
  v_cvt_pk_bf16_f32 v86, v68, v69
  v_cvt_pk_bf16_f32 v87, v70, v71
  s_nop 1
  v_permlane16_swap_b32 v84, v86
  v_permlane16_swap_b32 v85, v87
  buffer_store_dwordx4 v[84:87], v72, s[20:23], s38 offen offset:128 sc1
  s_add_u32 s38, s38, 73728
  s_waitcnt vmcnt(0)
  s_barrier
  s_cmp_lg_u32 s3, 0
  s_cbranch_scc1 Ls_skip_67
  s_lshl_b32 s50, s92, 7
  s_add_u32 s50, s50, 19456
  v_mov_b32 v2, 1
  s_mov_b64 exec, 1
  buffer_atomic_add v2, off, s[88:91], s50
  s_mov_b64 exec, -1
Ls_skip_67:
  s_add_u32 s85, s85, 1
  s_cmp_lt_u32 s85, 16
  s_cbranch_scc1 Lmg_rb_63
  s_branch Lmg_next_3
Lmg_t6_32:
  s_mov_b32 s85, 0
Lmg_rb_68:
  s_mov_b32 s92, s85
  s_barrier
  s_cmp_lg_u32 s3, 0
  s_cbranch_scc1 Lw_skip_69
  s_mov_b64 exec, 1
  s_lshl_b32 s50, s92, 7
  s_add_u32 s50, s50, 19456
  s_mov_b32 s52, 0
Lw_lp_70:
  buffer_load_dword v2, off, s[88:91], s50 sc1
  s_waitcnt vmcnt(0)
  v_readfirstlane_b32 s51, v2
  s_add_u32 s52, s52, 1
  s_cmp_gt_u32 s52, 2000000
  s_cbranch_scc1 Lw_lp_70_x
  s_cmp_ge_u32 s51, 48
  s_cbranch_scc1 Lw_lp_70_x
  s_sleep 4
  s_branch Lw_lp_70
Lw_lp_70_x:
  s_mov_b64 exec, -1
Lw_skip_69:
  s_barrier
  s_add_u32 s12, s98, 0x57d2000
  s_addc_u32 s13, s99, 0
  s_mov_b32 s14, 0x900000
  s_mov_b32 s15, 0x20000
  s_add_u32 s16, s98, 0x60d2000
  s_addc_u32 s17, s99, 0
  s_mov_b32 s18, 0x900000
  s_mov_b32 s19, 0x20000
  s_lshl_b32 s30, s92, 4
  s_add_u32 s30, s30, s93
  s_lshl_b32 s30, s30, 1
  s_add_u32 s30, s30, 0
  v_and_b32 v1, 63, v0
  v_lshrrev_b32 v2, 6, v0
  s_lshl_b32 s24, s30, 2
  v_add_u32 v2, s24, v2
  s_movk_i32 s25, 4608
  v_mul_lo_u32 v2, v2, s25
  v_lshl_add_u32 v3, v1, 4, v2
  v_cmp_gt_u32 vcc, 32, v1
  v_mov_b32 v5, 0x7ffffff0
  v_add_u32 v4, 4096, v3
  v_cndmask_b32 v6, v5, v4, vcc
  v_cndmask_b32 v9, 0, 1.0, vcc
  buffer_load_dwordx4 v[12:15], v3, s[12:15], 0 offen offset:0
  buffer_load_dwordx4 v[16:19], v3, s[12:15], 0 offen offset:1024
  buffer_load_dwordx4 v[20:23], v3, s[12:15], 0 offen offset:2048
  buffer_load_dwordx4 v[24:27], v3, s[12:15], 0 offen offset:3072
  buffer_load_dwordx4 v[28:31], v6, s[12:15], 0 offen
  s_waitcnt vmcnt(0)
  v_lshlrev_b32 v72, 16, v12
  v_and_b32 v73, 0xffff0000, v12
  v_lshlrev_b32 v74, 16, v13
  v_and_b32 v75, 0xffff0000, v13
  v_lshlrev_b32 v76, 16, v14
  v_and_b32 v77, 0xffff0000, v14
  v_lshlrev_b32 v78, 16, v15
  v_and_b32 v79, 0xffff0000, v15
  v_lshlrev_b32 v80, 16, v16
  v_and_b32 v81, 0xffff0000, v16
  v_lshlrev_b32 v82, 16, v17
  v_and_b32 v83, 0xffff0000, v17
  v_lshlrev_b32 v84, 16, v18
  v_and_b32 v85, 0xffff0000, v18
  v_lshlrev_b32 v86, 16, v19
  v_and_b32 v87, 0xffff0000, v19
  v_lshlrev_b32 v88, 16, v20
  v_and_b32 v89, 0xffff0000, v20
  v_lshlrev_b32 v90, 16, v21
  v_and_b32 v91, 0xffff0000, v21
  v_lshlrev_b32 v92, 16, v22
  v_and_b32 v93, 0xffff0000, v22
  v_lshlrev_b32 v94, 16, v23
  v_and_b32 v95, 0xffff0000, v23
  v_lshlrev_b32 v96, 16, v24
  v_and_b32 v97, 0xffff0000, v24
  v_lshlrev_b32 v98, 16, v25
  v_and_b32 v99, 0xffff0000, v25
  v_lshlrev_b32 v100, 16, v26
  v_and_b32 v101, 0xffff0000, v26
  v_lshlrev_b32 v102, 16, v27
  v_and_b32 v103, 0xffff0000, v27
  v_lshlrev_b32 v104, 16, v28
  v_and_b32 v105, 0xffff0000, v28
  v_lshlrev_b32 v106, 16, v29
  v_and_b32 v107, 0xffff0000, v29
  v_lshlrev_b32 v108, 16, v30
  v_and_b32 v109, 0xffff0000, v30
  v_lshlrev_b32 v110, 16, v31
  v_and_b32 v111, 0xffff0000, v31
  v_add_f32 v8, v72, v73
  v_add_f32 v8, v8, v74
  v_add_f32 v8, v8, v75
  v_add_f32 v8, v8, v76
  v_add_f32 v8, v8, v77
  v_add_f32 v8, v8, v78
  v_add_f32 v8, v8, v79
  v_add_f32 v8, v8, v80
  v_add_f32 v8, v8, v81
  v_add_f32 v8, v8, v82
  v_add_f32 v8, v8, v83
  v_add_f32 v8, v8, v84
  v_add_f32 v8, v8, v85
  v_add_f32 v8, v8, v86
  v_add_f32 v8, v8, v87
  v_add_f32 v8, v8, v88
  v_add_f32 v8, v8, v89
  v_add_f32 v8, v8, v90
  v_add_f32 v8, v8, v91
  v_add_f32 v8, v8, v92
  v_add_f32 v8, v8, v93
  v_add_f32 v8, v8, v94
  v_add_f32 v8, v8, v95
  v_add_f32 v8, v8, v96
  v_add_f32 v8, v8, v97
  v_add_f32 v8, v8, v98
  v_add_f32 v8, v8, v99
  v_add_f32 v8, v8, v100
  v_add_f32 v8, v8, v101
  v_add_f32 v8, v8, v102
  v_add_f32 v8, v8, v103
  v_add_f32 v8, v8, v104
  v_add_f32 v8, v8, v105
  v_add_f32 v8, v8, v106
  v_add_f32 v8, v8, v107
  v_add_f32 v8, v8, v108
  v_add_f32 v8, v8, v109
  v_add_f32 v8, v8, v110
  v_add_f32 v8, v8, v111
  s_nop 1
  v_add_f32_dpp v8, v8, v8 row_ror:8 row_mask:0xf bank_mask:0xf
  s_nop 1
  v_add_f32_dpp v8, v8, v8 row_ror:4 row_mask:0xf bank_mask:0xf
  s_nop 1
  v_add_f32_dpp v8, v8, v8 row_ror:2 row_mask:0xf bank_mask:0xf
  s_nop 1
  v_add_f32_dpp v8, v8, v8 row_ror:1 row_mask:0xf bank_mask:0xf
  v_mov_b32 v11, v8
  s_nop 1
  v_permlane16_swap_b32 v8, v11
  s_nop 1
  v_add_f32 v8, v8, v11
  v_mov_b32 v11, v8
  s_nop 1
  v_permlane32_swap_b32 v8, v11
  s_nop 1
  v_add_f32 v8, v8, v11
  s_mov_b32 s27, 0x39e38e39
  v_mul_f32 v8, s27, v8
  v_mov_b32 v10, 0
  v_mov_b32 v112, 0
  v_sub_f32 v11, v72, v8
  v_fmac_f32 v10, v11, v11
  v_sub_f32 v11, v73, v8
  v_fmac_f32 v10, v11, v11
  v_sub_f32 v11, v74, v8
  v_fmac_f32 v10, v11, v11
  v_sub_f32 v11, v75, v8
  v_fmac_f32 v10, v11, v11
  v_sub_f32 v11, v76, v8
  v_fmac_f32 v10, v11, v11
  v_sub_f32 v11, v77, v8
  v_fmac_f32 v10, v11, v11
  v_sub_f32 v11, v78, v8
  v_fmac_f32 v10, v11, v11
  v_sub_f32 v11, v79, v8
  v_fmac_f32 v10, v11, v11
  v_sub_f32 v11, v80, v8
  v_fmac_f32 v10, v11, v11
  v_sub_f32 v11, v81, v8
  v_fmac_f32 v10, v11, v11
  v_sub_f32 v11, v82, v8
  v_fmac_f32 v10, v11, v11
  v_sub_f32 v11, v83, v8
  v_fmac_f32 v10, v11, v11
  v_sub_f32 v11, v84, v8
  v_fmac_f32 v10, v11, v11
  v_sub_f32 v11, v85, v8
  v_fmac_f32 v10, v11, v11
  v_sub_f32 v11, v86, v8
  v_fmac_f32 v10, v11, v11
  v_sub_f32 v11, v87, v8
  v_fmac_f32 v10, v11, v11
  v_sub_f32 v11, v88, v8
  v_fmac_f32 v10, v11, v11
  v_sub_f32 v11, v89, v8
  v_fmac_f32 v10, v11, v11
  v_sub_f32 v11, v90, v8
  v_fmac_f32 v10, v11, v11
  v_sub_f32 v11, v91, v8
  v_fmac_f32 v10, v11, v11
  v_sub_f32 v11, v92, v8
  v_fmac_f32 v10, v11, v11
  v_sub_f32 v11, v93, v8
  v_fmac_f32 v10, v11, v11
  v_sub_f32 v11, v94, v8
  v_fmac_f32 v10, v11, v11
  v_sub_f32 v11, v95, v8
  v_fmac_f32 v10, v11, v11
  v_sub_f32 v11, v96, v8
  v_fmac_f32 v10, v11, v11
  v_sub_f32 v11, v97, v8
  v_fmac_f32 v10, v11, v11
  v_sub_f32 v11, v98, v8
  v_fmac_f32 v10, v11, v11
  v_sub_f32 v11, v99, v8
  v_fmac_f32 v10, v11, v11
  v_sub_f32 v11, v100, v8
  v_fmac_f32 v10, v11, v11
  v_sub_f32 v11, v101, v8
  v_fmac_f32 v10, v11, v11
  v_sub_f32 v11, v102, v8
  v_fmac_f32 v10, v11, v11
  v_sub_f32 v11, v103, v8
  v_fmac_f32 v10, v11, v11
  v_sub_f32 v11, v104, v8
  v_fmac_f32 v112, v11, v11
  v_sub_f32 v11, v105, v8
  v_fmac_f32 v112, v11, v11
  v_sub_f32 v11, v106, v8
  v_fmac_f32 v112, v11, v11
  v_sub_f32 v11, v107, v8
  v_fmac_f32 v112, v11, v11
  v_sub_f32 v11, v108, v8
  v_fmac_f32 v112, v11, v11
  v_sub_f32 v11, v109, v8
  v_fmac_f32 v112, v11, v11
  v_sub_f32 v11, v110, v8
  v_fmac_f32 v112, v11, v11
  v_sub_f32 v11, v111, v8
  v_fmac_f32 v112, v11, v11
  v_fmac_f32 v10, v112, v9
  s_nop 1
  v_add_f32_dpp v10, v10, v10 row_ror:8 row_mask:0xf bank_mask:0xf
  s_nop 1
  v_add_f32_dpp v10, v10, v10 row_ror:4 row_mask:0xf bank_mask:0xf
  s_nop 1
  v_add_f32_dpp v10, v10, v10 row_ror:2 row_mask:0xf bank_mask:0xf
  s_nop 1
  v_add_f32_dpp v10, v10, v10 row_ror:1 row_mask:0xf bank_mask:0xf
  v_mov_b32 v11, v10
  s_nop 1
  v_permlane16_swap_b32 v10, v11
  s_nop 1
  v_add_f32 v10, v10, v11
  v_mov_b32 v11, v10
  s_nop 1
  v_permlane32_swap_b32 v10, v11
  s_nop 1
  v_add_f32 v10, v10, v11
  v_mul_f32 v10, s27, v10
  v_cvt_pk_bf16_f32 v11, v10, v10
  v_lshlrev_b32 v10, 16, v11
  v_cvt_pk_bf16_f32 v11, v8, v8
  v_lshlrev_b32 v8, 16, v11
  v_add_f32 v10, 0x3727c5ac, v10
  v_cvt_pk_bf16_f32 v11, v10, v10
  v_lshlrev_b32 v10, 16, v11
  v_sqrt_f32 v10, v10
  s_nop 0
  v_cvt_pk_bf16_f32 v11, v10, v10
  v_lshlrev_b32 v10, 16, v11
  v_rcp_f32 v10, v10
  s_nop 0
  v_sub_f32 v72, v72, v8
  v_sub_f32 v73, v73, v8
  v_cvt_pk_bf16_f32 v11, v72, v73
  v_lshlrev_b32 v72, 16, v11
  v_and_b32 v73, 0xffff0000, v11
  v_mul_f32 v72, v72, v10
  v_mul_f32 v73, v73, v10
  v_cvt_pk_bf16_f32 v12, v72, v73
  v_sub_f32 v74, v74, v8
  v_sub_f32 v75, v75, v8
  v_cvt_pk_bf16_f32 v11, v74, v75
  v_lshlrev_b32 v74, 16, v11
  v_and_b32 v75, 0xffff0000, v11
  v_mul_f32 v74, v74, v10
  v_mul_f32 v75, v75, v10
  v_cvt_pk_bf16_f32 v13, v74, v75
  v_sub_f32 v76, v76, v8
  v_sub_f32 v77, v77, v8
  v_cvt_pk_bf16_f32 v11, v76, v77
  v_lshlrev_b32 v76, 16, v11
  v_and_b32 v77, 0xffff0000, v11
  v_mul_f32 v76, v76, v10
  v_mul_f32 v77, v77, v10
  v_cvt_pk_bf16_f32 v14, v76, v77
  v_sub_f32 v78, v78, v8
  v_sub_f32 v79, v79, v8
  v_cvt_pk_bf16_f32 v11, v78, v79
  v_lshlrev_b32 v78, 16, v11
  v_and_b32 v79, 0xffff0000, v11
  v_mul_f32 v78, v78, v10
  v_mul_f32 v79, v79, v10
  v_cvt_pk_bf16_f32 v15, v78, v79
  v_sub_f32 v80, v80, v8
  v_sub_f32 v81, v81, v8
  v_cvt_pk_bf16_f32 v11, v80, v81
  v_lshlrev_b32 v80, 16, v11
  v_and_b32 v81, 0xffff0000, v11
  v_mul_f32 v80, v80, v10
  v_mul_f32 v81, v81, v10
  v_cvt_pk_bf16_f32 v16, v80, v81
  v_sub_f32 v82, v82, v8
  v_sub_f32 v83, v83, v8
  v_cvt_pk_bf16_f32 v11, v82, v83
  v_lshlrev_b32 v82, 16, v11
  v_and_b32 v83, 0xffff0000, v11
  v_mul_f32 v82, v82, v10
  v_mul_f32 v83, v83, v10
  v_cvt_pk_bf16_f32 v17, v82, v83
  v_sub_f32 v84, v84, v8
  v_sub_f32 v85, v85, v8
  v_cvt_pk_bf16_f32 v11, v84, v85
  v_lshlrev_b32 v84, 16, v11
  v_and_b32 v85, 0xffff0000, v11
  v_mul_f32 v84, v84, v10
  v_mul_f32 v85, v85, v10
  v_cvt_pk_bf16_f32 v18, v84, v85
  v_sub_f32 v86, v86, v8
  v_sub_f32 v87, v87, v8
  v_cvt_pk_bf16_f32 v11, v86, v87
  v_lshlrev_b32 v86, 16, v11
  v_and_b32 v87, 0xffff0000, v11
  v_mul_f32 v86, v86, v10
  v_mul_f32 v87, v87, v10
  v_cvt_pk_bf16_f32 v19, v86, v87
  v_sub_f32 v88, v88, v8
  v_sub_f32 v89, v89, v8
  v_cvt_pk_bf16_f32 v11, v88, v89
  v_lshlrev_b32 v88, 16, v11
  v_and_b32 v89, 0xffff0000, v11
  v_mul_f32 v88, v88, v10
  v_mul_f32 v89, v89, v10
  v_cvt_pk_bf16_f32 v20, v88, v89
  v_sub_f32 v90, v90, v8
  v_sub_f32 v91, v91, v8
  v_cvt_pk_bf16_f32 v11, v90, v91
  v_lshlrev_b32 v90, 16, v11
  v_and_b32 v91, 0xffff0000, v11
  v_mul_f32 v90, v90, v10
  v_mul_f32 v91, v91, v10
  v_cvt_pk_bf16_f32 v21, v90, v91
  v_sub_f32 v92, v92, v8
  v_sub_f32 v93, v93, v8
  v_cvt_pk_bf16_f32 v11, v92, v93
  v_lshlrev_b32 v92, 16, v11
  v_and_b32 v93, 0xffff0000, v11
  v_mul_f32 v92, v92, v10
  v_mul_f32 v93, v93, v10
  v_cvt_pk_bf16_f32 v22, v92, v93
  v_sub_f32 v94, v94, v8
  v_sub_f32 v95, v95, v8
  v_cvt_pk_bf16_f32 v11, v94, v95
  v_lshlrev_b32 v94, 16, v11
  v_and_b32 v95, 0xffff0000, v11
  v_mul_f32 v94, v94, v10
  v_mul_f32 v95, v95, v10
  v_cvt_pk_bf16_f32 v23, v94, v95
  v_sub_f32 v96, v96, v8
  v_sub_f32 v97, v97, v8
  v_cvt_pk_bf16_f32 v11, v96, v97
  v_lshlrev_b32 v96, 16, v11
  v_and_b32 v97, 0xffff0000, v11
  v_mul_f32 v96, v96, v10
  v_mul_f32 v97, v97, v10
  v_cvt_pk_bf16_f32 v24, v96, v97
  v_sub_f32 v98, v98, v8
  v_sub_f32 v99, v99, v8
  v_cvt_pk_bf16_f32 v11, v98, v99
  v_lshlrev_b32 v98, 16, v11
  v_and_b32 v99, 0xffff0000, v11
  v_mul_f32 v98, v98, v10
  v_mul_f32 v99, v99, v10
  v_cvt_pk_bf16_f32 v25, v98, v99
  v_sub_f32 v100, v100, v8
  v_sub_f32 v101, v101, v8
  v_cvt_pk_bf16_f32 v11, v100, v101
  v_lshlrev_b32 v100, 16, v11
  v_and_b32 v101, 0xffff0000, v11
  v_mul_f32 v100, v100, v10
  v_mul_f32 v101, v101, v10
  v_cvt_pk_bf16_f32 v26, v100, v101
  v_sub_f32 v102, v102, v8
  v_sub_f32 v103, v103, v8
  v_cvt_pk_bf16_f32 v11, v102, v103
  v_lshlrev_b32 v102, 16, v11
  v_and_b32 v103, 0xffff0000, v11
  v_mul_f32 v102, v102, v10
  v_mul_f32 v103, v103, v10
  v_cvt_pk_bf16_f32 v27, v102, v103
  v_sub_f32 v104, v104, v8
  v_sub_f32 v105, v105, v8
  v_cvt_pk_bf16_f32 v11, v104, v105
  v_lshlrev_b32 v104, 16, v11
  v_and_b32 v105, 0xffff0000, v11
  v_mul_f32 v104, v104, v10
  v_mul_f32 v105, v105, v10
  v_cvt_pk_bf16_f32 v28, v104, v105
  v_sub_f32 v106, v106, v8
  v_sub_f32 v107, v107, v8
  v_cvt_pk_bf16_f32 v11, v106, v107
  v_lshlrev_b32 v106, 16, v11
  v_and_b32 v107, 0xffff0000, v11
  v_mul_f32 v106, v106, v10
  v_mul_f32 v107, v107, v10
  v_cvt_pk_bf16_f32 v29, v106, v107
  v_sub_f32 v108, v108, v8
  v_sub_f32 v109, v109, v8
  v_cvt_pk_bf16_f32 v11, v108, v109
  v_lshlrev_b32 v108, 16, v11
  v_and_b32 v109, 0xffff0000, v11
  v_mul_f32 v108, v108, v10
  v_mul_f32 v109, v109, v10
  v_cvt_pk_bf16_f32 v30, v108, v109
  v_sub_f32 v110, v110, v8
  v_sub_f32 v111, v111, v8
  v_cvt_pk_bf16_f32 v11, v110, v111
  v_lshlrev_b32 v110, 16, v11
  v_and_b32 v111, 0xffff0000, v11
  v_mul_f32 v110, v110, v10
  v_mul_f32 v111, v111, v10
  v_cvt_pk_bf16_f32 v31, v110, v111
  buffer_store_dwordx4 v[12:15], v3, s[16:19], 0 offen offset:0 sc1
  buffer_store_dwordx4 v[16:19], v3, s[16:19], 0 offen offset:1024 sc1
  buffer_store_dwordx4 v[20:23], v3, s[16:19], 0 offen offset:2048 sc1
  buffer_store_dwordx4 v[24:27], v3, s[16:19], 0 offen offset:3072 sc1
  buffer_store_dwordx4 v[28:31], v6, s[16:19], 0 offen sc1
  s_nop 1
  s_lshl_b32 s30, s92, 4
  s_add_u32 s30, s30, s93
  s_lshl_b32 s30, s30, 1
  s_add_u32 s30, s30, 1
  v_and_b32 v1, 63, v0
  v_lshrrev_b32 v2, 6, v0
  s_lshl_b32 s24, s30, 2
  v_add_u32 v2, s24, v2
  s_movk_i32 s25, 4608
  v_mul_lo_u32 v2, v2, s25
  v_lshl_add_u32 v3, v1, 4, v2
  v_cmp_gt_u32 vcc, 32, v1
  v_mov_b32 v5, 0x7ffffff0
  v_add_u32 v4, 4096, v3
  v_cndmask_b32 v6, v5, v4, vcc
  v_cndmask_b32 v9, 0, 1.0, vcc
  buffer_load_dwordx4 v[12:15], v3, s[12:15], 0 offen offset:0
  buffer_load_dwordx4 v[16:19], v3, s[12:15], 0 offen offset:1024
  buffer_load_dwordx4 v[20:23], v3, s[12:15], 0 offen offset:2048
  buffer_load_dwordx4 v[24:27], v3, s[12:15], 0 offen offset:3072
  buffer_load_dwordx4 v[28:31], v6, s[12:15], 0 offen
  s_waitcnt vmcnt(0)
  v_lshlrev_b32 v72, 16, v12
  v_and_b32 v73, 0xffff0000, v12
  v_lshlrev_b32 v74, 16, v13
  v_and_b32 v75, 0xffff0000, v13
  v_lshlrev_b32 v76, 16, v14
  v_and_b32 v77, 0xffff0000, v14
  v_lshlrev_b32 v78, 16, v15
  v_and_b32 v79, 0xffff0000, v15
  v_lshlrev_b32 v80, 16, v16
  v_and_b32 v81, 0xffff0000, v16
  v_lshlrev_b32 v82, 16, v17
  v_and_b32 v83, 0xffff0000, v17
  v_lshlrev_b32 v84, 16, v18
  v_and_b32 v85, 0xffff0000, v18
  v_lshlrev_b32 v86, 16, v19
  v_and_b32 v87, 0xffff0000, v19
  v_lshlrev_b32 v88, 16, v20
  v_and_b32 v89, 0xffff0000, v20
  v_lshlrev_b32 v90, 16, v21
  v_and_b32 v91, 0xffff0000, v21
  v_lshlrev_b32 v92, 16, v22
  v_and_b32 v93, 0xffff0000, v22
  v_lshlrev_b32 v94, 16, v23
  v_and_b32 v95, 0xffff0000, v23
  v_lshlrev_b32 v96, 16, v24
  v_and_b32 v97, 0xffff0000, v24
  v_lshlrev_b32 v98, 16, v25
  v_and_b32 v99, 0xffff0000, v25
  v_lshlrev_b32 v100, 16, v26
  v_and_b32 v101, 0xffff0000, v26
  v_lshlrev_b32 v102, 16, v27
  v_and_b32 v103, 0xffff0000, v27
  v_lshlrev_b32 v104, 16, v28
  v_and_b32 v105, 0xffff0000, v28
  v_lshlrev_b32 v106, 16, v29
  v_and_b32 v107, 0xffff0000, v29
  v_lshlrev_b32 v108, 16, v30
  v_and_b32 v109, 0xffff0000, v30
  v_lshlrev_b32 v110, 16, v31
  v_and_b32 v111, 0xffff0000, v31
  v_add_f32 v8, v72, v73
  v_add_f32 v8, v8, v74
  v_add_f32 v8, v8, v75
  v_add_f32 v8, v8, v76
  v_add_f32 v8, v8, v77
  v_add_f32 v8, v8, v78
  v_add_f32 v8, v8, v79
  v_add_f32 v8, v8, v80
  v_add_f32 v8, v8, v81
  v_add_f32 v8, v8, v82
  v_add_f32 v8, v8, v83
  v_add_f32 v8, v8, v84
  v_add_f32 v8, v8, v85
  v_add_f32 v8, v8, v86
  v_add_f32 v8, v8, v87
  v_add_f32 v8, v8, v88
  v_add_f32 v8, v8, v89
  v_add_f32 v8, v8, v90
  v_add_f32 v8, v8, v91
  v_add_f32 v8, v8, v92
  v_add_f32 v8, v8, v93
  v_add_f32 v8, v8, v94
  v_add_f32 v8, v8, v95
  v_add_f32 v8, v8, v96
  v_add_f32 v8, v8, v97
  v_add_f32 v8, v8, v98
  v_add_f32 v8, v8, v99
  v_add_f32 v8, v8, v100
  v_add_f32 v8, v8, v101
  v_add_f32 v8, v8, v102
  v_add_f32 v8, v8, v103
  v_add_f32 v8, v8, v104
  v_add_f32 v8, v8, v105
  v_add_f32 v8, v8, v106
  v_add_f32 v8, v8, v107
  v_add_f32 v8, v8, v108
  v_add_f32 v8, v8, v109
  v_add_f32 v8, v8, v110
  v_add_f32 v8, v8, v111
  s_nop 1
  v_add_f32_dpp v8, v8, v8 row_ror:8 row_mask:0xf bank_mask:0xf
  s_nop 1
  v_add_f32_dpp v8, v8, v8 row_ror:4 row_mask:0xf bank_mask:0xf
  s_nop 1
  v_add_f32_dpp v8, v8, v8 row_ror:2 row_mask:0xf bank_mask:0xf
  s_nop 1
  v_add_f32_dpp v8, v8, v8 row_ror:1 row_mask:0xf bank_mask:0xf
  v_mov_b32 v11, v8
  s_nop 1
  v_permlane16_swap_b32 v8, v11
  s_nop 1
  v_add_f32 v8, v8, v11
  v_mov_b32 v11, v8
  s_nop 1
  v_permlane32_swap_b32 v8, v11
  s_nop 1
  v_add_f32 v8, v8, v11
  s_mov_b32 s27, 0x39e38e39
  v_mul_f32 v8, s27, v8
  v_mov_b32 v10, 0
  v_mov_b32 v112, 0
  v_sub_f32 v11, v72, v8
  v_fmac_f32 v10, v11, v11
  v_sub_f32 v11, v73, v8
  v_fmac_f32 v10, v11, v11
  v_sub_f32 v11, v74, v8
  v_fmac_f32 v10, v11, v11
  v_sub_f32 v11, v75, v8
  v_fmac_f32 v10, v11, v11
  v_sub_f32 v11, v76, v8
  v_fmac_f32 v10, v11, v11
  v_sub_f32 v11, v77, v8
  v_fmac_f32 v10, v11, v11
  v_sub_f32 v11, v78, v8
  v_fmac_f32 v10, v11, v11
  v_sub_f32 v11, v79, v8
  v_fmac_f32 v10, v11, v11
  v_sub_f32 v11, v80, v8
  v_fmac_f32 v10, v11, v11
  v_sub_f32 v11, v81, v8
  v_fmac_f32 v10, v11, v11
  v_sub_f32 v11, v82, v8
  v_fmac_f32 v10, v11, v11
  v_sub_f32 v11, v83, v8
  v_fmac_f32 v10, v11, v11
  v_sub_f32 v11, v84, v8
  v_fmac_f32 v10, v11, v11
  v_sub_f32 v11, v85, v8
  v_fmac_f32 v10, v11, v11
  v_sub_f32 v11, v86, v8
  v_fmac_f32 v10, v11, v11
  v_sub_f32 v11, v87, v8
  v_fmac_f32 v10, v11, v11
  v_sub_f32 v11, v88, v8
  v_fmac_f32 v10, v11, v11
  v_sub_f32 v11, v89, v8
  v_fmac_f32 v10, v11, v11
  v_sub_f32 v11, v90, v8
  v_fmac_f32 v10, v11, v11
  v_sub_f32 v11, v91, v8
  v_fmac_f32 v10, v11, v11
  v_sub_f32 v11, v92, v8
  v_fmac_f32 v10, v11, v11
  v_sub_f32 v11, v93, v8
  v_fmac_f32 v10, v11, v11
  v_sub_f32 v11, v94, v8
  v_fmac_f32 v10, v11, v11
  v_sub_f32 v11, v95, v8
  v_fmac_f32 v10, v11, v11
  v_sub_f32 v11, v96, v8
  v_fmac_f32 v10, v11, v11
  v_sub_f32 v11, v97, v8
  v_fmac_f32 v10, v11, v11
  v_sub_f32 v11, v98, v8
  v_fmac_f32 v10, v11, v11
  v_sub_f32 v11, v99, v8
  v_fmac_f32 v10, v11, v11
  v_sub_f32 v11, v100, v8
  v_fmac_f32 v10, v11, v11
  v_sub_f32 v11, v101, v8
  v_fmac_f32 v10, v11, v11
  v_sub_f32 v11, v102, v8
  v_fmac_f32 v10, v11, v11
  v_sub_f32 v11, v103, v8
  v_fmac_f32 v10, v11, v11
  v_sub_f32 v11, v104, v8
  v_fmac_f32 v112, v11, v11
  v_sub_f32 v11, v105, v8
  v_fmac_f32 v112, v11, v11
  v_sub_f32 v11, v106, v8
  v_fmac_f32 v112, v11, v11
  v_sub_f32 v11, v107, v8
  v_fmac_f32 v112, v11, v11
  v_sub_f32 v11, v108, v8
  v_fmac_f32 v112, v11, v11
  v_sub_f32 v11, v109, v8
  v_fmac_f32 v112, v11, v11
  v_sub_f32 v11, v110, v8
  v_fmac_f32 v112, v11, v11
  v_sub_f32 v11, v111, v8
  v_fmac_f32 v112, v11, v11
  v_fmac_f32 v10, v112, v9
  s_nop 1
  v_add_f32_dpp v10, v10, v10 row_ror:8 row_mask:0xf bank_mask:0xf
  s_nop 1
  v_add_f32_dpp v10, v10, v10 row_ror:4 row_mask:0xf bank_mask:0xf
  s_nop 1
  v_add_f32_dpp v10, v10, v10 row_ror:2 row_mask:0xf bank_mask:0xf
  s_nop 1
  v_add_f32_dpp v10, v10, v10 row_ror:1 row_mask:0xf bank_mask:0xf
  v_mov_b32 v11, v10
  s_nop 1
  v_permlane16_swap_b32 v10, v11
  s_nop 1
  v_add_f32 v10, v10, v11
  v_mov_b32 v11, v10
  s_nop 1
  v_permlane32_swap_b32 v10, v11
  s_nop 1
  v_add_f32 v10, v10, v11
  v_mul_f32 v10, s27, v10
  v_cvt_pk_bf16_f32 v11, v10, v10
  v_lshlrev_b32 v10, 16, v11
  v_cvt_pk_bf16_f32 v11, v8, v8
  v_lshlrev_b32 v8, 16, v11
  v_add_f32 v10, 0x3727c5ac, v10
  v_cvt_pk_bf16_f32 v11, v10, v10
  v_lshlrev_b32 v10, 16, v11
  v_sqrt_f32 v10, v10
  s_nop 0
  v_cvt_pk_bf16_f32 v11, v10, v10
  v_lshlrev_b32 v10, 16, v11
  v_rcp_f32 v10, v10
  s_nop 0
  v_sub_f32 v72, v72, v8
  v_sub_f32 v73, v73, v8
  v_cvt_pk_bf16_f32 v11, v72, v73
  v_lshlrev_b32 v72, 16, v11
  v_and_b32 v73, 0xffff0000, v11
  v_mul_f32 v72, v72, v10
  v_mul_f32 v73, v73, v10
  v_cvt_pk_bf16_f32 v12, v72, v73
  v_sub_f32 v74, v74, v8
  v_sub_f32 v75, v75, v8
  v_cvt_pk_bf16_f32 v11, v74, v75
  v_lshlrev_b32 v74, 16, v11
  v_and_b32 v75, 0xffff0000, v11
  v_mul_f32 v74, v74, v10
  v_mul_f32 v75, v75, v10
  v_cvt_pk_bf16_f32 v13, v74, v75
  v_sub_f32 v76, v76, v8
  v_sub_f32 v77, v77, v8
  v_cvt_pk_bf16_f32 v11, v76, v77
  v_lshlrev_b32 v76, 16, v11
  v_and_b32 v77, 0xffff0000, v11
  v_mul_f32 v76, v76, v10
  v_mul_f32 v77, v77, v10
  v_cvt_pk_bf16_f32 v14, v76, v77
  v_sub_f32 v78, v78, v8
  v_sub_f32 v79, v79, v8
  v_cvt_pk_bf16_f32 v11, v78, v79
  v_lshlrev_b32 v78, 16, v11
  v_and_b32 v79, 0xffff0000, v11
  v_mul_f32 v78, v78, v10
  v_mul_f32 v79, v79, v10
  v_cvt_pk_bf16_f32 v15, v78, v79
  v_sub_f32 v80, v80, v8
  v_sub_f32 v81, v81, v8
  v_cvt_pk_bf16_f32 v11, v80, v81
  v_lshlrev_b32 v80, 16, v11
  v_and_b32 v81, 0xffff0000, v11
  v_mul_f32 v80, v80, v10
  v_mul_f32 v81, v81, v10
  v_cvt_pk_bf16_f32 v16, v80, v81
  v_sub_f32 v82, v82, v8
  v_sub_f32 v83, v83, v8
  v_cvt_pk_bf16_f32 v11, v82, v83
  v_lshlrev_b32 v82, 16, v11
  v_and_b32 v83, 0xffff0000, v11
  v_mul_f32 v82, v82, v10
  v_mul_f32 v83, v83, v10
  v_cvt_pk_bf16_f32 v17, v82, v83
  v_sub_f32 v84, v84, v8
  v_sub_f32 v85, v85, v8
  v_cvt_pk_bf16_f32 v11, v84, v85
  v_lshlrev_b32 v84, 16, v11
  v_and_b32 v85, 0xffff0000, v11
  v_mul_f32 v84, v84, v10
  v_mul_f32 v85, v85, v10
  v_cvt_pk_bf16_f32 v18, v84, v85
  v_sub_f32 v86, v86, v8
  v_sub_f32 v87, v87, v8
  v_cvt_pk_bf16_f32 v11, v86, v87
  v_lshlrev_b32 v86, 16, v11
  v_and_b32 v87, 0xffff0000, v11
  v_mul_f32 v86, v86, v10
  v_mul_f32 v87, v87, v10
  v_cvt_pk_bf16_f32 v19, v86, v87
  v_sub_f32 v88, v88, v8
  v_sub_f32 v89, v89, v8
  v_cvt_pk_bf16_f32 v11, v88, v89
  v_lshlrev_b32 v88, 16, v11
  v_and_b32 v89, 0xffff0000, v11
  v_mul_f32 v88, v88, v10
  v_mul_f32 v89, v89, v10
  v_cvt_pk_bf16_f32 v20, v88, v89
  v_sub_f32 v90, v90, v8
  v_sub_f32 v91, v91, v8
  v_cvt_pk_bf16_f32 v11, v90, v91
  v_lshlrev_b32 v90, 16, v11
  v_and_b32 v91, 0xffff0000, v11
  v_mul_f32 v90, v90, v10
  v_mul_f32 v91, v91, v10
  v_cvt_pk_bf16_f32 v21, v90, v91
  v_sub_f32 v92, v92, v8
  v_sub_f32 v93, v93, v8
  v_cvt_pk_bf16_f32 v11, v92, v93
  v_lshlrev_b32 v92, 16, v11
  v_and_b32 v93, 0xffff0000, v11
  v_mul_f32 v92, v92, v10
  v_mul_f32 v93, v93, v10
  v_cvt_pk_bf16_f32 v22, v92, v93
  v_sub_f32 v94, v94, v8
  v_sub_f32 v95, v95, v8
  v_cvt_pk_bf16_f32 v11, v94, v95
  v_lshlrev_b32 v94, 16, v11
  v_and_b32 v95, 0xffff0000, v11
  v_mul_f32 v94, v94, v10
  v_mul_f32 v95, v95, v10
  v_cvt_pk_bf16_f32 v23, v94, v95
  v_sub_f32 v96, v96, v8
  v_sub_f32 v97, v97, v8
  v_cvt_pk_bf16_f32 v11, v96, v97
  v_lshlrev_b32 v96, 16, v11
  v_and_b32 v97, 0xffff0000, v11
  v_mul_f32 v96, v96, v10
  v_mul_f32 v97, v97, v10
  v_cvt_pk_bf16_f32 v24, v96, v97
  v_sub_f32 v98, v98, v8
  v_sub_f32 v99, v99, v8
  v_cvt_pk_bf16_f32 v11, v98, v99
  v_lshlrev_b32 v98, 16, v11
  v_and_b32 v99, 0xffff0000, v11
  v_mul_f32 v98, v98, v10
  v_mul_f32 v99, v99, v10
  v_cvt_pk_bf16_f32 v25, v98, v99
  v_sub_f32 v100, v100, v8
  v_sub_f32 v101, v101, v8
  v_cvt_pk_bf16_f32 v11, v100, v101
  v_lshlrev_b32 v100, 16, v11
  v_and_b32 v101, 0xffff0000, v11
  v_mul_f32 v100, v100, v10
  v_mul_f32 v101, v101, v10
  v_cvt_pk_bf16_f32 v26, v100, v101
  v_sub_f32 v102, v102, v8
  v_sub_f32 v103, v103, v8
  v_cvt_pk_bf16_f32 v11, v102, v103
  v_lshlrev_b32 v102, 16, v11
  v_and_b32 v103, 0xffff0000, v11
  v_mul_f32 v102, v102, v10
  v_mul_f32 v103, v103, v10
  v_cvt_pk_bf16_f32 v27, v102, v103
  v_sub_f32 v104, v104, v8
  v_sub_f32 v105, v105, v8
  v_cvt_pk_bf16_f32 v11, v104, v105
  v_lshlrev_b32 v104, 16, v11
  v_and_b32 v105, 0xffff0000, v11
  v_mul_f32 v104, v104, v10
  v_mul_f32 v105, v105, v10
  v_cvt_pk_bf16_f32 v28, v104, v105
  v_sub_f32 v106, v106, v8
  v_sub_f32 v107, v107, v8
  v_cvt_pk_bf16_f32 v11, v106, v107
  v_lshlrev_b32 v106, 16, v11
  v_and_b32 v107, 0xffff0000, v11
  v_mul_f32 v106, v106, v10
  v_mul_f32 v107, v107, v10
  v_cvt_pk_bf16_f32 v29, v106, v107
  v_sub_f32 v108, v108, v8
  v_sub_f32 v109, v109, v8
  v_cvt_pk_bf16_f32 v11, v108, v109
  v_lshlrev_b32 v108, 16, v11
  v_and_b32 v109, 0xffff0000, v11
  v_mul_f32 v108, v108, v10
  v_mul_f32 v109, v109, v10
  v_cvt_pk_bf16_f32 v30, v108, v109
  v_sub_f32 v110, v110, v8
  v_sub_f32 v111, v111, v8
  v_cvt_pk_bf16_f32 v11, v110, v111
  v_lshlrev_b32 v110, 16, v11
  v_and_b32 v111, 0xffff0000, v11
  v_mul_f32 v110, v110, v10
  v_mul_f32 v111, v111, v10
  v_cvt_pk_bf16_f32 v31, v110, v111
  buffer_store_dwordx4 v[12:15], v3, s[16:19], 0 offen offset:0 sc1
  buffer_store_dwordx4 v[16:19], v3, s[16:19], 0 offen offset:1024 sc1
  buffer_store_dwordx4 v[20:23], v3, s[16:19], 0 offen offset:2048 sc1
  buffer_store_dwordx4 v[24:27], v3, s[16:19], 0 offen offset:3072 sc1
  buffer_store_dwordx4 v[28:31], v6, s[16:19], 0 offen sc1
  s_nop 1
  s_waitcnt vmcnt(0)
  s_barrier
  s_cmp_lg_u32 s3, 0
  s_cbranch_scc1 Ls_skip_71
  s_lshl_b32 s50, s92, 7
  s_add_u32 s50, s50, 21504
  v_mov_b32 v2, 1
  s_mov_b64 exec, 1
  buffer_atomic_add v2, off, s[88:91], s50
  s_mov_b64 exec, -1
Ls_skip_71:
  s_add_u32 s85, s85, 1
  s_cmp_lt_u32 s85, 16
  s_cbranch_scc1 Lmg_rb_68
  s_branch Lmg_next_3
Lmg_t7_33:
  s_mov_b32 s10, s98
  s_mov_b32 s11, s99
  s_mov_b32 s32, s92
  s_mov_b32 s36, s93
  s_load_dwordx2 s[4:5], s[0:1], 72
  s_load_dwordx2 s[6:7], s[0:1], 80
  s_waitcnt lgkmcnt(0)
  s_mov_b32 s12, s4
  s_mov_b32 s13, s5
  s_mov_b32 s14, 0x800000
  s_mov_b32 s15, 0x20000
  s_add_u32 s16, s10, 0x60d2000
  s_addc_u32 s17, s11, 0
  s_mov_b32 s18, 0x900000
  s_mov_b32 s19, 0x20000
  s_add_u32 s20, s10, 0x69d2000
  s_addc_u32 s21, s11, 0
  s_mov_b32 s22, 0x900000
  s_mov_b32 s23, 0x20000
  s_add_u32 s24, s10, 0x4ed2000
  s_addc_u32 s25, s11, 0
  s_mov_b32 s26, 0x900000
  s_mov_b32 s27, 0x20000
  s_mov_b32 s56, s6
  s_mov_b32 s57, s7
  s_mov_b32 s58, 0x1000
  s_mov_b32 s59, 0x20000
  s_mul_i32 s46, s32, 1048576
  s_mul_i32 s47, s36, 512
  v_and_b32 v1, 63, v0
  v_lshrrev_b32 v2, 3, v1
  v_xor_b32 v3, v2, v1
  v_and_b32 v3, 7, v3
  s_mov_b32 s40, 4096
  v_mul_lo_u32 v2, v2, s40
  v_lshl_add_u32 v2, v3, 4, v2
  s_add_u32 s41, s3, 0
  s_mul_i32 s41, s41, 32768
  v_add_u32 v4, s41, v2
  s_add_u32 s41, s3, 4
  s_mul_i32 s41, s41, 32768
  v_add_u32 v5, s41, v2
  s_add_u32 s41, s3, 8
  s_mul_i32 s41, s41, 32768
  v_add_u32 v6, s41, v2
  s_add_u32 s41, s3, 12
  s_mul_i32 s41, s41, 32768
  v_add_u32 v7, s41, v2
  s_add_u32 s41, s3, 16
  s_mul_i32 s41, s41, 32768
  v_add_u32 v8, s41, v2
  s_add_u32 s41, s3, 20
  s_mul_i32 s41, s41, 32768
  v_add_u32 v9, s41, v2
  s_add_u32 s41, s3, 24
  s_mul_i32 s41, s41, 32768
  v_add_u32 v10, s41, v2
  s_add_u32 s41, s3, 28
  s_mul_i32 s41, s41, 32768
  v_add_u32 v11, s41, v2
  s_add_u32 s41, s3, 0
  s_min_u32 s41, s41, 15
  s_lshl_b32 s41, s41, 6
  v_add_u32 v28, s41, v1
  s_mov_b32 s42, 0x8000000
  v_mul_hi_u32 v29, v28, s42
  v_mul_u32_u24 v30, 32, v29
  v_sub_u32 v30, v28, v30
  v_and_b32 v31, 3, v29
  v_bfe_u32 v32, v29, 3, 1
  v_lshl_add_u32 v31, v32, 2, v31
  v_lshrrev_b32 v32, 1, v30
  v_sub_u32 v32, v32, v31
  v_add_u32 v31, 16, v32
  v_cmp_gt_i32 vcc, 0, v32
  s_nop 1
  v_cndmask_b32 v32, v32, v31, vcc
  v_and_b32 v30, 1, v30
  v_lshlrev_b32 v30, 4, v30
  v_lshl_add_u32 v30, v32, 5, v30
  s_mov_b32 s42, 4608
  v_mul_lo_u32 v29, v29, s42
  v_add_u32 v12, v29, v30
  s_add_u32 s41, s3, 4
  s_min_u32 s41, s41, 15
  s_lshl_b32 s41, s41, 6
  v_add_u32 v28, s41, v1
  s_mov_b32 s42, 0x8000000
  v_mul_hi_u32 v29, v28, s42
  v_mul_u32_u24 v30, 32, v29
  v_sub_u32 v30, v28, v30
  v_and_b32 v31, 3, v29
  v_bfe_u32 v32, v29, 3, 1
  v_lshl_add_u32 v31, v32, 2, v31
  v_lshrrev_b32 v32, 1, v30
  v_sub_u32 v32, v32, v31
  v_add_u32 v31, 16, v32
  v_cmp_gt_i32 vcc, 0, v32
  s_nop 1
  v_cndmask_b32 v32, v32, v31, vcc
  v_and_b32 v30, 1, v30
  v_lshlrev_b32 v30, 4, v30
  v_lshl_add_u32 v30, v32, 5, v30
  s_mov_b32 s42, 4608
  v_mul_lo_u32 v29, v29, s42
  v_add_u32 v13, v29, v30
  s_add_u32 s41, s3, 8
  s_min_u32 s41, s41, 15
  s_lshl_b32 s41, s41, 6
  v_add_u32 v28, s41, v1
  s_mov_b32 s42, 0x8000000
  v_mul_hi_u32 v29, v28, s42
  v_mul_u32_u24 v30, 32, v29
  v_sub_u32 v30, v28, v30
  v_and_b32 v31, 3, v29
  v_bfe_u32 v32, v29, 3, 1
  v_lshl_add_u32 v31, v32, 2, v31
  v_lshrrev_b32 v32, 1, v30
  v_sub_u32 v32, v32, v31
  v_add_u32 v31, 16, v32
  v_cmp_gt_i32 vcc, 0, v32
  s_nop 1
  v_cndmask_b32 v32, v32, v31, vcc
  v_and_b32 v30, 1, v30
  v_lshlrev_b32 v30, 4, v30
  v_lshl_add_u32 v30, v32, 5, v30
  s_mov_b32 s42, 4608
  v_mul_lo_u32 v29, v29, s42
  v_add_u32 v14, v29, v30
  s_add_u32 s41, s3, 12
  s_min_u32 s41, s41, 15
  s_lshl_b32 s41, s41, 6
  v_add_u32 v28, s41, v1
  s_mov_b32 s42, 0x8000000
  v_mul_hi_u32 v29, v28, s42
  v_mul_u32_u24 v30, 32, v29
  v_sub_u32 v30, v28, v30
  v_and_b32 v31, 3, v29
  v_bfe_u32 v32, v29, 3, 1
  v_lshl_add_u32 v31, v32, 2, v31
  v_lshrrev_b32 v32, 1, v30
  v_sub_u32 v32, v32, v31
  v_add_u32 v31, 16, v32
  v_cmp_gt_i32 vcc, 0, v32
  s_nop 1
  v_cndmask_b32 v32, v32, v31, vcc
  v_and_b32 v30, 1, v30
  v_lshlrev_b32 v30, 4, v30
  v_lshl_add_u32 v30, v32, 5, v30
  s_mov_b32 s42, 4608
  v_mul_lo_u32 v29, v29, s42
  v_add_u32 v15, v29, v30
  v_and_b32 v2, 15, v1
  v_lshrrev_b32 v28, 4, v1
  v_and_b32 v3, 7, v2
  v_xor_b32 v3, v3, v28
  v_lshlrev_b32 v3, 4, v3
  v_lshl_add_u32 v3, v2, 7, v3
  s_lshr_b32 s41, s3, 1
  s_mul_i32 s41, s41, 16384
  s_add_u32 s41, s41, 65536
  v_add_u32 v16, s41, v3
  v_xor_b32 v17, 64, v16
  v_bfe_u32 v2, v1, 2, 2
  v_lshl_add_u32 v2, v28, 3, v2
  v_and_b32 v31, 3, v2
  v_bfe_u32 v32, v2, 3, 1
  v_lshl_add_u32 v31, v32, 2, v31
  v_mul_u32_u24 v2, 512, v2
  v_and_b32 v3, 3, v1
  v_lshl_add_u32 v2, v3, 3, v2
  s_and_b32 s41, s3, 1
  s_mul_i32 s41, s41, 8
  s_add_u32 s42, s41, 0
  v_add_u32 v29, s42, v31
  v_subrev_u32 v30, 16, v29
  v_cmp_le_u32 vcc, 16, v29
  s_nop 1
  v_cndmask_b32 v29, v29, v30, vcc
  v_lshl_add_u32 v18, v29, 5, v2
  s_add_u32 s42, s41, 1
  v_add_u32 v29, s42, v31
  v_subrev_u32 v30, 16, v29
  v_cmp_le_u32 vcc, 16, v29
  s_nop 1
  v_cndmask_b32 v29, v29, v30, vcc
  v_lshl_add_u32 v19, v29, 5, v2
  s_add_u32 s42, s41, 2
  v_add_u32 v29, s42, v31
  v_subrev_u32 v30, 16, v29
  v_cmp_le_u32 vcc, 16, v29
  s_nop 1
  v_cndmask_b32 v29, v29, v30, vcc
  v_lshl_add_u32 v20, v29, 5, v2
  s_add_u32 s42, s41, 3
  v_add_u32 v29, s42, v31
  v_subrev_u32 v30, 16, v29
  v_cmp_le_u32 vcc, 16, v29
  s_nop 1
  v_cndmask_b32 v29, v29, v30, vcc
  v_lshl_add_u32 v21, v29, 5, v2
  s_add_u32 s42, s41, 4
  v_add_u32 v29, s42, v31
  v_subrev_u32 v30, 16, v29
  v_cmp_le_u32 vcc, 16, v29
  s_nop 1
  v_cndmask_b32 v29, v29, v30, vcc
  v_lshl_add_u32 v22, v29, 5, v2
  s_add_u32 s42, s41, 5
  v_add_u32 v29, s42, v31
  v_subrev_u32 v30, 16, v29
  v_cmp_le_u32 vcc, 16, v29
  s_nop 1
  v_cndmask_b32 v29, v29, v30, vcc
  v_lshl_add_u32 v23, v29, 5, v2
  s_add_u32 s42, s41, 6
  v_add_u32 v29, s42, v31
  v_subrev_u32 v30, 16, v29
  v_cmp_le_u32 vcc, 16, v29
  s_nop 1
  v_cndmask_b32 v29, v29, v30, vcc
  v_lshl_add_u32 v24, v29, 5, v2
  s_add_u32 s42, s41, 7
  v_add_u32 v29, s42, v31
  v_subrev_u32 v30, 16, v29
  v_cmp_le_u32 vcc, 16, v29
  s_nop 1
  v_cndmask_b32 v29, v29, v30, vcc
  v_lshl_add_u32 v25, v29, 5, v2
  s_lshl_b32 s44, s3, 10
  s_add_u32 s45, s44, 65536
  v_accvgpr_write_b32 a0, 0
  v_accvgpr_write_b32 a1, 0
  v_accvgpr_write_b32 a2, 0
  v_accvgpr_write_b32 a3, 0
  v_accvgpr_write_b32 a4, 0
  v_accvgpr_write_b32 a5, 0
  v_accvgpr_write_b32 a6, 0
  v_accvgpr_write_b32 a7, 0
  v_accvgpr_write_b32 a8, 0
  v_accvgpr_write_b32 a9, 0
  v_accvgpr_write_b32 a10, 0
  v_accvgpr_write_b32 a11, 0
  v_accvgpr_write_b32 a12, 0
  v_accvgpr_write_b32 a13, 0
  v_accvgpr_write_b32 a14, 0
  v_accvgpr_write_b32 a15, 0
  v_accvgpr_write_b32 a16, 0
  v_accvgpr_write_b32 a17, 0
  v_accvgpr_write_b32 a18, 0
  v_accvgpr_write_b32 a19, 0
  v_accvgpr_write_b32 a20, 0
  v_accvgpr_write_b32 a21, 0
  v_accvgpr_write_b32 a22, 0
  v_accvgpr_write_b32 a23, 0
  v_accvgpr_write_b32 a24, 0
  v_accvgpr_write_b32 a25, 0
  v_accvgpr_write_b32 a26, 0
  v_accvgpr_write_b32 a27, 0
  v_accvgpr_write_b32 a28, 0
  v_accvgpr_write_b32 a29, 0
  v_accvgpr_write_b32 a30, 0
  v_accvgpr_write_b32 a31, 0
  v_accvgpr_write_b32 a32, 0
  v_accvgpr_write_b32 a33, 0
  v_accvgpr_write_b32 a34, 0
  v_accvgpr_write_b32 a35, 0
  v_accvgpr_write_b32 a36, 0
  v_accvgpr_write_b32 a37, 0
  v_accvgpr_write_b32 a38, 0
  v_accvgpr_write_b32 a39, 0
  v_accvgpr_write_b32 a40, 0
  v_accvgpr_write_b32 a41, 0
  v_accvgpr_write_b32 a42, 0
  v_accvgpr_write_b32 a43, 0
  v_accvgpr_write_b32 a44, 0
  v_accvgpr_write_b32 a45, 0
  v_accvgpr_write_b32 a46, 0
  v_accvgpr_write_b32 a47, 0
  v_accvgpr_write_b32 a48, 0
  v_accvgpr_write_b32 a49, 0
  v_accvgpr_write_b32 a50, 0
  v_accvgpr_write_b32 a51, 0
  v_accvgpr_write_b32 a52, 0
  v_accvgpr_write_b32 a53, 0
  v_accvgpr_write_b32 a54, 0
  v_accvgpr_write_b32 a55, 0
  v_accvgpr_write_b32 a56, 0
  v_accvgpr_write_b32 a57, 0
  v_accvgpr_write_b32 a58, 0
  v_accvgpr_write_b32 a59, 0
  v_accvgpr_write_b32 a60, 0
  v_accvgpr_write_b32 a61, 0
  v_accvgpr_write_b32 a62, 0
  v_accvgpr_write_b32 a63, 0
  v_accvgpr_write_b32 a64, 0
  v_accvgpr_write_b32 a65, 0
  v_accvgpr_write_b32 a66, 0
  v_accvgpr_write_b32 a67, 0
  v_accvgpr_write_b32 a68, 0
  v_accvgpr_write_b32 a69, 0
  v_accvgpr_write_b32 a70, 0
  v_accvgpr_write_b32 a71, 0
  v_accvgpr_write_b32 a72, 0
  v_accvgpr_write_b32 a73, 0
  v_accvgpr_write_b32 a74, 0
  v_accvgpr_write_b32 a75, 0
  v_accvgpr_write_b32 a76, 0
  v_accvgpr_write_b32 a77, 0
  v_accvgpr_write_b32 a78, 0
  v_accvgpr_write_b32 a79, 0
  v_accvgpr_write_b32 a80, 0
  v_accvgpr_write_b32 a81, 0
  v_accvgpr_write_b32 a82, 0
  v_accvgpr_write_b32 a83, 0
  v_accvgpr_write_b32 a84, 0
  v_accvgpr_write_b32 a85, 0
  v_accvgpr_write_b32 a86, 0
  v_accvgpr_write_b32 a87, 0
  v_accvgpr_write_b32 a88, 0
  v_accvgpr_write_b32 a89, 0
  v_accvgpr_write_b32 a90, 0
  v_accvgpr_write_b32 a91, 0
  v_accvgpr_write_b32 a92, 0
  v_accvgpr_write_b32 a93, 0
  v_accvgpr_write_b32 a94, 0
  v_accvgpr_write_b32 a95, 0
  v_accvgpr_write_b32 a96, 0
  v_accvgpr_write_b32 a97, 0
  v_accvgpr_write_b32 a98, 0
  v_accvgpr_write_b32 a99, 0
  v_accvgpr_write_b32 a100, 0
  v_accvgpr_write_b32 a101, 0
  v_accvgpr_write_b32 a102, 0
  v_accvgpr_write_b32 a103, 0
  v_accvgpr_write_b32 a104, 0
  v_accvgpr_write_b32 a105, 0
  v_accvgpr_write_b32 a106, 0
  v_accvgpr_write_b32 a107, 0
  v_accvgpr_write_b32 a108, 0
  v_accvgpr_write_b32 a109, 0
  v_accvgpr_write_b32 a110, 0
  v_accvgpr_write_b32 a111, 0
  v_accvgpr_write_b32 a112, 0
  v_accvgpr_write_b32 a113, 0
  v_accvgpr_write_b32 a114, 0
  v_accvgpr_write_b32 a115, 0
  v_accvgpr_write_b32 a116, 0
  v_accvgpr_write_b32 a117, 0
  v_accvgpr_write_b32 a118, 0
  v_accvgpr_write_b32 a119, 0
  v_accvgpr_write_b32 a120, 0
  v_accvgpr_write_b32 a121, 0
  v_accvgpr_write_b32 a122, 0
  v_accvgpr_write_b32 a123, 0
  v_accvgpr_write_b32 a124, 0
  v_accvgpr_write_b32 a125, 0
  v_accvgpr_write_b32 a126, 0
  v_accvgpr_write_b32 a127, 0
  v_accvgpr_write_b32 a128, 0
  v_accvgpr_write_b32 a129, 0
  v_accvgpr_write_b32 a130, 0
  v_accvgpr_write_b32 a131, 0
  v_accvgpr_write_b32 a132, 0
  v_accvgpr_write_b32 a133, 0
  v_accvgpr_write_b32 a134, 0
  v_accvgpr_write_b32 a135, 0
  v_accvgpr_write_b32 a136, 0
  v_accvgpr_write_b32 a137, 0
  v_accvgpr_write_b32 a138, 0
  v_accvgpr_write_b32 a139, 0
  v_accvgpr_write_b32 a140, 0
  v_accvgpr_write_b32 a141, 0
  v_accvgpr_write_b32 a142, 0
  v_accvgpr_write_b32 a143, 0
  v_accvgpr_write_b32 a144, 0
  v_accvgpr_write_b32 a145, 0
  v_accvgpr_write_b32 a146, 0
  v_accvgpr_write_b32 a147, 0
  v_accvgpr_write_b32 a148, 0
  v_accvgpr_write_b32 a149, 0
  v_accvgpr_write_b32 a150, 0
  v_accvgpr_write_b32 a151, 0
  v_accvgpr_write_b32 a152, 0
  v_accvgpr_write_b32 a153, 0
  v_accvgpr_write_b32 a154, 0
  v_accvgpr_write_b32 a155, 0
  v_accvgpr_write_b32 a156, 0
  v_accvgpr_write_b32 a157, 0
  v_accvgpr_write_b32 a158, 0
  v_accvgpr_write_b32 a159, 0
  v_accvgpr_write_b32 a160, 0
  v_accvgpr_write_b32 a161, 0
  v_accvgpr_write_b32 a162, 0
  v_accvgpr_write_b32 a163, 0
  v_accvgpr_write_b32 a164, 0
  v_accvgpr_write_b32 a165, 0
  v_accvgpr_write_b32 a166, 0
  v_accvgpr_write_b32 a167, 0
  v_accvgpr_write_b32 a168, 0
  v_accvgpr_write_b32 a169, 0
  v_accvgpr_write_b32 a170, 0
  v_accvgpr_write_b32 a171, 0
  v_accvgpr_write_b32 a172, 0
  v_accvgpr_write_b32 a173, 0
  v_accvgpr_write_b32 a174, 0
  v_accvgpr_write_b32 a175, 0
  v_accvgpr_write_b32 a176, 0
  v_accvgpr_write_b32 a177, 0
  v_accvgpr_write_b32 a178, 0
  v_accvgpr_write_b32 a179, 0
  v_accvgpr_write_b32 a180, 0
  v_accvgpr_write_b32 a181, 0
  v_accvgpr_write_b32 a182, 0
  v_accvgpr_write_b32 a183, 0
  v_accvgpr_write_b32 a184, 0
  v_accvgpr_write_b32 a185, 0
  v_accvgpr_write_b32 a186, 0
  v_accvgpr_write_b32 a187, 0
  v_accvgpr_write_b32 a188, 0
  v_accvgpr_write_b32 a189, 0
  v_accvgpr_write_b32 a190, 0
  v_accvgpr_write_b32 a191, 0
  v_accvgpr_write_b32 a192, 0
  v_accvgpr_write_b32 a193, 0
  v_accvgpr_write_b32 a194, 0
  v_accvgpr_write_b32 a195, 0
  v_accvgpr_write_b32 a196, 0
  v_accvgpr_write_b32 a197, 0
  v_accvgpr_write_b32 a198, 0
  v_accvgpr_write_b32 a199, 0
  v_accvgpr_write_b32 a200, 0
  v_accvgpr_write_b32 a201, 0
  v_accvgpr_write_b32 a202, 0
  v_accvgpr_write_b32 a203, 0
  v_accvgpr_write_b32 a204, 0
  v_accvgpr_write_b32 a205, 0
  v_accvgpr_write_b32 a206, 0
  v_accvgpr_write_b32 a207, 0
  v_accvgpr_write_b32 a208, 0
  v_accvgpr_write_b32 a209, 0
  v_accvgpr_write_b32 a210, 0
  v_accvgpr_write_b32 a211, 0
  v_accvgpr_write_b32 a212, 0
  v_accvgpr_write_b32 a213, 0
  v_accvgpr_write_b32 a214, 0
  v_accvgpr_write_b32 a215, 0
  v_accvgpr_write_b32 a216, 0
  v_accvgpr_write_b32 a217, 0
  v_accvgpr_write_b32 a218, 0
  v_accvgpr_write_b32 a219, 0
  v_accvgpr_write_b32 a220, 0
  v_accvgpr_write_b32 a221, 0
  v_accvgpr_write_b32 a222, 0
  v_accvgpr_write_b32 a223, 0
  v_accvgpr_write_b32 a224, 0
  v_accvgpr_write_b32 a225, 0
  v_accvgpr_write_b32 a226, 0
  v_accvgpr_write_b32 a227, 0
  v_accvgpr_write_b32 a228, 0
  v_accvgpr_write_b32 a229, 0
  v_accvgpr_write_b32 a230, 0
  v_accvgpr_write_b32 a231, 0
  v_accvgpr_write_b32 a232, 0
  v_accvgpr_write_b32 a233, 0
  v_accvgpr_write_b32 a234, 0
  v_accvgpr_write_b32 a235, 0
  v_accvgpr_write_b32 a236, 0
  v_accvgpr_write_b32 a237, 0
  v_accvgpr_write_b32 a238, 0
  v_accvgpr_write_b32 a239, 0
  v_accvgpr_write_b32 a240, 0
  v_accvgpr_write_b32 a241, 0
  v_accvgpr_write_b32 a242, 0
  v_accvgpr_write_b32 a243, 0
  v_accvgpr_write_b32 a244, 0
  v_accvgpr_write_b32 a245, 0
  v_accvgpr_write_b32 a246, 0
  v_accvgpr_write_b32 a247, 0
  v_accvgpr_write_b32 a248, 0
  v_accvgpr_write_b32 a249, 0
  v_accvgpr_write_b32 a250, 0
  v_accvgpr_write_b32 a251, 0
  v_accvgpr_write_b32 a252, 0
  v_accvgpr_write_b32 a253, 0
  v_accvgpr_write_b32 a254, 0
  v_accvgpr_write_b32 a255, 0
  s_mov_b32 s49, 0
Lwspp_74:
  s_barrier
  s_add_u32 m0, s45, 0
  s_nop 0
  buffer_load_dwordx4 v4, s[12:15], s46 offen lds
  s_add_u32 m0, s45, 4096
  s_nop 0
  buffer_load_dwordx4 v5, s[12:15], s46 offen lds
  s_add_u32 m0, s45, 8192
  s_nop 0
  buffer_load_dwordx4 v6, s[12:15], s46 offen lds
  s_add_u32 m0, s45, 12288
  s_nop 0
  buffer_load_dwordx4 v7, s[12:15], s46 offen lds
  s_add_u32 m0, s45, 16384
  s_nop 0
  buffer_load_dwordx4 v8, s[12:15], s46 offen lds
  s_add_u32 m0, s45, 20480
  s_nop 0
  buffer_load_dwordx4 v9, s[12:15], s46 offen lds
  s_add_u32 m0, s45, 24576
  s_nop 0
  buffer_load_dwordx4 v10, s[12:15], s46 offen lds
  s_add_u32 m0, s45, 28672
  s_nop 0
  buffer_load_dwordx4 v11, s[12:15], s46 offen lds
  s_add_u32 s46, s46, 128
  s_add_u32 m0, s45, 32768
  s_nop 0
  buffer_load_dwordx4 v4, s[12:15], s46 offen lds
  s_add_u32 m0, s45, 36864
  s_nop 0
  buffer_load_dwordx4 v5, s[12:15], s46 offen lds
  s_add_u32 m0, s45, 40960
  s_nop 0
  buffer_load_dwordx4 v6, s[12:15], s46 offen lds
  s_add_u32 m0, s45, 45056
  s_nop 0
  buffer_load_dwordx4 v7, s[12:15], s46 offen lds
  s_add_u32 m0, s45, 49152
  s_nop 0
  buffer_load_dwordx4 v8, s[12:15], s46 offen lds
  s_add_u32 m0, s45, 53248
  s_nop 0
  buffer_load_dwordx4 v9, s[12:15], s46 offen lds
  s_add_u32 m0, s45, 57344
  s_nop 0
  buffer_load_dwordx4 v10, s[12:15], s46 offen lds
  s_add_u32 m0, s45, 61440
  s_nop 0
  buffer_load_dwordx4 v11, s[12:15], s46 offen lds
  s_add_u32 s46, s46, 128
  s_getpc_b64 s[60:61]
Lpc_75:
  s_add_u32 s60, s60, Lmg_we0_72-Lpc_75
  s_addc_u32 s61, s61, 0
  v_mbcnt_lo_u32_b32 v254, -1, 0
  v_mbcnt_hi_u32_b32 v254, -1, v254
  v_lshlrev_b32 v254, 7, v254
  s_lshl_b32 s62, s3, 13
  v_add_u32 v254, s62, v254
  v_min_u32 v254, Lmg_we1_73-Lmg_we0_72-4, v254
  global_load_dword v255, v254, s[60:61]
  s_cmp_lg_u32 s3, 0
  s_cbranch_scc1 Lw_skip_76
  s_mov_b64 exec, 1
  s_lshl_b32 s50, s49, 7
  s_add_u32 s50, s50, 21504
  s_mov_b32 s52, 0
Lw_lp_77:
  buffer_load_dword v2, off, s[88:91], s50 sc1
  s_waitcnt vmcnt(0)
  v_readfirstlane_b32 s51, v2
  s_add_u32 s52, s52, 1
  s_cmp_gt_u32 s52, 2000000
  s_cbranch_scc1 Lw_lp_77_x
  s_cmp_ge_u32 s51, 16
  s_cbranch_scc1 Lw_lp_77_x
  s_sleep 4
  s_branch Lw_lp_77
Lw_lp_77_x:
  s_mov_b64 exec, -1
Lw_skip_76:
  s_barrier
  s_add_u32 m0, s44, 0
  s_nop 0
  buffer_load_dwordx4 v12, s[16:19], s47 offen lds
  s_add_u32 m0, s44, 4096
  s_nop 0
  buffer_load_dwordx4 v13, s[16:19], s47 offen lds
  s_add_u32 m0, s44, 8192
  s_nop 0
  buffer_load_dwordx4 v14, s[16:19], s47 offen lds
  s_add_u32 m0, s44, 12288
  s_nop 0
  buffer_load_dwordx4 v15, s[16:19], s47 offen lds
  s_add_u32 s47, s47, 147456
  s_add_u32 m0, s44, 16384
  s_nop 0
  buffer_load_dwordx4 v12, s[16:19], s47 offen lds
  s_add_u32 m0, s44, 20480
  s_nop 0
  buffer_load_dwordx4 v13, s[16:19], s47 offen lds
  s_add_u32 m0, s44, 24576
  s_nop 0
  buffer_load_dwordx4 v14, s[16:19], s47 offen lds
  s_add_u32 m0, s44, 28672
  s_nop 0
  buffer_load_dwordx4 v15, s[16:19], s47 offen lds
  s_add_u32 s47, s47, 147456
  s_add_u32 m0, s44, 32768
  s_nop 0
  buffer_load_dwordx4 v12, s[16:19], s47 offen lds
  s_add_u32 m0, s44, 36864
  s_nop 0
  buffer_load_dwordx4 v13, s[16:19], s47 offen lds
  s_add_u32 m0, s44, 40960
  s_nop 0
  buffer_load_dwordx4 v14, s[16:19], s47 offen lds
  s_add_u32 m0, s44, 45056
  s_nop 0
  buffer_load_dwordx4 v15, s[16:19], s47 offen lds
  s_add_u32 s47, s47, 147456
  s_add_u32 m0, s44, 49152
  s_nop 0
  buffer_load_dwordx4 v12, s[16:19], s47 offen lds
  s_add_u32 m0, s44, 53248
  s_nop 0
  buffer_load_dwordx4 v13, s[16:19], s47 offen lds
  s_add_u32 m0, s44, 57344
  s_nop 0
  buffer_load_dwordx4 v14, s[16:19], s47 offen lds
  s_add_u32 m0, s44, 61440
  s_nop 0
  buffer_load_dwordx4 v15, s[16:19], s47 offen lds
  s_add_u32 s47, s47, 147456
  s_waitcnt vmcnt(8)
  s_barrier
  ds_read_b128 v[28:31], v16 offset:0
  ds_read_b128 v[32:35], v16 offset:2048
  ds_read_b128 v[36:39], v16 offset:4096
  ds_read_b128 v[40:43], v16 offset:6144
  ds_read_b128 v[44:47], v16 offset:8192
  ds_read_b128 v[48:51], v16 offset:10240
  ds_read_b128 v[52:55], v16 offset:12288
  ds_read_b128 v[56:59], v16 offset:14336
  ds_read_b64_tr_b16 v[60:61], v18 offset:0
  ds_read_b64_tr_b16 v[62:63], v18 offset:2048
  ds_read_b64_tr_b16 v[64:65], v19 offset:0
  ds_read_b64_tr_b16 v[66:67], v19 offset:2048
  ds_read_b64_tr_b16 v[68:69], v20 offset:0
  ds_read_b64_tr_b16 v[70:71], v20 offset:2048
  ds_read_b64_tr_b16 v[72:73], v21 offset:0
  ds_read_b64_tr_b16 v[74:75], v21 offset:2048
  ds_read_b64_tr_b16 v[76:77], v22 offset:0
  ds_read_b64_tr_b16 v[78:79], v22 offset:2048
  ds_read_b64_tr_b16 v[80:81], v23 offset:0
  ds_read_b64_tr_b16 v[82:83], v23 offset:2048
  ds_read_b64_tr_b16 v[84:85], v24 offset:0
  ds_read_b64_tr_b16 v[86:87], v24 offset:2048
  ds_read_b64_tr_b16 v[88:89], v25 offset:0
  ds_read_b64_tr_b16 v[90:91], v25 offset:2048
  s_waitcnt lgkmcnt(0)
  v_mfma_f32_16x16x32_bf16 a[0:3], v[60:63], v[28:31], a[0:3]
  ds_read_b128 v[92:95], v17 offset:0
  v_mfma_f32_16x16x32_bf16 a[4:7], v[64:67], v[28:31], a[4:7]
  ds_read_b128 v[96:99], v17 offset:2048
  v_mfma_f32_16x16x32_bf16 a[8:11], v[68:71], v[28:31], a[8:11]
  ds_read_b128 v[100:103], v17 offset:4096
  v_mfma_f32_16x16x32_bf16 a[12:15], v[72:75], v[28:31], a[12:15]
  v_mfma_f32_16x16x32_bf16 a[16:19], v[76:79], v[28:31], a[16:19]
  ds_read_b128 v[104:107], v17 offset:6144
  v_mfma_f32_16x16x32_bf16 a[20:23], v[80:83], v[28:31], a[20:23]
  ds_read_b128 v[108:111], v17 offset:8192
  v_mfma_f32_16x16x32_bf16 a[24:27], v[84:87], v[28:31], a[24:27]
  v_mfma_f32_16x16x32_bf16 a[28:31], v[88:91], v[28:31], a[28:31]
  ds_read_b128 v[112:115], v17 offset:10240
  v_mfma_f32_16x16x32_bf16 a[32:35], v[60:63], v[32:35], a[32:35]
  ds_read_b128 v[116:119], v17 offset:12288
  v_mfma_f32_16x16x32_bf16 a[36:39], v[64:67], v[32:35], a[36:39]
  v_mfma_f32_16x16x32_bf16 a[40:43], v[68:71], v[32:35], a[40:43]
  ds_read_b128 v[120:123], v17 offset:14336
  v_mfma_f32_16x16x32_bf16 a[44:47], v[72:75], v[32:35], a[44:47]
  ds_read_b64_tr_b16 v[124:125], v18 offset:16384
  v_mfma_f32_16x16x32_bf16 a[48:51], v[76:79], v[32:35], a[48:51]
  v_mfma_f32_16x16x32_bf16 a[52:55], v[80:83], v[32:35], a[52:55]
  ds_read_b64_tr_b16 v[126:127], v18 offset:18432
  v_mfma_f32_16x16x32_bf16 a[56:59], v[84:87], v[32:35], a[56:59]
  ds_read_b64_tr_b16 v[128:129], v19 offset:16384
  v_mfma_f32_16x16x32_bf16 a[60:63], v[88:91], v[32:35], a[60:63]
  v_mfma_f32_16x16x32_bf16 a[64:67], v[60:63], v[36:39], a[64:67]
  ds_read_b64_tr_b16 v[130:131], v19 offset:18432
  v_mfma_f32_16x16x32_bf16 a[68:71], v[64:67], v[36:39], a[68:71]
  ds_read_b64_tr_b16 v[132:133], v20 offset:16384
  v_mfma_f32_16x16x32_bf16 a[72:75], v[68:71], v[36:39], a[72:75]
  ds_read_b64_tr_b16 v[134:135], v20 offset:18432
  v_mfma_f32_16x16x32_bf16 a[76:79], v[72:75], v[36:39], a[76:79]
  v_mfma_f32_16x16x32_bf16 a[80:83], v[76:79], v[36:39], a[80:83]
  ds_read_b64_tr_b16 v[136:137], v21 offset:16384
  v_mfma_f32_16x16x32_bf16 a[84:87], v[80:83], v[36:39], a[84:87]
  ds_read_b64_tr_b16 v[138:139], v21 offset:18432
  v_mfma_f32_16x16x32_bf16 a[88:91], v[84:87], v[36:39], a[88:91]
  v_mfma_f32_16x16x32_bf16 a[92:95], v[88:91], v[36:39], a[92:95]
  ds_read_b64_tr_b16 v[140:141], v22 offset:16384
  v_mfma_f32_16x16x32_bf16 a[96:99], v[60:63], v[40:43], a[96:99]
  ds_read_b64_tr_b16 v[142:143], v22 offset:18432
  v_mfma_f32_16x16x32_bf16 a[100:103], v[64:67], v[40:43], a[100:103]
  v_mfma_f32_16x16x32_bf16 a[104:107], v[68:71], v[40:43], a[104:107]
  ds_read_b64_tr_b16 v[144:145], v23 offset:16384
  v_mfma_f32_16x16x32_bf16 a[108:111], v[72:75], v[40:43], a[108:111]
  ds_read_b64_tr_b16 v[146:147], v23 offset:18432
  v_mfma_f32_16x16x32_bf16 a[112:115], v[76:79], v[40:43], a[112:115]
  v_mfma_f32_16x16x32_bf16 a[116:119], v[80:83], v[40:43], a[116:119]
  ds_read_b64_tr_b16 v[148:149], v24 offset:16384
  v_mfma_f32_16x16x32_bf16 a[120:123], v[84:87], v[40:43], a[120:123]
  ds_read_b64_tr_b16 v[150:151], v24 offset:18432
  v_mfma_f32_16x16x32_bf16 a[124:127], v[88:91], v[40:43], a[124:127]
  v_mfma_f32_16x16x32_bf16 a[128:131], v[60:63], v[44:47], a[128:131]
  ds_read_b64_tr_b16 v[152:153], v25 offset:16384
  v_mfma_f32_16x16x32_bf16 a[132:135], v[64:67], v[44:47], a[132:135]
  ds_read_b64_tr_b16 v[154:155], v25 offset:18432
  v_mfma_f32_16x16x32_bf16 a[136:139], v[68:71], v[44:47], a[136:139]
  v_mfma_f32_16x16x32_bf16 a[140:143], v[72:75], v[44:47], a[140:143]
  v_mfma_f32_16x16x32_bf16 a[144:147], v[76:79], v[44:47], a[144:147]
  v_mfma_f32_16x16x32_bf16 a[148:151], v[80:83], v[44:47], a[148:151]
  v_mfma_f32_16x16x32_bf16 a[152:155], v[84:87], v[44:47], a[152:155]
  v_mfma_f32_16x16x32_bf16 a[156:159], v[88:91], v[44:47], a[156:159]
  v_mfma_f32_16x16x32_bf16 a[160:163], v[60:63], v[48:51], a[160:163]
  v_mfma_f32_16x16x32_bf16 a[164:167], v[64:67], v[48:51], a[164:167]
  v_mfma_f32_16x16x32_bf16 a[168:171], v[68:71], v[48:51], a[168:171]
  v_mfma_f32_16x16x32_bf16 a[172:175], v[72:75], v[48:51], a[172:175]
  v_mfma_f32_16x16x32_bf16 a[176:179], v[76:79], v[48:51], a[176:179]
  v_mfma_f32_16x16x32_bf16 a[180:183], v[80:83], v[48:51], a[180:183]
  v_mfma_f32_16x16x32_bf16 a[184:187], v[84:87], v[48:51], a[184:187]
  v_mfma_f32_16x16x32_bf16 a[188:191], v[88:91], v[48:51], a[188:191]
  v_mfma_f32_16x16x32_bf16 a[192:195], v[60:63], v[52:55], a[192:195]
  v_mfma_f32_16x16x32_bf16 a[196:199], v[64:67], v[52:55], a[196:199]
  v_mfma_f32_16x16x32_bf16 a[200:203], v[68:71], v[52:55], a[200:203]
  v_mfma_f32_16x16x32_bf16 a[204:207], v[72:75], v[52:55], a[204:207]
  v_mfma_f32_16x16x32_bf16 a[208:211], v[76:79], v[52:55], a[208:211]
  v_mfma_f32_16x16x32_bf16 a[212:215], v[80:83], v[52:55], a[212:215]
  v_mfma_f32_16x16x32_bf16 a[216:219], v[84:87], v[52:55], a[216:219]
  v_mfma_f32_16x16x32_bf16 a[220:223], v[88:91], v[52:55], a[220:223]
  v_mfma_f32_16x16x32_bf16 a[224:227], v[60:63], v[56:59], a[224:227]
  v_mfma_f32_16x16x32_bf16 a[228:231], v[64:67], v[56:59], a[228:231]
  v_mfma_f32_16x16x32_bf16 a[232:235], v[68:71], v[56:59], a[232:235]
  v_mfma_f32_16x16x32_bf16 a[236:239], v[72:75], v[56:59], a[236:239]
  v_mfma_f32_16x16x32_bf16 a[240:243], v[76:79], v[56:59], a[240:243]
  v_mfma_f32_16x16x32_bf16 a[244:247], v[80:83], v[56:59], a[244:247]
  v_mfma_f32_16x16x32_bf16 a[248:251], v[84:87], v[56:59], a[248:251]
  v_mfma_f32_16x16x32_bf16 a[252:255], v[88:91], v[56:59], a[252:255]
  s_waitcnt vmcnt(0) lgkmcnt(0)
  s_barrier
  v_mfma_f32_16x16x32_bf16 a[0:3], v[124:127], v[92:95], a[0:3]
  ds_read_b128 v[28:31], v16 offset:32768
  v_mfma_f32_16x16x32_bf16 a[4:7], v[128:131], v[92:95], a[4:7]
  ds_read_b128 v[32:35], v16 offset:34816
  v_mfma_f32_16x16x32_bf16 a[8:11], v[132:135], v[92:95], a[8:11]
  ds_read_b128 v[36:39], v16 offset:36864
  v_mfma_f32_16x16x32_bf16 a[12:15], v[136:139], v[92:95], a[12:15]
  v_mfma_f32_16x16x32_bf16 a[16:19], v[140:143], v[92:95], a[16:19]
  ds_read_b128 v[40:43], v16 offset:38912
  v_mfma_f32_16x16x32_bf16 a[20:23], v[144:147], v[92:95], a[20:23]
  ds_read_b128 v[44:47], v16 offset:40960
  v_mfma_f32_16x16x32_bf16 a[24:27], v[148:151], v[92:95], a[24:27]
  v_mfma_f32_16x16x32_bf16 a[28:31], v[152:155], v[92:95], a[28:31]
  ds_read_b128 v[48:51], v16 offset:43008
  v_mfma_f32_16x16x32_bf16 a[32:35], v[124:127], v[96:99], a[32:35]
  ds_read_b128 v[52:55], v16 offset:45056
  v_mfma_f32_16x16x32_bf16 a[36:39], v[128:131], v[96:99], a[36:39]
  v_mfma_f32_16x16x32_bf16 a[40:43], v[132:135], v[96:99], a[40:43]
  ds_read_b128 v[56:59], v16 offset:47104
  v_mfma_f32_16x16x32_bf16 a[44:47], v[136:139], v[96:99], a[44:47]
  ds_read_b64_tr_b16 v[60:61], v18 offset:32768
  v_mfma_f32_16x16x32_bf16 a[48:51], v[140:143], v[96:99], a[48:51]
  v_mfma_f32_16x16x32_bf16 a[52:55], v[144:147], v[96:99], a[52:55]
  ds_read_b64_tr_b16 v[62:63], v18 offset:34816
  v_mfma_f32_16x16x32_bf16 a[56:59], v[148:151], v[96:99], a[56:59]
  ds_read_b64_tr_b16 v[64:65], v19 offset:32768
  v_mfma_f32_16x16x32_bf16 a[60:63], v[152:155], v[96:99], a[60:63]
  v_mfma_f32_16x16x32_bf16 a[64:67], v[124:127], v[100:103], a[64:67]
  ds_read_b64_tr_b16 v[66:67], v19 offset:34816
  v_mfma_f32_16x16x32_bf16 a[68:71], v[128:131], v[100:103], a[68:71]
  ds_read_b64_tr_b16 v[68:69], v20 offset:32768
  v_mfma_f32_16x16x32_bf16 a[72:75], v[132:135], v[100:103], a[72:75]
  ds_read_b64_tr_b16 v[70:71], v20 offset:34816
  v_mfma_f32_16x16x32_bf16 a[76:79], v[136:139], v[100:103], a[76:79]
  v_mfma_f32_16x16x32_bf16 a[80:83], v[140:143], v[100:103], a[80:83]
  ds_read_b64_tr_b16 v[72:73], v21 offset:32768
  v_mfma_f32_16x16x32_bf16 a[84:87], v[144:147], v[100:103], a[84:87]
  ds_read_b64_tr_b16 v[74:75], v21 offset:34816
  v_mfma_f32_16x16x32_bf16 a[88:91], v[148:151], v[100:103], a[88:91]
  v_mfma_f32_16x16x32_bf16 a[92:95], v[152:155], v[100:103], a[92:95]
  ds_read_b64_tr_b16 v[76:77], v22 offset:32768
  v_mfma_f32_16x16x32_bf16 a[96:99], v[124:127], v[104:107], a[96:99]
  ds_read_b64_tr_b16 v[78:79], v22 offset:34816
  v_mfma_f32_16x16x32_bf16 a[100:103], v[128:131], v[104:107], a[100:103]
  v_mfma_f32_16x16x32_bf16 a[104:107], v[132:135], v[104:107], a[104:107]
  ds_read_b64_tr_b16 v[80:81], v23 offset:32768
  v_mfma_f32_16x16x32_bf16 a[108:111], v[136:139], v[104:107], a[108:111]
  ds_read_b64_tr_b16 v[82:83], v23 offset:34816
  v_mfma_f32_16x16x32_bf16 a[112:115], v[140:143], v[104:107], a[112:115]
  v_mfma_f32_16x16x32_bf16 a[116:119], v[144:147], v[104:107], a[116:119]
  ds_read_b64_tr_b16 v[84:85], v24 offset:32768
  v_mfma_f32_16x16x32_bf16 a[120:123], v[148:151], v[104:107], a[120:123]
  ds_read_b64_tr_b16 v[86:87], v24 offset:34816
  v_mfma_f32_16x16x32_bf16 a[124:127], v[152:155], v[104:107], a[124:127]
  v_mfma_f32_16x16x32_bf16 a[128:131], v[124:127], v[108:111], a[128:131]
  ds_read_b64_tr_b16 v[88:89], v25 offset:32768
  v_mfma_f32_16x16x32_bf16 a[132:135], v[128:131], v[108:111], a[132:135]
  ds_read_b64_tr_b16 v[90:91], v25 offset:34816
  v_mfma_f32_16x16x32_bf16 a[136:139], v[132:135], v[108:111], a[136:139]
  v_mfma_f32_16x16x32_bf16 a[140:143], v[136:139], v[108:111], a[140:143]
  v_mfma_f32_16x16x32_bf16 a[144:147], v[140:143], v[108:111], a[144:147]
  v_mfma_f32_16x16x32_bf16 a[148:151], v[144:147], v[108:111], a[148:151]
  v_mfma_f32_16x16x32_bf16 a[152:155], v[148:151], v[108:111], a[152:155]
  v_mfma_f32_16x16x32_bf16 a[156:159], v[152:155], v[108:111], a[156:159]
  v_mfma_f32_16x16x32_bf16 a[160:163], v[124:127], v[112:115], a[160:163]
  v_mfma_f32_16x16x32_bf16 a[164:167], v[128:131], v[112:115], a[164:167]
  v_mfma_f32_16x16x32_bf16 a[168:171], v[132:135], v[112:115], a[168:171]
  v_mfma_f32_16x16x32_bf16 a[172:175], v[136:139], v[112:115], a[172:175]
  v_mfma_f32_16x16x32_bf16 a[176:179], v[140:143], v[112:115], a[176:179]
  v_mfma_f32_16x16x32_bf16 a[180:183], v[144:147], v[112:115], a[180:183]
  v_mfma_f32_16x16x32_bf16 a[184:187], v[148:151], v[112:115], a[184:187]
  v_mfma_f32_16x16x32_bf16 a[188:191], v[152:155], v[112:115], a[188:191]
  v_mfma_f32_16x16x32_bf16 a[192:195], v[124:127], v[116:119], a[192:195]
  v_mfma_f32_16x16x32_bf16 a[196:199], v[128:131], v[116:119], a[196:199]
  v_mfma_f32_16x16x32_bf16 a[200:203], v[132:135], v[116:119], a[200:203]
  v_mfma_f32_16x16x32_bf16 a[204:207], v[136:139], v[116:119], a[204:207]
  v_mfma_f32_16x16x32_bf16 a[208:211], v[140:143], v[116:119], a[208:211]
  v_mfma_f32_16x16x32_bf16 a[212:215], v[144:147], v[116:119], a[212:215]
  v_mfma_f32_16x16x32_bf16 a[216:219], v[148:151], v[116:119], a[216:219]
  v_mfma_f32_16x16x32_bf16 a[220:223], v[152:155], v[116:119], a[220:223]
  v_mfma_f32_16x16x32_bf16 a[224:227], v[124:127], v[120:123], a[224:227]
  v_mfma_f32_16x16x32_bf16 a[228:231], v[128:131], v[120:123], a[228:231]
  v_mfma_f32_16x16x32_bf16 a[232:235], v[132:135], v[120:123], a[232:235]
  v_mfma_f32_16x16x32_bf16 a[236:239], v[136:139], v[120:123], a[236:239]
  v_mfma_f32_16x16x32_bf16 a[240:243], v[140:143], v[120:123], a[240:243]
  v_mfma_f32_16x16x32_bf16 a[244:247], v[144:147], v[120:123], a[244:247]
  v_mfma_f32_16x16x32_bf16 a[248:251], v[148:151], v[120:123], a[248:251]
  v_mfma_f32_16x16x32_bf16 a[252:255], v[152:155], v[120:123], a[252:255]
  s_waitcnt lgkmcnt(0)
  v_mfma_f32_16x16x32_bf16 a[0:3], v[60:63], v[28:31], a[0:3]
  ds_read_b128 v[92:95], v17 offset:32768
  v_mfma_f32_16x16x32_bf16 a[4:7], v[64:67], v[28:31], a[4:7]
  ds_read_b128 v[96:99], v17 offset:34816
  v_mfma_f32_16x16x32_bf16 a[8:11], v[68:71], v[28:31], a[8:11]
  ds_read_b128 v[100:103], v17 offset:36864
  v_mfma_f32_16x16x32_bf16 a[12:15], v[72:75], v[28:31], a[12:15]
  v_mfma_f32_16x16x32_bf16 a[16:19], v[76:79], v[28:31], a[16:19]
  ds_read_b128 v[104:107], v17 offset:38912
  v_mfma_f32_16x16x32_bf16 a[20:23], v[80:83], v[28:31], a[20:23]
  ds_read_b128 v[108:111], v17 offset:40960
  v_mfma_f32_16x16x32_bf16 a[24:27], v[84:87], v[28:31], a[24:27]
  v_mfma_f32_16x16x32_bf16 a[28:31], v[88:91], v[28:31], a[28:31]
  ds_read_b128 v[112:115], v17 offset:43008
  v_mfma_f32_16x16x32_bf16 a[32:35], v[60:63], v[32:35], a[32:35]
  ds_read_b128 v[116:119], v17 offset:45056
  v_mfma_f32_16x16x32_bf16 a[36:39], v[64:67], v[32:35], a[36:39]
  v_mfma_f32_16x16x32_bf16 a[40:43], v[68:71], v[32:35], a[40:43]
  ds_read_b128 v[120:123], v17 offset:47104
  v_mfma_f32_16x16x32_bf16 a[44:47], v[72:75], v[32:35], a[44:47]
  ds_read_b64_tr_b16 v[124:125], v18 offset:49152
  v_mfma_f32_16x16x32_bf16 a[48:51], v[76:79], v[32:35], a[48:51]
  v_mfma_f32_16x16x32_bf16 a[52:55], v[80:83], v[32:35], a[52:55]
  ds_read_b64_tr_b16 v[126:127], v18 offset:51200
  v_mfma_f32_16x16x32_bf16 a[56:59], v[84:87], v[32:35], a[56:59]
  ds_read_b64_tr_b16 v[128:129], v19 offset:49152
  v_mfma_f32_16x16x32_bf16 a[60:63], v[88:91], v[32:35], a[60:63]
  v_mfma_f32_16x16x32_bf16 a[64:67], v[60:63], v[36:39], a[64:67]
  ds_read_b64_tr_b16 v[130:131], v19 offset:51200
  v_mfma_f32_16x16x32_bf16 a[68:71], v[64:67], v[36:39], a[68:71]
  ds_read_b64_tr_b16 v[132:133], v20 offset:49152
  v_mfma_f32_16x16x32_bf16 a[72:75], v[68:71], v[36:39], a[72:75]
  ds_read_b64_tr_b16 v[134:135], v20 offset:51200
  v_mfma_f32_16x16x32_bf16 a[76:79], v[72:75], v[36:39], a[76:79]
  v_mfma_f32_16x16x32_bf16 a[80:83], v[76:79], v[36:39], a[80:83]
  ds_read_b64_tr_b16 v[136:137], v21 offset:49152
  v_mfma_f32_16x16x32_bf16 a[84:87], v[80:83], v[36:39], a[84:87]
  ds_read_b64_tr_b16 v[138:139], v21 offset:51200
  v_mfma_f32_16x16x32_bf16 a[88:91], v[84:87], v[36:39], a[88:91]
  v_mfma_f32_16x16x32_bf16 a[92:95], v[88:91], v[36:39], a[92:95]
  ds_read_b64_tr_b16 v[140:141], v22 offset:49152
  v_mfma_f32_16x16x32_bf16 a[96:99], v[60:63], v[40:43], a[96:99]
  ds_read_b64_tr_b16 v[142:143], v22 offset:51200
  v_mfma_f32_16x16x32_bf16 a[100:103], v[64:67], v[40:43], a[100:103]
  v_mfma_f32_16x16x32_bf16 a[104:107], v[68:71], v[40:43], a[104:107]
  ds_read_b64_tr_b16 v[144:145], v23 offset:49152
  v_mfma_f32_16x16x32_bf16 a[108:111], v[72:75], v[40:43], a[108:111]
  ds_read_b64_tr_b16 v[146:147], v23 offset:51200
  v_mfma_f32_16x16x32_bf16 a[112:115], v[76:79], v[40:43], a[112:115]
  v_mfma_f32_16x16x32_bf16 a[116:119], v[80:83], v[40:43], a[116:119]
  ds_read_b64_tr_b16 v[148:149], v24 offset:49152
  v_mfma_f32_16x16x32_bf16 a[120:123], v[84:87], v[40:43], a[120:123]
  ds_read_b64_tr_b16 v[150:151], v24 offset:51200
  v_mfma_f32_16x16x32_bf16 a[124:127], v[88:91], v[40:43], a[124:127]
  v_mfma_f32_16x16x32_bf16 a[128:131], v[60:63], v[44:47], a[128:131]
  ds_read_b64_tr_b16 v[152:153], v25 offset:49152
  v_mfma_f32_16x16x32_bf16 a[132:135], v[64:67], v[44:47], a[132:135]
  ds_read_b64_tr_b16 v[154:155], v25 offset:51200
  v_mfma_f32_16x16x32_bf16 a[136:139], v[68:71], v[44:47], a[136:139]
  v_mfma_f32_16x16x32_bf16 a[140:143], v[72:75], v[44:47], a[140:143]
  v_mfma_f32_16x16x32_bf16 a[144:147], v[76:79], v[44:47], a[144:147]
  v_mfma_f32_16x16x32_bf16 a[148:151], v[80:83], v[44:47], a[148:151]
  v_mfma_f32_16x16x32_bf16 a[152:155], v[84:87], v[44:47], a[152:155]
  v_mfma_f32_16x16x32_bf16 a[156:159], v[88:91], v[44:47], a[156:159]
  v_mfma_f32_16x16x32_bf16 a[160:163], v[60:63], v[48:51], a[160:163]
  v_mfma_f32_16x16x32_bf16 a[164:167], v[64:67], v[48:51], a[164:167]
  v_mfma_f32_16x16x32_bf16 a[168:171], v[68:71], v[48:51], a[168:171]
  v_mfma_f32_16x16x32_bf16 a[172:175], v[72:75], v[48:51], a[172:175]
  v_mfma_f32_16x16x32_bf16 a[176:179], v[76:79], v[48:51], a[176:179]
  v_mfma_f32_16x16x32_bf16 a[180:183], v[80:83], v[48:51], a[180:183]
  v_mfma_f32_16x16x32_bf16 a[184:187], v[84:87], v[48:51], a[184:187]
  v_mfma_f32_16x16x32_bf16 a[188:191], v[88:91], v[48:51], a[188:191]
  v_mfma_f32_16x16x32_bf16 a[192:195], v[60:63], v[52:55], a[192:195]
  v_mfma_f32_16x16x32_bf16 a[196:199], v[64:67], v[52:55], a[196:199]
  v_mfma_f32_16x16x32_bf16 a[200:203], v[68:71], v[52:55], a[200:203]
  v_mfma_f32_16x16x32_bf16 a[204:207], v[72:75], v[52:55], a[204:207]
  v_mfma_f32_16x16x32_bf16 a[208:211], v[76:79], v[52:55], a[208:211]
  v_mfma_f32_16x16x32_bf16 a[212:215], v[80:83], v[52:55], a[212:215]
  v_mfma_f32_16x16x32_bf16 a[216:219], v[84:87], v[52:55], a[216:219]
  v_mfma_f32_16x16x32_bf16 a[220:223], v[88:91], v[52:55], a[220:223]
  v_mfma_f32_16x16x32_bf16 a[224:227], v[60:63], v[56:59], a[224:227]
  v_mfma_f32_16x16x32_bf16 a[228:231], v[64:67], v[56:59], a[228:231]
  v_mfma_f32_16x16x32_bf16 a[232:235], v[68:71], v[56:59], a[232:235]
  v_mfma_f32_16x16x32_bf16 a[236:239], v[72:75], v[56:59], a[236:239]
  v_mfma_f32_16x16x32_bf16 a[240:243], v[76:79], v[56:59], a[240:243]
  v_mfma_f32_16x16x32_bf16 a[244:247], v[80:83], v[56:59], a[244:247]
  v_mfma_f32_16x16x32_bf16 a[248:251], v[84:87], v[56:59], a[248:251]
  v_mfma_f32_16x16x32_bf16 a[252:255], v[88:91], v[56:59], a[252:255]
  s_waitcnt lgkmcnt(0)
  v_mfma_f32_16x16x32_bf16 a[0:3], v[124:127], v[92:95], a[0:3]
  v_mfma_f32_16x16x32_bf16 a[4:7], v[128:131], v[92:95], a[4:7]
  v_mfma_f32_16x16x32_bf16 a[8:11], v[132:135], v[92:95], a[8:11]
  v_mfma_f32_16x16x32_bf16 a[12:15], v[136:139], v[92:95], a[12:15]
  v_mfma_f32_16x16x32_bf16 a[16:19], v[140:143], v[92:95], a[16:19]
  v_mfma_f32_16x16x32_bf16 a[20:23], v[144:147], v[92:95], a[20:23]
  v_mfma_f32_16x16x32_bf16 a[24:27], v[148:151], v[92:95], a[24:27]
  v_mfma_f32_16x16x32_bf16 a[28:31], v[152:155], v[92:95], a[28:31]
  v_mfma_f32_16x16x32_bf16 a[32:35], v[124:127], v[96:99], a[32:35]
  v_mfma_f32_16x16x32_bf16 a[36:39], v[128:131], v[96:99], a[36:39]
  v_mfma_f32_16x16x32_bf16 a[40:43], v[132:135], v[96:99], a[40:43]
  v_mfma_f32_16x16x32_bf16 a[44:47], v[136:139], v[96:99], a[44:47]
  v_mfma_f32_16x16x32_bf16 a[48:51], v[140:143], v[96:99], a[48:51]
  v_mfma_f32_16x16x32_bf16 a[52:55], v[144:147], v[96:99], a[52:55]
  v_mfma_f32_16x16x32_bf16 a[56:59], v[148:151], v[96:99], a[56:59]
  v_mfma_f32_16x16x32_bf16 a[60:63], v[152:155], v[96:99], a[60:63]
  v_mfma_f32_16x16x32_bf16 a[64:67], v[124:127], v[100:103], a[64:67]
  v_mfma_f32_16x16x32_bf16 a[68:71], v[128:131], v[100:103], a[68:71]
  v_mfma_f32_16x16x32_bf16 a[72:75], v[132:135], v[100:103], a[72:75]
  v_mfma_f32_16x16x32_bf16 a[76:79], v[136:139], v[100:103], a[76:79]
  v_mfma_f32_16x16x32_bf16 a[80:83], v[140:143], v[100:103], a[80:83]
  v_mfma_f32_16x16x32_bf16 a[84:87], v[144:147], v[100:103], a[84:87]
  v_mfma_f32_16x16x32_bf16 a[88:91], v[148:151], v[100:103], a[88:91]
  v_mfma_f32_16x16x32_bf16 a[92:95], v[152:155], v[100:103], a[92:95]
  v_mfma_f32_16x16x32_bf16 a[96:99], v[124:127], v[104:107], a[96:99]
  v_mfma_f32_16x16x32_bf16 a[100:103], v[128:131], v[104:107], a[100:103]
  v_mfma_f32_16x16x32_bf16 a[104:107], v[132:135], v[104:107], a[104:107]
  v_mfma_f32_16x16x32_bf16 a[108:111], v[136:139], v[104:107], a[108:111]
  v_mfma_f32_16x16x32_bf16 a[112:115], v[140:143], v[104:107], a[112:115]
  v_mfma_f32_16x16x32_bf16 a[116:119], v[144:147], v[104:107], a[116:119]
  v_mfma_f32_16x16x32_bf16 a[120:123], v[148:151], v[104:107], a[120:123]
  v_mfma_f32_16x16x32_bf16 a[124:127], v[152:155], v[104:107], a[124:127]
  v_mfma_f32_16x16x32_bf16 a[128:131], v[124:127], v[108:111], a[128:131]
  v_mfma_f32_16x16x32_bf16 a[132:135], v[128:131], v[108:111], a[132:135]
  v_mfma_f32_16x16x32_bf16 a[136:139], v[132:135], v[108:111], a[136:139]
  v_mfma_f32_16x16x32_bf16 a[140:143], v[136:139], v[108:111], a[140:143]
  v_mfma_f32_16x16x32_bf16 a[144:147], v[140:143], v[108:111], a[144:147]
  v_mfma_f32_16x16x32_bf16 a[148:151], v[144:147], v[108:111], a[148:151]
  v_mfma_f32_16x16x32_bf16 a[152:155], v[148:151], v[108:111], a[152:155]
  v_mfma_f32_16x16x32_bf16 a[156:159], v[152:155], v[108:111], a[156:159]
  v_mfma_f32_16x16x32_bf16 a[160:163], v[124:127], v[112:115], a[160:163]
  v_mfma_f32_16x16x32_bf16 a[164:167], v[128:131], v[112:115], a[164:167]
  v_mfma_f32_16x16x32_bf16 a[168:171], v[132:135], v[112:115], a[168:171]
  v_mfma_f32_16x16x32_bf16 a[172:175], v[136:139], v[112:115], a[172:175]
  v_mfma_f32_16x16x32_bf16 a[176:179], v[140:143], v[112:115], a[176:179]
  v_mfma_f32_16x16x32_bf16 a[180:183], v[144:147], v[112:115], a[180:183]
  v_mfma_f32_16x16x32_bf16 a[184:187], v[148:151], v[112:115], a[184:187]
  v_mfma_f32_16x16x32_bf16 a[188:191], v[152:155], v[112:115], a[188:191]
  v_mfma_f32_16x16x32_bf16 a[192:195], v[124:127], v[116:119], a[192:195]
  v_mfma_f32_16x16x32_bf16 a[196:199], v[128:131], v[116:119], a[196:199]
  v_mfma_f32_16x16x32_bf16 a[200:203], v[132:135], v[116:119], a[200:203]
  v_mfma_f32_16x16x32_bf16 a[204:207], v[136:139], v[116:119], a[204:207]
  v_mfma_f32_16x16x32_bf16 a[208:211], v[140:143], v[116:119], a[208:211]
  v_mfma_f32_16x16x32_bf16 a[212:215], v[144:147], v[116:119], a[212:215]
  v_mfma_f32_16x16x32_bf16 a[216:219], v[148:151], v[116:119], a[216:219]
  v_mfma_f32_16x16x32_bf16 a[220:223], v[152:155], v[116:119], a[220:223]
  v_mfma_f32_16x16x32_bf16 a[224:227], v[124:127], v[120:123], a[224:227]
  v_mfma_f32_16x16x32_bf16 a[228:231], v[128:131], v[120:123], a[228:231]
  v_mfma_f32_16x16x32_bf16 a[232:235], v[132:135], v[120:123], a[232:235]
  v_mfma_f32_16x16x32_bf16 a[236:239], v[136:139], v[120:123], a[236:239]
  v_mfma_f32_16x16x32_bf16 a[240:243], v[140:143], v[120:123], a[240:243]
  v_mfma_f32_16x16x32_bf16 a[244:247], v[144:147], v[120:123], a[244:247]
  v_mfma_f32_16x16x32_bf16 a[248:251], v[148:151], v[120:123], a[248:251]
  v_mfma_f32_16x16x32_bf16 a[252:255], v[152:155], v[120:123], a[252:255]
  s_nop 7
  s_nop 7
  s_add_u32 s49, s49, 1
  s_cmp_lt_u32 s49, 16
  s_cbranch_scc1 Lwspp_74
Lwspe_78:
  s_mov_b32 s52, s56
  s_mov_b32 s53, s57
  s_mov_b32 s54, 4096
  s_mov_b32 s55, 0x20000
Lmg_we0_72:
  v_and_b32 v30, 15, v1
  s_mov_b32 s40, 4608
  v_mul_lo_u32 v28, v30, s40
  v_bfe_u32 v30, v1, 4, 1
  v_lshl_add_u32 v28, v30, 5, v28
  v_bfe_u32 v30, v1, 5, 1
  v_lshl_add_u32 v28, v30, 4, v28
  v_and_b32 v29, 15, v1
  v_lshlrev_b32 v29, 1, v29
  s_lshr_b32 s40, s3, 1
  s_mul_i32 s40, s40, 128
  s_mul_i32 s41, s32, 256
  s_add_u32 s40, s40, s41
  s_mov_b32 s39, s40
  s_mul_i32 s40, s40, 4608
  s_and_b32 s41, s3, 1
  s_mul_i32 s41, s41, 128
  s_mul_i32 s42, s36, 256
  s_add_u32 s41, s41, s42
  s_lshl_b32 s41, s41, 1
  s_add_u32 s38, s40, s41
  s_lshl_b32 s39, s39, 1
  v_bfe_u32 v208, v1, 4, 1
  v_lshlrev_b32 v208, 1, v208
  v_bfe_u32 v209, v1, 5, 1
  v_or_b32 v208, v208, v209
  v_and_b32 v209, 7, v1
  v_xor_b32 v208, v208, v209
  v_lshlrev_b32 v208, 4, v208
  v_and_b32 v209, 15, v1
  v_lshl_add_u32 v208, v209, 7, v208
  v_xor_b32 v209, 64, v208
  s_lshl_b32 s40, s32, 1
  s_lshr_b32 s41, s3, 1
  s_add_u32 s40, s40, s41
  s_mul_i32 s40, s40, 36
  s_lshl_b32 s41, s36, 2
  s_add_u32 s40, s40, s41
  s_and_b32 s41, s3, 1
  s_lshl_b32 s41, s41, 1
  s_add_u32 s40, s40, s41
  s_lshl_b32 s58, s40, 14
  s_lshl_b32 s40, s3, 15
  v_add_u32 v212, s40, v208
  v_add_u32 v213, s40, v209
  s_barrier
  v_lshlrev_b32 v215, 4, v1
  v_add_u32 v214, s40, v215
  s_add_u32 s37, s38, 0
  buffer_load_ushort v32, v29, s[52:55], s39 offen offset:0
  buffer_load_dwordx4 v[40:43], v28, s[24:27], s37 offen offset:0
  buffer_load_dwordx4 v[44:47], v28, s[24:27], s37 offen offset:64
  buffer_load_dwordx4 v[48:51], v28, s[24:27], s37 offen offset:128
  buffer_load_dwordx4 v[52:55], v28, s[24:27], s37 offen offset:192
  s_add_u32 s37, s38, 73728
  buffer_load_ushort v33, v29, s[52:55], s39 offen offset:32
  buffer_load_dwordx4 v[56:59], v28, s[24:27], s37 offen offset:0
  buffer_load_dwordx4 v[60:63], v28, s[24:27], s37 offen offset:64
  buffer_load_dwordx4 v[64:67], v28, s[24:27], s37 offen offset:128
  buffer_load_dwordx4 v[68:71], v28, s[24:27], s37 offen offset:192
  s_add_u32 s37, s38, 147456
  buffer_load_ushort v34, v29, s[52:55], s39 offen offset:64
  buffer_load_dwordx4 v[72:75], v28, s[24:27], s37 offen offset:0
  buffer_load_dwordx4 v[76:79], v28, s[24:27], s37 offen offset:64
  buffer_load_dwordx4 v[80:83], v28, s[24:27], s37 offen offset:128
  buffer_load_dwordx4 v[84:87], v28, s[24:27], s37 offen offset:192
  s_add_u32 s37, s38, 221184
  buffer_load_ushort v35, v29, s[52:55], s39 offen offset:96
  buffer_load_dwordx4 v[88:91], v28, s[24:27], s37 offen offset:0
  buffer_load_dwordx4 v[92:95], v28, s[24:27], s37 offen offset:64
  buffer_load_dwordx4 v[96:99], v28, s[24:27], s37 offen offset:128
  buffer_load_dwordx4 v[100:103], v28, s[24:27], s37 offen offset:192
  s_add_u32 s37, s38, 294912
  buffer_load_ushort v36, v29, s[52:55], s39 offen offset:128
  buffer_load_dwordx4 v[104:107], v28, s[24:27], s37 offen offset:0
  buffer_load_dwordx4 v[108:111], v28, s[24:27], s37 offen offset:64
  buffer_load_dwordx4 v[112:115], v28, s[24:27], s37 offen offset:128
  buffer_load_dwordx4 v[116:119], v28, s[24:27], s37 offen offset:192
  s_add_u32 s37, s38, 368640
  buffer_load_ushort v37, v29, s[52:55], s39 offen offset:160
  buffer_load_dwordx4 v[120:123], v28, s[24:27], s37 offen offset:0
  buffer_load_dwordx4 v[124:127], v28, s[24:27], s37 offen offset:64
  buffer_load_dwordx4 v[128:131], v28, s[24:27], s37 offen offset:128
  buffer_load_dwordx4 v[132:135], v28, s[24:27], s37 offen offset:192
  s_add_u32 s37, s38, 442368
  buffer_load_ushort v38, v29, s[52:55], s39 offen offset:192
  buffer_load_dwordx4 v[136:139], v28, s[24:27], s37 offen offset:0
  buffer_load_dwordx4 v[140:143], v28, s[24:27], s37 offen offset:64
  buffer_load_dwordx4 v[144:147], v28, s[24:27], s37 offen offset:128
  buffer_load_dwordx4 v[148:151], v28, s[24:27], s37 offen offset:192
  s_add_u32 s37, s38, 516096
  buffer_load_ushort v39, v29, s[52:55], s39 offen offset:224
  buffer_load_dwordx4 v[152:155], v28, s[24:27], s37 offen offset:0
  buffer_load_dwordx4 v[156:159], v28, s[24:27], s37 offen offset:64
  buffer_load_dwordx4 v[160:163], v28, s[24:27], s37 offen offset:128
  buffer_load_dwordx4 v[164:167], v28, s[24:27], s37 offen offset:192
  s_waitcnt vmcnt(35)
  v_lshlrev_b32 v32, 16, v32
  v_mov_b32 v210, v32
  v_mov_b32 v211, v32
  s_add_u32 s37, s38, 0
  v_accvgpr_read_b32 v184, a0
  v_accvgpr_read_b32 v185, a1
  v_accvgpr_read_b32 v186, a2
  v_accvgpr_read_b32 v187, a3
  v_cvt_pk_bf16_f32 v168, v184, v185
  v_cvt_pk_bf16_f32 v169, v186, v187
  v_accvgpr_read_b32 v188, a4
  v_accvgpr_read_b32 v189, a5
  v_accvgpr_read_b32 v190, a6
  v_accvgpr_read_b32 v191, a7
  v_cvt_pk_bf16_f32 v170, v188, v189
  v_cvt_pk_bf16_f32 v171, v190, v191
  s_nop 1
  v_permlane16_swap_b32 v168, v170
  v_permlane16_swap_b32 v169, v171
  v_lshlrev_b32 v172, 16, v168
  v_and_b32 v173, 0xffff0000, v168
  v_lshlrev_b32 v174, 16, v169
  v_and_b32 v175, 0xffff0000, v169
  v_lshlrev_b32 v176, 16, v170
  v_and_b32 v177, 0xffff0000, v170
  v_lshlrev_b32 v178, 16, v171
  v_and_b32 v179, 0xffff0000, v171
  v_pk_add_f32 v[172:173], v[172:173], v[210:211]
  v_pk_add_f32 v[174:175], v[174:175], v[210:211]
  v_pk_add_f32 v[176:177], v[176:177], v[210:211]
  v_pk_add_f32 v[178:179], v[178:179], v[210:211]
  v_cvt_pk_bf16_f32 v180, v172, v173
  v_lshlrev_b32 v172, 16, v180
  v_and_b32 v173, 0xffff0000, v180
  v_cvt_pk_bf16_f32 v180, v174, v175
  v_lshlrev_b32 v174, 16, v180
  v_and_b32 v175, 0xffff0000, v180
  v_cvt_pk_bf16_f32 v180, v176, v177
  v_lshlrev_b32 v176, 16, v180
  v_and_b32 v177, 0xffff0000, v180
  v_cvt_pk_bf16_f32 v180, v178, v179
  v_lshlrev_b32 v178, 16, v180
  v_and_b32 v179, 0xffff0000, v180
  v_lshlrev_b32 v182, 16, v40
  v_and_b32 v183, 0xffff0000, v40
  v_pk_mul_f32 v[172:173], v[172:173], v[182:183]
  v_lshlrev_b32 v182, 16, v41
  v_and_b32 v183, 0xffff0000, v41
  v_pk_mul_f32 v[174:175], v[174:175], v[182:183]
  v_lshlrev_b32 v182, 16, v42
  v_and_b32 v183, 0xffff0000, v42
  v_pk_mul_f32 v[176:177], v[176:177], v[182:183]
  v_lshlrev_b32 v182, 16, v43
  v_and_b32 v183, 0xffff0000, v43
  v_pk_mul_f32 v[178:179], v[178:179], v[182:183]
  v_cvt_pk_bf16_f32 v192, v172, v173
  v_cvt_pk_bf16_f32 v193, v174, v175
  v_cvt_pk_bf16_f32 v194, v176, v177
  v_cvt_pk_bf16_f32 v195, v178, v179
  ds_write_b128 v212, v[192:195] offset:0
  v_accvgpr_read_b32 v184, a8
  v_accvgpr_read_b32 v185, a9
  v_accvgpr_read_b32 v186, a10
  v_accvgpr_read_b32 v187, a11
  v_cvt_pk_bf16_f32 v168, v184, v185
  v_cvt_pk_bf16_f32 v169, v186, v187
  v_accvgpr_read_b32 v188, a12
  v_accvgpr_read_b32 v189, a13
  v_accvgpr_read_b32 v190, a14
  v_accvgpr_read_b32 v191, a15
  v_cvt_pk_bf16_f32 v170, v188, v189
  v_cvt_pk_bf16_f32 v171, v190, v191
  s_nop 1
  v_permlane16_swap_b32 v168, v170
  v_permlane16_swap_b32 v169, v171
  v_lshlrev_b32 v172, 16, v168
  v_and_b32 v173, 0xffff0000, v168
  v_lshlrev_b32 v174, 16, v169
  v_and_b32 v175, 0xffff0000, v169
  v_lshlrev_b32 v176, 16, v170
  v_and_b32 v177, 0xffff0000, v170
  v_lshlrev_b32 v178, 16, v171
  v_and_b32 v179, 0xffff0000, v171
  v_pk_add_f32 v[172:173], v[172:173], v[210:211]
  v_pk_add_f32 v[174:175], v[174:175], v[210:211]
  v_pk_add_f32 v[176:177], v[176:177], v[210:211]
  v_pk_add_f32 v[178:179], v[178:179], v[210:211]
  v_cvt_pk_bf16_f32 v180, v172, v173
  v_lshlrev_b32 v172, 16, v180
  v_and_b32 v173, 0xffff0000, v180
  v_cvt_pk_bf16_f32 v180, v174, v175
  v_lshlrev_b32 v174, 16, v180
  v_and_b32 v175, 0xffff0000, v180
  v_cvt_pk_bf16_f32 v180, v176, v177
  v_lshlrev_b32 v176, 16, v180
  v_and_b32 v177, 0xffff0000, v180
  v_cvt_pk_bf16_f32 v180, v178, v179
  v_lshlrev_b32 v178, 16, v180
  v_and_b32 v179, 0xffff0000, v180
  v_lshlrev_b32 v182, 16, v44
  v_and_b32 v183, 0xffff0000, v44
  v_pk_mul_f32 v[172:173], v[172:173], v[182:183]
  v_lshlrev_b32 v182, 16, v45
  v_and_b32 v183, 0xffff0000, v45
  v_pk_mul_f32 v[174:175], v[174:175], v[182:183]
  v_lshlrev_b32 v182, 16, v46
  v_and_b32 v183, 0xffff0000, v46
  v_pk_mul_f32 v[176:177], v[176:177], v[182:183]
  v_lshlrev_b32 v182, 16, v47
  v_and_b32 v183, 0xffff0000, v47
  v_pk_mul_f32 v[178:179], v[178:179], v[182:183]
  v_cvt_pk_bf16_f32 v196, v172, v173
  v_cvt_pk_bf16_f32 v197, v174, v175
  v_cvt_pk_bf16_f32 v198, v176, v177
  v_cvt_pk_bf16_f32 v199, v178, v179
  ds_write_b128 v213, v[196:199] offset:0
  v_accvgpr_read_b32 v184, a16
  v_accvgpr_read_b32 v185, a17
  v_accvgpr_read_b32 v186, a18
  v_accvgpr_read_b32 v187, a19
  v_cvt_pk_bf16_f32 v168, v184, v185
  v_cvt_pk_bf16_f32 v169, v186, v187
  v_accvgpr_read_b32 v188, a20
  v_accvgpr_read_b32 v189, a21
  v_accvgpr_read_b32 v190, a22
  v_accvgpr_read_b32 v191, a23
  v_cvt_pk_bf16_f32 v170, v188, v189
  v_cvt_pk_bf16_f32 v171, v190, v191
  s_nop 1
  v_permlane16_swap_b32 v168, v170
  v_permlane16_swap_b32 v169, v171
  v_lshlrev_b32 v172, 16, v168
  v_and_b32 v173, 0xffff0000, v168
  v_lshlrev_b32 v174, 16, v169
  v_and_b32 v175, 0xffff0000, v169
  v_lshlrev_b32 v176, 16, v170
  v_and_b32 v177, 0xffff0000, v170
  v_lshlrev_b32 v178, 16, v171
  v_and_b32 v179, 0xffff0000, v171
  v_pk_add_f32 v[172:173], v[172:173], v[210:211]
  v_pk_add_f32 v[174:175], v[174:175], v[210:211]
  v_pk_add_f32 v[176:177], v[176:177], v[210:211]
  v_pk_add_f32 v[178:179], v[178:179], v[210:211]
  v_cvt_pk_bf16_f32 v180, v172, v173
  v_lshlrev_b32 v172, 16, v180
  v_and_b32 v173, 0xffff0000, v180
  v_cvt_pk_bf16_f32 v180, v174, v175
  v_lshlrev_b32 v174, 16, v180
  v_and_b32 v175, 0xffff0000, v180
  v_cvt_pk_bf16_f32 v180, v176, v177
  v_lshlrev_b32 v176, 16, v180
  v_and_b32 v177, 0xffff0000, v180
  v_cvt_pk_bf16_f32 v180, v178, v179
  v_lshlrev_b32 v178, 16, v180
  v_and_b32 v179, 0xffff0000, v180
  v_lshlrev_b32 v182, 16, v48
  v_and_b32 v183, 0xffff0000, v48
  v_pk_mul_f32 v[172:173], v[172:173], v[182:183]
  v_lshlrev_b32 v182, 16, v49
  v_and_b32 v183, 0xffff0000, v49
  v_pk_mul_f32 v[174:175], v[174:175], v[182:183]
  v_lshlrev_b32 v182, 16, v50
  v_and_b32 v183, 0xffff0000, v50
  v_pk_mul_f32 v[176:177], v[176:177], v[182:183]
  v_lshlrev_b32 v182, 16, v51
  v_and_b32 v183, 0xffff0000, v51
  v_pk_mul_f32 v[178:179], v[178:179], v[182:183]
  v_cvt_pk_bf16_f32 v200, v172, v173
  v_cvt_pk_bf16_f32 v201, v174, v175
  v_cvt_pk_bf16_f32 v202, v176, v177
  v_cvt_pk_bf16_f32 v203, v178, v179
  ds_write_b128 v212, v[200:203] offset:16384
  v_accvgpr_read_b32 v184, a24
  v_accvgpr_read_b32 v185, a25
  v_accvgpr_read_b32 v186, a26
  v_accvgpr_read_b32 v187, a27
  v_cvt_pk_bf16_f32 v168, v184, v185
  v_cvt_pk_bf16_f32 v169, v186, v187
  v_accvgpr_read_b32 v188, a28
  v_accvgpr_read_b32 v189, a29
  v_accvgpr_read_b32 v190, a30
  v_accvgpr_read_b32 v191, a31
  v_cvt_pk_bf16_f32 v170, v188, v189
  v_cvt_pk_bf16_f32 v171, v190, v191
  s_nop 1
  v_permlane16_swap_b32 v168, v170
  v_permlane16_swap_b32 v169, v171
  v_lshlrev_b32 v172, 16, v168
  v_and_b32 v173, 0xffff0000, v168
  v_lshlrev_b32 v174, 16, v169
  v_and_b32 v175, 0xffff0000, v169
  v_lshlrev_b32 v176, 16, v170
  v_and_b32 v177, 0xffff0000, v170
  v_lshlrev_b32 v178, 16, v171
  v_and_b32 v179, 0xffff0000, v171
  v_pk_add_f32 v[172:173], v[172:173], v[210:211]
  v_pk_add_f32 v[174:175], v[174:175], v[210:211]
  v_pk_add_f32 v[176:177], v[176:177], v[210:211]
  v_pk_add_f32 v[178:179], v[178:179], v[210:211]
  v_cvt_pk_bf16_f32 v180, v172, v173
  v_lshlrev_b32 v172, 16, v180
  v_and_b32 v173, 0xffff0000, v180
  v_cvt_pk_bf16_f32 v180, v174, v175
  v_lshlrev_b32 v174, 16, v180
  v_and_b32 v175, 0xffff0000, v180
  v_cvt_pk_bf16_f32 v180, v176, v177
  v_lshlrev_b32 v176, 16, v180
  v_and_b32 v177, 0xffff0000, v180
  v_cvt_pk_bf16_f32 v180, v178, v179
  v_lshlrev_b32 v178, 16, v180
  v_and_b32 v179, 0xffff0000, v180
  v_lshlrev_b32 v182, 16, v52
  v_and_b32 v183, 0xffff0000, v52
  v_pk_mul_f32 v[172:173], v[172:173], v[182:183]
  v_lshlrev_b32 v182, 16, v53
  v_and_b32 v183, 0xffff0000, v53
  v_pk_mul_f32 v[174:175], v[174:175], v[182:183]
  v_lshlrev_b32 v182, 16, v54
  v_and_b32 v183, 0xffff0000, v54
  v_pk_mul_f32 v[176:177], v[176:177], v[182:183]
  v_lshlrev_b32 v182, 16, v55
  v_and_b32 v183, 0xffff0000, v55
  v_pk_mul_f32 v[178:179], v[178:179], v[182:183]
  v_cvt_pk_bf16_f32 v204, v172, v173
  v_cvt_pk_bf16_f32 v205, v174, v175
  v_cvt_pk_bf16_f32 v206, v176, v177
  v_cvt_pk_bf16_f32 v207, v178, v179
  ds_write_b128 v213, v[204:207] offset:16384
  s_waitcnt vmcnt(30)
  v_lshlrev_b32 v33, 16, v33
  v_mov_b32 v210, v33
  v_mov_b32 v211, v33
  s_add_u32 s37, s38, 73728
  v_accvgpr_read_b32 v184, a32
  v_accvgpr_read_b32 v185, a33
  v_accvgpr_read_b32 v186, a34
  v_accvgpr_read_b32 v187, a35
  v_cvt_pk_bf16_f32 v168, v184, v185
  v_cvt_pk_bf16_f32 v169, v186, v187
  v_accvgpr_read_b32 v188, a36
  v_accvgpr_read_b32 v189, a37
  v_accvgpr_read_b32 v190, a38
  v_accvgpr_read_b32 v191, a39
  v_cvt_pk_bf16_f32 v170, v188, v189
  v_cvt_pk_bf16_f32 v171, v190, v191
  s_nop 1
  v_permlane16_swap_b32 v168, v170
  v_permlane16_swap_b32 v169, v171
  v_lshlrev_b32 v172, 16, v168
  v_and_b32 v173, 0xffff0000, v168
  v_lshlrev_b32 v174, 16, v169
  v_and_b32 v175, 0xffff0000, v169
  v_lshlrev_b32 v176, 16, v170
  v_and_b32 v177, 0xffff0000, v170
  v_lshlrev_b32 v178, 16, v171
  v_and_b32 v179, 0xffff0000, v171
  v_pk_add_f32 v[172:173], v[172:173], v[210:211]
  v_pk_add_f32 v[174:175], v[174:175], v[210:211]
  v_pk_add_f32 v[176:177], v[176:177], v[210:211]
  v_pk_add_f32 v[178:179], v[178:179], v[210:211]
  v_cvt_pk_bf16_f32 v180, v172, v173
  v_lshlrev_b32 v172, 16, v180
  v_and_b32 v173, 0xffff0000, v180
  v_cvt_pk_bf16_f32 v180, v174, v175
  v_lshlrev_b32 v174, 16, v180
  v_and_b32 v175, 0xffff0000, v180
  v_cvt_pk_bf16_f32 v180, v176, v177
  v_lshlrev_b32 v176, 16, v180
  v_and_b32 v177, 0xffff0000, v180
  v_cvt_pk_bf16_f32 v180, v178, v179
  v_lshlrev_b32 v178, 16, v180
  v_and_b32 v179, 0xffff0000, v180
  v_lshlrev_b32 v182, 16, v56
  v_and_b32 v183, 0xffff0000, v56
  v_pk_mul_f32 v[172:173], v[172:173], v[182:183]
  v_lshlrev_b32 v182, 16, v57
  v_and_b32 v183, 0xffff0000, v57
  v_pk_mul_f32 v[174:175], v[174:175], v[182:183]
  v_lshlrev_b32 v182, 16, v58
  v_and_b32 v183, 0xffff0000, v58
  v_pk_mul_f32 v[176:177], v[176:177], v[182:183]
  v_lshlrev_b32 v182, 16, v59
  v_and_b32 v183, 0xffff0000, v59
  v_pk_mul_f32 v[178:179], v[178:179], v[182:183]
  v_cvt_pk_bf16_f32 v192, v172, v173
  v_cvt_pk_bf16_f32 v193, v174, v175
  v_cvt_pk_bf16_f32 v194, v176, v177
  v_cvt_pk_bf16_f32 v195, v178, v179
  ds_write_b128 v212, v[192:195] offset:2048
  v_accvgpr_read_b32 v184, a40
  v_accvgpr_read_b32 v185, a41
  v_accvgpr_read_b32 v186, a42
  v_accvgpr_read_b32 v187, a43
  v_cvt_pk_bf16_f32 v168, v184, v185
  v_cvt_pk_bf16_f32 v169, v186, v187
  v_accvgpr_read_b32 v188, a44
  v_accvgpr_read_b32 v189, a45
  v_accvgpr_read_b32 v190, a46
  v_accvgpr_read_b32 v191, a47
  v_cvt_pk_bf16_f32 v170, v188, v189
  v_cvt_pk_bf16_f32 v171, v190, v191
  s_nop 1
  v_permlane16_swap_b32 v168, v170
  v_permlane16_swap_b32 v169, v171
  v_lshlrev_b32 v172, 16, v168
  v_and_b32 v173, 0xffff0000, v168
  v_lshlrev_b32 v174, 16, v169
  v_and_b32 v175, 0xffff0000, v169
  v_lshlrev_b32 v176, 16, v170
  v_and_b32 v177, 0xffff0000, v170
  v_lshlrev_b32 v178, 16, v171
  v_and_b32 v179, 0xffff0000, v171
  v_pk_add_f32 v[172:173], v[172:173], v[210:211]
  v_pk_add_f32 v[174:175], v[174:175], v[210:211]
  v_pk_add_f32 v[176:177], v[176:177], v[210:211]
  v_pk_add_f32 v[178:179], v[178:179], v[210:211]
  v_cvt_pk_bf16_f32 v180, v172, v173
  v_lshlrev_b32 v172, 16, v180
  v_and_b32 v173, 0xffff0000, v180
  v_cvt_pk_bf16_f32 v180, v174, v175
  v_lshlrev_b32 v174, 16, v180
  v_and_b32 v175, 0xffff0000, v180
  v_cvt_pk_bf16_f32 v180, v176, v177
  v_lshlrev_b32 v176, 16, v180
  v_and_b32 v177, 0xffff0000, v180
  v_cvt_pk_bf16_f32 v180, v178, v179
  v_lshlrev_b32 v178, 16, v180
  v_and_b32 v179, 0xffff0000, v180
  v_lshlrev_b32 v182, 16, v60
  v_and_b32 v183, 0xffff0000, v60
  v_pk_mul_f32 v[172:173], v[172:173], v[182:183]
  v_lshlrev_b32 v182, 16, v61
  v_and_b32 v183, 0xffff0000, v61
  v_pk_mul_f32 v[174:175], v[174:175], v[182:183]
  v_lshlrev_b32 v182, 16, v62
  v_and_b32 v183, 0xffff0000, v62
  v_pk_mul_f32 v[176:177], v[176:177], v[182:183]
  v_lshlrev_b32 v182, 16, v63
  v_and_b32 v183, 0xffff0000, v63
  v_pk_mul_f32 v[178:179], v[178:179], v[182:183]
  v_cvt_pk_bf16_f32 v196, v172, v173
  v_cvt_pk_bf16_f32 v197, v174, v175
  v_cvt_pk_bf16_f32 v198, v176, v177
  v_cvt_pk_bf16_f32 v199, v178, v179
  ds_write_b128 v213, v[196:199] offset:2048
  v_accvgpr_read_b32 v184, a48
  v_accvgpr_read_b32 v185, a49
  v_accvgpr_read_b32 v186, a50
  v_accvgpr_read_b32 v187, a51
  v_cvt_pk_bf16_f32 v168, v184, v185
  v_cvt_pk_bf16_f32 v169, v186, v187
  v_accvgpr_read_b32 v188, a52
  v_accvgpr_read_b32 v189, a53
  v_accvgpr_read_b32 v190, a54
  v_accvgpr_read_b32 v191, a55
  v_cvt_pk_bf16_f32 v170, v188, v189
  v_cvt_pk_bf16_f32 v171, v190, v191
  s_nop 1
  v_permlane16_swap_b32 v168, v170
  v_permlane16_swap_b32 v169, v171
  v_lshlrev_b32 v172, 16, v168
  v_and_b32 v173, 0xffff0000, v168
  v_lshlrev_b32 v174, 16, v169
  v_and_b32 v175, 0xffff0000, v169
  v_lshlrev_b32 v176, 16, v170
  v_and_b32 v177, 0xffff0000, v170
  v_lshlrev_b32 v178, 16, v171
  v_and_b32 v179, 0xffff0000, v171
  v_pk_add_f32 v[172:173], v[172:173], v[210:211]
  v_pk_add_f32 v[174:175], v[174:175], v[210:211]
  v_pk_add_f32 v[176:177], v[176:177], v[210:211]
  v_pk_add_f32 v[178:179], v[178:179], v[210:211]
  v_cvt_pk_bf16_f32 v180, v172, v173
  v_lshlrev_b32 v172, 16, v180
  v_and_b32 v173, 0xffff0000, v180
  v_cvt_pk_bf16_f32 v180, v174, v175
  v_lshlrev_b32 v174, 16, v180
  v_and_b32 v175, 0xffff0000, v180
  v_cvt_pk_bf16_f32 v180, v176, v177
  v_lshlrev_b32 v176, 16, v180
  v_and_b32 v177, 0xffff0000, v180
  v_cvt_pk_bf16_f32 v180, v178, v179
  v_lshlrev_b32 v178, 16, v180
  v_and_b32 v179, 0xffff0000, v180
  v_lshlrev_b32 v182, 16, v64
  v_and_b32 v183, 0xffff0000, v64
  v_pk_mul_f32 v[172:173], v[172:173], v[182:183]
  v_lshlrev_b32 v182, 16, v65
  v_and_b32 v183, 0xffff0000, v65
  v_pk_mul_f32 v[174:175], v[174:175], v[182:183]
  v_lshlrev_b32 v182, 16, v66
  v_and_b32 v183, 0xffff0000, v66
  v_pk_mul_f32 v[176:177], v[176:177], v[182:183]
  v_lshlrev_b32 v182, 16, v67
  v_and_b32 v183, 0xffff0000, v67
  v_pk_mul_f32 v[178:179], v[178:179], v[182:183]
  v_cvt_pk_bf16_f32 v200, v172, v173
  v_cvt_pk_bf16_f32 v201, v174, v175
  v_cvt_pk_bf16_f32 v202, v176, v177
  v_cvt_pk_bf16_f32 v203, v178, v179
  ds_write_b128 v212, v[200:203] offset:18432
  v_accvgpr_read_b32 v184, a56
  v_accvgpr_read_b32 v185, a57
  v_accvgpr_read_b32 v186, a58
  v_accvgpr_read_b32 v187, a59
  v_cvt_pk_bf16_f32 v168, v184, v185
  v_cvt_pk_bf16_f32 v169, v186, v187
  v_accvgpr_read_b32 v188, a60
  v_accvgpr_read_b32 v189, a61
  v_accvgpr_read_b32 v190, a62
  v_accvgpr_read_b32 v191, a63
  v_cvt_pk_bf16_f32 v170, v188, v189
  v_cvt_pk_bf16_f32 v171, v190, v191
  s_nop 1
  v_permlane16_swap_b32 v168, v170
  v_permlane16_swap_b32 v169, v171
  v_lshlrev_b32 v172, 16, v168
  v_and_b32 v173, 0xffff0000, v168
  v_lshlrev_b32 v174, 16, v169
  v_and_b32 v175, 0xffff0000, v169
  v_lshlrev_b32 v176, 16, v170
  v_and_b32 v177, 0xffff0000, v170
  v_lshlrev_b32 v178, 16, v171
  v_and_b32 v179, 0xffff0000, v171
  v_pk_add_f32 v[172:173], v[172:173], v[210:211]
  v_pk_add_f32 v[174:175], v[174:175], v[210:211]
  v_pk_add_f32 v[176:177], v[176:177], v[210:211]
  v_pk_add_f32 v[178:179], v[178:179], v[210:211]
  v_cvt_pk_bf16_f32 v180, v172, v173
  v_lshlrev_b32 v172, 16, v180
  v_and_b32 v173, 0xffff0000, v180
  v_cvt_pk_bf16_f32 v180, v174, v175
  v_lshlrev_b32 v174, 16, v180
  v_and_b32 v175, 0xffff0000, v180
  v_cvt_pk_bf16_f32 v180, v176, v177
  v_lshlrev_b32 v176, 16, v180
  v_and_b32 v177, 0xffff0000, v180
  v_cvt_pk_bf16_f32 v180, v178, v179
  v_lshlrev_b32 v178, 16, v180
  v_and_b32 v179, 0xffff0000, v180
  v_lshlrev_b32 v182, 16, v68
  v_and_b32 v183, 0xffff0000, v68
  v_pk_mul_f32 v[172:173], v[172:173], v[182:183]
  v_lshlrev_b32 v182, 16, v69
  v_and_b32 v183, 0xffff0000, v69
  v_pk_mul_f32 v[174:175], v[174:175], v[182:183]
  v_lshlrev_b32 v182, 16, v70
  v_and_b32 v183, 0xffff0000, v70
  v_pk_mul_f32 v[176:177], v[176:177], v[182:183]
  v_lshlrev_b32 v182, 16, v71
  v_and_b32 v183, 0xffff0000, v71
  v_pk_mul_f32 v[178:179], v[178:179], v[182:183]
  v_cvt_pk_bf16_f32 v204, v172, v173
  v_cvt_pk_bf16_f32 v205, v174, v175
  v_cvt_pk_bf16_f32 v206, v176, v177
  v_cvt_pk_bf16_f32 v207, v178, v179
  ds_write_b128 v213, v[204:207] offset:18432
  s_waitcnt lgkmcnt(4)
  ds_read_b128 v[216:219], v214 offset:0
  ds_read_b128 v[220:223], v214 offset:1024
  ds_read_b128 v[224:227], v214 offset:16384
  ds_read_b128 v[228:231], v214 offset:17408
  s_waitcnt lgkmcnt(0)
  s_add_u32 s40, s58, 0
  buffer_store_dwordx4 v[216:219], v215, s[20:23], s40 offen offset:0 sc1
  buffer_store_dwordx4 v[220:223], v215, s[20:23], s40 offen offset:1024 sc1
  s_add_u32 s40, s58, 16384
  buffer_store_dwordx4 v[224:227], v215, s[20:23], s40 offen offset:0 sc1
  buffer_store_dwordx4 v[228:231], v215, s[20:23], s40 offen offset:1024 sc1
  s_waitcnt vmcnt(29)
  v_lshlrev_b32 v34, 16, v34
  v_mov_b32 v210, v34
  v_mov_b32 v211, v34
  s_add_u32 s37, s38, 147456
  v_accvgpr_read_b32 v184, a64
  v_accvgpr_read_b32 v185, a65
  v_accvgpr_read_b32 v186, a66
  v_accvgpr_read_b32 v187, a67
  v_cvt_pk_bf16_f32 v168, v184, v185
  v_cvt_pk_bf16_f32 v169, v186, v187
  v_accvgpr_read_b32 v188, a68
  v_accvgpr_read_b32 v189, a69
  v_accvgpr_read_b32 v190, a70
  v_accvgpr_read_b32 v191, a71
  v_cvt_pk_bf16_f32 v170, v188, v189
  v_cvt_pk_bf16_f32 v171, v190, v191
  s_nop 1
  v_permlane16_swap_b32 v168, v170
  v_permlane16_swap_b32 v169, v171
  v_lshlrev_b32 v172, 16, v168
  v_and_b32 v173, 0xffff0000, v168
  v_lshlrev_b32 v174, 16, v169
  v_and_b32 v175, 0xffff0000, v169
  v_lshlrev_b32 v176, 16, v170
  v_and_b32 v177, 0xffff0000, v170
  v_lshlrev_b32 v178, 16, v171
  v_and_b32 v179, 0xffff0000, v171
  v_pk_add_f32 v[172:173], v[172:173], v[210:211]
  v_pk_add_f32 v[174:175], v[174:175], v[210:211]
  v_pk_add_f32 v[176:177], v[176:177], v[210:211]
  v_pk_add_f32 v[178:179], v[178:179], v[210:211]
  v_cvt_pk_bf16_f32 v180, v172, v173
  v_lshlrev_b32 v172, 16, v180
  v_and_b32 v173, 0xffff0000, v180
  v_cvt_pk_bf16_f32 v180, v174, v175
  v_lshlrev_b32 v174, 16, v180
  v_and_b32 v175, 0xffff0000, v180
  v_cvt_pk_bf16_f32 v180, v176, v177
  v_lshlrev_b32 v176, 16, v180
  v_and_b32 v177, 0xffff0000, v180
  v_cvt_pk_bf16_f32 v180, v178, v179
  v_lshlrev_b32 v178, 16, v180
  v_and_b32 v179, 0xffff0000, v180
  v_lshlrev_b32 v182, 16, v72
  v_and_b32 v183, 0xffff0000, v72
  v_pk_mul_f32 v[172:173], v[172:173], v[182:183]
  v_lshlrev_b32 v182, 16, v73
  v_and_b32 v183, 0xffff0000, v73
  v_pk_mul_f32 v[174:175], v[174:175], v[182:183]
  v_lshlrev_b32 v182, 16, v74
  v_and_b32 v183, 0xffff0000, v74
  v_pk_mul_f32 v[176:177], v[176:177], v[182:183]
  v_lshlrev_b32 v182, 16, v75
  v_and_b32 v183, 0xffff0000, v75
  v_pk_mul_f32 v[178:179], v[178:179], v[182:183]
  v_cvt_pk_bf16_f32 v192, v172, v173
  v_cvt_pk_bf16_f32 v193, v174, v175
  v_cvt_pk_bf16_f32 v194, v176, v177
  v_cvt_pk_bf16_f32 v195, v178, v179
  ds_write_b128 v212, v[192:195] offset:4096
  v_accvgpr_read_b32 v184, a72
  v_accvgpr_read_b32 v185, a73
  v_accvgpr_read_b32 v186, a74
  v_accvgpr_read_b32 v187, a75
  v_cvt_pk_bf16_f32 v168, v184, v185
  v_cvt_pk_bf16_f32 v169, v186, v187
  v_accvgpr_read_b32 v188, a76
  v_accvgpr_read_b32 v189, a77
  v_accvgpr_read_b32 v190, a78
  v_accvgpr_read_b32 v191, a79
  v_cvt_pk_bf16_f32 v170, v188, v189
  v_cvt_pk_bf16_f32 v171, v190, v191
  s_nop 1
  v_permlane16_swap_b32 v168, v170
  v_permlane16_swap_b32 v169, v171
  v_lshlrev_b32 v172, 16, v168
  v_and_b32 v173, 0xffff0000, v168
  v_lshlrev_b32 v174, 16, v169
  v_and_b32 v175, 0xffff0000, v169
  v_lshlrev_b32 v176, 16, v170
  v_and_b32 v177, 0xffff0000, v170
  v_lshlrev_b32 v178, 16, v171
  v_and_b32 v179, 0xffff0000, v171
  v_pk_add_f32 v[172:173], v[172:173], v[210:211]
  v_pk_add_f32 v[174:175], v[174:175], v[210:211]
  v_pk_add_f32 v[176:177], v[176:177], v[210:211]
  v_pk_add_f32 v[178:179], v[178:179], v[210:211]
  v_cvt_pk_bf16_f32 v180, v172, v173
  v_lshlrev_b32 v172, 16, v180
  v_and_b32 v173, 0xffff0000, v180
  v_cvt_pk_bf16_f32 v180, v174, v175
  v_lshlrev_b32 v174, 16, v180
  v_and_b32 v175, 0xffff0000, v180
  v_cvt_pk_bf16_f32 v180, v176, v177
  v_lshlrev_b32 v176, 16, v180
  v_and_b32 v177, 0xffff0000, v180
  v_cvt_pk_bf16_f32 v180, v178, v179
  v_lshlrev_b32 v178, 16, v180
  v_and_b32 v179, 0xffff0000, v180
  v_lshlrev_b32 v182, 16, v76
  v_and_b32 v183, 0xffff0000, v76
  v_pk_mul_f32 v[172:173], v[172:173], v[182:183]
  v_lshlrev_b32 v182, 16, v77
  v_and_b32 v183, 0xffff0000, v77
  v_pk_mul_f32 v[174:175], v[174:175], v[182:183]
  v_lshlrev_b32 v182, 16, v78
  v_and_b32 v183, 0xffff0000, v78
  v_pk_mul_f32 v[176:177], v[176:177], v[182:183]
  v_lshlrev_b32 v182, 16, v79
  v_and_b32 v183, 0xffff0000, v79
  v_pk_mul_f32 v[178:179], v[178:179], v[182:183]
  v_cvt_pk_bf16_f32 v196, v172, v173
  v_cvt_pk_bf16_f32 v197, v174, v175
  v_cvt_pk_bf16_f32 v198, v176, v177
  v_cvt_pk_bf16_f32 v199, v178, v179
  ds_write_b128 v213, v[196:199] offset:4096
  v_accvgpr_read_b32 v184, a80
  v_accvgpr_read_b32 v185, a81
  v_accvgpr_read_b32 v186, a82
  v_accvgpr_read_b32 v187, a83
  v_cvt_pk_bf16_f32 v168, v184, v185
  v_cvt_pk_bf16_f32 v169, v186, v187
  v_accvgpr_read_b32 v188, a84
  v_accvgpr_read_b32 v189, a85
  v_accvgpr_read_b32 v190, a86
  v_accvgpr_read_b32 v191, a87
  v_cvt_pk_bf16_f32 v170, v188, v189
  v_cvt_pk_bf16_f32 v171, v190, v191
  s_nop 1
  v_permlane16_swap_b32 v168, v170
  v_permlane16_swap_b32 v169, v171
  v_lshlrev_b32 v172, 16, v168
  v_and_b32 v173, 0xffff0000, v168
  v_lshlrev_b32 v174, 16, v169
  v_and_b32 v175, 0xffff0000, v169
  v_lshlrev_b32 v176, 16, v170
  v_and_b32 v177, 0xffff0000, v170
  v_lshlrev_b32 v178, 16, v171
  v_and_b32 v179, 0xffff0000, v171
  v_pk_add_f32 v[172:173], v[172:173], v[210:211]
  v_pk_add_f32 v[174:175], v[174:175], v[210:211]
  v_pk_add_f32 v[176:177], v[176:177], v[210:211]
  v_pk_add_f32 v[178:179], v[178:179], v[210:211]
  v_cvt_pk_bf16_f32 v180, v172, v173
  v_lshlrev_b32 v172, 16, v180
  v_and_b32 v173, 0xffff0000, v180
  v_cvt_pk_bf16_f32 v180, v174, v175
  v_lshlrev_b32 v174, 16, v180
  v_and_b32 v175, 0xffff0000, v180
  v_cvt_pk_bf16_f32 v180, v176, v177
  v_lshlrev_b32 v176, 16, v180
  v_and_b32 v177, 0xffff0000, v180
  v_cvt_pk_bf16_f32 v180, v178, v179
  v_lshlrev_b32 v178, 16, v180
  v_and_b32 v179, 0xffff0000, v180
  v_lshlrev_b32 v182, 16, v80
  v_and_b32 v183, 0xffff0000, v80
  v_pk_mul_f32 v[172:173], v[172:173], v[182:183]
  v_lshlrev_b32 v182, 16, v81
  v_and_b32 v183, 0xffff0000, v81
  v_pk_mul_f32 v[174:175], v[174:175], v[182:183]
  v_lshlrev_b32 v182, 16, v82
  v_and_b32 v183, 0xffff0000, v82
  v_pk_mul_f32 v[176:177], v[176:177], v[182:183]
  v_lshlrev_b32 v182, 16, v83
  v_and_b32 v183, 0xffff0000, v83
  v_pk_mul_f32 v[178:179], v[178:179], v[182:183]
  v_cvt_pk_bf16_f32 v200, v172, v173
  v_cvt_pk_bf16_f32 v201, v174, v175
  v_cvt_pk_bf16_f32 v202, v176, v177
  v_cvt_pk_bf16_f32 v203, v178, v179
  ds_write_b128 v212, v[200:203] offset:20480
  v_accvgpr_read_b32 v184, a88
  v_accvgpr_read_b32 v185, a89
  v_accvgpr_read_b32 v186, a90
  v_accvgpr_read_b32 v187, a91
  v_cvt_pk_bf16_f32 v168, v184, v185
  v_cvt_pk_bf16_f32 v169, v186, v187
  v_accvgpr_read_b32 v188, a92
  v_accvgpr_read_b32 v189, a93
  v_accvgpr_read_b32 v190, a94
  v_accvgpr_read_b32 v191, a95
  v_cvt_pk_bf16_f32 v170, v188, v189
  v_cvt_pk_bf16_f32 v171, v190, v191
  s_nop 1
  v_permlane16_swap_b32 v168, v170
  v_permlane16_swap_b32 v169, v171
  v_lshlrev_b32 v172, 16, v168
  v_and_b32 v173, 0xffff0000, v168
  v_lshlrev_b32 v174, 16, v169
  v_and_b32 v175, 0xffff0000, v169
  v_lshlrev_b32 v176, 16, v170
  v_and_b32 v177, 0xffff0000, v170
  v_lshlrev_b32 v178, 16, v171
  v_and_b32 v179, 0xffff0000, v171
  v_pk_add_f32 v[172:173], v[172:173], v[210:211]
  v_pk_add_f32 v[174:175], v[174:175], v[210:211]
  v_pk_add_f32 v[176:177], v[176:177], v[210:211]
  v_pk_add_f32 v[178:179], v[178:179], v[210:211]
  v_cvt_pk_bf16_f32 v180, v172, v173
  v_lshlrev_b32 v172, 16, v180
  v_and_b32 v173, 0xffff0000, v180
  v_cvt_pk_bf16_f32 v180, v174, v175
  v_lshlrev_b32 v174, 16, v180
  v_and_b32 v175, 0xffff0000, v180
  v_cvt_pk_bf16_f32 v180, v176, v177
  v_lshlrev_b32 v176, 16, v180
  v_and_b32 v177, 0xffff0000, v180
  v_cvt_pk_bf16_f32 v180, v178, v179
  v_lshlrev_b32 v178, 16, v180
  v_and_b32 v179, 0xffff0000, v180
  v_lshlrev_b32 v182, 16, v84
  v_and_b32 v183, 0xffff0000, v84
  v_pk_mul_f32 v[172:173], v[172:173], v[182:183]
  v_lshlrev_b32 v182, 16, v85
  v_and_b32 v183, 0xffff0000, v85
  v_pk_mul_f32 v[174:175], v[174:175], v[182:183]
  v_lshlrev_b32 v182, 16, v86
  v_and_b32 v183, 0xffff0000, v86
  v_pk_mul_f32 v[176:177], v[176:177], v[182:183]
  v_lshlrev_b32 v182, 16, v87
  v_and_b32 v183, 0xffff0000, v87
  v_pk_mul_f32 v[178:179], v[178:179], v[182:183]
  v_cvt_pk_bf16_f32 v204, v172, v173
  v_cvt_pk_bf16_f32 v205, v174, v175
  v_cvt_pk_bf16_f32 v206, v176, v177
  v_cvt_pk_bf16_f32 v207, v178, v179
  ds_write_b128 v213, v[204:207] offset:20480
  s_waitcnt lgkmcnt(4)
  ds_read_b128 v[216:219], v214 offset:2048
  ds_read_b128 v[220:223], v214 offset:3072
  ds_read_b128 v[224:227], v214 offset:18432
  ds_read_b128 v[228:231], v214 offset:19456
  s_waitcnt lgkmcnt(0)
  s_add_u32 s40, s58, 2048
  buffer_store_dwordx4 v[216:219], v215, s[20:23], s40 offen offset:0 sc1
  buffer_store_dwordx4 v[220:223], v215, s[20:23], s40 offen offset:1024 sc1
  s_add_u32 s40, s58, 18432
  buffer_store_dwordx4 v[224:227], v215, s[20:23], s40 offen offset:0 sc1
  buffer_store_dwordx4 v[228:231], v215, s[20:23], s40 offen offset:1024 sc1
  s_waitcnt vmcnt(28)
  v_lshlrev_b32 v35, 16, v35
  v_mov_b32 v210, v35
  v_mov_b32 v211, v35
  s_add_u32 s37, s38, 221184
  v_accvgpr_read_b32 v184, a96
  v_accvgpr_read_b32 v185, a97
  v_accvgpr_read_b32 v186, a98
  v_accvgpr_read_b32 v187, a99
  v_cvt_pk_bf16_f32 v168, v184, v185
  v_cvt_pk_bf16_f32 v169, v186, v187
  v_accvgpr_read_b32 v188, a100
  v_accvgpr_read_b32 v189, a101
  v_accvgpr_read_b32 v190, a102
  v_accvgpr_read_b32 v191, a103
  v_cvt_pk_bf16_f32 v170, v188, v189
  v_cvt_pk_bf16_f32 v171, v190, v191
  s_nop 1
  v_permlane16_swap_b32 v168, v170
  v_permlane16_swap_b32 v169, v171
  v_lshlrev_b32 v172, 16, v168
  v_and_b32 v173, 0xffff0000, v168
  v_lshlrev_b32 v174, 16, v169
  v_and_b32 v175, 0xffff0000, v169
  v_lshlrev_b32 v176, 16, v170
  v_and_b32 v177, 0xffff0000, v170
  v_lshlrev_b32 v178, 16, v171
  v_and_b32 v179, 0xffff0000, v171
  v_pk_add_f32 v[172:173], v[172:173], v[210:211]
  v_pk_add_f32 v[174:175], v[174:175], v[210:211]
  v_pk_add_f32 v[176:177], v[176:177], v[210:211]
  v_pk_add_f32 v[178:179], v[178:179], v[210:211]
  v_cvt_pk_bf16_f32 v180, v172, v173
  v_lshlrev_b32 v172, 16, v180
  v_and_b32 v173, 0xffff0000, v180
  v_cvt_pk_bf16_f32 v180, v174, v175
  v_lshlrev_b32 v174, 16, v180
  v_and_b32 v175, 0xffff0000, v180
  v_cvt_pk_bf16_f32 v180, v176, v177
  v_lshlrev_b32 v176, 16, v180
  v_and_b32 v177, 0xffff0000, v180
  v_cvt_pk_bf16_f32 v180, v178, v179
  v_lshlrev_b32 v178, 16, v180
  v_and_b32 v179, 0xffff0000, v180
  v_lshlrev_b32 v182, 16, v88
  v_and_b32 v183, 0xffff0000, v88
  v_pk_mul_f32 v[172:173], v[172:173], v[182:183]
  v_lshlrev_b32 v182, 16, v89
  v_and_b32 v183, 0xffff0000, v89
  v_pk_mul_f32 v[174:175], v[174:175], v[182:183]
  v_lshlrev_b32 v182, 16, v90
  v_and_b32 v183, 0xffff0000, v90
  v_pk_mul_f32 v[176:177], v[176:177], v[182:183]
  v_lshlrev_b32 v182, 16, v91
  v_and_b32 v183, 0xffff0000, v91
  v_pk_mul_f32 v[178:179], v[178:179], v[182:183]
  v_cvt_pk_bf16_f32 v192, v172, v173
  v_cvt_pk_bf16_f32 v193, v174, v175
  v_cvt_pk_bf16_f32 v194, v176, v177
  v_cvt_pk_bf16_f32 v195, v178, v179
  ds_write_b128 v212, v[192:195] offset:6144
  v_accvgpr_read_b32 v184, a104
  v_accvgpr_read_b32 v185, a105
  v_accvgpr_read_b32 v186, a106
  v_accvgpr_read_b32 v187, a107
  v_cvt_pk_bf16_f32 v168, v184, v185
  v_cvt_pk_bf16_f32 v169, v186, v187
  v_accvgpr_read_b32 v188, a108
  v_accvgpr_read_b32 v189, a109
  v_accvgpr_read_b32 v190, a110
  v_accvgpr_read_b32 v191, a111
  v_cvt_pk_bf16_f32 v170, v188, v189
  v_cvt_pk_bf16_f32 v171, v190, v191
  s_nop 1
  v_permlane16_swap_b32 v168, v170
  v_permlane16_swap_b32 v169, v171
  v_lshlrev_b32 v172, 16, v168
  v_and_b32 v173, 0xffff0000, v168
  v_lshlrev_b32 v174, 16, v169
  v_and_b32 v175, 0xffff0000, v169
  v_lshlrev_b32 v176, 16, v170
  v_and_b32 v177, 0xffff0000, v170
  v_lshlrev_b32 v178, 16, v171
  v_and_b32 v179, 0xffff0000, v171
  v_pk_add_f32 v[172:173], v[172:173], v[210:211]
  v_pk_add_f32 v[174:175], v[174:175], v[210:211]
  v_pk_add_f32 v[176:177], v[176:177], v[210:211]
  v_pk_add_f32 v[178:179], v[178:179], v[210:211]
  v_cvt_pk_bf16_f32 v180, v172, v173
  v_lshlrev_b32 v172, 16, v180
  v_and_b32 v173, 0xffff0000, v180
  v_cvt_pk_bf16_f32 v180, v174, v175
  v_lshlrev_b32 v174, 16, v180
  v_and_b32 v175, 0xffff0000, v180
  v_cvt_pk_bf16_f32 v180, v176, v177
  v_lshlrev_b32 v176, 16, v180
  v_and_b32 v177, 0xffff0000, v180
  v_cvt_pk_bf16_f32 v180, v178, v179
  v_lshlrev_b32 v178, 16, v180
  v_and_b32 v179, 0xffff0000, v180
  v_lshlrev_b32 v182, 16, v92
  v_and_b32 v183, 0xffff0000, v92
  v_pk_mul_f32 v[172:173], v[172:173], v[182:183]
  v_lshlrev_b32 v182, 16, v93
  v_and_b32 v183, 0xffff0000, v93
  v_pk_mul_f32 v[174:175], v[174:175], v[182:183]
  v_lshlrev_b32 v182, 16, v94
  v_and_b32 v183, 0xffff0000, v94
  v_pk_mul_f32 v[176:177], v[176:177], v[182:183]
  v_lshlrev_b32 v182, 16, v95
  v_and_b32 v183, 0xffff0000, v95
  v_pk_mul_f32 v[178:179], v[178:179], v[182:183]
  v_cvt_pk_bf16_f32 v196, v172, v173
  v_cvt_pk_bf16_f32 v197, v174, v175
  v_cvt_pk_bf16_f32 v198, v176, v177
  v_cvt_pk_bf16_f32 v199, v178, v179
  ds_write_b128 v213, v[196:199] offset:6144
  v_accvgpr_read_b32 v184, a112
  v_accvgpr_read_b32 v185, a113
  v_accvgpr_read_b32 v186, a114
  v_accvgpr_read_b32 v187, a115
  v_cvt_pk_bf16_f32 v168, v184, v185
  v_cvt_pk_bf16_f32 v169, v186, v187
  v_accvgpr_read_b32 v188, a116
  v_accvgpr_read_b32 v189, a117
  v_accvgpr_read_b32 v190, a118
  v_accvgpr_read_b32 v191, a119
  v_cvt_pk_bf16_f32 v170, v188, v189
  v_cvt_pk_bf16_f32 v171, v190, v191
  s_nop 1
  v_permlane16_swap_b32 v168, v170
  v_permlane16_swap_b32 v169, v171
  v_lshlrev_b32 v172, 16, v168
  v_and_b32 v173, 0xffff0000, v168
  v_lshlrev_b32 v174, 16, v169
  v_and_b32 v175, 0xffff0000, v169
  v_lshlrev_b32 v176, 16, v170
  v_and_b32 v177, 0xffff0000, v170
  v_lshlrev_b32 v178, 16, v171
  v_and_b32 v179, 0xffff0000, v171
  v_pk_add_f32 v[172:173], v[172:173], v[210:211]
  v_pk_add_f32 v[174:175], v[174:175], v[210:211]
  v_pk_add_f32 v[176:177], v[176:177], v[210:211]
  v_pk_add_f32 v[178:179], v[178:179], v[210:211]
  v_cvt_pk_bf16_f32 v180, v172, v173
  v_lshlrev_b32 v172, 16, v180
  v_and_b32 v173, 0xffff0000, v180
  v_cvt_pk_bf16_f32 v180, v174, v175
  v_lshlrev_b32 v174, 16, v180
  v_and_b32 v175, 0xffff0000, v180
  v_cvt_pk_bf16_f32 v180, v176, v177
  v_lshlrev_b32 v176, 16, v180
  v_and_b32 v177, 0xffff0000, v180
  v_cvt_pk_bf16_f32 v180, v178, v179
  v_lshlrev_b32 v178, 16, v180
  v_and_b32 v179, 0xffff0000, v180
  v_lshlrev_b32 v182, 16, v96
  v_and_b32 v183, 0xffff0000, v96
  v_pk_mul_f32 v[172:173], v[172:173], v[182:183]
  v_lshlrev_b32 v182, 16, v97
  v_and_b32 v183, 0xffff0000, v97
  v_pk_mul_f32 v[174:175], v[174:175], v[182:183]
  v_lshlrev_b32 v182, 16, v98
  v_and_b32 v183, 0xffff0000, v98
  v_pk_mul_f32 v[176:177], v[176:177], v[182:183]
  v_lshlrev_b32 v182, 16, v99
  v_and_b32 v183, 0xffff0000, v99
  v_pk_mul_f32 v[178:179], v[178:179], v[182:183]
  v_cvt_pk_bf16_f32 v200, v172, v173
  v_cvt_pk_bf16_f32 v201, v174, v175
  v_cvt_pk_bf16_f32 v202, v176, v177
  v_cvt_pk_bf16_f32 v203, v178, v179
  ds_write_b128 v212, v[200:203] offset:22528
  v_accvgpr_read_b32 v184, a120
  v_accvgpr_read_b32 v185, a121
  v_accvgpr_read_b32 v186, a122
  v_accvgpr_read_b32 v187, a123
  v_cvt_pk_bf16_f32 v168, v184, v185
  v_cvt_pk_bf16_f32 v169, v186, v187
  v_accvgpr_read_b32 v188, a124
  v_accvgpr_read_b32 v189, a125
  v_accvgpr_read_b32 v190, a126
  v_accvgpr_read_b32 v191, a127
  v_cvt_pk_bf16_f32 v170, v188, v189
  v_cvt_pk_bf16_f32 v171, v190, v191
  s_nop 1
  v_permlane16_swap_b32 v168, v170
  v_permlane16_swap_b32 v169, v171
  v_lshlrev_b32 v172, 16, v168
  v_and_b32 v173, 0xffff0000, v168
  v_lshlrev_b32 v174, 16, v169
  v_and_b32 v175, 0xffff0000, v169
  v_lshlrev_b32 v176, 16, v170
  v_and_b32 v177, 0xffff0000, v170
  v_lshlrev_b32 v178, 16, v171
  v_and_b32 v179, 0xffff0000, v171
  v_pk_add_f32 v[172:173], v[172:173], v[210:211]
  v_pk_add_f32 v[174:175], v[174:175], v[210:211]
  v_pk_add_f32 v[176:177], v[176:177], v[210:211]
  v_pk_add_f32 v[178:179], v[178:179], v[210:211]
  v_cvt_pk_bf16_f32 v180, v172, v173
  v_lshlrev_b32 v172, 16, v180
  v_and_b32 v173, 0xffff0000, v180
  v_cvt_pk_bf16_f32 v180, v174, v175
  v_lshlrev_b32 v174, 16, v180
  v_and_b32 v175, 0xffff0000, v180
  v_cvt_pk_bf16_f32 v180, v176, v177
  v_lshlrev_b32 v176, 16, v180
  v_and_b32 v177, 0xffff0000, v180
  v_cvt_pk_bf16_f32 v180, v178, v179
  v_lshlrev_b32 v178, 16, v180
  v_and_b32 v179, 0xffff0000, v180
  v_lshlrev_b32 v182, 16, v100
  v_and_b32 v183, 0xffff0000, v100
  v_pk_mul_f32 v[172:173], v[172:173], v[182:183]
  v_lshlrev_b32 v182, 16, v101
  v_and_b32 v183, 0xffff0000, v101
  v_pk_mul_f32 v[174:175], v[174:175], v[182:183]
  v_lshlrev_b32 v182, 16, v102
  v_and_b32 v183, 0xffff0000, v102
  v_pk_mul_f32 v[176:177], v[176:177], v[182:183]
  v_lshlrev_b32 v182, 16, v103
  v_and_b32 v183, 0xffff0000, v103
  v_pk_mul_f32 v[178:179], v[178:179], v[182:183]
  v_cvt_pk_bf16_f32 v204, v172, v173
  v_cvt_pk_bf16_f32 v205, v174, v175
  v_cvt_pk_bf16_f32 v206, v176, v177
  v_cvt_pk_bf16_f32 v207, v178, v179
  ds_write_b128 v213, v[204:207] offset:22528
  s_waitcnt lgkmcnt(4)
  ds_read_b128 v[216:219], v214 offset:4096
  ds_read_b128 v[220:223], v214 offset:5120
  ds_read_b128 v[224:227], v214 offset:20480
  ds_read_b128 v[228:231], v214 offset:21504
  s_waitcnt lgkmcnt(0)
  s_add_u32 s40, s58, 4096
  buffer_store_dwordx4 v[216:219], v215, s[20:23], s40 offen offset:0 sc1
  buffer_store_dwordx4 v[220:223], v215, s[20:23], s40 offen offset:1024 sc1
  s_add_u32 s40, s58, 20480
  buffer_store_dwordx4 v[224:227], v215, s[20:23], s40 offen offset:0 sc1
  buffer_store_dwordx4 v[228:231], v215, s[20:23], s40 offen offset:1024 sc1
  s_waitcnt vmcnt(27)
  v_lshlrev_b32 v36, 16, v36
  v_mov_b32 v210, v36
  v_mov_b32 v211, v36
  s_add_u32 s37, s38, 294912
  v_accvgpr_read_b32 v184, a128
  v_accvgpr_read_b32 v185, a129
  v_accvgpr_read_b32 v186, a130
  v_accvgpr_read_b32 v187, a131
  v_cvt_pk_bf16_f32 v168, v184, v185
  v_cvt_pk_bf16_f32 v169, v186, v187
  v_accvgpr_read_b32 v188, a132
  v_accvgpr_read_b32 v189, a133
  v_accvgpr_read_b32 v190, a134
  v_accvgpr_read_b32 v191, a135
  v_cvt_pk_bf16_f32 v170, v188, v189
  v_cvt_pk_bf16_f32 v171, v190, v191
  s_nop 1
  v_permlane16_swap_b32 v168, v170
  v_permlane16_swap_b32 v169, v171
  v_lshlrev_b32 v172, 16, v168
  v_and_b32 v173, 0xffff0000, v168
  v_lshlrev_b32 v174, 16, v169
  v_and_b32 v175, 0xffff0000, v169
  v_lshlrev_b32 v176, 16, v170
  v_and_b32 v177, 0xffff0000, v170
  v_lshlrev_b32 v178, 16, v171
  v_and_b32 v179, 0xffff0000, v171
  v_pk_add_f32 v[172:173], v[172:173], v[210:211]
  v_pk_add_f32 v[174:175], v[174:175], v[210:211]
  v_pk_add_f32 v[176:177], v[176:177], v[210:211]
  v_pk_add_f32 v[178:179], v[178:179], v[210:211]
  v_cvt_pk_bf16_f32 v180, v172, v173
  v_lshlrev_b32 v172, 16, v180
  v_and_b32 v173, 0xffff0000, v180
  v_cvt_pk_bf16_f32 v180, v174, v175
  v_lshlrev_b32 v174, 16, v180
  v_and_b32 v175, 0xffff0000, v180
  v_cvt_pk_bf16_f32 v180, v176, v177
  v_lshlrev_b32 v176, 16, v180
  v_and_b32 v177, 0xffff0000, v180
  v_cvt_pk_bf16_f32 v180, v178, v179
  v_lshlrev_b32 v178, 16, v180
  v_and_b32 v179, 0xffff0000, v180
  v_lshlrev_b32 v182, 16, v104
  v_and_b32 v183, 0xffff0000, v104
  v_pk_mul_f32 v[172:173], v[172:173], v[182:183]
  v_lshlrev_b32 v182, 16, v105
  v_and_b32 v183, 0xffff0000, v105
  v_pk_mul_f32 v[174:175], v[174:175], v[182:183]
  v_lshlrev_b32 v182, 16, v106
  v_and_b32 v183, 0xffff0000, v106
  v_pk_mul_f32 v[176:177], v[176:177], v[182:183]
  v_lshlrev_b32 v182, 16, v107
  v_and_b32 v183, 0xffff0000, v107
  v_pk_mul_f32 v[178:179], v[178:179], v[182:183]
  v_cvt_pk_bf16_f32 v192, v172, v173
  v_cvt_pk_bf16_f32 v193, v174, v175
  v_cvt_pk_bf16_f32 v194, v176, v177
  v_cvt_pk_bf16_f32 v195, v178, v179
  ds_write_b128 v212, v[192:195] offset:8192
  v_accvgpr_read_b32 v184, a136
  v_accvgpr_read_b32 v185, a137
  v_accvgpr_read_b32 v186, a138
  v_accvgpr_read_b32 v187, a139
  v_cvt_pk_bf16_f32 v168, v184, v185
  v_cvt_pk_bf16_f32 v169, v186, v187
  v_accvgpr_read_b32 v188, a140
  v_accvgpr_read_b32 v189, a141
  v_accvgpr_read_b32 v190, a142
  v_accvgpr_read_b32 v191, a143
  v_cvt_pk_bf16_f32 v170, v188, v189
  v_cvt_pk_bf16_f32 v171, v190, v191
  s_nop 1
  v_permlane16_swap_b32 v168, v170
  v_permlane16_swap_b32 v169, v171
  v_lshlrev_b32 v172, 16, v168
  v_and_b32 v173, 0xffff0000, v168
  v_lshlrev_b32 v174, 16, v169
  v_and_b32 v175, 0xffff0000, v169
  v_lshlrev_b32 v176, 16, v170
  v_and_b32 v177, 0xffff0000, v170
  v_lshlrev_b32 v178, 16, v171
  v_and_b32 v179, 0xffff0000, v171
  v_pk_add_f32 v[172:173], v[172:173], v[210:211]
  v_pk_add_f32 v[174:175], v[174:175], v[210:211]
  v_pk_add_f32 v[176:177], v[176:177], v[210:211]
  v_pk_add_f32 v[178:179], v[178:179], v[210:211]
  v_cvt_pk_bf16_f32 v180, v172, v173
  v_lshlrev_b32 v172, 16, v180
  v_and_b32 v173, 0xffff0000, v180
  v_cvt_pk_bf16_f32 v180, v174, v175
  v_lshlrev_b32 v174, 16, v180
  v_and_b32 v175, 0xffff0000, v180
  v_cvt_pk_bf16_f32 v180, v176, v177
  v_lshlrev_b32 v176, 16, v180
  v_and_b32 v177, 0xffff0000, v180
  v_cvt_pk_bf16_f32 v180, v178, v179
  v_lshlrev_b32 v178, 16, v180
  v_and_b32 v179, 0xffff0000, v180
  v_lshlrev_b32 v182, 16, v108
  v_and_b32 v183, 0xffff0000, v108
  v_pk_mul_f32 v[172:173], v[172:173], v[182:183]
  v_lshlrev_b32 v182, 16, v109
  v_and_b32 v183, 0xffff0000, v109
  v_pk_mul_f32 v[174:175], v[174:175], v[182:183]
  v_lshlrev_b32 v182, 16, v110
  v_and_b32 v183, 0xffff0000, v110
  v_pk_mul_f32 v[176:177], v[176:177], v[182:183]
  v_lshlrev_b32 v182, 16, v111
  v_and_b32 v183, 0xffff0000, v111
  v_pk_mul_f32 v[178:179], v[178:179], v[182:183]
  v_cvt_pk_bf16_f32 v196, v172, v173
  v_cvt_pk_bf16_f32 v197, v174, v175
  v_cvt_pk_bf16_f32 v198, v176, v177
  v_cvt_pk_bf16_f32 v199, v178, v179
  ds_write_b128 v213, v[196:199] offset:8192
  v_accvgpr_read_b32 v184, a144
  v_accvgpr_read_b32 v185, a145
  v_accvgpr_read_b32 v186, a146
  v_accvgpr_read_b32 v187, a147
  v_cvt_pk_bf16_f32 v168, v184, v185
  v_cvt_pk_bf16_f32 v169, v186, v187
  v_accvgpr_read_b32 v188, a148
  v_accvgpr_read_b32 v189, a149
  v_accvgpr_read_b32 v190, a150
  v_accvgpr_read_b32 v191, a151
  v_cvt_pk_bf16_f32 v170, v188, v189
  v_cvt_pk_bf16_f32 v171, v190, v191
  s_nop 1
  v_permlane16_swap_b32 v168, v170
  v_permlane16_swap_b32 v169, v171
  v_lshlrev_b32 v172, 16, v168
  v_and_b32 v173, 0xffff0000, v168
  v_lshlrev_b32 v174, 16, v169
  v_and_b32 v175, 0xffff0000, v169
  v_lshlrev_b32 v176, 16, v170
  v_and_b32 v177, 0xffff0000, v170
  v_lshlrev_b32 v178, 16, v171
  v_and_b32 v179, 0xffff0000, v171
  v_pk_add_f32 v[172:173], v[172:173], v[210:211]
  v_pk_add_f32 v[174:175], v[174:175], v[210:211]
  v_pk_add_f32 v[176:177], v[176:177], v[210:211]
  v_pk_add_f32 v[178:179], v[178:179], v[210:211]
  v_cvt_pk_bf16_f32 v180, v172, v173
  v_lshlrev_b32 v172, 16, v180
  v_and_b32 v173, 0xffff0000, v180
  v_cvt_pk_bf16_f32 v180, v174, v175
  v_lshlrev_b32 v174, 16, v180
  v_and_b32 v175, 0xffff0000, v180
  v_cvt_pk_bf16_f32 v180, v176, v177
  v_lshlrev_b32 v176, 16, v180
  v_and_b32 v177, 0xffff0000, v180
  v_cvt_pk_bf16_f32 v180, v178, v179
  v_lshlrev_b32 v178, 16, v180
  v_and_b32 v179, 0xffff0000, v180
  v_lshlrev_b32 v182, 16, v112
  v_and_b32 v183, 0xffff0000, v112
  v_pk_mul_f32 v[172:173], v[172:173], v[182:183]
  v_lshlrev_b32 v182, 16, v113
  v_and_b32 v183, 0xffff0000, v113
  v_pk_mul_f32 v[174:175], v[174:175], v[182:183]
  v_lshlrev_b32 v182, 16, v114
  v_and_b32 v183, 0xffff0000, v114
  v_pk_mul_f32 v[176:177], v[176:177], v[182:183]
  v_lshlrev_b32 v182, 16, v115
  v_and_b32 v183, 0xffff0000, v115
  v_pk_mul_f32 v[178:179], v[178:179], v[182:183]
  v_cvt_pk_bf16_f32 v200, v172, v173
  v_cvt_pk_bf16_f32 v201, v174, v175
  v_cvt_pk_bf16_f32 v202, v176, v177
  v_cvt_pk_bf16_f32 v203, v178, v179
  ds_write_b128 v212, v[200:203] offset:24576
  v_accvgpr_read_b32 v184, a152
  v_accvgpr_read_b32 v185, a153
  v_accvgpr_read_b32 v186, a154
  v_accvgpr_read_b32 v187, a155
  v_cvt_pk_bf16_f32 v168, v184, v185
  v_cvt_pk_bf16_f32 v169, v186, v187
  v_accvgpr_read_b32 v188, a156
  v_accvgpr_read_b32 v189, a157
  v_accvgpr_read_b32 v190, a158
  v_accvgpr_read_b32 v191, a159
  v_cvt_pk_bf16_f32 v170, v188, v189
  v_cvt_pk_bf16_f32 v171, v190, v191
  s_nop 1
  v_permlane16_swap_b32 v168, v170
  v_permlane16_swap_b32 v169, v171
  v_lshlrev_b32 v172, 16, v168
  v_and_b32 v173, 0xffff0000, v168
  v_lshlrev_b32 v174, 16, v169
  v_and_b32 v175, 0xffff0000, v169
  v_lshlrev_b32 v176, 16, v170
  v_and_b32 v177, 0xffff0000, v170
  v_lshlrev_b32 v178, 16, v171
  v_and_b32 v179, 0xffff0000, v171
  v_pk_add_f32 v[172:173], v[172:173], v[210:211]
  v_pk_add_f32 v[174:175], v[174:175], v[210:211]
  v_pk_add_f32 v[176:177], v[176:177], v[210:211]
  v_pk_add_f32 v[178:179], v[178:179], v[210:211]
  v_cvt_pk_bf16_f32 v180, v172, v173
  v_lshlrev_b32 v172, 16, v180
  v_and_b32 v173, 0xffff0000, v180
  v_cvt_pk_bf16_f32 v180, v174, v175
  v_lshlrev_b32 v174, 16, v180
  v_and_b32 v175, 0xffff0000, v180
  v_cvt_pk_bf16_f32 v180, v176, v177
  v_lshlrev_b32 v176, 16, v180
  v_and_b32 v177, 0xffff0000, v180
  v_cvt_pk_bf16_f32 v180, v178, v179
  v_lshlrev_b32 v178, 16, v180
  v_and_b32 v179, 0xffff0000, v180
  v_lshlrev_b32 v182, 16, v116
  v_and_b32 v183, 0xffff0000, v116
  v_pk_mul_f32 v[172:173], v[172:173], v[182:183]
  v_lshlrev_b32 v182, 16, v117
  v_and_b32 v183, 0xffff0000, v117
  v_pk_mul_f32 v[174:175], v[174:175], v[182:183]
  v_lshlrev_b32 v182, 16, v118
  v_and_b32 v183, 0xffff0000, v118
  v_pk_mul_f32 v[176:177], v[176:177], v[182:183]
  v_lshlrev_b32 v182, 16, v119
  v_and_b32 v183, 0xffff0000, v119
  v_pk_mul_f32 v[178:179], v[178:179], v[182:183]
  v_cvt_pk_bf16_f32 v204, v172, v173
  v_cvt_pk_bf16_f32 v205, v174, v175
  v_cvt_pk_bf16_f32 v206, v176, v177
  v_cvt_pk_bf16_f32 v207, v178, v179
  ds_write_b128 v213, v[204:207] offset:24576
  s_waitcnt lgkmcnt(4)
  ds_read_b128 v[216:219], v214 offset:6144
  ds_read_b128 v[220:223], v214 offset:7168
  ds_read_b128 v[224:227], v214 offset:22528
  ds_read_b128 v[228:231], v214 offset:23552
  s_waitcnt lgkmcnt(0)
  s_add_u32 s40, s58, 6144
  buffer_store_dwordx4 v[216:219], v215, s[20:23], s40 offen offset:0 sc1
  buffer_store_dwordx4 v[220:223], v215, s[20:23], s40 offen offset:1024 sc1
  s_add_u32 s40, s58, 22528
  buffer_store_dwordx4 v[224:227], v215, s[20:23], s40 offen offset:0 sc1
  buffer_store_dwordx4 v[228:231], v215, s[20:23], s40 offen offset:1024 sc1
  s_waitcnt vmcnt(26)
  v_lshlrev_b32 v37, 16, v37
  v_mov_b32 v210, v37
  v_mov_b32 v211, v37
  s_add_u32 s37, s38, 368640
  v_accvgpr_read_b32 v184, a160
  v_accvgpr_read_b32 v185, a161
  v_accvgpr_read_b32 v186, a162
  v_accvgpr_read_b32 v187, a163
  v_cvt_pk_bf16_f32 v168, v184, v185
  v_cvt_pk_bf16_f32 v169, v186, v187
  v_accvgpr_read_b32 v188, a164
  v_accvgpr_read_b32 v189, a165
  v_accvgpr_read_b32 v190, a166
  v_accvgpr_read_b32 v191, a167
  v_cvt_pk_bf16_f32 v170, v188, v189
  v_cvt_pk_bf16_f32 v171, v190, v191
  s_nop 1
  v_permlane16_swap_b32 v168, v170
  v_permlane16_swap_b32 v169, v171
  v_lshlrev_b32 v172, 16, v168
  v_and_b32 v173, 0xffff0000, v168
  v_lshlrev_b32 v174, 16, v169
  v_and_b32 v175, 0xffff0000, v169
  v_lshlrev_b32 v176, 16, v170
  v_and_b32 v177, 0xffff0000, v170
  v_lshlrev_b32 v178, 16, v171
  v_and_b32 v179, 0xffff0000, v171
  v_pk_add_f32 v[172:173], v[172:173], v[210:211]
  v_pk_add_f32 v[174:175], v[174:175], v[210:211]
  v_pk_add_f32 v[176:177], v[176:177], v[210:211]
  v_pk_add_f32 v[178:179], v[178:179], v[210:211]
  v_cvt_pk_bf16_f32 v180, v172, v173
  v_lshlrev_b32 v172, 16, v180
  v_and_b32 v173, 0xffff0000, v180
  v_cvt_pk_bf16_f32 v180, v174, v175
  v_lshlrev_b32 v174, 16, v180
  v_and_b32 v175, 0xffff0000, v180
  v_cvt_pk_bf16_f32 v180, v176, v177
  v_lshlrev_b32 v176, 16, v180
  v_and_b32 v177, 0xffff0000, v180
  v_cvt_pk_bf16_f32 v180, v178, v179
  v_lshlrev_b32 v178, 16, v180
  v_and_b32 v179, 0xffff0000, v180
  v_lshlrev_b32 v182, 16, v120
  v_and_b32 v183, 0xffff0000, v120
  v_pk_mul_f32 v[172:173], v[172:173], v[182:183]
  v_lshlrev_b32 v182, 16, v121
  v_and_b32 v183, 0xffff0000, v121
  v_pk_mul_f32 v[174:175], v[174:175], v[182:183]
  v_lshlrev_b32 v182, 16, v122
  v_and_b32 v183, 0xffff0000, v122
  v_pk_mul_f32 v[176:177], v[176:177], v[182:183]
  v_lshlrev_b32 v182, 16, v123
  v_and_b32 v183, 0xffff0000, v123
  v_pk_mul_f32 v[178:179], v[178:179], v[182:183]
  v_cvt_pk_bf16_f32 v192, v172, v173
  v_cvt_pk_bf16_f32 v193, v174, v175
  v_cvt_pk_bf16_f32 v194, v176, v177
  v_cvt_pk_bf16_f32 v195, v178, v179
  ds_write_b128 v212, v[192:195] offset:10240
  v_accvgpr_read_b32 v184, a168
  v_accvgpr_read_b32 v185, a169
  v_accvgpr_read_b32 v186, a170
  v_accvgpr_read_b32 v187, a171
  v_cvt_pk_bf16_f32 v168, v184, v185
  v_cvt_pk_bf16_f32 v169, v186, v187
  v_accvgpr_read_b32 v188, a172
  v_accvgpr_read_b32 v189, a173
  v_accvgpr_read_b32 v190, a174
  v_accvgpr_read_b32 v191, a175
  v_cvt_pk_bf16_f32 v170, v188, v189
  v_cvt_pk_bf16_f32 v171, v190, v191
  s_nop 1
  v_permlane16_swap_b32 v168, v170
  v_permlane16_swap_b32 v169, v171
  v_lshlrev_b32 v172, 16, v168
  v_and_b32 v173, 0xffff0000, v168
  v_lshlrev_b32 v174, 16, v169
  v_and_b32 v175, 0xffff0000, v169
  v_lshlrev_b32 v176, 16, v170
  v_and_b32 v177, 0xffff0000, v170
  v_lshlrev_b32 v178, 16, v171
  v_and_b32 v179, 0xffff0000, v171
  v_pk_add_f32 v[172:173], v[172:173], v[210:211]
  v_pk_add_f32 v[174:175], v[174:175], v[210:211]
  v_pk_add_f32 v[176:177], v[176:177], v[210:211]
  v_pk_add_f32 v[178:179], v[178:179], v[210:211]
  v_cvt_pk_bf16_f32 v180, v172, v173
  v_lshlrev_b32 v172, 16, v180
  v_and_b32 v173, 0xffff0000, v180
  v_cvt_pk_bf16_f32 v180, v174, v175
  v_lshlrev_b32 v174, 16, v180
  v_and_b32 v175, 0xffff0000, v180
  v_cvt_pk_bf16_f32 v180, v176, v177
  v_lshlrev_b32 v176, 16, v180
  v_and_b32 v177, 0xffff0000, v180
  v_cvt_pk_bf16_f32 v180, v178, v179
  v_lshlrev_b32 v178, 16, v180
  v_and_b32 v179, 0xffff0000, v180
  v_lshlrev_b32 v182, 16, v124
  v_and_b32 v183, 0xffff0000, v124
  v_pk_mul_f32 v[172:173], v[172:173], v[182:183]
  v_lshlrev_b32 v182, 16, v125
  v_and_b32 v183, 0xffff0000, v125
  v_pk_mul_f32 v[174:175], v[174:175], v[182:183]
  v_lshlrev_b32 v182, 16, v126
  v_and_b32 v183, 0xffff0000, v126
  v_pk_mul_f32 v[176:177], v[176:177], v[182:183]
  v_lshlrev_b32 v182, 16, v127
  v_and_b32 v183, 0xffff0000, v127
  v_pk_mul_f32 v[178:179], v[178:179], v[182:183]
  v_cvt_pk_bf16_f32 v196, v172, v173
  v_cvt_pk_bf16_f32 v197, v174, v175
  v_cvt_pk_bf16_f32 v198, v176, v177
  v_cvt_pk_bf16_f32 v199, v178, v179
  ds_write_b128 v213, v[196:199] offset:10240
  v_accvgpr_read_b32 v184, a176
  v_accvgpr_read_b32 v185, a177
  v_accvgpr_read_b32 v186, a178
  v_accvgpr_read_b32 v187, a179
  v_cvt_pk_bf16_f32 v168, v184, v185
  v_cvt_pk_bf16_f32 v169, v186, v187
  v_accvgpr_read_b32 v188, a180
  v_accvgpr_read_b32 v189, a181
  v_accvgpr_read_b32 v190, a182
  v_accvgpr_read_b32 v191, a183
  v_cvt_pk_bf16_f32 v170, v188, v189
  v_cvt_pk_bf16_f32 v171, v190, v191
  s_nop 1
  v_permlane16_swap_b32 v168, v170
  v_permlane16_swap_b32 v169, v171
  v_lshlrev_b32 v172, 16, v168
  v_and_b32 v173, 0xffff0000, v168
  v_lshlrev_b32 v174, 16, v169
  v_and_b32 v175, 0xffff0000, v169
  v_lshlrev_b32 v176, 16, v170
  v_and_b32 v177, 0xffff0000, v170
  v_lshlrev_b32 v178, 16, v171
  v_and_b32 v179, 0xffff0000, v171
  v_pk_add_f32 v[172:173], v[172:173], v[210:211]
  v_pk_add_f32 v[174:175], v[174:175], v[210:211]
  v_pk_add_f32 v[176:177], v[176:177], v[210:211]
  v_pk_add_f32 v[178:179], v[178:179], v[210:211]
  v_cvt_pk_bf16_f32 v180, v172, v173
  v_lshlrev_b32 v172, 16, v180
  v_and_b32 v173, 0xffff0000, v180
  v_cvt_pk_bf16_f32 v180, v174, v175
  v_lshlrev_b32 v174, 16, v180
  v_and_b32 v175, 0xffff0000, v180
  v_cvt_pk_bf16_f32 v180, v176, v177
  v_lshlrev_b32 v176, 16, v180
  v_and_b32 v177, 0xffff0000, v180
  v_cvt_pk_bf16_f32 v180, v178, v179
  v_lshlrev_b32 v178, 16, v180
  v_and_b32 v179, 0xffff0000, v180
  v_lshlrev_b32 v182, 16, v128
  v_and_b32 v183, 0xffff0000, v128
  v_pk_mul_f32 v[172:173], v[172:173], v[182:183]
  v_lshlrev_b32 v182, 16, v129
  v_and_b32 v183, 0xffff0000, v129
  v_pk_mul_f32 v[174:175], v[174:175], v[182:183]
  v_lshlrev_b32 v182, 16, v130
  v_and_b32 v183, 0xffff0000, v130
  v_pk_mul_f32 v[176:177], v[176:177], v[182:183]
  v_lshlrev_b32 v182, 16, v131
  v_and_b32 v183, 0xffff0000, v131
  v_pk_mul_f32 v[178:179], v[178:179], v[182:183]
  v_cvt_pk_bf16_f32 v200, v172, v173
  v_cvt_pk_bf16_f32 v201, v174, v175
  v_cvt_pk_bf16_f32 v202, v176, v177
  v_cvt_pk_bf16_f32 v203, v178, v179
  ds_write_b128 v212, v[200:203] offset:26624
  v_accvgpr_read_b32 v184, a184
  v_accvgpr_read_b32 v185, a185
  v_accvgpr_read_b32 v186, a186
  v_accvgpr_read_b32 v187, a187
  v_cvt_pk_bf16_f32 v168, v184, v185
  v_cvt_pk_bf16_f32 v169, v186, v187
  v_accvgpr_read_b32 v188, a188
  v_accvgpr_read_b32 v189, a189
  v_accvgpr_read_b32 v190, a190
  v_accvgpr_read_b32 v191, a191
  v_cvt_pk_bf16_f32 v170, v188, v189
  v_cvt_pk_bf16_f32 v171, v190, v191
  s_nop 1
  v_permlane16_swap_b32 v168, v170
  v_permlane16_swap_b32 v169, v171
  v_lshlrev_b32 v172, 16, v168
  v_and_b32 v173, 0xffff0000, v168
  v_lshlrev_b32 v174, 16, v169
  v_and_b32 v175, 0xffff0000, v169
  v_lshlrev_b32 v176, 16, v170
  v_and_b32 v177, 0xffff0000, v170
  v_lshlrev_b32 v178, 16, v171
  v_and_b32 v179, 0xffff0000, v171
  v_pk_add_f32 v[172:173], v[172:173], v[210:211]
  v_pk_add_f32 v[174:175], v[174:175], v[210:211]
  v_pk_add_f32 v[176:177], v[176:177], v[210:211]
  v_pk_add_f32 v[178:179], v[178:179], v[210:211]
  v_cvt_pk_bf16_f32 v180, v172, v173
  v_lshlrev_b32 v172, 16, v180
  v_and_b32 v173, 0xffff0000, v180
  v_cvt_pk_bf16_f32 v180, v174, v175
  v_lshlrev_b32 v174, 16, v180
  v_and_b32 v175, 0xffff0000, v180
  v_cvt_pk_bf16_f32 v180, v176, v177
  v_lshlrev_b32 v176, 16, v180
  v_and_b32 v177, 0xffff0000, v180
  v_cvt_pk_bf16_f32 v180, v178, v179
  v_lshlrev_b32 v178, 16, v180
  v_and_b32 v179, 0xffff0000, v180
  v_lshlrev_b32 v182, 16, v132
  v_and_b32 v183, 0xffff0000, v132
  v_pk_mul_f32 v[172:173], v[172:173], v[182:183]
  v_lshlrev_b32 v182, 16, v133
  v_and_b32 v183, 0xffff0000, v133
  v_pk_mul_f32 v[174:175], v[174:175], v[182:183]
  v_lshlrev_b32 v182, 16, v134
  v_and_b32 v183, 0xffff0000, v134
  v_pk_mul_f32 v[176:177], v[176:177], v[182:183]
  v_lshlrev_b32 v182, 16, v135
  v_and_b32 v183, 0xffff0000, v135
  v_pk_mul_f32 v[178:179], v[178:179], v[182:183]
  v_cvt_pk_bf16_f32 v204, v172, v173
  v_cvt_pk_bf16_f32 v205, v174, v175
  v_cvt_pk_bf16_f32 v206, v176, v177
  v_cvt_pk_bf16_f32 v207, v178, v179
  ds_write_b128 v213, v[204:207] offset:26624
  s_waitcnt lgkmcnt(4)
  ds_read_b128 v[216:219], v214 offset:8192
  ds_read_b128 v[220:223], v214 offset:9216
  ds_read_b128 v[224:227], v214 offset:24576
  ds_read_b128 v[228:231], v214 offset:25600
  s_waitcnt lgkmcnt(0)
  s_add_u32 s40, s58, 8192
  buffer_store_dwordx4 v[216:219], v215, s[20:23], s40 offen offset:0 sc1
  buffer_store_dwordx4 v[220:223], v215, s[20:23], s40 offen offset:1024 sc1
  s_add_u32 s40, s58, 24576
  buffer_store_dwordx4 v[224:227], v215, s[20:23], s40 offen offset:0 sc1
  buffer_store_dwordx4 v[228:231], v215, s[20:23], s40 offen offset:1024 sc1
  s_waitcnt vmcnt(25)
  v_lshlrev_b32 v38, 16, v38
  v_mov_b32 v210, v38
  v_mov_b32 v211, v38
  s_add_u32 s37, s38, 442368
  v_accvgpr_read_b32 v184, a192
  v_accvgpr_read_b32 v185, a193
  v_accvgpr_read_b32 v186, a194
  v_accvgpr_read_b32 v187, a195
  v_cvt_pk_bf16_f32 v168, v184, v185
  v_cvt_pk_bf16_f32 v169, v186, v187
  v_accvgpr_read_b32 v188, a196
  v_accvgpr_read_b32 v189, a197
  v_accvgpr_read_b32 v190, a198
  v_accvgpr_read_b32 v191, a199
  v_cvt_pk_bf16_f32 v170, v188, v189
  v_cvt_pk_bf16_f32 v171, v190, v191
  s_nop 1
  v_permlane16_swap_b32 v168, v170
  v_permlane16_swap_b32 v169, v171
  v_lshlrev_b32 v172, 16, v168
  v_and_b32 v173, 0xffff0000, v168
  v_lshlrev_b32 v174, 16, v169
  v_and_b32 v175, 0xffff0000, v169
  v_lshlrev_b32 v176, 16, v170
  v_and_b32 v177, 0xffff0000, v170
  v_lshlrev_b32 v178, 16, v171
  v_and_b32 v179, 0xffff0000, v171
  v_pk_add_f32 v[172:173], v[172:173], v[210:211]
  v_pk_add_f32 v[174:175], v[174:175], v[210:211]
  v_pk_add_f32 v[176:177], v[176:177], v[210:211]
  v_pk_add_f32 v[178:179], v[178:179], v[210:211]
  v_cvt_pk_bf16_f32 v180, v172, v173
  v_lshlrev_b32 v172, 16, v180
  v_and_b32 v173, 0xffff0000, v180
  v_cvt_pk_bf16_f32 v180, v174, v175
  v_lshlrev_b32 v174, 16, v180
  v_and_b32 v175, 0xffff0000, v180
  v_cvt_pk_bf16_f32 v180, v176, v177
  v_lshlrev_b32 v176, 16, v180
  v_and_b32 v177, 0xffff0000, v180
  v_cvt_pk_bf16_f32 v180, v178, v179
  v_lshlrev_b32 v178, 16, v180
  v_and_b32 v179, 0xffff0000, v180
  v_lshlrev_b32 v182, 16, v136
  v_and_b32 v183, 0xffff0000, v136
  v_pk_mul_f32 v[172:173], v[172:173], v[182:183]
  v_lshlrev_b32 v182, 16, v137
  v_and_b32 v183, 0xffff0000, v137
  v_pk_mul_f32 v[174:175], v[174:175], v[182:183]
  v_lshlrev_b32 v182, 16, v138
  v_and_b32 v183, 0xffff0000, v138
  v_pk_mul_f32 v[176:177], v[176:177], v[182:183]
  v_lshlrev_b32 v182, 16, v139
  v_and_b32 v183, 0xffff0000, v139
  v_pk_mul_f32 v[178:179], v[178:179], v[182:183]
  v_cvt_pk_bf16_f32 v192, v172, v173
  v_cvt_pk_bf16_f32 v193, v174, v175
  v_cvt_pk_bf16_f32 v194, v176, v177
  v_cvt_pk_bf16_f32 v195, v178, v179
  ds_write_b128 v212, v[192:195] offset:12288
  v_accvgpr_read_b32 v184, a200
  v_accvgpr_read_b32 v185, a201
  v_accvgpr_read_b32 v186, a202
  v_accvgpr_read_b32 v187, a203
  v_cvt_pk_bf16_f32 v168, v184, v185
  v_cvt_pk_bf16_f32 v169, v186, v187
  v_accvgpr_read_b32 v188, a204
  v_accvgpr_read_b32 v189, a205
  v_accvgpr_read_b32 v190, a206
  v_accvgpr_read_b32 v191, a207
  v_cvt_pk_bf16_f32 v170, v188, v189
  v_cvt_pk_bf16_f32 v171, v190, v191
  s_nop 1
  v_permlane16_swap_b32 v168, v170
  v_permlane16_swap_b32 v169, v171
  v_lshlrev_b32 v172, 16, v168
  v_and_b32 v173, 0xffff0000, v168
  v_lshlrev_b32 v174, 16, v169
  v_and_b32 v175, 0xffff0000, v169
  v_lshlrev_b32 v176, 16, v170
  v_and_b32 v177, 0xffff0000, v170
  v_lshlrev_b32 v178, 16, v171
  v_and_b32 v179, 0xffff0000, v171
  v_pk_add_f32 v[172:173], v[172:173], v[210:211]
  v_pk_add_f32 v[174:175], v[174:175], v[210:211]
  v_pk_add_f32 v[176:177], v[176:177], v[210:211]
  v_pk_add_f32 v[178:179], v[178:179], v[210:211]
  v_cvt_pk_bf16_f32 v180, v172, v173
  v_lshlrev_b32 v172, 16, v180
  v_and_b32 v173, 0xffff0000, v180
  v_cvt_pk_bf16_f32 v180, v174, v175
  v_lshlrev_b32 v174, 16, v180
  v_and_b32 v175, 0xffff0000, v180
  v_cvt_pk_bf16_f32 v180, v176, v177
  v_lshlrev_b32 v176, 16, v180
  v_and_b32 v177, 0xffff0000, v180
  v_cvt_pk_bf16_f32 v180, v178, v179
  v_lshlrev_b32 v178, 16, v180
  v_and_b32 v179, 0xffff0000, v180
  v_lshlrev_b32 v182, 16, v140
  v_and_b32 v183, 0xffff0000, v140
  v_pk_mul_f32 v[172:173], v[172:173], v[182:183]
  v_lshlrev_b32 v182, 16, v141
  v_and_b32 v183, 0xffff0000, v141
  v_pk_mul_f32 v[174:175], v[174:175], v[182:183]
  v_lshlrev_b32 v182, 16, v142
  v_and_b32 v183, 0xffff0000, v142
  v_pk_mul_f32 v[176:177], v[176:177], v[182:183]
  v_lshlrev_b32 v182, 16, v143
  v_and_b32 v183, 0xffff0000, v143
  v_pk_mul_f32 v[178:179], v[178:179], v[182:183]
  v_cvt_pk_bf16_f32 v196, v172, v173
  v_cvt_pk_bf16_f32 v197, v174, v175
  v_cvt_pk_bf16_f32 v198, v176, v177
  v_cvt_pk_bf16_f32 v199, v178, v179
  ds_write_b128 v213, v[196:199] offset:12288
  v_accvgpr_read_b32 v184, a208
  v_accvgpr_read_b32 v185, a209
  v_accvgpr_read_b32 v186, a210
  v_accvgpr_read_b32 v187, a211
  v_cvt_pk_bf16_f32 v168, v184, v185
  v_cvt_pk_bf16_f32 v169, v186, v187
  v_accvgpr_read_b32 v188, a212
  v_accvgpr_read_b32 v189, a213
  v_accvgpr_read_b32 v190, a214
  v_accvgpr_read_b32 v191, a215
  v_cvt_pk_bf16_f32 v170, v188, v189
  v_cvt_pk_bf16_f32 v171, v190, v191
  s_nop 1
  v_permlane16_swap_b32 v168, v170
  v_permlane16_swap_b32 v169, v171
  v_lshlrev_b32 v172, 16, v168
  v_and_b32 v173, 0xffff0000, v168
  v_lshlrev_b32 v174, 16, v169
  v_and_b32 v175, 0xffff0000, v169
  v_lshlrev_b32 v176, 16, v170
  v_and_b32 v177, 0xffff0000, v170
  v_lshlrev_b32 v178, 16, v171
  v_and_b32 v179, 0xffff0000, v171
  v_pk_add_f32 v[172:173], v[172:173], v[210:211]
  v_pk_add_f32 v[174:175], v[174:175], v[210:211]
  v_pk_add_f32 v[176:177], v[176:177], v[210:211]
  v_pk_add_f32 v[178:179], v[178:179], v[210:211]
  v_cvt_pk_bf16_f32 v180, v172, v173
  v_lshlrev_b32 v172, 16, v180
  v_and_b32 v173, 0xffff0000, v180
  v_cvt_pk_bf16_f32 v180, v174, v175
  v_lshlrev_b32 v174, 16, v180
  v_and_b32 v175, 0xffff0000, v180
  v_cvt_pk_bf16_f32 v180, v176, v177
  v_lshlrev_b32 v176, 16, v180
  v_and_b32 v177, 0xffff0000, v180
  v_cvt_pk_bf16_f32 v180, v178, v179
  v_lshlrev_b32 v178, 16, v180
  v_and_b32 v179, 0xffff0000, v180
  v_lshlrev_b32 v182, 16, v144
  v_and_b32 v183, 0xffff0000, v144
  v_pk_mul_f32 v[172:173], v[172:173], v[182:183]
  v_lshlrev_b32 v182, 16, v145
  v_and_b32 v183, 0xffff0000, v145
  v_pk_mul_f32 v[174:175], v[174:175], v[182:183]
  v_lshlrev_b32 v182, 16, v146
  v_and_b32 v183, 0xffff0000, v146
  v_pk_mul_f32 v[176:177], v[176:177], v[182:183]
  v_lshlrev_b32 v182, 16, v147
  v_and_b32 v183, 0xffff0000, v147
  v_pk_mul_f32 v[178:179], v[178:179], v[182:183]
  v_cvt_pk_bf16_f32 v200, v172, v173
  v_cvt_pk_bf16_f32 v201, v174, v175
  v_cvt_pk_bf16_f32 v202, v176, v177
  v_cvt_pk_bf16_f32 v203, v178, v179
  ds_write_b128 v212, v[200:203] offset:28672
  v_accvgpr_read_b32 v184, a216
  v_accvgpr_read_b32 v185, a217
  v_accvgpr_read_b32 v186, a218
  v_accvgpr_read_b32 v187, a219
  v_cvt_pk_bf16_f32 v168, v184, v185
  v_cvt_pk_bf16_f32 v169, v186, v187
  v_accvgpr_read_b32 v188, a220
  v_accvgpr_read_b32 v189, a221
  v_accvgpr_read_b32 v190, a222
  v_accvgpr_read_b32 v191, a223
  v_cvt_pk_bf16_f32 v170, v188, v189
  v_cvt_pk_bf16_f32 v171, v190, v191
  s_nop 1
  v_permlane16_swap_b32 v168, v170
  v_permlane16_swap_b32 v169, v171
  v_lshlrev_b32 v172, 16, v168
  v_and_b32 v173, 0xffff0000, v168
  v_lshlrev_b32 v174, 16, v169
  v_and_b32 v175, 0xffff0000, v169
  v_lshlrev_b32 v176, 16, v170
  v_and_b32 v177, 0xffff0000, v170
  v_lshlrev_b32 v178, 16, v171
  v_and_b32 v179, 0xffff0000, v171
  v_pk_add_f32 v[172:173], v[172:173], v[210:211]
  v_pk_add_f32 v[174:175], v[174:175], v[210:211]
  v_pk_add_f32 v[176:177], v[176:177], v[210:211]
  v_pk_add_f32 v[178:179], v[178:179], v[210:211]
  v_cvt_pk_bf16_f32 v180, v172, v173
  v_lshlrev_b32 v172, 16, v180
  v_and_b32 v173, 0xffff0000, v180
  v_cvt_pk_bf16_f32 v180, v174, v175
  v_lshlrev_b32 v174, 16, v180
  v_and_b32 v175, 0xffff0000, v180
  v_cvt_pk_bf16_f32 v180, v176, v177
  v_lshlrev_b32 v176, 16, v180
  v_and_b32 v177, 0xffff0000, v180
  v_cvt_pk_bf16_f32 v180, v178, v179
  v_lshlrev_b32 v178, 16, v180
  v_and_b32 v179, 0xffff0000, v180
  v_lshlrev_b32 v182, 16, v148
  v_and_b32 v183, 0xffff0000, v148
  v_pk_mul_f32 v[172:173], v[172:173], v[182:183]
  v_lshlrev_b32 v182, 16, v149
  v_and_b32 v183, 0xffff0000, v149
  v_pk_mul_f32 v[174:175], v[174:175], v[182:183]
  v_lshlrev_b32 v182, 16, v150
  v_and_b32 v183, 0xffff0000, v150
  v_pk_mul_f32 v[176:177], v[176:177], v[182:183]
  v_lshlrev_b32 v182, 16, v151
  v_and_b32 v183, 0xffff0000, v151
  v_pk_mul_f32 v[178:179], v[178:179], v[182:183]
  v_cvt_pk_bf16_f32 v204, v172, v173
  v_cvt_pk_bf16_f32 v205, v174, v175
  v_cvt_pk_bf16_f32 v206, v176, v177
  v_cvt_pk_bf16_f32 v207, v178, v179
  ds_write_b128 v213, v[204:207] offset:28672
  s_waitcnt lgkmcnt(4)
  ds_read_b128 v[216:219], v214 offset:10240
  ds_read_b128 v[220:223], v214 offset:11264
  ds_read_b128 v[224:227], v214 offset:26624
  ds_read_b128 v[228:231], v214 offset:27648
  s_waitcnt lgkmcnt(0)
  s_add_u32 s40, s58, 10240
  buffer_store_dwordx4 v[216:219], v215, s[20:23], s40 offen offset:0 sc1
  buffer_store_dwordx4 v[220:223], v215, s[20:23], s40 offen offset:1024 sc1
  s_add_u32 s40, s58, 26624
  buffer_store_dwordx4 v[224:227], v215, s[20:23], s40 offen offset:0 sc1
  buffer_store_dwordx4 v[228:231], v215, s[20:23], s40 offen offset:1024 sc1
  s_waitcnt vmcnt(24)
  v_lshlrev_b32 v39, 16, v39
  v_mov_b32 v210, v39
  v_mov_b32 v211, v39
  s_add_u32 s37, s38, 516096
  v_accvgpr_read_b32 v184, a224
  v_accvgpr_read_b32 v185, a225
  v_accvgpr_read_b32 v186, a226
  v_accvgpr_read_b32 v187, a227
  v_cvt_pk_bf16_f32 v168, v184, v185
  v_cvt_pk_bf16_f32 v169, v186, v187
  v_accvgpr_read_b32 v188, a228
  v_accvgpr_read_b32 v189, a229
  v_accvgpr_read_b32 v190, a230
  v_accvgpr_read_b32 v191, a231
  v_cvt_pk_bf16_f32 v170, v188, v189
  v_cvt_pk_bf16_f32 v171, v190, v191
  s_nop 1
  v_permlane16_swap_b32 v168, v170
  v_permlane16_swap_b32 v169, v171
  v_lshlrev_b32 v172, 16, v168
  v_and_b32 v173, 0xffff0000, v168
  v_lshlrev_b32 v174, 16, v169
  v_and_b32 v175, 0xffff0000, v169
  v_lshlrev_b32 v176, 16, v170
  v_and_b32 v177, 0xffff0000, v170
  v_lshlrev_b32 v178, 16, v171
  v_and_b32 v179, 0xffff0000, v171
  v_pk_add_f32 v[172:173], v[172:173], v[210:211]
  v_pk_add_f32 v[174:175], v[174:175], v[210:211]
  v_pk_add_f32 v[176:177], v[176:177], v[210:211]
  v_pk_add_f32 v[178:179], v[178:179], v[210:211]
  v_cvt_pk_bf16_f32 v180, v172, v173
  v_lshlrev_b32 v172, 16, v180
  v_and_b32 v173, 0xffff0000, v180
  v_cvt_pk_bf16_f32 v180, v174, v175
  v_lshlrev_b32 v174, 16, v180
  v_and_b32 v175, 0xffff0000, v180
  v_cvt_pk_bf16_f32 v180, v176, v177
  v_lshlrev_b32 v176, 16, v180
  v_and_b32 v177, 0xffff0000, v180
  v_cvt_pk_bf16_f32 v180, v178, v179
  v_lshlrev_b32 v178, 16, v180
  v_and_b32 v179, 0xffff0000, v180
  v_lshlrev_b32 v182, 16, v152
  v_and_b32 v183, 0xffff0000, v152
  v_pk_mul_f32 v[172:173], v[172:173], v[182:183]
  v_lshlrev_b32 v182, 16, v153
  v_and_b32 v183, 0xffff0000, v153
  v_pk_mul_f32 v[174:175], v[174:175], v[182:183]
  v_lshlrev_b32 v182, 16, v154
  v_and_b32 v183, 0xffff0000, v154
  v_pk_mul_f32 v[176:177], v[176:177], v[182:183]
  v_lshlrev_b32 v182, 16, v155
  v_and_b32 v183, 0xffff0000, v155
  v_pk_mul_f32 v[178:179], v[178:179], v[182:183]
  v_cvt_pk_bf16_f32 v192, v172, v173
  v_cvt_pk_bf16_f32 v193, v174, v175
  v_cvt_pk_bf16_f32 v194, v176, v177
  v_cvt_pk_bf16_f32 v195, v178, v179
  ds_write_b128 v212, v[192:195] offset:14336
  v_accvgpr_read_b32 v184, a232
  v_accvgpr_read_b32 v185, a233
  v_accvgpr_read_b32 v186, a234
  v_accvgpr_read_b32 v187, a235
  v_cvt_pk_bf16_f32 v168, v184, v185
  v_cvt_pk_bf16_f32 v169, v186, v187
  v_accvgpr_read_b32 v188, a236
  v_accvgpr_read_b32 v189, a237
  v_accvgpr_read_b32 v190, a238
  v_accvgpr_read_b32 v191, a239
  v_cvt_pk_bf16_f32 v170, v188, v189
  v_cvt_pk_bf16_f32 v171, v190, v191
  s_nop 1
  v_permlane16_swap_b32 v168, v170
  v_permlane16_swap_b32 v169, v171
  v_lshlrev_b32 v172, 16, v168
  v_and_b32 v173, 0xffff0000, v168
  v_lshlrev_b32 v174, 16, v169
  v_and_b32 v175, 0xffff0000, v169
  v_lshlrev_b32 v176, 16, v170
  v_and_b32 v177, 0xffff0000, v170
  v_lshlrev_b32 v178, 16, v171
  v_and_b32 v179, 0xffff0000, v171
  v_pk_add_f32 v[172:173], v[172:173], v[210:211]
  v_pk_add_f32 v[174:175], v[174:175], v[210:211]
  v_pk_add_f32 v[176:177], v[176:177], v[210:211]
  v_pk_add_f32 v[178:179], v[178:179], v[210:211]
  v_cvt_pk_bf16_f32 v180, v172, v173
  v_lshlrev_b32 v172, 16, v180
  v_and_b32 v173, 0xffff0000, v180
  v_cvt_pk_bf16_f32 v180, v174, v175
  v_lshlrev_b32 v174, 16, v180
  v_and_b32 v175, 0xffff0000, v180
  v_cvt_pk_bf16_f32 v180, v176, v177
  v_lshlrev_b32 v176, 16, v180
  v_and_b32 v177, 0xffff0000, v180
  v_cvt_pk_bf16_f32 v180, v178, v179
  v_lshlrev_b32 v178, 16, v180
  v_and_b32 v179, 0xffff0000, v180
  v_lshlrev_b32 v182, 16, v156
  v_and_b32 v183, 0xffff0000, v156
  v_pk_mul_f32 v[172:173], v[172:173], v[182:183]
  v_lshlrev_b32 v182, 16, v157
  v_and_b32 v183, 0xffff0000, v157
  v_pk_mul_f32 v[174:175], v[174:175], v[182:183]
  v_lshlrev_b32 v182, 16, v158
  v_and_b32 v183, 0xffff0000, v158
  v_pk_mul_f32 v[176:177], v[176:177], v[182:183]
  v_lshlrev_b32 v182, 16, v159
  v_and_b32 v183, 0xffff0000, v159
  v_pk_mul_f32 v[178:179], v[178:179], v[182:183]
  v_cvt_pk_bf16_f32 v196, v172, v173
  v_cvt_pk_bf16_f32 v197, v174, v175
  v_cvt_pk_bf16_f32 v198, v176, v177
  v_cvt_pk_bf16_f32 v199, v178, v179
  ds_write_b128 v213, v[196:199] offset:14336
  v_accvgpr_read_b32 v184, a240
  v_accvgpr_read_b32 v185, a241
  v_accvgpr_read_b32 v186, a242
  v_accvgpr_read_b32 v187, a243
  v_cvt_pk_bf16_f32 v168, v184, v185
  v_cvt_pk_bf16_f32 v169, v186, v187
  v_accvgpr_read_b32 v188, a244
  v_accvgpr_read_b32 v189, a245
  v_accvgpr_read_b32 v190, a246
  v_accvgpr_read_b32 v191, a247
  v_cvt_pk_bf16_f32 v170, v188, v189
  v_cvt_pk_bf16_f32 v171, v190, v191
  s_nop 1
  v_permlane16_swap_b32 v168, v170
  v_permlane16_swap_b32 v169, v171
  v_lshlrev_b32 v172, 16, v168
  v_and_b32 v173, 0xffff0000, v168
  v_lshlrev_b32 v174, 16, v169
  v_and_b32 v175, 0xffff0000, v169
  v_lshlrev_b32 v176, 16, v170
  v_and_b32 v177, 0xffff0000, v170
  v_lshlrev_b32 v178, 16, v171
  v_and_b32 v179, 0xffff0000, v171
  v_pk_add_f32 v[172:173], v[172:173], v[210:211]
  v_pk_add_f32 v[174:175], v[174:175], v[210:211]
  v_pk_add_f32 v[176:177], v[176:177], v[210:211]
  v_pk_add_f32 v[178:179], v[178:179], v[210:211]
  v_cvt_pk_bf16_f32 v180, v172, v173
  v_lshlrev_b32 v172, 16, v180
  v_and_b32 v173, 0xffff0000, v180
  v_cvt_pk_bf16_f32 v180, v174, v175
  v_lshlrev_b32 v174, 16, v180
  v_and_b32 v175, 0xffff0000, v180
  v_cvt_pk_bf16_f32 v180, v176, v177
  v_lshlrev_b32 v176, 16, v180
  v_and_b32 v177, 0xffff0000, v180
  v_cvt_pk_bf16_f32 v180, v178, v179
  v_lshlrev_b32 v178, 16, v180
  v_and_b32 v179, 0xffff0000, v180
  v_lshlrev_b32 v182, 16, v160
  v_and_b32 v183, 0xffff0000, v160
  v_pk_mul_f32 v[172:173], v[172:173], v[182:183]
  v_lshlrev_b32 v182, 16, v161
  v_and_b32 v183, 0xffff0000, v161
  v_pk_mul_f32 v[174:175], v[174:175], v[182:183]
  v_lshlrev_b32 v182, 16, v162
  v_and_b32 v183, 0xffff0000, v162
  v_pk_mul_f32 v[176:177], v[176:177], v[182:183]
  v_lshlrev_b32 v182, 16, v163
  v_and_b32 v183, 0xffff0000, v163
  v_pk_mul_f32 v[178:179], v[178:179], v[182:183]
  v_cvt_pk_bf16_f32 v200, v172, v173
  v_cvt_pk_bf16_f32 v201, v174, v175
  v_cvt_pk_bf16_f32 v202, v176, v177
  v_cvt_pk_bf16_f32 v203, v178, v179
  ds_write_b128 v212, v[200:203] offset:30720
  v_accvgpr_read_b32 v184, a248
  v_accvgpr_read_b32 v185, a249
  v_accvgpr_read_b32 v186, a250
  v_accvgpr_read_b32 v187, a251
  v_cvt_pk_bf16_f32 v168, v184, v185
  v_cvt_pk_bf16_f32 v169, v186, v187
  v_accvgpr_read_b32 v188, a252
  v_accvgpr_read_b32 v189, a253
  v_accvgpr_read_b32 v190, a254
  v_accvgpr_read_b32 v191, a255
  v_cvt_pk_bf16_f32 v170, v188, v189
  v_cvt_pk_bf16_f32 v171, v190, v191
  s_nop 1
  v_permlane16_swap_b32 v168, v170
  v_permlane16_swap_b32 v169, v171
  v_lshlrev_b32 v172, 16, v168
  v_and_b32 v173, 0xffff0000, v168
  v_lshlrev_b32 v174, 16, v169
  v_and_b32 v175, 0xffff0000, v169
  v_lshlrev_b32 v176, 16, v170
  v_and_b32 v177, 0xffff0000, v170
  v_lshlrev_b32 v178, 16, v171
  v_and_b32 v179, 0xffff0000, v171
  v_pk_add_f32 v[172:173], v[172:173], v[210:211]
  v_pk_add_f32 v[174:175], v[174:175], v[210:211]
  v_pk_add_f32 v[176:177], v[176:177], v[210:211]
  v_pk_add_f32 v[178:179], v[178:179], v[210:211]
  v_cvt_pk_bf16_f32 v180, v172, v173
  v_lshlrev_b32 v172, 16, v180
  v_and_b32 v173, 0xffff0000, v180
  v_cvt_pk_bf16_f32 v180, v174, v175
  v_lshlrev_b32 v174, 16, v180
  v_and_b32 v175, 0xffff0000, v180
  v_cvt_pk_bf16_f32 v180, v176, v177
  v_lshlrev_b32 v176, 16, v180
  v_and_b32 v177, 0xffff0000, v180
  v_cvt_pk_bf16_f32 v180, v178, v179
  v_lshlrev_b32 v178, 16, v180
  v_and_b32 v179, 0xffff0000, v180
  v_lshlrev_b32 v182, 16, v164
  v_and_b32 v183, 0xffff0000, v164
  v_pk_mul_f32 v[172:173], v[172:173], v[182:183]
  v_lshlrev_b32 v182, 16, v165
  v_and_b32 v183, 0xffff0000, v165
  v_pk_mul_f32 v[174:175], v[174:175], v[182:183]
  v_lshlrev_b32 v182, 16, v166
  v_and_b32 v183, 0xffff0000, v166
  v_pk_mul_f32 v[176:177], v[176:177], v[182:183]
  v_lshlrev_b32 v182, 16, v167
  v_and_b32 v183, 0xffff0000, v167
  v_pk_mul_f32 v[178:179], v[178:179], v[182:183]
  v_cvt_pk_bf16_f32 v204, v172, v173
  v_cvt_pk_bf16_f32 v205, v174, v175
  v_cvt_pk_bf16_f32 v206, v176, v177
  v_cvt_pk_bf16_f32 v207, v178, v179
  ds_write_b128 v213, v[204:207] offset:30720
  s_waitcnt lgkmcnt(4)
  ds_read_b128 v[216:219], v214 offset:12288
  ds_read_b128 v[220:223], v214 offset:13312
  ds_read_b128 v[224:227], v214 offset:28672
  ds_read_b128 v[228:231], v214 offset:29696
  s_waitcnt lgkmcnt(0)
  s_add_u32 s40, s58, 12288
  buffer_store_dwordx4 v[216:219], v215, s[20:23], s40 offen offset:0 sc1
  buffer_store_dwordx4 v[220:223], v215, s[20:23], s40 offen offset:1024 sc1
  s_add_u32 s40, s58, 28672
  buffer_store_dwordx4 v[224:227], v215, s[20:23], s40 offen offset:0 sc1
  buffer_store_dwordx4 v[228:231], v215, s[20:23], s40 offen offset:1024 sc1
  s_waitcnt lgkmcnt(0)
  ds_read_b128 v[216:219], v214 offset:14336
  ds_read_b128 v[220:223], v214 offset:15360
  ds_read_b128 v[224:227], v214 offset:30720
  ds_read_b128 v[228:231], v214 offset:31744
  s_waitcnt lgkmcnt(0)
  s_add_u32 s40, s58, 14336
  buffer_store_dwordx4 v[216:219], v215, s[20:23], s40 offen offset:0 sc1
  buffer_store_dwordx4 v[220:223], v215, s[20:23], s40 offen offset:1024 sc1
  s_add_u32 s40, s58, 30720
  buffer_store_dwordx4 v[224:227], v215, s[20:23], s40 offen offset:0 sc1
  buffer_store_dwordx4 v[228:231], v215, s[20:23], s40 offen offset:1024 sc1
Lmg_we1_73:
  s_waitcnt vmcnt(0)
  s_barrier
  s_cmp_lg_u32 s3, 0
  s_cbranch_scc1 Ls_skip_79
  s_lshl_b32 s50, s92, 7
  s_add_u32 s50, s50, 23552
  v_mov_b32 v2, 1
  s_mov_b64 exec, 1
  buffer_atomic_add v2, off, s[88:91], s50
  s_mov_b64 exec, -1
Ls_skip_79:
  s_branch Lmg_next_3
Lmg_wout_24:
  s_getreg_b32 s84, hwreg(HW_REG_XCC_ID)
  s_and_b32 s84, s84, 7
  s_mov_b32 s85, 0
Lmg_wl_80:
  s_add_u32 s87, s84, s85
  s_and_b32 s87, s87, 7
  s_cmp_eq_u32 s85, 0
  s_cbranch_scc1 Lmg_ns_81
  s_cmp_lg_u32 s3, 0
  s_cbranch_scc1 Lw_skip_82
  s_mov_b64 exec, 1
  s_lshl_b32 s50, s87, 7
  s_add_u32 s50, s50, 23552
  s_mov_b32 s52, 0
Lw_lp_83:
  buffer_load_dword v2, off, s[88:91], s50 sc1
  s_waitcnt vmcnt(0)
  v_readfirstlane_b32 s51, v2
  s_add_u32 s52, s52, 1
  s_cmp_gt_u32 s52, 2000000
  s_cbranch_scc1 Lw_lp_83_x
  s_cmp_ge_u32 s51, 9
  s_cbranch_scc1 Lw_lp_83_x
  s_sleep 4
  s_branch Lw_lp_83
Lw_lp_83_x:
  s_mov_b64 exec, -1
Lw_skip_82:
  s_barrier
Lmg_ns_81:
  s_lshl_b32 s50, s87, 7
  s_add_u32 s50, s50, 34816
  s_barrier
  s_cmp_lg_u32 s3, 0
  s_cbranch_scc1 Lmg_tk_84
  v_mov_b32 v2, 1
  s_mov_b64 exec, 1
  buffer_atomic_add v2, off, s[88:91], s50 sc0
  s_waitcnt vmcnt(0)
  v_mov_b32 v3, 163824
  ds_write_b32 v3, v2
  s_waitcnt lgkmcnt(0)
  s_mov_b64 exec, -1
Lmg_tk_84:
  s_barrier
  v_mov_b32 v3, 163824
  ds_read_b32 v2, v3
  s_waitcnt lgkmcnt(0)
  v_readfirstlane_b32 s96, v2
  s_nop 3
  s_cmp_lt_u32 s96, 18
  s_cbranch_scc1 Lmg_wt_85
  s_add_u32 s85, s85, 1
  s_cmp_lt_u32 s85, 8
  s_cbranch_scc1 Lmg_wl_80
  s_branch Lmg_done_1
Lmg_wt_85:
  s_cmp_ge_u32 s96, 9
  s_cselect_b32 s30, 1, 0
  s_lshl_b32 s92, s87, 1
  s_add_u32 s92, s92, s30
  s_mul_i32 s30, s30, 9
  s_sub_u32 s93, s96, s30
  s_cmp_lg_u32 s3, 0
  s_cbranch_scc1 Lw_skip_88
  s_mov_b64 exec, 1
  s_mov_b32 s50, 23424
  s_mov_b32 s52, 0
Lw_lp_89:
  buffer_load_dword v2, off, s[88:91], s50 sc1
  s_waitcnt vmcnt(0)
  v_readfirstlane_b32 s51, v2
  s_add_u32 s52, s52, 1
  s_cmp_gt_u32 s52, 2000000
  s_cbranch_scc1 Lw_lp_89_x
  s_cmp_ge_u32 s51, 16
  s_cbranch_scc1 Lw_lp_89_x
  s_sleep 4
  s_branch Lw_lp_89
Lw_lp_89_x:
  s_mov_b64 exec, -1
Lw_skip_88:
  s_barrier
  s_getpc_b64 s[60:61]
Lpc_90:
  s_add_u32 s60, s60, Lmg_wo0_86-Lpc_90
  s_addc_u32 s61, s61, 0
  v_mbcnt_lo_u32_b32 v254, -1, 0
  v_mbcnt_hi_u32_b32 v254, -1, v254
  v_lshlrev_b32 v254, 7, v254
  s_lshl_b32 s62, s3, 13
  v_add_u32 v254, s62, v254
  v_min_u32 v254, Lmg_wo1_87-Lmg_wo0_86-4, v254
  global_load_dword v255, v254, s[60:61]
  s_load_dwordx2 s[4:5], s[0:1], 88
  s_waitcnt lgkmcnt(0)
  s_mov_b32 s16, s4
  s_mov_b32 s17, s5
  s_mov_b32 s18, 0x288000
  s_mov_b32 s19, 0x20000
  v_and_b32 v1, 63, v0
  v_lshrrev_b32 v2, 3, v1
  v_mul_u32_u24 v2, 1152, v2
  v_and_b32 v3, 7, v1
  v_lshl_add_u32 v2, v3, 4, v2
  s_and_b32 s40, s92, 1
  s_lshl_b32 s40, s40, 2
  s_add_u32 s40, s40, s3
  s_mul_i32 s40, s40, 331776
  s_lshl_b32 s41, s93, 7
  s_add_u32 s40, s40, s41
  buffer_load_dwordx4 v[248:251], v2, s[16:19], s40 offen
  s_add_u32 s40, s40, 9216
  buffer_load_dwordx4 v[248:251], v2, s[16:19], s40 offen
  s_add_u32 s40, s40, 9216
  buffer_load_dwordx4 v[248:251], v2, s[16:19], s40 offen
  s_add_u32 s40, s40, 9216
  buffer_load_dwordx4 v[248:251], v2, s[16:19], s40 offen
  s_add_u32 s40, s40, 9216
  buffer_load_dwordx4 v[248:251], v2, s[16:19], s40 offen
  s_add_u32 s40, s40, 9216
  buffer_load_dwordx4 v[248:251], v2, s[16:19], s40 offen
  s_add_u32 s40, s40, 9216
  buffer_load_dwordx4 v[248:251], v2, s[16:19], s40 offen
  s_add_u32 s40, s40, 9216
  buffer_load_dwordx4 v[248:251], v2, s[16:19], s40 offen
  s_add_u32 s40, s40, 9216
  buffer_load_dwordx4 v[248:251], v2, s[16:19], s40 offen
  s_add_u32 s40, s40, 9216
  buffer_load_dwordx4 v[248:251], v2, s[16:19], s40 offen
  s_add_u32 s40, s40, 9216
  buffer_load_dwordx4 v[248:251], v2, s[16:19], s40 offen
  s_add_u32 s40, s40, 9216
  buffer_load_dwordx4 v[248:251], v2, s[16:19], s40 offen
  s_add_u32 s40, s40, 9216
  buffer_load_dwordx4 v[248:251], v2, s[16:19], s40 offen
  s_add_u32 s40, s40, 9216
  buffer_load_dwordx4 v[248:251], v2, s[16:19], s40 offen
  s_add_u32 s40, s40, 9216
  buffer_load_dwordx4 v[248:251], v2, s[16:19], s40 offen
  s_add_u32 s40, s40, 9216
  buffer_load_dwordx4 v[248:251], v2, s[16:19], s40 offen
  s_add_u32 s40, s40, 9216
  buffer_load_dwordx4 v[248:251], v2, s[16:19], s40 offen
  s_add_u32 s40, s40, 9216
  buffer_load_dwordx4 v[248:251], v2, s[16:19], s40 offen
  s_add_u32 s40, s40, 9216
  buffer_load_dwordx4 v[248:251], v2, s[16:19], s40 offen
  s_add_u32 s40, s40, 9216
  buffer_load_dwordx4 v[248:251], v2, s[16:19], s40 offen
  s_add_u32 s40, s40, 9216
  buffer_load_dwordx4 v[248:251], v2, s[16:19], s40 offen
  s_add_u32 s40, s40, 9216
  buffer_load_dwordx4 v[248:251], v2, s[16:19], s40 offen
  s_add_u32 s40, s40, 9216
  buffer_load_dwordx4 v[248:251], v2, s[16:19], s40 offen
  s_add_u32 s40, s40, 9216
  buffer_load_dwordx4 v[248:251], v2, s[16:19], s40 offen
  s_add_u32 s40, s40, 9216
  buffer_load_dwordx4 v[248:251], v2, s[16:19], s40 offen
  s_add_u32 s40, s40, 9216
  buffer_load_dwordx4 v[248:251], v2, s[16:19], s40 offen
  s_add_u32 s40, s40, 9216
  buffer_load_dwordx4 v[248:251], v2, s[16:19], s40 offen
  s_add_u32 s40, s40, 9216
  buffer_load_dwordx4 v[248:251], v2, s[16:19], s40 offen
  s_add_u32 s40, s40, 9216
  buffer_load_dwordx4 v[248:251], v2, s[16:19], s40 offen
  s_add_u32 s40, s40, 9216
  buffer_load_dwordx4 v[248:251], v2, s[16:19], s40 offen
  s_add_u32 s40, s40, 9216
  buffer_load_dwordx4 v[248:251], v2, s[16:19], s40 offen
  s_add_u32 s40, s40, 9216
  buffer_load_dwordx4 v[248:251], v2, s[16:19], s40 offen
  s_add_u32 s40, s40, 9216
  buffer_load_dwordx4 v[248:251], v2, s[16:19], s40 offen
  s_add_u32 s40, s40, 9216
  buffer_load_dwordx4 v[248:251], v2, s[16:19], s40 offen
  s_add_u32 s40, s40, 9216
  buffer_load_dwordx4 v[248:251], v2, s[16:19], s40 offen
  s_add_u32 s40, s40, 9216
  buffer_load_dwordx4 v[248:251], v2, s[16:19], s40 offen
  s_add_u32 s40, s40, 9216
  s_cmp_lg_u32 s3, 0
  s_cbranch_scc1 Lw_skip_91
  s_mov_b64 exec, 1
  s_lshl_b32 s50, s87, 7
  s_add_u32 s50, s50, 23552
  s_mov_b32 s52, 0
Lw_lp_92:
  buffer_load_dword v2, off, s[88:91], s50 sc1
  s_waitcnt vmcnt(0)
  v_readfirstlane_b32 s51, v2
  s_add_u32 s52, s52, 1
  s_cmp_gt_u32 s52, 2000000
  s_cbranch_scc1 Lw_lp_92_x
  s_cmp_ge_u32 s51, 9
  s_cbranch_scc1 Lw_lp_92_x
  s_sleep 4
  s_branch Lw_lp_92
Lw_lp_92_x:
  s_mov_b64 exec, -1
Lw_skip_91:
  s_barrier
Lmg_wo0_86:
  s_mov_b32 s10, s98
  s_mov_b32 s11, s99
  s_mov_b32 s32, s92
  s_mov_b32 s36, s93
  s_load_dwordx2 s[4:5], s[0:1], 88
  s_load_dwordx2 s[8:9], s[0:1], 112
  s_waitcnt lgkmcnt(0)
  s_add_u32 s12, s10, 0x69d2000
  s_addc_u32 s13, s11, 0
  s_mov_b32 s14, 0x900000
  s_mov_b32 s15, 0x20000
  s_mov_b32 s16, s4
  s_mov_b32 s17, s5
  s_mov_b32 s18, 0x288000
  s_mov_b32 s19, 0x20000
  s_add_u32 s24, s10, 0x4a52000
  s_addc_u32 s25, s11, 0
  s_mov_b32 s26, 0x240000
  s_mov_b32 s27, 0x20000
  s_mov_b32 s20, s8
  s_mov_b32 s21, s9
  s_mov_b32 s22, 0x240000
  s_mov_b32 s23, 0x20000
  s_add_u32 s52, s10, 0x11680
  s_addc_u32 s53, s11, 0
  s_mov_b32 s54, 0x480
  s_mov_b32 s55, 0x20000
  s_mul_i32 s46, s32, 589824
  s_mul_i32 s47, s36, 128
  v_and_b32 v1, 63, v0
  v_lshlrev_b32 v2, 4, v1
  s_mul_i32 s41, s3, 4096
  v_add_u32 v4, s41, v2
  s_add_u32 s41, s3, 0
  s_min_u32 s41, s41, 3
  s_lshl_b32 s41, s41, 6
  v_add_u32 v48, s41, v1
  s_mov_b32 s42, 0x20000000
  v_mul_hi_u32 v49, v48, s42
  v_mul_u32_u24 v50, 8, v49
  v_sub_u32 v50, v48, v50
  v_bfe_u32 v51, v49, 1, 1
  v_bfe_u32 v52, v49, 3, 1
  v_lshl_add_u32 v51, v52, 1, v51
  v_lshrrev_b32 v52, 1, v50
  v_sub_u32 v52, v52, v51
  v_add_u32 v51, 4, v52
  v_cmp_gt_i32 vcc, 0, v52
  s_nop 1
  v_cndmask_b32 v52, v52, v51, vcc
  v_and_b32 v50, 1, v50
  v_lshlrev_b32 v50, 4, v50
  v_lshl_add_u32 v50, v52, 5, v50
  s_mov_b32 s42, 1152
  v_mul_lo_u32 v49, v49, s42
  v_add_u32 v8, v49, v50
  v_and_b32 v2, 15, v1
  v_lshrrev_b32 v48, 4, v1
  v_and_b32 v3, 7, v2
  v_xor_b32 v3, v3, v48
  v_lshlrev_b32 v3, 4, v3
  v_lshl_add_u32 v3, v2, 7, v3
  s_lshr_b32 s41, s3, 1
  s_mul_i32 s41, s41, 8192
  s_add_u32 s41, s41, 49152
  v_add_u32 v9, s41, v3
  v_xor_b32 v10, 64, v9
  v_add_u32 v13, 49152, v9
  v_add_u32 v14, 49152, v10
  v_bfe_u32 v2, v1, 2, 2
  v_lshl_add_u32 v2, v48, 3, v2
  v_bfe_u32 v51, v2, 1, 1
  v_bfe_u32 v52, v2, 3, 1
  v_lshl_add_u32 v51, v52, 1, v51
  v_mul_u32_u24 v2, 128, v2
  v_and_b32 v3, 3, v1
  v_lshl_add_u32 v2, v3, 3, v2
  s_and_b32 s41, s3, 1
  s_mul_i32 s41, s41, 2
  s_add_u32 s42, s41, 0
  v_add_u32 v49, s42, v51
  v_subrev_u32 v50, 4, v49
  v_cmp_le_u32 vcc, 4, v49
  s_nop 1
  v_cndmask_b32 v49, v49, v50, vcc
  v_lshl_add_u32 v11, v49, 5, v2
  s_add_u32 s42, s41, 1
  v_add_u32 v49, s42, v51
  v_subrev_u32 v50, 4, v49
  v_cmp_le_u32 vcc, 4, v49
  s_nop 1
  v_cndmask_b32 v49, v49, v50, vcc
  v_lshl_add_u32 v12, v49, 5, v2
  s_lshl_b32 s44, s3, 10
  s_add_u32 s45, s44, 49152
  s_mul_i32 s59, s3, 4096
  s_add_u32 s59, s59, 49152
  s_add_u32 m0, s59, 0
  s_nop 0
  buffer_load_dwordx4 v4, s[12:15], s46 offen offset:0 lds
  buffer_load_dwordx4 v4, s[12:15], s46 offen offset:1024 lds
  s_add_u32 m0, s44, 0
  s_nop 0
  buffer_load_dwordx4 v8, s[16:19], s47 offen lds
  s_add_u32 s47, s47, 36864
  s_add_u32 m0, s59, 0
  s_nop 0
  buffer_load_dwordx4 v4, s[12:15], s46 offen offset:2048 lds
  buffer_load_dwordx4 v4, s[12:15], s46 offen offset:3072 lds
  s_add_u32 m0, s44, 4096
  s_nop 0
  buffer_load_dwordx4 v8, s[16:19], s47 offen lds
  s_add_u32 s46, s46, 16384
  s_add_u32 s47, s47, 36864
  s_add_u32 m0, s59, 16384
  s_nop 0
  buffer_load_dwordx4 v4, s[12:15], s46 offen offset:0 lds
  buffer_load_dwordx4 v4, s[12:15], s46 offen offset:1024 lds
  s_add_u32 m0, s44, 8192
  s_nop 0
  buffer_load_dwordx4 v8, s[16:19], s47 offen lds
  s_add_u32 s47, s47, 36864
  s_add_u32 m0, s59, 16384
  s_nop 0
  buffer_load_dwordx4 v4, s[12:15], s46 offen offset:2048 lds
  buffer_load_dwordx4 v4, s[12:15], s46 offen offset:3072 lds
  s_add_u32 m0, s44, 12288
  s_nop 0
  buffer_load_dwordx4 v8, s[16:19], s47 offen lds
  s_add_u32 s46, s46, 16384
  s_add_u32 s47, s47, 36864
  s_add_u32 m0, s59, 32768
  s_nop 0
  buffer_load_dwordx4 v4, s[12:15], s46 offen offset:0 lds
  buffer_load_dwordx4 v4, s[12:15], s46 offen offset:1024 lds
  s_add_u32 m0, s44, 16384
  s_nop 0
  buffer_load_dwordx4 v8, s[16:19], s47 offen lds
  s_add_u32 s47, s47, 36864
  s_add_u32 m0, s59, 32768
  s_nop 0
  buffer_load_dwordx4 v4, s[12:15], s46 offen offset:2048 lds
  buffer_load_dwordx4 v4, s[12:15], s46 offen offset:3072 lds
  s_add_u32 m0, s44, 20480
  s_nop 0
  buffer_load_dwordx4 v8, s[16:19], s47 offen lds
  s_add_u32 s46, s46, 16384
  s_add_u32 s47, s47, 36864
  s_add_u32 m0, s59, 49152
  s_nop 0
  buffer_load_dwordx4 v4, s[12:15], s46 offen offset:0 lds
  buffer_load_dwordx4 v4, s[12:15], s46 offen offset:1024 lds
  s_add_u32 m0, s44, 24576
  s_nop 0
  buffer_load_dwordx4 v8, s[16:19], s47 offen lds
  s_add_u32 s47, s47, 36864
  s_add_u32 m0, s59, 49152
  s_nop 0
  buffer_load_dwordx4 v4, s[12:15], s46 offen offset:2048 lds
  buffer_load_dwordx4 v4, s[12:15], s46 offen offset:3072 lds
  s_add_u32 m0, s44, 28672
  s_nop 0
  buffer_load_dwordx4 v8, s[16:19], s47 offen lds
  s_add_u32 s46, s46, 16384
  s_add_u32 s47, s47, 36864
  s_add_u32 m0, s59, 65536
  s_nop 0
  buffer_load_dwordx4 v4, s[12:15], s46 offen offset:0 lds
  buffer_load_dwordx4 v4, s[12:15], s46 offen offset:1024 lds
  s_add_u32 m0, s44, 32768
  s_nop 0
  buffer_load_dwordx4 v8, s[16:19], s47 offen lds
  s_add_u32 s47, s47, 36864
  s_add_u32 m0, s59, 65536
  s_nop 0
  buffer_load_dwordx4 v4, s[12:15], s46 offen offset:2048 lds
  buffer_load_dwordx4 v4, s[12:15], s46 offen offset:3072 lds
  s_add_u32 m0, s44, 36864
  s_nop 0
  buffer_load_dwordx4 v8, s[16:19], s47 offen lds
  s_add_u32 s46, s46, 16384
  s_add_u32 s47, s47, 36864
  s_add_u32 m0, s59, 81920
  s_nop 0
  buffer_load_dwordx4 v4, s[12:15], s46 offen offset:0 lds
  buffer_load_dwordx4 v4, s[12:15], s46 offen offset:1024 lds
  s_add_u32 m0, s44, 40960
  s_nop 0
  buffer_load_dwordx4 v8, s[16:19], s47 offen lds
  s_add_u32 s47, s47, 36864
  s_add_u32 m0, s59, 81920
  s_nop 0
  buffer_load_dwordx4 v4, s[12:15], s46 offen offset:2048 lds
  buffer_load_dwordx4 v4, s[12:15], s46 offen offset:3072 lds
  s_add_u32 m0, s44, 45056
  s_nop 0
  buffer_load_dwordx4 v8, s[16:19], s47 offen lds
  s_add_u32 s46, s46, 16384
  s_add_u32 s47, s47, 36864
  v_mov_b32 v16, 0
  v_mov_b32 v17, 0
  v_mov_b32 v18, 0
  v_mov_b32 v19, 0
  v_mov_b32 v20, 0
  v_mov_b32 v21, 0
  v_mov_b32 v22, 0
  v_mov_b32 v23, 0
  v_mov_b32 v24, 0
  v_mov_b32 v25, 0
  v_mov_b32 v26, 0
  v_mov_b32 v27, 0
  v_mov_b32 v28, 0
  v_mov_b32 v29, 0
  v_mov_b32 v30, 0
  v_mov_b32 v31, 0
  v_mov_b32 v32, 0
  v_mov_b32 v33, 0
  v_mov_b32 v34, 0
  v_mov_b32 v35, 0
  v_mov_b32 v36, 0
  v_mov_b32 v37, 0
  v_mov_b32 v38, 0
  v_mov_b32 v39, 0
  v_mov_b32 v40, 0
  v_mov_b32 v41, 0
  v_mov_b32 v42, 0
  v_mov_b32 v43, 0
  v_mov_b32 v44, 0
  v_mov_b32 v45, 0
  v_mov_b32 v46, 0
  v_mov_b32 v47, 0
  s_waitcnt vmcnt(30)
  s_barrier
  ds_read_b128 a[0:3], v9 offset:0
  ds_read_b128 a[4:7], v9 offset:2048
  ds_read_b128 a[8:11], v9 offset:4096
  ds_read_b128 a[12:15], v9 offset:6144
  ds_read_b64_tr_b16 a[16:17], v11 offset:0
  ds_read_b64_tr_b16 a[18:19], v11 offset:512
  ds_read_b64_tr_b16 a[20:21], v12 offset:0
  ds_read_b64_tr_b16 a[22:23], v12 offset:512
  s_waitcnt lgkmcnt(0)
  v_mfma_f32_16x16x32_bf16 v[16:19], a[16:19], a[0:3], v[16:19]
  ds_read_b128 a[24:27], v10 offset:0
  ds_read_b128 a[28:31], v10 offset:2048
  v_mfma_f32_16x16x32_bf16 v[20:23], a[20:23], a[0:3], v[20:23]
  ds_read_b128 a[32:35], v10 offset:4096
  ds_read_b128 a[36:39], v10 offset:6144
  v_mfma_f32_16x16x32_bf16 v[24:27], a[16:19], a[4:7], v[24:27]
  ds_read_b64_tr_b16 a[40:41], v11 offset:4096
  ds_read_b64_tr_b16 a[42:43], v11 offset:4608
  v_mfma_f32_16x16x32_bf16 v[28:31], a[20:23], a[4:7], v[28:31]
  ds_read_b64_tr_b16 a[44:45], v12 offset:4096
  ds_read_b64_tr_b16 a[46:47], v12 offset:4608
  v_mfma_f32_16x16x32_bf16 v[32:35], a[16:19], a[8:11], v[32:35]
  v_mfma_f32_16x16x32_bf16 v[36:39], a[20:23], a[8:11], v[36:39]
  v_mfma_f32_16x16x32_bf16 v[40:43], a[16:19], a[12:15], v[40:43]
  v_mfma_f32_16x16x32_bf16 v[44:47], a[20:23], a[12:15], v[44:47]
  s_waitcnt vmcnt(24) lgkmcnt(0)
  s_barrier
  v_mfma_f32_16x16x32_bf16 v[16:19], a[40:43], a[24:27], v[16:19]
  ds_read_b128 a[0:3], v9 offset:16384
  ds_read_b128 a[4:7], v9 offset:18432
  s_add_u32 m0, s59, 0
  v_mfma_f32_16x16x32_bf16 v[20:23], a[44:47], a[24:27], v[20:23]
  ds_read_b128 a[8:11], v9 offset:20480
  ds_read_b128 a[12:15], v9 offset:22528
  buffer_load_dwordx4 v4, s[12:15], s46 offen offset:0 lds
  v_mfma_f32_16x16x32_bf16 v[24:27], a[40:43], a[28:31], v[24:27]
  ds_read_b64_tr_b16 a[16:17], v11 offset:8192
  ds_read_b64_tr_b16 a[18:19], v11 offset:8704
  buffer_load_dwordx4 v4, s[12:15], s46 offen offset:1024 lds
  v_mfma_f32_16x16x32_bf16 v[28:31], a[44:47], a[28:31], v[28:31]
  ds_read_b64_tr_b16 a[20:21], v12 offset:8192
  ds_read_b64_tr_b16 a[22:23], v12 offset:8704
  v_mfma_f32_16x16x32_bf16 v[32:35], a[40:43], a[32:35], v[32:35]
  s_add_u32 m0, s44, 0
  v_mfma_f32_16x16x32_bf16 v[36:39], a[44:47], a[32:35], v[36:39]
  buffer_load_dwordx4 v8, s[16:19], s47 offen lds
  v_mfma_f32_16x16x32_bf16 v[40:43], a[40:43], a[36:39], v[40:43]
  s_add_u32 s47, s47, 36864
  v_mfma_f32_16x16x32_bf16 v[44:47], a[44:47], a[36:39], v[44:47]
  s_mov_b32 s48, 4
Lres_93_loop:
  s_waitcnt lgkmcnt(0)
  v_mfma_f32_16x16x32_bf16 v[16:19], a[16:19], a[0:3], v[16:19]
  ds_read_b128 a[24:27], v10 offset:16384
  ds_read_b128 a[28:31], v10 offset:18432
  s_add_u32 m0, s59, 0
  v_mfma_f32_16x16x32_bf16 v[20:23], a[20:23], a[0:3], v[20:23]
  ds_read_b128 a[32:35], v10 offset:20480
  ds_read_b128 a[36:39], v10 offset:22528
  buffer_load_dwordx4 v4, s[12:15], s46 offen offset:2048 lds
  v_mfma_f32_16x16x32_bf16 v[24:27], a[16:19], a[4:7], v[24:27]
  ds_read_b64_tr_b16 a[40:41], v11 offset:12288
  ds_read_b64_tr_b16 a[42:43], v11 offset:12800
  buffer_load_dwordx4 v4, s[12:15], s46 offen offset:3072 lds
  v_mfma_f32_16x16x32_bf16 v[28:31], a[20:23], a[4:7], v[28:31]
  ds_read_b64_tr_b16 a[44:45], v12 offset:12288
  ds_read_b64_tr_b16 a[46:47], v12 offset:12800
  v_mfma_f32_16x16x32_bf16 v[32:35], a[16:19], a[8:11], v[32:35]
  s_add_u32 m0, s44, 4096
  v_mfma_f32_16x16x32_bf16 v[36:39], a[20:23], a[8:11], v[36:39]
  buffer_load_dwordx4 v8, s[16:19], s47 offen lds
  v_mfma_f32_16x16x32_bf16 v[40:43], a[16:19], a[12:15], v[40:43]
  s_add_u32 s46, s46, 16384
  s_add_u32 s47, s47, 36864
  v_mfma_f32_16x16x32_bf16 v[44:47], a[20:23], a[12:15], v[44:47]
  s_waitcnt vmcnt(24) lgkmcnt(0)
  s_barrier
  v_mfma_f32_16x16x32_bf16 v[16:19], a[40:43], a[24:27], v[16:19]
  ds_read_b128 a[0:3], v9 offset:32768
  ds_read_b128 a[4:7], v9 offset:34816
  s_add_u32 m0, s59, 16384
  v_mfma_f32_16x16x32_bf16 v[20:23], a[44:47], a[24:27], v[20:23]
  ds_read_b128 a[8:11], v9 offset:36864
  ds_read_b128 a[12:15], v9 offset:38912
  buffer_load_dwordx4 v4, s[12:15], s46 offen offset:0 lds
  v_mfma_f32_16x16x32_bf16 v[24:27], a[40:43], a[28:31], v[24:27]
  ds_read_b64_tr_b16 a[16:17], v11 offset:16384
  ds_read_b64_tr_b16 a[18:19], v11 offset:16896
  buffer_load_dwordx4 v4, s[12:15], s46 offen offset:1024 lds
  v_mfma_f32_16x16x32_bf16 v[28:31], a[44:47], a[28:31], v[28:31]
  ds_read_b64_tr_b16 a[20:21], v12 offset:16384
  ds_read_b64_tr_b16 a[22:23], v12 offset:16896
  v_mfma_f32_16x16x32_bf16 v[32:35], a[40:43], a[32:35], v[32:35]
  s_add_u32 m0, s44, 8192
  v_mfma_f32_16x16x32_bf16 v[36:39], a[44:47], a[32:35], v[36:39]
  buffer_load_dwordx4 v8, s[16:19], s47 offen lds
  v_mfma_f32_16x16x32_bf16 v[40:43], a[40:43], a[36:39], v[40:43]
  s_add_u32 s47, s47, 36864
  v_mfma_f32_16x16x32_bf16 v[44:47], a[44:47], a[36:39], v[44:47]
  s_waitcnt lgkmcnt(0)
  v_mfma_f32_16x16x32_bf16 v[16:19], a[16:19], a[0:3], v[16:19]
  ds_read_b128 a[24:27], v10 offset:32768
  ds_read_b128 a[28:31], v10 offset:34816
  s_add_u32 m0, s59, 16384
  v_mfma_f32_16x16x32_bf16 v[20:23], a[20:23], a[0:3], v[20:23]
  ds_read_b128 a[32:35], v10 offset:36864
  ds_read_b128 a[36:39], v10 offset:38912
  buffer_load_dwordx4 v4, s[12:15], s46 offen offset:2048 lds
  v_mfma_f32_16x16x32_bf16 v[24:27], a[16:19], a[4:7], v[24:27]
  ds_read_b64_tr_b16 a[40:41], v11 offset:20480
  ds_read_b64_tr_b16 a[42:43], v11 offset:20992
  buffer_load_dwordx4 v4, s[12:15], s46 offen offset:3072 lds
  v_mfma_f32_16x16x32_bf16 v[28:31], a[20:23], a[4:7], v[28:31]
  ds_read_b64_tr_b16 a[44:45], v12 offset:20480
  ds_read_b64_tr_b16 a[46:47], v12 offset:20992
  v_mfma_f32_16x16x32_bf16 v[32:35], a[16:19], a[8:11], v[32:35]
  s_add_u32 m0, s44, 12288
  v_mfma_f32_16x16x32_bf16 v[36:39], a[20:23], a[8:11], v[36:39]
  buffer_load_dwordx4 v8, s[16:19], s47 offen lds
  v_mfma_f32_16x16x32_bf16 v[40:43], a[16:19], a[12:15], v[40:43]
  s_add_u32 s46, s46, 16384
  s_add_u32 s47, s47, 36864
  v_mfma_f32_16x16x32_bf16 v[44:47], a[20:23], a[12:15], v[44:47]
  s_waitcnt vmcnt(24) lgkmcnt(0)
  s_barrier
  v_mfma_f32_16x16x32_bf16 v[16:19], a[40:43], a[24:27], v[16:19]
  ds_read_b128 a[0:3], v13 offset:0
  ds_read_b128 a[4:7], v13 offset:2048
  s_add_u32 m0, s59, 32768
  v_mfma_f32_16x16x32_bf16 v[20:23], a[44:47], a[24:27], v[20:23]
  ds_read_b128 a[8:11], v13 offset:4096
  ds_read_b128 a[12:15], v13 offset:6144
  buffer_load_dwordx4 v4, s[12:15], s46 offen offset:0 lds
  v_mfma_f32_16x16x32_bf16 v[24:27], a[40:43], a[28:31], v[24:27]
  ds_read_b64_tr_b16 a[16:17], v11 offset:24576
  ds_read_b64_tr_b16 a[18:19], v11 offset:25088
  buffer_load_dwordx4 v4, s[12:15], s46 offen offset:1024 lds
  v_mfma_f32_16x16x32_bf16 v[28:31], a[44:47], a[28:31], v[28:31]
  ds_read_b64_tr_b16 a[20:21], v12 offset:24576
  ds_read_b64_tr_b16 a[22:23], v12 offset:25088
  v_mfma_f32_16x16x32_bf16 v[32:35], a[40:43], a[32:35], v[32:35]
  s_add_u32 m0, s44, 16384
  v_mfma_f32_16x16x32_bf16 v[36:39], a[44:47], a[32:35], v[36:39]
  buffer_load_dwordx4 v8, s[16:19], s47 offen lds
  v_mfma_f32_16x16x32_bf16 v[40:43], a[40:43], a[36:39], v[40:43]
  s_add_u32 s47, s47, 36864
  v_mfma_f32_16x16x32_bf16 v[44:47], a[44:47], a[36:39], v[44:47]
  s_waitcnt lgkmcnt(0)
  v_mfma_f32_16x16x32_bf16 v[16:19], a[16:19], a[0:3], v[16:19]
  ds_read_b128 a[24:27], v14 offset:0
  ds_read_b128 a[28:31], v14 offset:2048
  s_add_u32 m0, s59, 32768
  v_mfma_f32_16x16x32_bf16 v[20:23], a[20:23], a[0:3], v[20:23]
  ds_read_b128 a[32:35], v14 offset:4096
  ds_read_b128 a[36:39], v14 offset:6144
  buffer_load_dwordx4 v4, s[12:15], s46 offen offset:2048 lds
  v_mfma_f32_16x16x32_bf16 v[24:27], a[16:19], a[4:7], v[24:27]
  ds_read_b64_tr_b16 a[40:41], v11 offset:28672
  ds_read_b64_tr_b16 a[42:43], v11 offset:29184
  buffer_load_dwordx4 v4, s[12:15], s46 offen offset:3072 lds
  v_mfma_f32_16x16x32_bf16 v[28:31], a[20:23], a[4:7], v[28:31]
  ds_read_b64_tr_b16 a[44:45], v12 offset:28672
  ds_read_b64_tr_b16 a[46:47], v12 offset:29184
  v_mfma_f32_16x16x32_bf16 v[32:35], a[16:19], a[8:11], v[32:35]
  s_add_u32 m0, s44, 20480
  v_mfma_f32_16x16x32_bf16 v[36:39], a[20:23], a[8:11], v[36:39]
  buffer_load_dwordx4 v8, s[16:19], s47 offen lds
  v_mfma_f32_16x16x32_bf16 v[40:43], a[16:19], a[12:15], v[40:43]
  s_add_u32 s46, s46, 16384
  s_add_u32 s47, s47, 36864
  v_mfma_f32_16x16x32_bf16 v[44:47], a[20:23], a[12:15], v[44:47]
  s_waitcnt vmcnt(24) lgkmcnt(0)
  s_barrier
  v_mfma_f32_16x16x32_bf16 v[16:19], a[40:43], a[24:27], v[16:19]
  ds_read_b128 a[0:3], v13 offset:16384
  ds_read_b128 a[4:7], v13 offset:18432
  s_add_u32 m0, s59, 49152
  v_mfma_f32_16x16x32_bf16 v[20:23], a[44:47], a[24:27], v[20:23]
  ds_read_b128 a[8:11], v13 offset:20480
  ds_read_b128 a[12:15], v13 offset:22528
  buffer_load_dwordx4 v4, s[12:15], s46 offen offset:0 lds
  v_mfma_f32_16x16x32_bf16 v[24:27], a[40:43], a[28:31], v[24:27]
  ds_read_b64_tr_b16 a[16:17], v11 offset:32768
  ds_read_b64_tr_b16 a[18:19], v11 offset:33280
  buffer_load_dwordx4 v4, s[12:15], s46 offen offset:1024 lds
  v_mfma_f32_16x16x32_bf16 v[28:31], a[44:47], a[28:31], v[28:31]
  ds_read_b64_tr_b16 a[20:21], v12 offset:32768
  ds_read_b64_tr_b16 a[22:23], v12 offset:33280
  v_mfma_f32_16x16x32_bf16 v[32:35], a[40:43], a[32:35], v[32:35]
  s_add_u32 m0, s44, 24576
  v_mfma_f32_16x16x32_bf16 v[36:39], a[44:47], a[32:35], v[36:39]
  buffer_load_dwordx4 v8, s[16:19], s47 offen lds
  v_mfma_f32_16x16x32_bf16 v[40:43], a[40:43], a[36:39], v[40:43]
  s_add_u32 s47, s47, 36864
  v_mfma_f32_16x16x32_bf16 v[44:47], a[44:47], a[36:39], v[44:47]
  s_waitcnt lgkmcnt(0)
  v_mfma_f32_16x16x32_bf16 v[16:19], a[16:19], a[0:3], v[16:19]
  ds_read_b128 a[24:27], v14 offset:16384
  ds_read_b128 a[28:31], v14 offset:18432
  s_add_u32 m0, s59, 49152
  v_mfma_f32_16x16x32_bf16 v[20:23], a[20:23], a[0:3], v[20:23]
  ds_read_b128 a[32:35], v14 offset:20480
  ds_read_b128 a[36:39], v14 offset:22528
  buffer_load_dwordx4 v4, s[12:15], s46 offen offset:2048 lds
  v_mfma_f32_16x16x32_bf16 v[24:27], a[16:19], a[4:7], v[24:27]
  ds_read_b64_tr_b16 a[40:41], v11 offset:36864
  ds_read_b64_tr_b16 a[42:43], v11 offset:37376
  buffer_load_dwordx4 v4, s[12:15], s46 offen offset:3072 lds
  v_mfma_f32_16x16x32_bf16 v[28:31], a[20:23], a[4:7], v[28:31]
  ds_read_b64_tr_b16 a[44:45], v12 offset:36864
  ds_read_b64_tr_b16 a[46:47], v12 offset:37376
  v_mfma_f32_16x16x32_bf16 v[32:35], a[16:19], a[8:11], v[32:35]
  s_add_u32 m0, s44, 28672
  v_mfma_f32_16x16x32_bf16 v[36:39], a[20:23], a[8:11], v[36:39]
  buffer_load_dwordx4 v8, s[16:19], s47 offen lds
  v_mfma_f32_16x16x32_bf16 v[40:43], a[16:19], a[12:15], v[40:43]
  s_add_u32 s46, s46, 16384
  s_add_u32 s47, s47, 36864
  v_mfma_f32_16x16x32_bf16 v[44:47], a[20:23], a[12:15], v[44:47]
  s_waitcnt vmcnt(24) lgkmcnt(0)
  s_barrier
  v_mfma_f32_16x16x32_bf16 v[16:19], a[40:43], a[24:27], v[16:19]
  ds_read_b128 a[0:3], v13 offset:32768
  ds_read_b128 a[4:7], v13 offset:34816
  s_add_u32 m0, s59, 65536
  v_mfma_f32_16x16x32_bf16 v[20:23], a[44:47], a[24:27], v[20:23]
  ds_read_b128 a[8:11], v13 offset:36864
  ds_read_b128 a[12:15], v13 offset:38912
  buffer_load_dwordx4 v4, s[12:15], s46 offen offset:0 lds
  v_mfma_f32_16x16x32_bf16 v[24:27], a[40:43], a[28:31], v[24:27]
  ds_read_b64_tr_b16 a[16:17], v11 offset:40960
  ds_read_b64_tr_b16 a[18:19], v11 offset:41472
  buffer_load_dwordx4 v4, s[12:15], s46 offen offset:1024 lds
  v_mfma_f32_16x16x32_bf16 v[28:31], a[44:47], a[28:31], v[28:31]
  ds_read_b64_tr_b16 a[20:21], v12 offset:40960
  ds_read_b64_tr_b16 a[22:23], v12 offset:41472
  v_mfma_f32_16x16x32_bf16 v[32:35], a[40:43], a[32:35], v[32:35]
  s_add_u32 m0, s44, 32768
  v_mfma_f32_16x16x32_bf16 v[36:39], a[44:47], a[32:35], v[36:39]
  buffer_load_dwordx4 v8, s[16:19], s47 offen lds
  v_mfma_f32_16x16x32_bf16 v[40:43], a[40:43], a[36:39], v[40:43]
  s_add_u32 s47, s47, 36864
  v_mfma_f32_16x16x32_bf16 v[44:47], a[44:47], a[36:39], v[44:47]
  s_waitcnt lgkmcnt(0)
  v_mfma_f32_16x16x32_bf16 v[16:19], a[16:19], a[0:3], v[16:19]
  ds_read_b128 a[24:27], v14 offset:32768
  ds_read_b128 a[28:31], v14 offset:34816
  s_add_u32 m0, s59, 65536
  v_mfma_f32_16x16x32_bf16 v[20:23], a[20:23], a[0:3], v[20:23]
  ds_read_b128 a[32:35], v14 offset:36864
  ds_read_b128 a[36:39], v14 offset:38912
  buffer_load_dwordx4 v4, s[12:15], s46 offen offset:2048 lds
  v_mfma_f32_16x16x32_bf16 v[24:27], a[16:19], a[4:7], v[24:27]
  ds_read_b64_tr_b16 a[40:41], v11 offset:45056
  ds_read_b64_tr_b16 a[42:43], v11 offset:45568
  buffer_load_dwordx4 v4, s[12:15], s46 offen offset:3072 lds
  v_mfma_f32_16x16x32_bf16 v[28:31], a[20:23], a[4:7], v[28:31]
  ds_read_b64_tr_b16 a[44:45], v12 offset:45056
  ds_read_b64_tr_b16 a[46:47], v12 offset:45568
  v_mfma_f32_16x16x32_bf16 v[32:35], a[16:19], a[8:11], v[32:35]
  s_add_u32 m0, s44, 36864
  v_mfma_f32_16x16x32_bf16 v[36:39], a[20:23], a[8:11], v[36:39]
  buffer_load_dwordx4 v8, s[16:19], s47 offen lds
  v_mfma_f32_16x16x32_bf16 v[40:43], a[16:19], a[12:15], v[40:43]
  s_add_u32 s46, s46, 16384
  s_add_u32 s47, s47, 36864
  v_mfma_f32_16x16x32_bf16 v[44:47], a[20:23], a[12:15], v[44:47]
  s_waitcnt vmcnt(24) lgkmcnt(0)
  s_barrier
  v_mfma_f32_16x16x32_bf16 v[16:19], a[40:43], a[24:27], v[16:19]
  ds_read_b128 a[0:3], v9 offset:0
  ds_read_b128 a[4:7], v9 offset:2048
  s_add_u32 m0, s59, 81920
  v_mfma_f32_16x16x32_bf16 v[20:23], a[44:47], a[24:27], v[20:23]
  ds_read_b128 a[8:11], v9 offset:4096
  ds_read_b128 a[12:15], v9 offset:6144
  buffer_load_dwordx4 v4, s[12:15], s46 offen offset:0 lds
  v_mfma_f32_16x16x32_bf16 v[24:27], a[40:43], a[28:31], v[24:27]
  ds_read_b64_tr_b16 a[16:17], v11 offset:0
  ds_read_b64_tr_b16 a[18:19], v11 offset:512
  buffer_load_dwordx4 v4, s[12:15], s46 offen offset:1024 lds
  v_mfma_f32_16x16x32_bf16 v[28:31], a[44:47], a[28:31], v[28:31]
  ds_read_b64_tr_b16 a[20:21], v12 offset:0
  ds_read_b64_tr_b16 a[22:23], v12 offset:512
  v_mfma_f32_16x16x32_bf16 v[32:35], a[40:43], a[32:35], v[32:35]
  s_add_u32 m0, s44, 40960
  v_mfma_f32_16x16x32_bf16 v[36:39], a[44:47], a[32:35], v[36:39]
  buffer_load_dwordx4 v8, s[16:19], s47 offen lds
  v_mfma_f32_16x16x32_bf16 v[40:43], a[40:43], a[36:39], v[40:43]
  s_add_u32 s47, s47, 36864
  v_mfma_f32_16x16x32_bf16 v[44:47], a[44:47], a[36:39], v[44:47]
  s_waitcnt lgkmcnt(0)
  v_mfma_f32_16x16x32_bf16 v[16:19], a[16:19], a[0:3], v[16:19]
  ds_read_b128 a[24:27], v10 offset:0
  ds_read_b128 a[28:31], v10 offset:2048
  s_add_u32 m0, s59, 81920
  v_mfma_f32_16x16x32_bf16 v[20:23], a[20:23], a[0:3], v[20:23]
  ds_read_b128 a[32:35], v10 offset:4096
  ds_read_b128 a[36:39], v10 offset:6144
  buffer_load_dwordx4 v4, s[12:15], s46 offen offset:2048 lds
  v_mfma_f32_16x16x32_bf16 v[24:27], a[16:19], a[4:7], v[24:27]
  ds_read_b64_tr_b16 a[40:41], v11 offset:4096
  ds_read_b64_tr_b16 a[42:43], v11 offset:4608
  buffer_load_dwordx4 v4, s[12:15], s46 offen offset:3072 lds
  v_mfma_f32_16x16x32_bf16 v[28:31], a[20:23], a[4:7], v[28:31]
  ds_read_b64_tr_b16 a[44:45], v12 offset:4096
  ds_read_b64_tr_b16 a[46:47], v12 offset:4608
  v_mfma_f32_16x16x32_bf16 v[32:35], a[16:19], a[8:11], v[32:35]
  s_add_u32 m0, s44, 45056
  v_mfma_f32_16x16x32_bf16 v[36:39], a[20:23], a[8:11], v[36:39]
  buffer_load_dwordx4 v8, s[16:19], s47 offen lds
  v_mfma_f32_16x16x32_bf16 v[40:43], a[16:19], a[12:15], v[40:43]
  s_add_u32 s46, s46, 16384
  s_add_u32 s47, s47, 36864
  v_mfma_f32_16x16x32_bf16 v[44:47], a[20:23], a[12:15], v[44:47]
  s_waitcnt vmcnt(24) lgkmcnt(0)
  s_barrier
  v_mfma_f32_16x16x32_bf16 v[16:19], a[40:43], a[24:27], v[16:19]
  ds_read_b128 a[0:3], v9 offset:16384
  ds_read_b128 a[4:7], v9 offset:18432
  s_add_u32 m0, s59, 0
  v_mfma_f32_16x16x32_bf16 v[20:23], a[44:47], a[24:27], v[20:23]
  ds_read_b128 a[8:11], v9 offset:20480
  ds_read_b128 a[12:15], v9 offset:22528
  buffer_load_dwordx4 v4, s[12:15], s46 offen offset:0 lds
  v_mfma_f32_16x16x32_bf16 v[24:27], a[40:43], a[28:31], v[24:27]
  ds_read_b64_tr_b16 a[16:17], v11 offset:8192
  ds_read_b64_tr_b16 a[18:19], v11 offset:8704
  buffer_load_dwordx4 v4, s[12:15], s46 offen offset:1024 lds
  v_mfma_f32_16x16x32_bf16 v[28:31], a[44:47], a[28:31], v[28:31]
  ds_read_b64_tr_b16 a[20:21], v12 offset:8192
  ds_read_b64_tr_b16 a[22:23], v12 offset:8704
  v_mfma_f32_16x16x32_bf16 v[32:35], a[40:43], a[32:35], v[32:35]
  s_add_u32 m0, s44, 0
  v_mfma_f32_16x16x32_bf16 v[36:39], a[44:47], a[32:35], v[36:39]
  buffer_load_dwordx4 v8, s[16:19], s47 offen lds
  v_mfma_f32_16x16x32_bf16 v[40:43], a[40:43], a[36:39], v[40:43]
  s_add_u32 s47, s47, 36864
  v_mfma_f32_16x16x32_bf16 v[44:47], a[44:47], a[36:39], v[44:47]
  s_sub_u32 s48, s48, 1
  s_cmp_lg_u32 s48, 0
  s_cbranch_scc1 Lres_93_loop
  s_waitcnt lgkmcnt(0)
  v_mfma_f32_16x16x32_bf16 v[16:19], a[16:19], a[0:3], v[16:19]
  ds_read_b128 a[24:27], v10 offset:16384
  ds_read_b128 a[28:31], v10 offset:18432
  s_add_u32 m0, s59, 0
  v_mfma_f32_16x16x32_bf16 v[20:23], a[20:23], a[0:3], v[20:23]
  ds_read_b128 a[32:35], v10 offset:20480
  ds_read_b128 a[36:39], v10 offset:22528
  buffer_load_dwordx4 v4, s[12:15], s46 offen offset:2048 lds
  v_mfma_f32_16x16x32_bf16 v[24:27], a[16:19], a[4:7], v[24:27]
  ds_read_b64_tr_b16 a[40:41], v11 offset:12288
  ds_read_b64_tr_b16 a[42:43], v11 offset:12800
  buffer_load_dwordx4 v4, s[12:15], s46 offen offset:3072 lds
  v_mfma_f32_16x16x32_bf16 v[28:31], a[20:23], a[4:7], v[28:31]
  ds_read_b64_tr_b16 a[44:45], v12 offset:12288
  ds_read_b64_tr_b16 a[46:47], v12 offset:12800
  v_mfma_f32_16x16x32_bf16 v[32:35], a[16:19], a[8:11], v[32:35]
  s_add_u32 m0, s44, 4096
  v_mfma_f32_16x16x32_bf16 v[36:39], a[20:23], a[8:11], v[36:39]
  buffer_load_dwordx4 v8, s[16:19], s47 offen lds
  v_mfma_f32_16x16x32_bf16 v[40:43], a[16:19], a[12:15], v[40:43]
  s_add_u32 s46, s46, 16384
  s_add_u32 s47, s47, 36864
  v_mfma_f32_16x16x32_bf16 v[44:47], a[20:23], a[12:15], v[44:47]
  s_waitcnt vmcnt(24) lgkmcnt(0)
  s_barrier
  v_mfma_f32_16x16x32_bf16 v[16:19], a[40:43], a[24:27], v[16:19]
  ds_read_b128 a[0:3], v9 offset:32768
  ds_read_b128 a[4:7], v9 offset:34816
  s_add_u32 m0, s59, 16384
  v_mfma_f32_16x16x32_bf16 v[20:23], a[44:47], a[24:27], v[20:23]
  ds_read_b128 a[8:11], v9 offset:36864
  ds_read_b128 a[12:15], v9 offset:38912
  buffer_load_dwordx4 v4, s[12:15], s46 offen offset:0 lds
  v_mfma_f32_16x16x32_bf16 v[24:27], a[40:43], a[28:31], v[24:27]
  ds_read_b64_tr_b16 a[16:17], v11 offset:16384
  ds_read_b64_tr_b16 a[18:19], v11 offset:16896
  buffer_load_dwordx4 v4, s[12:15], s46 offen offset:1024 lds
  v_mfma_f32_16x16x32_bf16 v[28:31], a[44:47], a[28:31], v[28:31]
  ds_read_b64_tr_b16 a[20:21], v12 offset:16384
  ds_read_b64_tr_b16 a[22:23], v12 offset:16896
  v_mfma_f32_16x16x32_bf16 v[32:35], a[40:43], a[32:35], v[32:35]
  s_add_u32 m0, s44, 8192
  v_mfma_f32_16x16x32_bf16 v[36:39], a[44:47], a[32:35], v[36:39]
  buffer_load_dwordx4 v8, s[16:19], s47 offen lds
  v_mfma_f32_16x16x32_bf16 v[40:43], a[40:43], a[36:39], v[40:43]
  s_add_u32 s47, s47, 36864
  v_mfma_f32_16x16x32_bf16 v[44:47], a[44:47], a[36:39], v[44:47]
  s_waitcnt lgkmcnt(0)
  v_mfma_f32_16x16x32_bf16 v[16:19], a[16:19], a[0:3], v[16:19]
  ds_read_b128 a[24:27], v10 offset:32768
  ds_read_b128 a[28:31], v10 offset:34816
  s_add_u32 m0, s59, 16384
  v_mfma_f32_16x16x32_bf16 v[20:23], a[20:23], a[0:3], v[20:23]
  ds_read_b128 a[32:35], v10 offset:36864
  ds_read_b128 a[36:39], v10 offset:38912
  buffer_load_dwordx4 v4, s[12:15], s46 offen offset:2048 lds
  v_mfma_f32_16x16x32_bf16 v[24:27], a[16:19], a[4:7], v[24:27]
  ds_read_b64_tr_b16 a[40:41], v11 offset:20480
  ds_read_b64_tr_b16 a[42:43], v11 offset:20992
  buffer_load_dwordx4 v4, s[12:15], s46 offen offset:3072 lds
  v_mfma_f32_16x16x32_bf16 v[28:31], a[20:23], a[4:7], v[28:31]
  ds_read_b64_tr_b16 a[44:45], v12 offset:20480
  ds_read_b64_tr_b16 a[46:47], v12 offset:20992
  v_mfma_f32_16x16x32_bf16 v[32:35], a[16:19], a[8:11], v[32:35]
  s_add_u32 m0, s44, 12288
  v_mfma_f32_16x16x32_bf16 v[36:39], a[20:23], a[8:11], v[36:39]
  buffer_load_dwordx4 v8, s[16:19], s47 offen lds
  v_mfma_f32_16x16x32_bf16 v[40:43], a[16:19], a[12:15], v[40:43]
  s_add_u32 s46, s46, 16384
  s_add_u32 s47, s47, 36864
  v_mfma_f32_16x16x32_bf16 v[44:47], a[20:23], a[12:15], v[44:47]
  s_waitcnt vmcnt(24) lgkmcnt(0)
  s_barrier
  v_mfma_f32_16x16x32_bf16 v[16:19], a[40:43], a[24:27], v[16:19]
  ds_read_b128 a[0:3], v13 offset:0
  ds_read_b128 a[4:7], v13 offset:2048
  s_add_u32 m0, s59, 32768
  v_mfma_f32_16x16x32_bf16 v[20:23], a[44:47], a[24:27], v[20:23]
  ds_read_b128 a[8:11], v13 offset:4096
  ds_read_b128 a[12:15], v13 offset:6144
  buffer_load_dwordx4 v4, s[12:15], s46 offen offset:0 lds
  v_mfma_f32_16x16x32_bf16 v[24:27], a[40:43], a[28:31], v[24:27]
  ds_read_b64_tr_b16 a[16:17], v11 offset:24576
  ds_read_b64_tr_b16 a[18:19], v11 offset:25088
  buffer_load_dwordx4 v4, s[12:15], s46 offen offset:1024 lds
  v_mfma_f32_16x16x32_bf16 v[28:31], a[44:47], a[28:31], v[28:31]
  ds_read_b64_tr_b16 a[20:21], v12 offset:24576
  ds_read_b64_tr_b16 a[22:23], v12 offset:25088
  v_mfma_f32_16x16x32_bf16 v[32:35], a[40:43], a[32:35], v[32:35]
  s_add_u32 m0, s44, 16384
  v_mfma_f32_16x16x32_bf16 v[36:39], a[44:47], a[32:35], v[36:39]
  buffer_load_dwordx4 v8, s[16:19], s47 offen lds
  v_mfma_f32_16x16x32_bf16 v[40:43], a[40:43], a[36:39], v[40:43]
  s_add_u32 s47, s47, 36864
  v_mfma_f32_16x16x32_bf16 v[44:47], a[44:47], a[36:39], v[44:47]
  s_waitcnt lgkmcnt(0)
  v_mfma_f32_16x16x32_bf16 v[16:19], a[16:19], a[0:3], v[16:19]
  ds_read_b128 a[24:27], v14 offset:0
  ds_read_b128 a[28:31], v14 offset:2048
  s_add_u32 m0, s59, 32768
  v_mfma_f32_16x16x32_bf16 v[20:23], a[20:23], a[0:3], v[20:23]
  ds_read_b128 a[32:35], v14 offset:4096
  ds_read_b128 a[36:39], v14 offset:6144
  buffer_load_dwordx4 v4, s[12:15], s46 offen offset:2048 lds
  v_mfma_f32_16x16x32_bf16 v[24:27], a[16:19], a[4:7], v[24:27]
  ds_read_b64_tr_b16 a[40:41], v11 offset:28672
  ds_read_b64_tr_b16 a[42:43], v11 offset:29184
  buffer_load_dwordx4 v4, s[12:15], s46 offen offset:3072 lds
  v_mfma_f32_16x16x32_bf16 v[28:31], a[20:23], a[4:7], v[28:31]
  ds_read_b64_tr_b16 a[44:45], v12 offset:28672
  ds_read_b64_tr_b16 a[46:47], v12 offset:29184
  v_mfma_f32_16x16x32_bf16 v[32:35], a[16:19], a[8:11], v[32:35]
  s_add_u32 m0, s44, 20480
  v_mfma_f32_16x16x32_bf16 v[36:39], a[20:23], a[8:11], v[36:39]
  buffer_load_dwordx4 v8, s[16:19], s47 offen lds
  v_mfma_f32_16x16x32_bf16 v[40:43], a[16:19], a[12:15], v[40:43]
  s_add_u32 s46, s46, 16384
  s_add_u32 s47, s47, 36864
  v_mfma_f32_16x16x32_bf16 v[44:47], a[20:23], a[12:15], v[44:47]
  s_waitcnt vmcnt(24) lgkmcnt(0)
  s_barrier
  v_mfma_f32_16x16x32_bf16 v[16:19], a[40:43], a[24:27], v[16:19]
  ds_read_b128 a[0:3], v13 offset:16384
  ds_read_b128 a[4:7], v13 offset:18432
  s_add_u32 m0, s59, 49152
  v_mfma_f32_16x16x32_bf16 v[20:23], a[44:47], a[24:27], v[20:23]
  ds_read_b128 a[8:11], v13 offset:20480
  ds_read_b128 a[12:15], v13 offset:22528
  buffer_load_dwordx4 v4, s[12:15], s46 offen offset:0 lds
  v_mfma_f32_16x16x32_bf16 v[24:27], a[40:43], a[28:31], v[24:27]
  ds_read_b64_tr_b16 a[16:17], v11 offset:32768
  ds_read_b64_tr_b16 a[18:19], v11 offset:33280
  buffer_load_dwordx4 v4, s[12:15], s46 offen offset:1024 lds
  v_mfma_f32_16x16x32_bf16 v[28:31], a[44:47], a[28:31], v[28:31]
  ds_read_b64_tr_b16 a[20:21], v12 offset:32768
  ds_read_b64_tr_b16 a[22:23], v12 offset:33280
  v_mfma_f32_16x16x32_bf16 v[32:35], a[40:43], a[32:35], v[32:35]
  s_add_u32 m0, s44, 24576
  v_mfma_f32_16x16x32_bf16 v[36:39], a[44:47], a[32:35], v[36:39]
  buffer_load_dwordx4 v8, s[16:19], s47 offen lds
  v_mfma_f32_16x16x32_bf16 v[40:43], a[40:43], a[36:39], v[40:43]
  s_add_u32 s47, s47, 36864
  v_mfma_f32_16x16x32_bf16 v[44:47], a[44:47], a[36:39], v[44:47]
  s_waitcnt lgkmcnt(0)
  v_mfma_f32_16x16x32_bf16 v[16:19], a[16:19], a[0:3], v[16:19]
  ds_read_b128 a[24:27], v14 offset:16384
  ds_read_b128 a[28:31], v14 offset:18432
  s_add_u32 m0, s59, 49152
  v_mfma_f32_16x16x32_bf16 v[20:23], a[20:23], a[0:3], v[20:23]
  ds_read_b128 a[32:35], v14 offset:20480
  ds_read_b128 a[36:39], v14 offset:22528
  buffer_load_dwordx4 v4, s[12:15], s46 offen offset:2048 lds
  v_mfma_f32_16x16x32_bf16 v[24:27], a[16:19], a[4:7], v[24:27]
  ds_read_b64_tr_b16 a[40:41], v11 offset:36864
  ds_read_b64_tr_b16 a[42:43], v11 offset:37376
  buffer_load_dwordx4 v4, s[12:15], s46 offen offset:3072 lds
  v_mfma_f32_16x16x32_bf16 v[28:31], a[20:23], a[4:7], v[28:31]
  ds_read_b64_tr_b16 a[44:45], v12 offset:36864
  ds_read_b64_tr_b16 a[46:47], v12 offset:37376
  v_mfma_f32_16x16x32_bf16 v[32:35], a[16:19], a[8:11], v[32:35]
  s_add_u32 m0, s44, 28672
  v_mfma_f32_16x16x32_bf16 v[36:39], a[20:23], a[8:11], v[36:39]
  buffer_load_dwordx4 v8, s[16:19], s47 offen lds
  v_mfma_f32_16x16x32_bf16 v[40:43], a[16:19], a[12:15], v[40:43]
  s_add_u32 s46, s46, 16384
  s_add_u32 s47, s47, 36864
  v_mfma_f32_16x16x32_bf16 v[44:47], a[20:23], a[12:15], v[44:47]
  s_waitcnt vmcnt(24) lgkmcnt(0)
  s_barrier
  v_mfma_f32_16x16x32_bf16 v[16:19], a[40:43], a[24:27], v[16:19]
  ds_read_b128 a[0:3], v13 offset:32768
  ds_read_b128 a[4:7], v13 offset:34816
  s_add_u32 m0, s59, 65536
  v_mfma_f32_16x16x32_bf16 v[20:23], a[44:47], a[24:27], v[20:23]
  ds_read_b128 a[8:11], v13 offset:36864
  ds_read_b128 a[12:15], v13 offset:38912
  buffer_load_dwordx4 v4, s[12:15], s46 offen offset:0 lds
  v_mfma_f32_16x16x32_bf16 v[24:27], a[40:43], a[28:31], v[24:27]
  ds_read_b64_tr_b16 a[16:17], v11 offset:40960
  ds_read_b64_tr_b16 a[18:19], v11 offset:41472
  buffer_load_dwordx4 v4, s[12:15], s46 offen offset:1024 lds
  v_mfma_f32_16x16x32_bf16 v[28:31], a[44:47], a[28:31], v[28:31]
  ds_read_b64_tr_b16 a[20:21], v12 offset:40960
  ds_read_b64_tr_b16 a[22:23], v12 offset:41472
  v_mfma_f32_16x16x32_bf16 v[32:35], a[40:43], a[32:35], v[32:35]
  s_add_u32 m0, s44, 32768
  v_mfma_f32_16x16x32_bf16 v[36:39], a[44:47], a[32:35], v[36:39]
  buffer_load_dwordx4 v8, s[16:19], s47 offen lds
  v_mfma_f32_16x16x32_bf16 v[40:43], a[40:43], a[36:39], v[40:43]
  s_add_u32 s47, s47, 36864
  v_mfma_f32_16x16x32_bf16 v[44:47], a[44:47], a[36:39], v[44:47]
  s_waitcnt lgkmcnt(0)
  v_mfma_f32_16x16x32_bf16 v[16:19], a[16:19], a[0:3], v[16:19]
  ds_read_b128 a[24:27], v14 offset:32768
  ds_read_b128 a[28:31], v14 offset:34816
  s_add_u32 m0, s59, 65536
  v_mfma_f32_16x16x32_bf16 v[20:23], a[20:23], a[0:3], v[20:23]
  ds_read_b128 a[32:35], v14 offset:36864
  ds_read_b128 a[36:39], v14 offset:38912
  buffer_load_dwordx4 v4, s[12:15], s46 offen offset:2048 lds
  v_mfma_f32_16x16x32_bf16 v[24:27], a[16:19], a[4:7], v[24:27]
  ds_read_b64_tr_b16 a[40:41], v11 offset:45056
  ds_read_b64_tr_b16 a[42:43], v11 offset:45568
  buffer_load_dwordx4 v4, s[12:15], s46 offen offset:3072 lds
  v_mfma_f32_16x16x32_bf16 v[28:31], a[20:23], a[4:7], v[28:31]
  ds_read_b64_tr_b16 a[44:45], v12 offset:45056
  ds_read_b64_tr_b16 a[46:47], v12 offset:45568
  v_mfma_f32_16x16x32_bf16 v[32:35], a[16:19], a[8:11], v[32:35]
  s_add_u32 m0, s44, 36864
  v_mfma_f32_16x16x32_bf16 v[36:39], a[20:23], a[8:11], v[36:39]
  buffer_load_dwordx4 v8, s[16:19], s47 offen lds
  v_mfma_f32_16x16x32_bf16 v[40:43], a[16:19], a[12:15], v[40:43]
  s_add_u32 s46, s46, 16384
  s_add_u32 s47, s47, 36864
  v_mfma_f32_16x16x32_bf16 v[44:47], a[20:23], a[12:15], v[44:47]
  s_waitcnt vmcnt(24) lgkmcnt(0)
  s_barrier
  v_mfma_f32_16x16x32_bf16 v[16:19], a[40:43], a[24:27], v[16:19]
  ds_read_b128 a[0:3], v9 offset:0
  ds_read_b128 a[4:7], v9 offset:2048
  s_add_u32 m0, s59, 81920
  v_mfma_f32_16x16x32_bf16 v[20:23], a[44:47], a[24:27], v[20:23]
  ds_read_b128 a[8:11], v9 offset:4096
  ds_read_b128 a[12:15], v9 offset:6144
  buffer_load_dwordx4 v4, s[12:15], s46 offen offset:0 lds
  v_mfma_f32_16x16x32_bf16 v[24:27], a[40:43], a[28:31], v[24:27]
  ds_read_b64_tr_b16 a[16:17], v11 offset:0
  ds_read_b64_tr_b16 a[18:19], v11 offset:512
  buffer_load_dwordx4 v4, s[12:15], s46 offen offset:1024 lds
  v_mfma_f32_16x16x32_bf16 v[28:31], a[44:47], a[28:31], v[28:31]
  ds_read_b64_tr_b16 a[20:21], v12 offset:0
  ds_read_b64_tr_b16 a[22:23], v12 offset:512
  v_mfma_f32_16x16x32_bf16 v[32:35], a[40:43], a[32:35], v[32:35]
  s_add_u32 m0, s44, 40960
  v_mfma_f32_16x16x32_bf16 v[36:39], a[44:47], a[32:35], v[36:39]
  buffer_load_dwordx4 v8, s[16:19], s47 offen lds
  v_mfma_f32_16x16x32_bf16 v[40:43], a[40:43], a[36:39], v[40:43]
  s_add_u32 s47, s47, 36864
  v_mfma_f32_16x16x32_bf16 v[44:47], a[44:47], a[36:39], v[44:47]
  s_waitcnt lgkmcnt(0)
  v_mfma_f32_16x16x32_bf16 v[16:19], a[16:19], a[0:3], v[16:19]
  ds_read_b128 a[24:27], v10 offset:0
  ds_read_b128 a[28:31], v10 offset:2048
  s_add_u32 m0, s59, 81920
  v_mfma_f32_16x16x32_bf16 v[20:23], a[20:23], a[0:3], v[20:23]
  ds_read_b128 a[32:35], v10 offset:4096
  ds_read_b128 a[36:39], v10 offset:6144
  buffer_load_dwordx4 v4, s[12:15], s46 offen offset:2048 lds
  v_mfma_f32_16x16x32_bf16 v[24:27], a[16:19], a[4:7], v[24:27]
  ds_read_b64_tr_b16 a[40:41], v11 offset:4096
  ds_read_b64_tr_b16 a[42:43], v11 offset:4608
  buffer_load_dwordx4 v4, s[12:15], s46 offen offset:3072 lds
  v_mfma_f32_16x16x32_bf16 v[28:31], a[20:23], a[4:7], v[28:31]
  ds_read_b64_tr_b16 a[44:45], v12 offset:4096
  ds_read_b64_tr_b16 a[46:47], v12 offset:4608
  v_mfma_f32_16x16x32_bf16 v[32:35], a[16:19], a[8:11], v[32:35]
  s_add_u32 m0, s44, 45056
  v_mfma_f32_16x16x32_bf16 v[36:39], a[20:23], a[8:11], v[36:39]
  buffer_load_dwordx4 v8, s[16:19], s47 offen lds
  v_mfma_f32_16x16x32_bf16 v[40:43], a[16:19], a[12:15], v[40:43]
  s_add_u32 s46, s46, 16384
  s_add_u32 s47, s47, 36864
  v_mfma_f32_16x16x32_bf16 v[44:47], a[20:23], a[12:15], v[44:47]
  s_waitcnt vmcnt(24) lgkmcnt(0)
  s_barrier
  v_mfma_f32_16x16x32_bf16 v[16:19], a[40:43], a[24:27], v[16:19]
  ds_read_b128 a[0:3], v9 offset:16384
  ds_read_b128 a[4:7], v9 offset:18432
  v_mfma_f32_16x16x32_bf16 v[20:23], a[44:47], a[24:27], v[20:23]
  ds_read_b128 a[8:11], v9 offset:20480
  ds_read_b128 a[12:15], v9 offset:22528
  v_mfma_f32_16x16x32_bf16 v[24:27], a[40:43], a[28:31], v[24:27]
  ds_read_b64_tr_b16 a[16:17], v11 offset:8192
  ds_read_b64_tr_b16 a[18:19], v11 offset:8704
  v_mfma_f32_16x16x32_bf16 v[28:31], a[44:47], a[28:31], v[28:31]
  ds_read_b64_tr_b16 a[20:21], v12 offset:8192
  ds_read_b64_tr_b16 a[22:23], v12 offset:8704
  v_mfma_f32_16x16x32_bf16 v[32:35], a[40:43], a[32:35], v[32:35]
  v_mfma_f32_16x16x32_bf16 v[36:39], a[44:47], a[32:35], v[36:39]
  v_mfma_f32_16x16x32_bf16 v[40:43], a[40:43], a[36:39], v[40:43]
  v_mfma_f32_16x16x32_bf16 v[44:47], a[44:47], a[36:39], v[44:47]
  s_waitcnt lgkmcnt(0)
  v_mfma_f32_16x16x32_bf16 v[16:19], a[16:19], a[0:3], v[16:19]
  ds_read_b128 a[24:27], v10 offset:16384
  ds_read_b128 a[28:31], v10 offset:18432
  v_mfma_f32_16x16x32_bf16 v[20:23], a[20:23], a[0:3], v[20:23]
  ds_read_b128 a[32:35], v10 offset:20480
  ds_read_b128 a[36:39], v10 offset:22528
  v_mfma_f32_16x16x32_bf16 v[24:27], a[16:19], a[4:7], v[24:27]
  ds_read_b64_tr_b16 a[40:41], v11 offset:12288
  ds_read_b64_tr_b16 a[42:43], v11 offset:12800
  v_mfma_f32_16x16x32_bf16 v[28:31], a[20:23], a[4:7], v[28:31]
  ds_read_b64_tr_b16 a[44:45], v12 offset:12288
  ds_read_b64_tr_b16 a[46:47], v12 offset:12800
  v_mfma_f32_16x16x32_bf16 v[32:35], a[16:19], a[8:11], v[32:35]
  v_mfma_f32_16x16x32_bf16 v[36:39], a[20:23], a[8:11], v[36:39]
  v_mfma_f32_16x16x32_bf16 v[40:43], a[16:19], a[12:15], v[40:43]
  v_mfma_f32_16x16x32_bf16 v[44:47], a[20:23], a[12:15], v[44:47]
  s_waitcnt vmcnt(18) lgkmcnt(0)
  s_barrier
  v_mfma_f32_16x16x32_bf16 v[16:19], a[40:43], a[24:27], v[16:19]
  ds_read_b128 a[0:3], v9 offset:32768
  ds_read_b128 a[4:7], v9 offset:34816
  v_mfma_f32_16x16x32_bf16 v[20:23], a[44:47], a[24:27], v[20:23]
  ds_read_b128 a[8:11], v9 offset:36864
  ds_read_b128 a[12:15], v9 offset:38912
  v_mfma_f32_16x16x32_bf16 v[24:27], a[40:43], a[28:31], v[24:27]
  ds_read_b64_tr_b16 a[16:17], v11 offset:16384
  ds_read_b64_tr_b16 a[18:19], v11 offset:16896
  v_mfma_f32_16x16x32_bf16 v[28:31], a[44:47], a[28:31], v[28:31]
  ds_read_b64_tr_b16 a[20:21], v12 offset:16384
  ds_read_b64_tr_b16 a[22:23], v12 offset:16896
  v_mfma_f32_16x16x32_bf16 v[32:35], a[40:43], a[32:35], v[32:35]
  v_mfma_f32_16x16x32_bf16 v[36:39], a[44:47], a[32:35], v[36:39]
  v_mfma_f32_16x16x32_bf16 v[40:43], a[40:43], a[36:39], v[40:43]
  v_mfma_f32_16x16x32_bf16 v[44:47], a[44:47], a[36:39], v[44:47]
  s_waitcnt lgkmcnt(0)
  v_mfma_f32_16x16x32_bf16 v[16:19], a[16:19], a[0:3], v[16:19]
  ds_read_b128 a[24:27], v10 offset:32768
  ds_read_b128 a[28:31], v10 offset:34816
  v_mfma_f32_16x16x32_bf16 v[20:23], a[20:23], a[0:3], v[20:23]
  ds_read_b128 a[32:35], v10 offset:36864
  ds_read_b128 a[36:39], v10 offset:38912
  v_mfma_f32_16x16x32_bf16 v[24:27], a[16:19], a[4:7], v[24:27]
  ds_read_b64_tr_b16 a[40:41], v11 offset:20480
  ds_read_b64_tr_b16 a[42:43], v11 offset:20992
  v_mfma_f32_16x16x32_bf16 v[28:31], a[20:23], a[4:7], v[28:31]
  ds_read_b64_tr_b16 a[44:45], v12 offset:20480
  ds_read_b64_tr_b16 a[46:47], v12 offset:20992
  v_mfma_f32_16x16x32_bf16 v[32:35], a[16:19], a[8:11], v[32:35]
  v_mfma_f32_16x16x32_bf16 v[36:39], a[20:23], a[8:11], v[36:39]
  v_mfma_f32_16x16x32_bf16 v[40:43], a[16:19], a[12:15], v[40:43]
  v_mfma_f32_16x16x32_bf16 v[44:47], a[20:23], a[12:15], v[44:47]
  s_waitcnt vmcnt(12) lgkmcnt(0)
  s_barrier
  v_mfma_f32_16x16x32_bf16 v[16:19], a[40:43], a[24:27], v[16:19]
  ds_read_b128 a[0:3], v13 offset:0
  ds_read_b128 a[4:7], v13 offset:2048
  v_mfma_f32_16x16x32_bf16 v[20:23], a[44:47], a[24:27], v[20:23]
  ds_read_b128 a[8:11], v13 offset:4096
  ds_read_b128 a[12:15], v13 offset:6144
  v_mfma_f32_16x16x32_bf16 v[24:27], a[40:43], a[28:31], v[24:27]
  ds_read_b64_tr_b16 a[16:17], v11 offset:24576
  ds_read_b64_tr_b16 a[18:19], v11 offset:25088
  v_mfma_f32_16x16x32_bf16 v[28:31], a[44:47], a[28:31], v[28:31]
  ds_read_b64_tr_b16 a[20:21], v12 offset:24576
  ds_read_b64_tr_b16 a[22:23], v12 offset:25088
  v_mfma_f32_16x16x32_bf16 v[32:35], a[40:43], a[32:35], v[32:35]
  v_mfma_f32_16x16x32_bf16 v[36:39], a[44:47], a[32:35], v[36:39]
  v_mfma_f32_16x16x32_bf16 v[40:43], a[40:43], a[36:39], v[40:43]
  v_mfma_f32_16x16x32_bf16 v[44:47], a[44:47], a[36:39], v[44:47]
  s_waitcnt lgkmcnt(0)
  v_mfma_f32_16x16x32_bf16 v[16:19], a[16:19], a[0:3], v[16:19]
  ds_read_b128 a[24:27], v14 offset:0
  ds_read_b128 a[28:31], v14 offset:2048
  v_mfma_f32_16x16x32_bf16 v[20:23], a[20:23], a[0:3], v[20:23]
  ds_read_b128 a[32:35], v14 offset:4096
  ds_read_b128 a[36:39], v14 offset:6144
  v_mfma_f32_16x16x32_bf16 v[24:27], a[16:19], a[4:7], v[24:27]
  ds_read_b64_tr_b16 a[40:41], v11 offset:28672
  ds_read_b64_tr_b16 a[42:43], v11 offset:29184
  v_mfma_f32_16x16x32_bf16 v[28:31], a[20:23], a[4:7], v[28:31]
  ds_read_b64_tr_b16 a[44:45], v12 offset:28672
  ds_read_b64_tr_b16 a[46:47], v12 offset:29184
  v_mfma_f32_16x16x32_bf16 v[32:35], a[16:19], a[8:11], v[32:35]
  v_mfma_f32_16x16x32_bf16 v[36:39], a[20:23], a[8:11], v[36:39]
  v_mfma_f32_16x16x32_bf16 v[40:43], a[16:19], a[12:15], v[40:43]
  v_mfma_f32_16x16x32_bf16 v[44:47], a[20:23], a[12:15], v[44:47]
  s_waitcnt vmcnt(6) lgkmcnt(0)
  s_barrier
  v_mfma_f32_16x16x32_bf16 v[16:19], a[40:43], a[24:27], v[16:19]
  ds_read_b128 a[0:3], v13 offset:16384
  ds_read_b128 a[4:7], v13 offset:18432
  v_mfma_f32_16x16x32_bf16 v[20:23], a[44:47], a[24:27], v[20:23]
  ds_read_b128 a[8:11], v13 offset:20480
  ds_read_b128 a[12:15], v13 offset:22528
  v_mfma_f32_16x16x32_bf16 v[24:27], a[40:43], a[28:31], v[24:27]
  ds_read_b64_tr_b16 a[16:17], v11 offset:32768
  ds_read_b64_tr_b16 a[18:19], v11 offset:33280
  v_mfma_f32_16x16x32_bf16 v[28:31], a[44:47], a[28:31], v[28:31]
  ds_read_b64_tr_b16 a[20:21], v12 offset:32768
  ds_read_b64_tr_b16 a[22:23], v12 offset:33280
  v_mfma_f32_16x16x32_bf16 v[32:35], a[40:43], a[32:35], v[32:35]
  v_mfma_f32_16x16x32_bf16 v[36:39], a[44:47], a[32:35], v[36:39]
  v_mfma_f32_16x16x32_bf16 v[40:43], a[40:43], a[36:39], v[40:43]
  v_mfma_f32_16x16x32_bf16 v[44:47], a[44:47], a[36:39], v[44:47]
  s_waitcnt lgkmcnt(0)
  v_mfma_f32_16x16x32_bf16 v[16:19], a[16:19], a[0:3], v[16:19]
  ds_read_b128 a[24:27], v14 offset:16384
  ds_read_b128 a[28:31], v14 offset:18432
  v_mfma_f32_16x16x32_bf16 v[20:23], a[20:23], a[0:3], v[20:23]
  ds_read_b128 a[32:35], v14 offset:20480
  ds_read_b128 a[36:39], v14 offset:22528
  v_mfma_f32_16x16x32_bf16 v[24:27], a[16:19], a[4:7], v[24:27]
  ds_read_b64_tr_b16 a[40:41], v11 offset:36864
  ds_read_b64_tr_b16 a[42:43], v11 offset:37376
  v_mfma_f32_16x16x32_bf16 v[28:31], a[20:23], a[4:7], v[28:31]
  ds_read_b64_tr_b16 a[44:45], v12 offset:36864
  ds_read_b64_tr_b16 a[46:47], v12 offset:37376
  v_mfma_f32_16x16x32_bf16 v[32:35], a[16:19], a[8:11], v[32:35]
  v_mfma_f32_16x16x32_bf16 v[36:39], a[20:23], a[8:11], v[36:39]
  v_mfma_f32_16x16x32_bf16 v[40:43], a[16:19], a[12:15], v[40:43]
  v_mfma_f32_16x16x32_bf16 v[44:47], a[20:23], a[12:15], v[44:47]
  s_waitcnt vmcnt(0) lgkmcnt(0)
  s_barrier
  v_mfma_f32_16x16x32_bf16 v[16:19], a[40:43], a[24:27], v[16:19]
  ds_read_b128 a[0:3], v13 offset:32768
  ds_read_b128 a[4:7], v13 offset:34816
  v_mfma_f32_16x16x32_bf16 v[20:23], a[44:47], a[24:27], v[20:23]
  ds_read_b128 a[8:11], v13 offset:36864
  ds_read_b128 a[12:15], v13 offset:38912
  v_mfma_f32_16x16x32_bf16 v[24:27], a[40:43], a[28:31], v[24:27]
  ds_read_b64_tr_b16 a[16:17], v11 offset:40960
  ds_read_b64_tr_b16 a[18:19], v11 offset:41472
  v_mfma_f32_16x16x32_bf16 v[28:31], a[44:47], a[28:31], v[28:31]
  ds_read_b64_tr_b16 a[20:21], v12 offset:40960
  ds_read_b64_tr_b16 a[22:23], v12 offset:41472
  v_mfma_f32_16x16x32_bf16 v[32:35], a[40:43], a[32:35], v[32:35]
  v_mfma_f32_16x16x32_bf16 v[36:39], a[44:47], a[32:35], v[36:39]
  v_mfma_f32_16x16x32_bf16 v[40:43], a[40:43], a[36:39], v[40:43]
  v_mfma_f32_16x16x32_bf16 v[44:47], a[44:47], a[36:39], v[44:47]
  s_waitcnt lgkmcnt(0)
  v_mfma_f32_16x16x32_bf16 v[16:19], a[16:19], a[0:3], v[16:19]
  ds_read_b128 a[24:27], v14 offset:32768
  ds_read_b128 a[28:31], v14 offset:34816
  v_mfma_f32_16x16x32_bf16 v[20:23], a[20:23], a[0:3], v[20:23]
  ds_read_b128 a[32:35], v14 offset:36864
  ds_read_b128 a[36:39], v14 offset:38912
  v_mfma_f32_16x16x32_bf16 v[24:27], a[16:19], a[4:7], v[24:27]
  ds_read_b64_tr_b16 a[40:41], v11 offset:45056
  ds_read_b64_tr_b16 a[42:43], v11 offset:45568
  v_mfma_f32_16x16x32_bf16 v[28:31], a[20:23], a[4:7], v[28:31]
  ds_read_b64_tr_b16 a[44:45], v12 offset:45056
  ds_read_b64_tr_b16 a[46:47], v12 offset:45568
  v_mfma_f32_16x16x32_bf16 v[32:35], a[16:19], a[8:11], v[32:35]
  v_mfma_f32_16x16x32_bf16 v[36:39], a[20:23], a[8:11], v[36:39]
  v_mfma_f32_16x16x32_bf16 v[40:43], a[16:19], a[12:15], v[40:43]
  v_mfma_f32_16x16x32_bf16 v[44:47], a[20:23], a[12:15], v[44:47]
  s_waitcnt lgkmcnt(0)
  v_mfma_f32_16x16x32_bf16 v[16:19], a[40:43], a[24:27], v[16:19]
  v_mfma_f32_16x16x32_bf16 v[20:23], a[44:47], a[24:27], v[20:23]
  v_mfma_f32_16x16x32_bf16 v[24:27], a[40:43], a[28:31], v[24:27]
  v_mfma_f32_16x16x32_bf16 v[28:31], a[44:47], a[28:31], v[28:31]
  v_mfma_f32_16x16x32_bf16 v[32:35], a[40:43], a[32:35], v[32:35]
  v_mfma_f32_16x16x32_bf16 v[36:39], a[44:47], a[32:35], v[36:39]
  v_mfma_f32_16x16x32_bf16 v[40:43], a[40:43], a[36:39], v[40:43]
  v_mfma_f32_16x16x32_bf16 v[44:47], a[44:47], a[36:39], v[44:47]
  s_nop 7
  s_nop 7
  v_and_b32 v50, 15, v1
  s_mov_b32 s40, 1152
  v_mul_lo_u32 v48, v50, s40
  v_bfe_u32 v50, v1, 4, 1
  v_lshl_add_u32 v48, v50, 5, v48
  v_bfe_u32 v50, v1, 5, 1
  v_lshl_add_u32 v48, v50, 4, v48
  v_bfe_u32 v50, v1, 4, 1
  v_lshlrev_b32 v49, 5, v50
  v_bfe_u32 v50, v1, 5, 1
  v_lshl_add_u32 v49, v50, 4, v49
  s_lshr_b32 s40, s3, 1
  s_mul_i32 s40, s40, 64
  s_mul_i32 s41, s32, 128
  s_add_u32 s40, s40, s41
  s_mul_i32 s40, s40, 1152
  s_and_b32 s41, s3, 1
  s_mul_i32 s41, s41, 32
  s_mul_i32 s42, s36, 64
  s_add_u32 s41, s41, s42
  s_mov_b32 s39, s41
  s_lshl_b32 s41, s41, 1
  s_add_u32 s38, s40, s41
  s_lshl_b32 s39, s39, 1
  buffer_load_dwordx4 v[60:63], v49, s[52:55], s39 offen offset:0
  s_mov_b32 s37, s38
  buffer_load_dwordx4 v[64:67], v48, s[24:27], s37 offen offset:0
  s_add_u32 s37, s37, 18432
  buffer_load_dwordx4 v[68:71], v48, s[24:27], s37 offen offset:0
  s_add_u32 s37, s37, 18432
  buffer_load_dwordx4 v[72:75], v48, s[24:27], s37 offen offset:0
  s_add_u32 s37, s37, 18432
  buffer_load_dwordx4 v[76:79], v48, s[24:27], s37 offen offset:0
  s_add_u32 s37, s37, 18432
  s_waitcnt vmcnt(4)
  v_lshlrev_b32 v52, 16, v60
  v_and_b32 v53, 0xffff0000, v60
  v_lshlrev_b32 v54, 16, v61
  v_and_b32 v55, 0xffff0000, v61
  v_lshlrev_b32 v56, 16, v62
  v_and_b32 v57, 0xffff0000, v62
  v_lshlrev_b32 v58, 16, v63
  v_and_b32 v59, 0xffff0000, v63
  s_mov_b32 s37, s38
  v_cvt_pk_bf16_f32 v80, v16, v17
  v_cvt_pk_bf16_f32 v81, v18, v19
  v_cvt_pk_bf16_f32 v82, v20, v21
  v_cvt_pk_bf16_f32 v83, v22, v23
  s_nop 1
  v_permlane16_swap_b32 v80, v82
  v_permlane16_swap_b32 v81, v83
  v_lshlrev_b32 v84, 16, v80
  v_and_b32 v85, 0xffff0000, v80
  v_lshlrev_b32 v86, 16, v81
  v_and_b32 v87, 0xffff0000, v81
  v_lshlrev_b32 v88, 16, v82
  v_and_b32 v89, 0xffff0000, v82
  v_lshlrev_b32 v90, 16, v83
  v_and_b32 v91, 0xffff0000, v83
  v_mul_f32 v84, v84, v52
  v_mul_f32 v85, v85, v53
  v_mul_f32 v86, v86, v54
  v_mul_f32 v87, v87, v55
  v_mul_f32 v88, v88, v56
  v_mul_f32 v89, v89, v57
  v_mul_f32 v90, v90, v58
  v_mul_f32 v91, v91, v59
  v_cvt_pk_bf16_f32 v92, v84, v85
  v_lshlrev_b32 v84, 16, v92
  v_and_b32 v85, 0xffff0000, v92
  v_cvt_pk_bf16_f32 v92, v86, v87
  v_lshlrev_b32 v86, 16, v92
  v_and_b32 v87, 0xffff0000, v92
  v_cvt_pk_bf16_f32 v92, v88, v89
  v_lshlrev_b32 v88, 16, v92
  v_and_b32 v89, 0xffff0000, v92
  v_cvt_pk_bf16_f32 v92, v90, v91
  v_lshlrev_b32 v90, 16, v92
  v_and_b32 v91, 0xffff0000, v92
  s_waitcnt vmcnt(3)
  v_lshlrev_b32 v93, 16, v64
  v_and_b32 v94, 0xffff0000, v64
  v_add_f32 v84, v84, v93
  v_add_f32 v85, v85, v94
  v_cvt_pk_bf16_f32 v80, v84, v85
  v_lshlrev_b32 v93, 16, v65
  v_and_b32 v94, 0xffff0000, v65
  v_add_f32 v86, v86, v93
  v_add_f32 v87, v87, v94
  v_cvt_pk_bf16_f32 v81, v86, v87
  v_lshlrev_b32 v93, 16, v66
  v_and_b32 v94, 0xffff0000, v66
  v_add_f32 v88, v88, v93
  v_add_f32 v89, v89, v94
  v_cvt_pk_bf16_f32 v82, v88, v89
  v_lshlrev_b32 v93, 16, v67
  v_and_b32 v94, 0xffff0000, v67
  v_add_f32 v90, v90, v93
  v_add_f32 v91, v91, v94
  v_cvt_pk_bf16_f32 v83, v90, v91
  buffer_store_dwordx4 v[80:83], v48, s[20:23], s37 offen offset:0
  s_add_u32 s37, s37, 18432
  v_cvt_pk_bf16_f32 v104, v24, v25
  v_cvt_pk_bf16_f32 v105, v26, v27
  v_cvt_pk_bf16_f32 v106, v28, v29
  v_cvt_pk_bf16_f32 v107, v30, v31
  s_nop 1
  v_permlane16_swap_b32 v104, v106
  v_permlane16_swap_b32 v105, v107
  v_lshlrev_b32 v108, 16, v104
  v_and_b32 v109, 0xffff0000, v104
  v_lshlrev_b32 v110, 16, v105
  v_and_b32 v111, 0xffff0000, v105
  v_lshlrev_b32 v112, 16, v106
  v_and_b32 v113, 0xffff0000, v106
  v_lshlrev_b32 v114, 16, v107
  v_and_b32 v115, 0xffff0000, v107
  v_mul_f32 v108, v108, v52
  v_mul_f32 v109, v109, v53
  v_mul_f32 v110, v110, v54
  v_mul_f32 v111, v111, v55
  v_mul_f32 v112, v112, v56
  v_mul_f32 v113, v113, v57
  v_mul_f32 v114, v114, v58
  v_mul_f32 v115, v115, v59
  v_cvt_pk_bf16_f32 v116, v108, v109
  v_lshlrev_b32 v108, 16, v116
  v_and_b32 v109, 0xffff0000, v116
  v_cvt_pk_bf16_f32 v116, v110, v111
  v_lshlrev_b32 v110, 16, v116
  v_and_b32 v111, 0xffff0000, v116
  v_cvt_pk_bf16_f32 v116, v112, v113
  v_lshlrev_b32 v112, 16, v116
  v_and_b32 v113, 0xffff0000, v116
  v_cvt_pk_bf16_f32 v116, v114, v115
  v_lshlrev_b32 v114, 16, v116
  v_and_b32 v115, 0xffff0000, v116
  s_waitcnt vmcnt(3)
  v_lshlrev_b32 v117, 16, v68
  v_and_b32 v118, 0xffff0000, v68
  v_add_f32 v108, v108, v117
  v_add_f32 v109, v109, v118
  v_cvt_pk_bf16_f32 v104, v108, v109
  v_lshlrev_b32 v117, 16, v69
  v_and_b32 v118, 0xffff0000, v69
  v_add_f32 v110, v110, v117
  v_add_f32 v111, v111, v118
  v_cvt_pk_bf16_f32 v105, v110, v111
  v_lshlrev_b32 v117, 16, v70
  v_and_b32 v118, 0xffff0000, v70
  v_add_f32 v112, v112, v117
  v_add_f32 v113, v113, v118
  v_cvt_pk_bf16_f32 v106, v112, v113
  v_lshlrev_b32 v117, 16, v71
  v_and_b32 v118, 0xffff0000, v71
  v_add_f32 v114, v114, v117
  v_add_f32 v115, v115, v118
  v_cvt_pk_bf16_f32 v107, v114, v115
  buffer_store_dwordx4 v[104:107], v48, s[20:23], s37 offen offset:0
  s_add_u32 s37, s37, 18432
  v_cvt_pk_bf16_f32 v80, v32, v33
  v_cvt_pk_bf16_f32 v81, v34, v35
  v_cvt_pk_bf16_f32 v82, v36, v37
  v_cvt_pk_bf16_f32 v83, v38, v39
  s_nop 1
  v_permlane16_swap_b32 v80, v82
  v_permlane16_swap_b32 v81, v83
  v_lshlrev_b32 v84, 16, v80
  v_and_b32 v85, 0xffff0000, v80
  v_lshlrev_b32 v86, 16, v81
  v_and_b32 v87, 0xffff0000, v81
  v_lshlrev_b32 v88, 16, v82
  v_and_b32 v89, 0xffff0000, v82
  v_lshlrev_b32 v90, 16, v83
  v_and_b32 v91, 0xffff0000, v83
  v_mul_f32 v84, v84, v52
  v_mul_f32 v85, v85, v53
  v_mul_f32 v86, v86, v54
  v_mul_f32 v87, v87, v55
  v_mul_f32 v88, v88, v56
  v_mul_f32 v89, v89, v57
  v_mul_f32 v90, v90, v58
  v_mul_f32 v91, v91, v59
  v_cvt_pk_bf16_f32 v92, v84, v85
  v_lshlrev_b32 v84, 16, v92
  v_and_b32 v85, 0xffff0000, v92
  v_cvt_pk_bf16_f32 v92, v86, v87
  v_lshlrev_b32 v86, 16, v92
  v_and_b32 v87, 0xffff0000, v92
  v_cvt_pk_bf16_f32 v92, v88, v89
  v_lshlrev_b32 v88, 16, v92
  v_and_b32 v89, 0xffff0000, v92
  v_cvt_pk_bf16_f32 v92, v90, v91
  v_lshlrev_b32 v90, 16, v92
  v_and_b32 v91, 0xffff0000, v92
  s_waitcnt vmcnt(3)
  v_lshlrev_b32 v93, 16, v72
  v_and_b32 v94, 0xffff0000, v72
  v_add_f32 v84, v84, v93
  v_add_f32 v85, v85, v94
  v_cvt_pk_bf16_f32 v80, v84, v85
  v_lshlrev_b32 v93, 16, v73
  v_and_b32 v94, 0xffff0000, v73
  v_add_f32 v86, v86, v93
  v_add_f32 v87, v87, v94
  v_cvt_pk_bf16_f32 v81, v86, v87
  v_lshlrev_b32 v93, 16, v74
  v_and_b32 v94, 0xffff0000, v74
  v_add_f32 v88, v88, v93
  v_add_f32 v89, v89, v94
  v_cvt_pk_bf16_f32 v82, v88, v89
  v_lshlrev_b32 v93, 16, v75
  v_and_b32 v94, 0xffff0000, v75
  v_add_f32 v90, v90, v93
  v_add_f32 v91, v91, v94
  v_cvt_pk_bf16_f32 v83, v90, v91
  buffer_store_dwordx4 v[80:83], v48, s[20:23], s37 offen offset:0
  s_add_u32 s37, s37, 18432
  v_cvt_pk_bf16_f32 v104, v40, v41
  v_cvt_pk_bf16_f32 v105, v42, v43
  v_cvt_pk_bf16_f32 v106, v44, v45
  v_cvt_pk_bf16_f32 v107, v46, v47
  s_nop 1
  v_permlane16_swap_b32 v104, v106
  v_permlane16_swap_b32 v105, v107
  v_lshlrev_b32 v108, 16, v104
  v_and_b32 v109, 0xffff0000, v104
  v_lshlrev_b32 v110, 16, v105
  v_and_b32 v111, 0xffff0000, v105
  v_lshlrev_b32 v112, 16, v106
  v_and_b32 v113, 0xffff0000, v106
  v_lshlrev_b32 v114, 16, v107
  v_and_b32 v115, 0xffff0000, v107
  v_mul_f32 v108, v108, v52
  v_mul_f32 v109, v109, v53
  v_mul_f32 v110, v110, v54
  v_mul_f32 v111, v111, v55
  v_mul_f32 v112, v112, v56
  v_mul_f32 v113, v113, v57
  v_mul_f32 v114, v114, v58
  v_mul_f32 v115, v115, v59
  v_cvt_pk_bf16_f32 v116, v108, v109
  v_lshlrev_b32 v108, 16, v116
  v_and_b32 v109, 0xffff0000, v116
  v_cvt_pk_bf16_f32 v116, v110, v111
  v_lshlrev_b32 v110, 16, v116
  v_and_b32 v111, 0xffff0000, v116
  v_cvt_pk_bf16_f32 v116, v112, v113
  v_lshlrev_b32 v112, 16, v116
  v_and_b32 v113, 0xffff0000, v116
  v_cvt_pk_bf16_f32 v116, v114, v115
  v_lshlrev_b32 v114, 16, v116
  v_and_b32 v115, 0xffff0000, v116
  s_waitcnt vmcnt(3)
  v_lshlrev_b32 v117, 16, v76
  v_and_b32 v118, 0xffff0000, v76
  v_add_f32 v108, v108, v117
  v_add_f32 v109, v109, v118
  v_cvt_pk_bf16_f32 v104, v108, v109
  v_lshlrev_b32 v117, 16, v77
  v_and_b32 v118, 0xffff0000, v77
  v_add_f32 v110, v110, v117
  v_add_f32 v111, v111, v118
  v_cvt_pk_bf16_f32 v105, v110, v111
  v_lshlrev_b32 v117, 16, v78
  v_and_b32 v118, 0xffff0000, v78
  v_add_f32 v112, v112, v117
  v_add_f32 v113, v113, v118
  v_cvt_pk_bf16_f32 v106, v112, v113
  v_lshlrev_b32 v117, 16, v79
  v_and_b32 v118, 0xffff0000, v79
  v_add_f32 v114, v114, v117
  v_add_f32 v115, v115, v118
  v_cvt_pk_bf16_f32 v107, v114, v115
  buffer_store_dwordx4 v[104:107], v48, s[20:23], s37 offen offset:0
  s_add_u32 s37, s37, 18432
  s_nop 1
Lmg_wo1_87:
  s_waitcnt vmcnt(0)
  s_branch Lmg_wl_80
Lmg_done_1:
  s_endpgm
.p2align 2
.type mega_kernel_tab,@object
mega_kernel_tab:
  .long 0,16,32,48,64,80,96,112,128,144,160,176,192,208,224,240
  .long 256,272,288,304,320,336,352,368,384,400,416,432,448,464,480,496
  .long 512,528,544,560,576,592,608,624,640,656,672,688,704,720,736,752
  .long 768,784,800,816,832,848,864,880,896,912,928,944,960,976,992,1008
  .long 1024,1040,1056,1072,1088,1104,1120,1136,1152,1168,1184,1200,1216,1232,1248,1264
  .long 1280,1296,1312,1328,1344,1360,1376,1392,1408,1424,1440,1456,1472,1488,1504,1520
  .long 1536,1552,1568,1584,1600,1616,1632,1648,1664,1680,1696,1712,1728,1744,1760,1776
  .long 1792,1808,1824,1840,1856,1872,1888,1904,1920,1936,1952,1968,1984,2000,2016,2032
  .long 65537,69633,73729,77825,81921,86017,90113,94209,98305,102401,106497,110593,114689,118785,122881,126977
  .long 131073,135169,139265,143361,147457,151553,155649,159745,163841,167937,172033,176129,180225,184321,188417,192513
  .long 65553,69649,73745,77841,81937,86033,90129,94225,98321,102417,106513,110609,114705,118801,122897,126993
  .long 131089,135185,139281,143377,147473,151569,155665,159761,163857,167953,172049,176145,180241,184337,188433,192529
  .long 1,4097,8193,12289,16385,20481,24577,28673,32769,36865,40961,45057,49153,53249,57345,61441
  .long 65569,69665,73761,77857,81953,86049,90145,94241,98337,102433,106529,110625,114721,118817,122913,127009
  .long 131105,135201,139297,143393,147489,151585,155681,159777,163873,167969,172065,176161,180257,184353,188449,192545
  .long 17,4113,8209,12305,16401,20497,24593,28689,32785,36881,40977,45073,49169,53265,57361,61457
  .long 65585,69681,73777,77873,81969,86065,90161,94257,98353,102449,106545,110641,114737,118833,122929,127025
  .long 131121,135217,139313,143409,147505,151601,155697,159793,163889,167985,172081,176177,180273,184369,188465,192561
  .long 33,4129,8225,12321,16417,20513,24609,28705,32801,36897,40993,45089,49185,53281,57377,61473
  .long 65601,69697,73793,77889,81985,86081,90177,94273,98369,102465,106561,110657,114753,118849,122945,127041
  .long 131137,135233,139329,143425,147521,151617,155713,159809,163905,168001,172097,176193,180289,184385,188481,192577
  .long 49,4145,8241,12337,16433,20529,24625,28721,32817,36913,41009,45105,49201,53297,57393,61489
  .long 65617,69713,73809,77905,82001,86097,90193,94289,98385,102481,106577,110673,114769,118865,122961,127057
  .long 131153,135249,139345,143441,147537,151633,155729,159825,163921,168017,172113,176209,180305,184401,188497,192593
  .long 65,4161,8257,12353,16449,20545,24641,28737,32833,36929,41025,45121,49217,53313,57409,61505
  .long 65633,69729,73825,77921,82017,86113,90209,94305,98401,102497,106593,110689,114785,118881,122977,127073
  .long 131169,135265,139361,143457,147553,151649,155745,159841,163937,168033,172129,176225,180321,184417,188513,192609
  .long 81,4177,8273,12369,16465,20561,24657,28753,32849,36945,41041,45137,49233,53329,57425,61521
  .long 65649,69745,73841,77937,82033,86129,90225,94321,98417,102513,106609,110705,114801,118897,122993,127089
  .long 131185,135281,139377,143473,147569,151665,155761,159857,163953,168049,172145,176241,180337,184433,188529,192625
  .long 97,4193,8289,12385,16481,20577,24673,28769,32865,36961,41057,45153,49249,53345,57441,61537
  .long 113,4209,8305,12401,16497,20593,24689,28785,32881,36977,41073,45169,49265,53361,57457,61553
  .long 2,4098,8194,12290,16386,20482,24578,28674,32770,36866,40962,45058,49154,53250,57346,61442
  .long 65538,69634,73730,77826,81922,86018,90114,94210,98306,102402,106498,110594,114690,118786,122882,126978
  .long 3,4099,8195,12291,16387,20483,24579,28675,32771,1048579,1052675,1056771,1060867,1064963,1069059,1073155
  .long 1077251,1081347,2097155,2101251,2105347,2109443,2113539,2117635,2121731,2125827,2129923,3145731,3149827,3153923,3158019,3162115
  .long 3166211,3170307,3174403,3178499,4,4100,8196,12292,16388,20484,24580,28676,5,4101,8197,12293
  .long 16389,20485,24581,28677,32773,36869,40965,45061,49157,53253,57349,61445,65541,69637,73733,77829
  .long 81925,86021,90117,94213,1048581,1052677,1056773,1060869,1064965,1069061,1073157,1077253,1081349,1085445,1089541,1093637
  .long 1097733,1101829,1105925,1110021,1114117,1118213,1122309,1126405,1130501,1134597,1138693,1142789,6,4102,8198,12294
  .long 16390,20486,24582,28678,32774,36870,40966,45062,49158,53254,57350,61446,7,4103,8199,12295
  .long 16391,20487,24583,28679,32775,23,4119,8215,12311,16407,20503,24599,28695,32791,39,4135
  .long 8231,12327,16423,20519,24615,28711,32807,55,4151,8247,12343,16439,20535,24631,28727,32823
  .long 71,4167,8263,12359,16455,20551,24647,28743,32839,87,4183,8279,12375,16471,20567,24663
  .long 28759,32855,103,4199,8295,12391,16487,20583,24679,28775,32871,119,4215,8311,12407,16503
  .long 20599,24695,28791,32887
.section .rodata,"a"
.p2align 6
.amdhsa_kernel mega_kernel
  .amdhsa_next_free_vgpr 512
  .amdhsa_next_free_sgpr 102
  .amdhsa_accum_offset 256
  .amdhsa_group_segment_fixed_size 0
  .amdhsa_kernarg_size 136
  .amdhsa_user_sgpr_count 2
  .amdhsa_user_sgpr_kernarg_segment_ptr 1
  .amdhsa_system_sgpr_workgroup_id_x 1
  .amdhsa_float_denorm_mode_32 3
  .amdhsa_float_denorm_mode_16_64 3
.end_amdhsa_kernel
.text
```
